```python
import torch

def _softmax(x, axis=-1):
    return torch.softmax(x, dim=axis)
def _gelu(x):
    return torch.nn.functional.gelu(x, approximate="tanh")
def _silu(x):
    return torch.nn.functional.silu(x)
def _sigmoid(x):
    return torch.sigmoid(x)
def _layernorm(x, axis=-1, eps=1e-5):
    m = x.mean(dim=axis, keepdim=True)
    v = x.var(dim=axis, keepdim=True, unbiased=False)
    return (x - m) / torch.sqrt(v + eps)
def _scatter_add(tgt, idx, src, axis=0):
    return tgt.clone().index_add_(axis, idx, src)
def _segment_sum(src, seg, n):
    out = torch.zeros((n,) + src.shape[1:], dtype=src.dtype)
    return out.index_add_(0, seg, src)
def _pad(x, pw):
    flat = tuple(v for pair in reversed(pw) for v in pair)
    return torch.nn.functional.pad(x, flat)

kernel_name = 'interleave_layers__mha_block__glu_gated_swiglu__prompt'

def setup_inputs():

    _w = (lambda a: (lambda t: t.to(torch.bfloat16) if t.is_floating_point() else t)(torch.as_tensor(a)))
    def _A_setup():
        B, S, D, H = 1, 2048, 448, 16
        return {
            "x": _w((lambda *s: torch.randn(*s, dtype=torch.bfloat16) * 0.05)(B, S, D)),
            "wqkv": _w((lambda *s: torch.randn(*s, dtype=torch.bfloat16) * 0.05)(D, 3 * D)),
            "wo": _w((lambda *s: torch.randn(*s, dtype=torch.bfloat16) * 0.05)(D, D)),
        }
    _A_in = _A_setup()

    def _B_setup():
        B, S, D, F = 1, 2048, 448, 1792
        return {
            "x": _w((lambda *s: torch.randn(*s, dtype=torch.bfloat16) * 0.05)(B, S, D)),
            "w1": _w((lambda *s: torch.randn(*s, dtype=torch.bfloat16) * 0.4)(D, F) * (2.0 / D) ** 0.5),
            "w3": _w((lambda *s: torch.randn(*s, dtype=torch.bfloat16) * 0.4)(D, F) * (2.0 / D) ** 0.5),
            "w2": _w((lambda *s: torch.randn(*s, dtype=torch.bfloat16) * 0.4)(F, D) * (2.0 / F) ** 0.5),
        }
    _B_in = _B_setup()

    return {
        "A_x": _A_in["x"],
        "A_wqkv": _A_in["wqkv"],
        "A_wo": _A_in["wo"],
        "B_x": _B_in["x"],
        "B_w1": _B_in["w1"],
        "B_w3": _B_in["w3"],
        "B_w2": _B_in["w2"],
    }

def reference(A_x, A_wqkv, A_wo, B_x, B_w1, B_w3, B_w2):
    def _A_ref(x, wqkv, wo):
        B, S, D = x.shape
        H = 16
        Dh = D // H
        qkv = (lambda x, *d: x.permute(*d))((x @ wqkv).reshape(B, S, 3, H, Dh), 2, 0, 3, 1, 4)
        q, k, v = qkv[0], qkv[1], qkv[2]
        scores = torch.einsum("bhqd,bhkd->bhqk", q, k) * (Dh ** -0.5)
        p = _softmax(scores, axis=-1)
        o = torch.einsum("bhqk,bhkd->bhqd", p, v)
        return (lambda x, *d: x.permute(*d))(o, 0, 2, 1, 3).reshape(B, S, D) @ wo

    def _B_ref(x, w1, w3, w2):
        gate = torch.einsum("bsd,df->bsf", x, w1)
        up = torch.einsum("bsd,df->bsf", x, w3)
        h = _silu(gate) * up
        out = torch.einsum("bsf,fd->bsd", h, w2)
        return out

    x = A_x
    x = x + _A_ref(_layernorm(x, axis=-1), A_wqkv, A_wo)
    x = x + _B_ref(_layernorm(x, axis=-1), B_w1, B_w3, B_w2)
    x = x + _A_ref(_layernorm(x, axis=-1), A_wqkv, A_wo)
    x = x + _B_ref(_layernorm(x, axis=-1), B_w1, B_w3, B_w2)
    return x
```

```asm
; @launch kernel=qkv0_kernel grid=(224,1,1) block=(256,1,1) lds=133120
; @launch kernel=attn_kernel grid=(256,1,1) block=(512,1,1) lds=131072
; @launch kernel=wo0_kernel grid=(224,1,1) block=(256,1,1) lds=116736
; @launch kernel=ffn1_kernel grid=(224,1,1) block=(256,1,1) lds=149504
; @launch kernel=ffn2_0_kernel grid=(224,1,1) block=(256,1,1) lds=133120
; @launch kernel=qkv1_kernel grid=(224,1,1) block=(256,1,1) lds=133120
; @launch kernel=attn_kernel grid=(256,1,1) block=(512,1,1) lds=131072
; @launch kernel=wo1_kernel grid=(224,1,1) block=(256,1,1) lds=116736
; @launch kernel=ffn1_kernel grid=(224,1,1) block=(256,1,1) lds=149504
; @launch kernel=ffn2_1_kernel grid=(224,1,1) block=(256,1,1) lds=133120
.amdgcn_target "amdgcn-amd-amdhsa--gfx950"
.text
.globl qkv0_kernel
.p2align 8
.type qkv0_kernel,@function
qkv0_kernel:
    s_cmp_ge_u32 s2, 224
    s_cbranch_scc1 L_qkv0_kernel_end
    s_load_dwordx2 s[4:5], s[0:1], 72
    s_load_dwordx2 s[6:7], s[0:1], 0
    s_load_dwordx2 s[34:35], s[0:1], 8
    s_lshr_b32 s45, s2, 3
    s_mov_b32 s44, 0x12492493
    s_mul_hi_u32 s28, s45, s44
    s_mul_i32 s44, s28, 14
    s_sub_u32 s29, s45, s44
    s_and_b32 s44, s2, 7
    s_mul_i32 s44, s44, 2
    s_add_u32 s28, s28, s44
    s_mov_b32 s50, 0x3f803f80
    v_lshrrev_b32 v2, 6, v0
    s_nop 0
    v_readfirstlane_b32 s51, v2
    v_and_b32 v9, 63, v0
    s_and_b32 s44, s51, 1
    s_lshl_b32 s44, s44, 2
    v_lshrrev_b32 v2, 4, v9
    v_add_u32 v2, s44, v2
    v_and_b32 v2, 7, v2
    v_and_b32 v3, 7, v9
    v_xor_b32 v2, v2, v3
    v_lshrrev_b32 v3, 3, v9
    v_mul_u32_u24 v3, 896, v3
    v_lshl_add_u32 v10, v2, 4, v3
    s_lshr_b32 s44, s51, 1
    s_lshl_b32 s44, s44, 2
    v_lshrrev_b32 v2, 4, v9
    v_or_b32 v3, s44, v2
    v_bfe_u32 v4, v9, 1, 3
    v_xor_b32 v3, v3, v4
    v_cmp_gt_u32 vcc, 6, v3
    s_nop 1
    v_cndmask_b32 v3, 0, v3, vcc
    v_and_b32 v4, 1, v9
    v_lshl_add_u32 v3, v3, 1, v4
    v_mul_u32_u24 v2, 2688, v2
    v_lshl_add_u32 v2, v3, 4, v2
    v_mov_b32 v11, v2
    s_waitcnt lgkmcnt(0)
    s_mov_b32 s8, s6
    s_mov_b32 s9, s7
    s_mov_b32 s10, 0x1c0000
    s_mov_b32 s11, 0x00020000
    s_mov_b32 s12, s34
    s_mov_b32 s13, s35
    s_mov_b32 s14, 0x126000
    s_mov_b32 s15, 0x00020000
    s_mul_i32 s52, s28, 114688
    s_mul_i32 s44, s51, 7168
    s_add_u32 s52, s52, s44
    s_mul_i32 s53, s29, 192
    s_mul_i32 s44, s51, 10752
    s_add_u32 s53, s53, s44
    s_lshl_b32 s54, s51, 10
    s_add_u32 s55, s52, 0
    s_add_u32 m0, s54, 0
    s_nop 0
    buffer_load_dwordx4 v10, s[8:11], s55 offen lds
    s_add_u32 s55, s52, 28672
    s_add_u32 m0, s54, 4096
    s_nop 0
    buffer_load_dwordx4 v10, s[8:11], s55 offen lds
    s_add_u32 s55, s52, 57344
    s_add_u32 m0, s54, 8192
    s_nop 0
    buffer_load_dwordx4 v10, s[8:11], s55 offen lds
    s_add_u32 s55, s52, 86016
    s_add_u32 m0, s54, 12288
    s_nop 0
    buffer_load_dwordx4 v10, s[8:11], s55 offen lds
    s_add_u32 s55, s53, 0
    s_add_u32 m0, s54, 16384
    s_nop 0
    buffer_load_dwordx4 v11, s[12:15], s55 offen lds
    s_add_u32 s55, s53, 43008
    s_add_u32 m0, s54, 20480
    s_nop 0
    buffer_load_dwordx4 v11, s[12:15], s55 offen lds
    s_add_u32 s55, s53, 86016
    s_add_u32 m0, s54, 24576
    s_nop 0
    buffer_load_dwordx4 v11, s[12:15], s55 offen lds
    s_add_u32 s55, s53, 129024
    s_add_u32 m0, s54, 28672
    s_nop 0
    buffer_load_dwordx4 v11, s[12:15], s55 offen lds
    s_add_u32 s55, s52, 128
    s_add_u32 m0, s54, 32768
    s_nop 0
    buffer_load_dwordx4 v10, s[8:11], s55 offen lds
    s_add_u32 s55, s52, 28800
    s_add_u32 m0, s54, 36864
    s_nop 0
    buffer_load_dwordx4 v10, s[8:11], s55 offen lds
    s_add_u32 s55, s52, 57472
    s_add_u32 m0, s54, 40960
    s_nop 0
    buffer_load_dwordx4 v10, s[8:11], s55 offen lds
    s_add_u32 s55, s52, 86144
    s_add_u32 m0, s54, 45056
    s_nop 0
    buffer_load_dwordx4 v10, s[8:11], s55 offen lds
    s_add_u32 s55, s53, 172032
    s_add_u32 m0, s54, 49152
    s_nop 0
    buffer_load_dwordx4 v11, s[12:15], s55 offen lds
    s_add_u32 s55, s53, 215040
    s_add_u32 m0, s54, 53248
    s_nop 0
    buffer_load_dwordx4 v11, s[12:15], s55 offen lds
    s_add_u32 s55, s53, 258048
    s_add_u32 m0, s54, 57344
    s_nop 0
    buffer_load_dwordx4 v11, s[12:15], s55 offen lds
    s_add_u32 s55, s53, 301056
    s_add_u32 m0, s54, 61440
    s_nop 0
    buffer_load_dwordx4 v11, s[12:15], s55 offen lds
    s_add_u32 s55, s52, 256
    s_add_u32 m0, s54, 65536
    s_nop 0
    buffer_load_dwordx4 v10, s[8:11], s55 offen lds
    s_add_u32 s55, s52, 28928
    s_add_u32 m0, s54, 69632
    s_nop 0
    buffer_load_dwordx4 v10, s[8:11], s55 offen lds
    s_add_u32 s55, s52, 57600
    s_add_u32 m0, s54, 73728
    s_nop 0
    buffer_load_dwordx4 v10, s[8:11], s55 offen lds
    s_add_u32 s55, s52, 86272
    s_add_u32 m0, s54, 77824
    s_nop 0
    buffer_load_dwordx4 v10, s[8:11], s55 offen lds
    s_add_u32 s55, s53, 344064
    s_add_u32 m0, s54, 81920
    s_nop 0
    buffer_load_dwordx4 v11, s[12:15], s55 offen lds
    s_add_u32 s55, s53, 387072
    s_add_u32 m0, s54, 86016
    s_nop 0
    buffer_load_dwordx4 v11, s[12:15], s55 offen lds
    s_add_u32 s55, s53, 430080
    s_add_u32 m0, s54, 90112
    s_nop 0
    buffer_load_dwordx4 v11, s[12:15], s55 offen lds
    s_add_u32 s55, s53, 473088
    s_add_u32 m0, s54, 94208
    s_nop 0
    buffer_load_dwordx4 v11, s[12:15], s55 offen lds
    s_add_u32 s20, s4, 0x400000
    s_addc_u32 s21, s5, 0
    s_mov_b32 s22, 0x600000
    s_mov_b32 s23, 0x00020000
    v_and_b32 v6, 15, v0
    v_bfe_u32 v7, v0, 4, 2
    s_lshr_b32 s44, s51, 1
    s_mul_i32 s44, s44, 64
    s_mul_i32 s45, s28, 128
    s_add_u32 s44, s44, s45
    v_add_u32 v100, s44, v6
    s_and_b32 s44, s51, 1
    s_mul_i32 s44, s44, 48
    s_mul_i32 s45, s29, 96
    s_add_u32 s44, s44, s45
    v_lshlrev_b32 v101, 2, v7
    v_add_u32 v101, s44, v101
    s_lshr_b32 s44, s51, 1
    s_mul_i32 s44, s44, 8192
    v_bfe_u32 v2, v6, 1, 3
    v_mul_u32_u24 v3, 128, v6
    v_add_u32 v3, s44, v3
    v_add_u32 v4, 0, v7
    v_xor_b32 v4, v4, v2
    v_lshl_add_u32 v4, v4, 4, v3
    v_add_u32 v12, 0, v4
    v_add_u32 v14, 32768, v4
    v_add_u32 v16, 65536, v4
    v_add_u32 v18, 98304, v4
    v_add_u32 v4, 4, v7
    v_xor_b32 v4, v4, v2
    v_lshl_add_u32 v4, v4, 4, v3
    v_add_u32 v13, 0, v4
    v_add_u32 v15, 32768, v4
    v_add_u32 v17, 65536, v4
    v_add_u32 v19, 98304, v4
    v_lshrrev_b32 v2, 2, v6
    v_lshl_add_u32 v3, v7, 3, v2
    v_mul_u32_u24 v3, 256, v3
    v_and_b32 v4, 3, v6
    v_lshl_add_u32 v3, v4, 3, v3
    v_and_b32 v4, 1, v7
    v_lshl_or_b32 v2, v4, 2, v2
    s_and_b32 s44, s51, 1
    s_mul_i32 s45, s44, 3
    s_add_u32 s45, s45, 0
    v_xor_b32 v4, s45, v2
    v_lshl_add_u32 v4, v4, 5, v3
    v_add_u32 v20, 16384, v4
    v_add_u32 v23, 49152, v4
    v_add_u32 v26, 81920, v4
    v_add_u32 v29, 114688, v4
    s_mul_i32 s45, s44, 3
    s_add_u32 s45, s45, 1
    v_xor_b32 v4, s45, v2
    v_lshl_add_u32 v4, v4, 5, v3
    v_add_u32 v21, 16384, v4
    v_add_u32 v24, 49152, v4
    v_add_u32 v27, 81920, v4
    v_add_u32 v30, 114688, v4
    s_mul_i32 s45, s44, 3
    s_add_u32 s45, s45, 2
    v_xor_b32 v4, s45, v2
    v_lshl_add_u32 v4, v4, 5, v3
    v_add_u32 v22, 16384, v4
    v_add_u32 v25, 49152, v4
    v_add_u32 v28, 81920, v4
    v_add_u32 v31, 114688, v4
    v_mov_b32 v99, s50
    v_mov_b32 v88, 0
    v_mov_b32 v92, 0
    v_mov_b32 v89, 0
    v_mov_b32 v93, 0
    v_mov_b32 v90, 0
    v_mov_b32 v94, 0
    v_mov_b32 v91, 0
    v_mov_b32 v95, 0
    v_mov_b32 v96, 0
    v_mov_b32 v97, 0
    v_mov_b32 v98, 0
    s_waitcnt vmcnt(16)
    s_barrier
    s_add_u32 s55, s52, 384
    s_add_u32 m0, s54, 98304
    s_nop 0
    buffer_load_dwordx4 v10, s[8:11], s55 offen lds
    s_add_u32 s55, s52, 29056
    s_add_u32 m0, s54, 102400
    s_nop 0
    buffer_load_dwordx4 v10, s[8:11], s55 offen lds
    s_add_u32 s55, s52, 57728
    s_add_u32 m0, s54, 106496
    s_nop 0
    buffer_load_dwordx4 v10, s[8:11], s55 offen lds
    s_add_u32 s55, s52, 86400
    s_add_u32 m0, s54, 110592
    s_nop 0
    buffer_load_dwordx4 v10, s[8:11], s55 offen lds
    s_add_u32 s55, s53, 516096
    s_add_u32 m0, s54, 114688
    s_nop 0
    buffer_load_dwordx4 v11, s[12:15], s55 offen lds
    s_add_u32 s55, s53, 559104
    s_add_u32 m0, s54, 118784
    s_nop 0
    buffer_load_dwordx4 v11, s[12:15], s55 offen lds
    s_add_u32 s55, s53, 602112
    s_add_u32 m0, s54, 122880
    s_nop 0
    buffer_load_dwordx4 v11, s[12:15], s55 offen lds
    s_add_u32 s55, s53, 645120
    s_add_u32 m0, s54, 126976
    s_nop 0
    buffer_load_dwordx4 v11, s[12:15], s55 offen lds
    ds_read_b128 v[32:35], v12 offset:0
    ds_read_b128 v[36:39], v12 offset:2048
    ds_read_b128 v[40:43], v12 offset:4096
    ds_read_b128 v[44:47], v12 offset:6144
    ds_read_b64_tr_b16 v[64:65], v20 offset:0
    ds_read_b64_tr_b16 v[66:67], v20 offset:1024
    ds_read_b64_tr_b16 v[68:69], v21 offset:0
    ds_read_b64_tr_b16 v[70:71], v21 offset:1024
    ds_read_b64_tr_b16 v[72:73], v22 offset:0
    ds_read_b64_tr_b16 v[74:75], v22 offset:1024
    ds_read_b128 v[48:51], v13 offset:0
    ds_read_b128 v[52:55], v13 offset:2048
    ds_read_b128 v[56:59], v13 offset:4096
    ds_read_b128 v[60:63], v13 offset:6144
    ds_read_b64_tr_b16 v[76:77], v20 offset:8192
    ds_read_b64_tr_b16 v[78:79], v20 offset:9216
    ds_read_b64_tr_b16 v[80:81], v21 offset:8192
    ds_read_b64_tr_b16 v[82:83], v21 offset:9216
    ds_read_b64_tr_b16 v[84:85], v22 offset:8192
    ds_read_b64_tr_b16 v[86:87], v22 offset:9216
    s_waitcnt lgkmcnt(10)
    v_mfma_f32_16x16x32_bf16 a[0:3], v[64:67], v[32:35], 0
    v_mfma_f32_16x16x32_bf16 a[4:7], v[68:71], v[32:35], 0
    v_mfma_f32_16x16x32_bf16 a[8:11], v[72:75], v[32:35], 0
    v_mfma_f32_16x16x32_bf16 a[12:15], v[64:67], v[36:39], 0
    v_mfma_f32_16x16x32_bf16 a[16:19], v[68:71], v[36:39], 0
    v_mfma_f32_16x16x32_bf16 a[20:23], v[72:75], v[36:39], 0
    v_mfma_f32_16x16x32_bf16 a[24:27], v[64:67], v[40:43], 0
    v_mfma_f32_16x16x32_bf16 a[28:31], v[68:71], v[40:43], 0
    v_mfma_f32_16x16x32_bf16 a[32:35], v[72:75], v[40:43], 0
    v_mfma_f32_16x16x32_bf16 a[36:39], v[64:67], v[44:47], 0
    v_mfma_f32_16x16x32_bf16 a[40:43], v[68:71], v[44:47], 0
    v_mfma_f32_16x16x32_bf16 a[44:47], v[72:75], v[44:47], 0
    v_dot2_f32_bf16 v88, v32, v99, v88
    v_dot2_f32_bf16 v92, v32, v32, v92
    v_dot2_f32_bf16 v89, v36, v99, v89
    v_dot2_f32_bf16 v93, v36, v36, v93
    v_dot2_f32_bf16 v90, v40, v99, v90
    v_dot2_f32_bf16 v94, v40, v40, v94
    v_dot2_f32_bf16 v91, v44, v99, v91
    v_dot2_f32_bf16 v95, v44, v44, v95
    v_dot2_f32_bf16 v96, v64, v99, v96
    v_dot2_f32_bf16 v97, v68, v99, v97
    v_dot2_f32_bf16 v98, v72, v99, v98
    v_dot2_f32_bf16 v88, v33, v99, v88
    v_dot2_f32_bf16 v92, v33, v33, v92
    v_dot2_f32_bf16 v89, v37, v99, v89
    v_dot2_f32_bf16 v93, v37, v37, v93
    v_dot2_f32_bf16 v90, v41, v99, v90
    v_dot2_f32_bf16 v94, v41, v41, v94
    v_dot2_f32_bf16 v91, v45, v99, v91
    v_dot2_f32_bf16 v95, v45, v45, v95
    v_dot2_f32_bf16 v96, v65, v99, v96
    v_dot2_f32_bf16 v97, v69, v99, v97
    v_dot2_f32_bf16 v98, v73, v99, v98
    v_dot2_f32_bf16 v88, v34, v99, v88
    v_dot2_f32_bf16 v92, v34, v34, v92
    v_dot2_f32_bf16 v89, v38, v99, v89
    v_dot2_f32_bf16 v93, v38, v38, v93
    v_dot2_f32_bf16 v90, v42, v99, v90
    v_dot2_f32_bf16 v94, v42, v42, v94
    v_dot2_f32_bf16 v91, v46, v99, v91
    v_dot2_f32_bf16 v95, v46, v46, v95
    v_dot2_f32_bf16 v96, v66, v99, v96
    v_dot2_f32_bf16 v97, v70, v99, v97
    v_dot2_f32_bf16 v98, v74, v99, v98
    v_dot2_f32_bf16 v88, v35, v99, v88
    v_dot2_f32_bf16 v92, v35, v35, v92
    v_dot2_f32_bf16 v89, v39, v99, v89
    v_dot2_f32_bf16 v93, v39, v39, v93
    v_dot2_f32_bf16 v90, v43, v99, v90
    v_dot2_f32_bf16 v94, v43, v43, v94
    v_dot2_f32_bf16 v91, v47, v99, v91
    v_dot2_f32_bf16 v95, v47, v47, v95
    v_dot2_f32_bf16 v96, v67, v99, v96
    v_dot2_f32_bf16 v97, v71, v99, v97
    v_dot2_f32_bf16 v98, v75, v99, v98
    s_waitcnt lgkmcnt(0)
    v_mfma_f32_16x16x32_bf16 a[0:3], v[76:79], v[48:51], a[0:3]
    v_mfma_f32_16x16x32_bf16 a[4:7], v[80:83], v[48:51], a[4:7]
    v_mfma_f32_16x16x32_bf16 a[8:11], v[84:87], v[48:51], a[8:11]
    v_mfma_f32_16x16x32_bf16 a[12:15], v[76:79], v[52:55], a[12:15]
    v_mfma_f32_16x16x32_bf16 a[16:19], v[80:83], v[52:55], a[16:19]
    v_mfma_f32_16x16x32_bf16 a[20:23], v[84:87], v[52:55], a[20:23]
    v_mfma_f32_16x16x32_bf16 a[24:27], v[76:79], v[56:59], a[24:27]
    v_mfma_f32_16x16x32_bf16 a[28:31], v[80:83], v[56:59], a[28:31]
    v_mfma_f32_16x16x32_bf16 a[32:35], v[84:87], v[56:59], a[32:35]
    v_mfma_f32_16x16x32_bf16 a[36:39], v[76:79], v[60:63], a[36:39]
    v_mfma_f32_16x16x32_bf16 a[40:43], v[80:83], v[60:63], a[40:43]
    v_mfma_f32_16x16x32_bf16 a[44:47], v[84:87], v[60:63], a[44:47]
    v_dot2_f32_bf16 v88, v48, v99, v88
    v_dot2_f32_bf16 v92, v48, v48, v92
    v_dot2_f32_bf16 v89, v52, v99, v89
    v_dot2_f32_bf16 v93, v52, v52, v93
    v_dot2_f32_bf16 v90, v56, v99, v90
    v_dot2_f32_bf16 v94, v56, v56, v94
    v_dot2_f32_bf16 v91, v60, v99, v91
    v_dot2_f32_bf16 v95, v60, v60, v95
    v_dot2_f32_bf16 v96, v76, v99, v96
    v_dot2_f32_bf16 v97, v80, v99, v97
    v_dot2_f32_bf16 v98, v84, v99, v98
    v_dot2_f32_bf16 v88, v49, v99, v88
    v_dot2_f32_bf16 v92, v49, v49, v92
    v_dot2_f32_bf16 v89, v53, v99, v89
    v_dot2_f32_bf16 v93, v53, v53, v93
    v_dot2_f32_bf16 v90, v57, v99, v90
    v_dot2_f32_bf16 v94, v57, v57, v94
    v_dot2_f32_bf16 v91, v61, v99, v91
    v_dot2_f32_bf16 v95, v61, v61, v95
    v_dot2_f32_bf16 v96, v77, v99, v96
    v_dot2_f32_bf16 v97, v81, v99, v97
    v_dot2_f32_bf16 v98, v85, v99, v98
    v_dot2_f32_bf16 v88, v50, v99, v88
    v_dot2_f32_bf16 v92, v50, v50, v92
    v_dot2_f32_bf16 v89, v54, v99, v89
    v_dot2_f32_bf16 v93, v54, v54, v93
    v_dot2_f32_bf16 v90, v58, v99, v90
    v_dot2_f32_bf16 v94, v58, v58, v94
    v_dot2_f32_bf16 v91, v62, v99, v91
    v_dot2_f32_bf16 v95, v62, v62, v95
    v_dot2_f32_bf16 v96, v78, v99, v96
    v_dot2_f32_bf16 v97, v82, v99, v97
    v_dot2_f32_bf16 v98, v86, v99, v98
    v_dot2_f32_bf16 v88, v51, v99, v88
    v_dot2_f32_bf16 v92, v51, v51, v92
    v_dot2_f32_bf16 v89, v55, v99, v89
    v_dot2_f32_bf16 v93, v55, v55, v93
    v_dot2_f32_bf16 v90, v59, v99, v90
    v_dot2_f32_bf16 v94, v59, v59, v94
    v_dot2_f32_bf16 v91, v63, v99, v91
    v_dot2_f32_bf16 v95, v63, v63, v95
    v_dot2_f32_bf16 v96, v79, v99, v96
    v_dot2_f32_bf16 v97, v83, v99, v97
    v_dot2_f32_bf16 v98, v87, v99, v98
    s_waitcnt vmcnt(16)
    s_barrier
    s_add_u32 s55, s52, 512
    s_add_u32 m0, s54, 0
    s_nop 0
    buffer_load_dwordx4 v10, s[8:11], s55 offen lds
    s_add_u32 s55, s52, 29184
    s_add_u32 m0, s54, 4096
    s_nop 0
    buffer_load_dwordx4 v10, s[8:11], s55 offen lds
    s_add_u32 s55, s52, 57856
    s_add_u32 m0, s54, 8192
    s_nop 0
    buffer_load_dwordx4 v10, s[8:11], s55 offen lds
    s_add_u32 s55, s52, 86528
    s_add_u32 m0, s54, 12288
    s_nop 0
    buffer_load_dwordx4 v10, s[8:11], s55 offen lds
    s_add_u32 s55, s53, 688128
    s_add_u32 m0, s54, 16384
    s_nop 0
    buffer_load_dwordx4 v11, s[12:15], s55 offen lds
    s_add_u32 s55, s53, 731136
    s_add_u32 m0, s54, 20480
    s_nop 0
    buffer_load_dwordx4 v11, s[12:15], s55 offen lds
    s_add_u32 s55, s53, 774144
    s_add_u32 m0, s54, 24576
    s_nop 0
    buffer_load_dwordx4 v11, s[12:15], s55 offen lds
    s_add_u32 s55, s53, 817152
    s_add_u32 m0, s54, 28672
    s_nop 0
    buffer_load_dwordx4 v11, s[12:15], s55 offen lds
    ds_read_b128 v[32:35], v14 offset:0
    ds_read_b128 v[36:39], v14 offset:2048
    ds_read_b128 v[40:43], v14 offset:4096
    ds_read_b128 v[44:47], v14 offset:6144
    ds_read_b64_tr_b16 v[64:65], v23 offset:0
    ds_read_b64_tr_b16 v[66:67], v23 offset:1024
    ds_read_b64_tr_b16 v[68:69], v24 offset:0
    ds_read_b64_tr_b16 v[70:71], v24 offset:1024
    ds_read_b64_tr_b16 v[72:73], v25 offset:0
    ds_read_b64_tr_b16 v[74:75], v25 offset:1024
    ds_read_b128 v[48:51], v15 offset:0
    ds_read_b128 v[52:55], v15 offset:2048
    ds_read_b128 v[56:59], v15 offset:4096
    ds_read_b128 v[60:63], v15 offset:6144
    ds_read_b64_tr_b16 v[76:77], v23 offset:8192
    ds_read_b64_tr_b16 v[78:79], v23 offset:9216
    ds_read_b64_tr_b16 v[80:81], v24 offset:8192
    ds_read_b64_tr_b16 v[82:83], v24 offset:9216
    ds_read_b64_tr_b16 v[84:85], v25 offset:8192
    ds_read_b64_tr_b16 v[86:87], v25 offset:9216
    s_waitcnt lgkmcnt(10)
    v_mfma_f32_16x16x32_bf16 a[0:3], v[64:67], v[32:35], a[0:3]
    v_mfma_f32_16x16x32_bf16 a[4:7], v[68:71], v[32:35], a[4:7]
    v_mfma_f32_16x16x32_bf16 a[8:11], v[72:75], v[32:35], a[8:11]
    v_mfma_f32_16x16x32_bf16 a[12:15], v[64:67], v[36:39], a[12:15]
    v_mfma_f32_16x16x32_bf16 a[16:19], v[68:71], v[36:39], a[16:19]
    v_mfma_f32_16x16x32_bf16 a[20:23], v[72:75], v[36:39], a[20:23]
    v_mfma_f32_16x16x32_bf16 a[24:27], v[64:67], v[40:43], a[24:27]
    v_mfma_f32_16x16x32_bf16 a[28:31], v[68:71], v[40:43], a[28:31]
    v_mfma_f32_16x16x32_bf16 a[32:35], v[72:75], v[40:43], a[32:35]
    v_mfma_f32_16x16x32_bf16 a[36:39], v[64:67], v[44:47], a[36:39]
    v_mfma_f32_16x16x32_bf16 a[40:43], v[68:71], v[44:47], a[40:43]
    v_mfma_f32_16x16x32_bf16 a[44:47], v[72:75], v[44:47], a[44:47]
    v_dot2_f32_bf16 v88, v32, v99, v88
    v_dot2_f32_bf16 v92, v32, v32, v92
    v_dot2_f32_bf16 v89, v36, v99, v89
    v_dot2_f32_bf16 v93, v36, v36, v93
    v_dot2_f32_bf16 v90, v40, v99, v90
    v_dot2_f32_bf16 v94, v40, v40, v94
    v_dot2_f32_bf16 v91, v44, v99, v91
    v_dot2_f32_bf16 v95, v44, v44, v95
    v_dot2_f32_bf16 v96, v64, v99, v96
    v_dot2_f32_bf16 v97, v68, v99, v97
    v_dot2_f32_bf16 v98, v72, v99, v98
    v_dot2_f32_bf16 v88, v33, v99, v88
    v_dot2_f32_bf16 v92, v33, v33, v92
    v_dot2_f32_bf16 v89, v37, v99, v89
    v_dot2_f32_bf16 v93, v37, v37, v93
    v_dot2_f32_bf16 v90, v41, v99, v90
    v_dot2_f32_bf16 v94, v41, v41, v94
    v_dot2_f32_bf16 v91, v45, v99, v91
    v_dot2_f32_bf16 v95, v45, v45, v95
    v_dot2_f32_bf16 v96, v65, v99, v96
    v_dot2_f32_bf16 v97, v69, v99, v97
    v_dot2_f32_bf16 v98, v73, v99, v98
    v_dot2_f32_bf16 v88, v34, v99, v88
    v_dot2_f32_bf16 v92, v34, v34, v92
    v_dot2_f32_bf16 v89, v38, v99, v89
    v_dot2_f32_bf16 v93, v38, v38, v93
    v_dot2_f32_bf16 v90, v42, v99, v90
    v_dot2_f32_bf16 v94, v42, v42, v94
    v_dot2_f32_bf16 v91, v46, v99, v91
    v_dot2_f32_bf16 v95, v46, v46, v95
    v_dot2_f32_bf16 v96, v66, v99, v96
    v_dot2_f32_bf16 v97, v70, v99, v97
    v_dot2_f32_bf16 v98, v74, v99, v98
    v_dot2_f32_bf16 v88, v35, v99, v88
    v_dot2_f32_bf16 v92, v35, v35, v92
    v_dot2_f32_bf16 v89, v39, v99, v89
    v_dot2_f32_bf16 v93, v39, v39, v93
    v_dot2_f32_bf16 v90, v43, v99, v90
    v_dot2_f32_bf16 v94, v43, v43, v94
    v_dot2_f32_bf16 v91, v47, v99, v91
    v_dot2_f32_bf16 v95, v47, v47, v95
    v_dot2_f32_bf16 v96, v67, v99, v96
    v_dot2_f32_bf16 v97, v71, v99, v97
    v_dot2_f32_bf16 v98, v75, v99, v98
    s_waitcnt lgkmcnt(0)
    v_mfma_f32_16x16x32_bf16 a[0:3], v[76:79], v[48:51], a[0:3]
    v_mfma_f32_16x16x32_bf16 a[4:7], v[80:83], v[48:51], a[4:7]
    v_mfma_f32_16x16x32_bf16 a[8:11], v[84:87], v[48:51], a[8:11]
    v_mfma_f32_16x16x32_bf16 a[12:15], v[76:79], v[52:55], a[12:15]
    v_mfma_f32_16x16x32_bf16 a[16:19], v[80:83], v[52:55], a[16:19]
    v_mfma_f32_16x16x32_bf16 a[20:23], v[84:87], v[52:55], a[20:23]
    v_mfma_f32_16x16x32_bf16 a[24:27], v[76:79], v[56:59], a[24:27]
    v_mfma_f32_16x16x32_bf16 a[28:31], v[80:83], v[56:59], a[28:31]
    v_mfma_f32_16x16x32_bf16 a[32:35], v[84:87], v[56:59], a[32:35]
    v_mfma_f32_16x16x32_bf16 a[36:39], v[76:79], v[60:63], a[36:39]
    v_mfma_f32_16x16x32_bf16 a[40:43], v[80:83], v[60:63], a[40:43]
    v_mfma_f32_16x16x32_bf16 a[44:47], v[84:87], v[60:63], a[44:47]
    v_dot2_f32_bf16 v88, v48, v99, v88
    v_dot2_f32_bf16 v92, v48, v48, v92
    v_dot2_f32_bf16 v89, v52, v99, v89
    v_dot2_f32_bf16 v93, v52, v52, v93
    v_dot2_f32_bf16 v90, v56, v99, v90
    v_dot2_f32_bf16 v94, v56, v56, v94
    v_dot2_f32_bf16 v91, v60, v99, v91
    v_dot2_f32_bf16 v95, v60, v60, v95
    v_dot2_f32_bf16 v96, v76, v99, v96
    v_dot2_f32_bf16 v97, v80, v99, v97
    v_dot2_f32_bf16 v98, v84, v99, v98
    v_dot2_f32_bf16 v88, v49, v99, v88
    v_dot2_f32_bf16 v92, v49, v49, v92
    v_dot2_f32_bf16 v89, v53, v99, v89
    v_dot2_f32_bf16 v93, v53, v53, v93
    v_dot2_f32_bf16 v90, v57, v99, v90
    v_dot2_f32_bf16 v94, v57, v57, v94
    v_dot2_f32_bf16 v91, v61, v99, v91
    v_dot2_f32_bf16 v95, v61, v61, v95
    v_dot2_f32_bf16 v96, v77, v99, v96
    v_dot2_f32_bf16 v97, v81, v99, v97
    v_dot2_f32_bf16 v98, v85, v99, v98
    v_dot2_f32_bf16 v88, v50, v99, v88
    v_dot2_f32_bf16 v92, v50, v50, v92
    v_dot2_f32_bf16 v89, v54, v99, v89
    v_dot2_f32_bf16 v93, v54, v54, v93
    v_dot2_f32_bf16 v90, v58, v99, v90
    v_dot2_f32_bf16 v94, v58, v58, v94
    v_dot2_f32_bf16 v91, v62, v99, v91
    v_dot2_f32_bf16 v95, v62, v62, v95
    v_dot2_f32_bf16 v96, v78, v99, v96
    v_dot2_f32_bf16 v97, v82, v99, v97
    v_dot2_f32_bf16 v98, v86, v99, v98
    v_dot2_f32_bf16 v88, v51, v99, v88
    v_dot2_f32_bf16 v92, v51, v51, v92
    v_dot2_f32_bf16 v89, v55, v99, v89
    v_dot2_f32_bf16 v93, v55, v55, v93
    v_dot2_f32_bf16 v90, v59, v99, v90
    v_dot2_f32_bf16 v94, v59, v59, v94
    v_dot2_f32_bf16 v91, v63, v99, v91
    v_dot2_f32_bf16 v95, v63, v63, v95
    v_dot2_f32_bf16 v96, v79, v99, v96
    v_dot2_f32_bf16 v97, v83, v99, v97
    v_dot2_f32_bf16 v98, v87, v99, v98
    s_waitcnt vmcnt(16)
    s_barrier
    s_add_u32 s55, s52, 640
    s_add_u32 m0, s54, 32768
    s_nop 0
    buffer_load_dwordx4 v10, s[8:11], s55 offen lds
    s_add_u32 s55, s52, 29312
    s_add_u32 m0, s54, 36864
    s_nop 0
    buffer_load_dwordx4 v10, s[8:11], s55 offen lds
    s_add_u32 s55, s52, 57984
    s_add_u32 m0, s54, 40960
    s_nop 0
    buffer_load_dwordx4 v10, s[8:11], s55 offen lds
    s_add_u32 s55, s52, 86656
    s_add_u32 m0, s54, 45056
    s_nop 0
    buffer_load_dwordx4 v10, s[8:11], s55 offen lds
    s_add_u32 s55, s53, 860160
    s_add_u32 m0, s54, 49152
    s_nop 0
    buffer_load_dwordx4 v11, s[12:15], s55 offen lds
    s_add_u32 s55, s53, 903168
    s_add_u32 m0, s54, 53248
    s_nop 0
    buffer_load_dwordx4 v11, s[12:15], s55 offen lds
    s_add_u32 s55, s53, 946176
    s_add_u32 m0, s54, 57344
    s_nop 0
    buffer_load_dwordx4 v11, s[12:15], s55 offen lds
    s_add_u32 s55, s53, 989184
    s_add_u32 m0, s54, 61440
    s_nop 0
    buffer_load_dwordx4 v11, s[12:15], s55 offen lds
    ds_read_b128 v[32:35], v16 offset:0
    ds_read_b128 v[36:39], v16 offset:2048
    ds_read_b128 v[40:43], v16 offset:4096
    ds_read_b128 v[44:47], v16 offset:6144
    ds_read_b64_tr_b16 v[64:65], v26 offset:0
    ds_read_b64_tr_b16 v[66:67], v26 offset:1024
    ds_read_b64_tr_b16 v[68:69], v27 offset:0
    ds_read_b64_tr_b16 v[70:71], v27 offset:1024
    ds_read_b64_tr_b16 v[72:73], v28 offset:0
    ds_read_b64_tr_b16 v[74:75], v28 offset:1024
    ds_read_b128 v[48:51], v17 offset:0
    ds_read_b128 v[52:55], v17 offset:2048
    ds_read_b128 v[56:59], v17 offset:4096
    ds_read_b128 v[60:63], v17 offset:6144
    ds_read_b64_tr_b16 v[76:77], v26 offset:8192
    ds_read_b64_tr_b16 v[78:79], v26 offset:9216
    ds_read_b64_tr_b16 v[80:81], v27 offset:8192
    ds_read_b64_tr_b16 v[82:83], v27 offset:9216
    ds_read_b64_tr_b16 v[84:85], v28 offset:8192
    ds_read_b64_tr_b16 v[86:87], v28 offset:9216
    s_waitcnt lgkmcnt(10)
    v_mfma_f32_16x16x32_bf16 a[0:3], v[64:67], v[32:35], a[0:3]
    v_mfma_f32_16x16x32_bf16 a[4:7], v[68:71], v[32:35], a[4:7]
    v_mfma_f32_16x16x32_bf16 a[8:11], v[72:75], v[32:35], a[8:11]
    v_mfma_f32_16x16x32_bf16 a[12:15], v[64:67], v[36:39], a[12:15]
    v_mfma_f32_16x16x32_bf16 a[16:19], v[68:71], v[36:39], a[16:19]
    v_mfma_f32_16x16x32_bf16 a[20:23], v[72:75], v[36:39], a[20:23]
    v_mfma_f32_16x16x32_bf16 a[24:27], v[64:67], v[40:43], a[24:27]
    v_mfma_f32_16x16x32_bf16 a[28:31], v[68:71], v[40:43], a[28:31]
    v_mfma_f32_16x16x32_bf16 a[32:35], v[72:75], v[40:43], a[32:35]
    v_mfma_f32_16x16x32_bf16 a[36:39], v[64:67], v[44:47], a[36:39]
    v_mfma_f32_16x16x32_bf16 a[40:43], v[68:71], v[44:47], a[40:43]
    v_mfma_f32_16x16x32_bf16 a[44:47], v[72:75], v[44:47], a[44:47]
    v_dot2_f32_bf16 v88, v32, v99, v88
    v_dot2_f32_bf16 v92, v32, v32, v92
    v_dot2_f32_bf16 v89, v36, v99, v89
    v_dot2_f32_bf16 v93, v36, v36, v93
    v_dot2_f32_bf16 v90, v40, v99, v90
    v_dot2_f32_bf16 v94, v40, v40, v94
    v_dot2_f32_bf16 v91, v44, v99, v91
    v_dot2_f32_bf16 v95, v44, v44, v95
    v_dot2_f32_bf16 v96, v64, v99, v96
    v_dot2_f32_bf16 v97, v68, v99, v97
    v_dot2_f32_bf16 v98, v72, v99, v98
    v_dot2_f32_bf16 v88, v33, v99, v88
    v_dot2_f32_bf16 v92, v33, v33, v92
    v_dot2_f32_bf16 v89, v37, v99, v89
    v_dot2_f32_bf16 v93, v37, v37, v93
    v_dot2_f32_bf16 v90, v41, v99, v90
    v_dot2_f32_bf16 v94, v41, v41, v94
    v_dot2_f32_bf16 v91, v45, v99, v91
    v_dot2_f32_bf16 v95, v45, v45, v95
    v_dot2_f32_bf16 v96, v65, v99, v96
    v_dot2_f32_bf16 v97, v69, v99, v97
    v_dot2_f32_bf16 v98, v73, v99, v98
    v_dot2_f32_bf16 v88, v34, v99, v88
    v_dot2_f32_bf16 v92, v34, v34, v92
    v_dot2_f32_bf16 v89, v38, v99, v89
    v_dot2_f32_bf16 v93, v38, v38, v93
    v_dot2_f32_bf16 v90, v42, v99, v90
    v_dot2_f32_bf16 v94, v42, v42, v94
    v_dot2_f32_bf16 v91, v46, v99, v91
    v_dot2_f32_bf16 v95, v46, v46, v95
    v_dot2_f32_bf16 v96, v66, v99, v96
    v_dot2_f32_bf16 v97, v70, v99, v97
    v_dot2_f32_bf16 v98, v74, v99, v98
    v_dot2_f32_bf16 v88, v35, v99, v88
    v_dot2_f32_bf16 v92, v35, v35, v92
    v_dot2_f32_bf16 v89, v39, v99, v89
    v_dot2_f32_bf16 v93, v39, v39, v93
    v_dot2_f32_bf16 v90, v43, v99, v90
    v_dot2_f32_bf16 v94, v43, v43, v94
    v_dot2_f32_bf16 v91, v47, v99, v91
    v_dot2_f32_bf16 v95, v47, v47, v95
    v_dot2_f32_bf16 v96, v67, v99, v96
    v_dot2_f32_bf16 v97, v71, v99, v97
    v_dot2_f32_bf16 v98, v75, v99, v98
    s_waitcnt lgkmcnt(0)
    v_mfma_f32_16x16x32_bf16 a[0:3], v[76:79], v[48:51], a[0:3]
    v_mfma_f32_16x16x32_bf16 a[4:7], v[80:83], v[48:51], a[4:7]
    v_mfma_f32_16x16x32_bf16 a[8:11], v[84:87], v[48:51], a[8:11]
    v_mfma_f32_16x16x32_bf16 a[12:15], v[76:79], v[52:55], a[12:15]
    v_mfma_f32_16x16x32_bf16 a[16:19], v[80:83], v[52:55], a[16:19]
    v_mfma_f32_16x16x32_bf16 a[20:23], v[84:87], v[52:55], a[20:23]
    v_mfma_f32_16x16x32_bf16 a[24:27], v[76:79], v[56:59], a[24:27]
    v_mfma_f32_16x16x32_bf16 a[28:31], v[80:83], v[56:59], a[28:31]
    v_mfma_f32_16x16x32_bf16 a[32:35], v[84:87], v[56:59], a[32:35]
    v_mfma_f32_16x16x32_bf16 a[36:39], v[76:79], v[60:63], a[36:39]
    v_mfma_f32_16x16x32_bf16 a[40:43], v[80:83], v[60:63], a[40:43]
    v_mfma_f32_16x16x32_bf16 a[44:47], v[84:87], v[60:63], a[44:47]
    v_dot2_f32_bf16 v88, v48, v99, v88
    v_dot2_f32_bf16 v92, v48, v48, v92
    v_dot2_f32_bf16 v89, v52, v99, v89
    v_dot2_f32_bf16 v93, v52, v52, v93
    v_dot2_f32_bf16 v90, v56, v99, v90
    v_dot2_f32_bf16 v94, v56, v56, v94
    v_dot2_f32_bf16 v91, v60, v99, v91
    v_dot2_f32_bf16 v95, v60, v60, v95
    v_dot2_f32_bf16 v96, v76, v99, v96
    v_dot2_f32_bf16 v97, v80, v99, v97
    v_dot2_f32_bf16 v98, v84, v99, v98
    v_dot2_f32_bf16 v88, v49, v99, v88
    v_dot2_f32_bf16 v92, v49, v49, v92
    v_dot2_f32_bf16 v89, v53, v99, v89
    v_dot2_f32_bf16 v93, v53, v53, v93
    v_dot2_f32_bf16 v90, v57, v99, v90
    v_dot2_f32_bf16 v94, v57, v57, v94
    v_dot2_f32_bf16 v91, v61, v99, v91
    v_dot2_f32_bf16 v95, v61, v61, v95
    v_dot2_f32_bf16 v96, v77, v99, v96
    v_dot2_f32_bf16 v97, v81, v99, v97
    v_dot2_f32_bf16 v98, v85, v99, v98
    v_dot2_f32_bf16 v88, v50, v99, v88
    v_dot2_f32_bf16 v92, v50, v50, v92
    v_dot2_f32_bf16 v89, v54, v99, v89
    v_dot2_f32_bf16 v93, v54, v54, v93
    v_dot2_f32_bf16 v90, v58, v99, v90
    v_dot2_f32_bf16 v94, v58, v58, v94
    v_dot2_f32_bf16 v91, v62, v99, v91
    v_dot2_f32_bf16 v95, v62, v62, v95
    v_dot2_f32_bf16 v96, v78, v99, v96
    v_dot2_f32_bf16 v97, v82, v99, v97
    v_dot2_f32_bf16 v98, v86, v99, v98
    v_dot2_f32_bf16 v88, v51, v99, v88
    v_dot2_f32_bf16 v92, v51, v51, v92
    v_dot2_f32_bf16 v89, v55, v99, v89
    v_dot2_f32_bf16 v93, v55, v55, v93
    v_dot2_f32_bf16 v90, v59, v99, v90
    v_dot2_f32_bf16 v94, v59, v59, v94
    v_dot2_f32_bf16 v91, v63, v99, v91
    v_dot2_f32_bf16 v95, v63, v63, v95
    v_dot2_f32_bf16 v96, v79, v99, v96
    v_dot2_f32_bf16 v97, v83, v99, v97
    v_dot2_f32_bf16 v98, v87, v99, v98
    s_waitcnt vmcnt(16)
    s_barrier
    s_add_u32 s55, s52, 768
    s_add_u32 m0, s54, 65536
    s_nop 0
    buffer_load_dwordx4 v10, s[8:11], s55 offen lds
    s_add_u32 s55, s52, 29440
    s_add_u32 m0, s54, 69632
    s_nop 0
    buffer_load_dwordx4 v10, s[8:11], s55 offen lds
    s_add_u32 s55, s52, 58112
    s_add_u32 m0, s54, 73728
    s_nop 0
    buffer_load_dwordx4 v10, s[8:11], s55 offen lds
    s_add_u32 s55, s52, 86784
    s_add_u32 m0, s54, 77824
    s_nop 0
    buffer_load_dwordx4 v10, s[8:11], s55 offen lds
    s_add_u32 s55, s53, 1032192
    s_add_u32 m0, s54, 81920
    s_nop 0
    buffer_load_dwordx4 v11, s[12:15], s55 offen lds
    s_add_u32 s55, s53, 1075200
    s_add_u32 m0, s54, 86016
    s_nop 0
    buffer_load_dwordx4 v11, s[12:15], s55 offen lds
    s_add_u32 s55, s53, 1118208
    s_add_u32 m0, s54, 90112
    s_nop 0
    buffer_load_dwordx4 v11, s[12:15], s55 offen lds
    s_add_u32 s55, s53, 1161216
    s_add_u32 m0, s54, 94208
    s_nop 0
    buffer_load_dwordx4 v11, s[12:15], s55 offen lds
    ds_read_b128 v[32:35], v18 offset:0
    ds_read_b128 v[36:39], v18 offset:2048
    ds_read_b128 v[40:43], v18 offset:4096
    ds_read_b128 v[44:47], v18 offset:6144
    ds_read_b64_tr_b16 v[64:65], v29 offset:0
    ds_read_b64_tr_b16 v[66:67], v29 offset:1024
    ds_read_b64_tr_b16 v[68:69], v30 offset:0
    ds_read_b64_tr_b16 v[70:71], v30 offset:1024
    ds_read_b64_tr_b16 v[72:73], v31 offset:0
    ds_read_b64_tr_b16 v[74:75], v31 offset:1024
    ds_read_b128 v[48:51], v19 offset:0
    ds_read_b128 v[52:55], v19 offset:2048
    ds_read_b128 v[56:59], v19 offset:4096
    ds_read_b128 v[60:63], v19 offset:6144
    ds_read_b64_tr_b16 v[76:77], v29 offset:8192
    ds_read_b64_tr_b16 v[78:79], v29 offset:9216
    ds_read_b64_tr_b16 v[80:81], v30 offset:8192
    ds_read_b64_tr_b16 v[82:83], v30 offset:9216
    ds_read_b64_tr_b16 v[84:85], v31 offset:8192
    ds_read_b64_tr_b16 v[86:87], v31 offset:9216
    s_waitcnt lgkmcnt(10)
    v_mfma_f32_16x16x32_bf16 a[0:3], v[64:67], v[32:35], a[0:3]
    v_mfma_f32_16x16x32_bf16 a[4:7], v[68:71], v[32:35], a[4:7]
    v_mfma_f32_16x16x32_bf16 a[8:11], v[72:75], v[32:35], a[8:11]
    v_mfma_f32_16x16x32_bf16 a[12:15], v[64:67], v[36:39], a[12:15]
    v_mfma_f32_16x16x32_bf16 a[16:19], v[68:71], v[36:39], a[16:19]
    v_mfma_f32_16x16x32_bf16 a[20:23], v[72:75], v[36:39], a[20:23]
    v_mfma_f32_16x16x32_bf16 a[24:27], v[64:67], v[40:43], a[24:27]
    v_mfma_f32_16x16x32_bf16 a[28:31], v[68:71], v[40:43], a[28:31]
    v_mfma_f32_16x16x32_bf16 a[32:35], v[72:75], v[40:43], a[32:35]
    v_mfma_f32_16x16x32_bf16 a[36:39], v[64:67], v[44:47], a[36:39]
    v_mfma_f32_16x16x32_bf16 a[40:43], v[68:71], v[44:47], a[40:43]
    v_mfma_f32_16x16x32_bf16 a[44:47], v[72:75], v[44:47], a[44:47]
    v_dot2_f32_bf16 v88, v32, v99, v88
    v_dot2_f32_bf16 v92, v32, v32, v92
    v_dot2_f32_bf16 v89, v36, v99, v89
    v_dot2_f32_bf16 v93, v36, v36, v93
    v_dot2_f32_bf16 v90, v40, v99, v90
    v_dot2_f32_bf16 v94, v40, v40, v94
    v_dot2_f32_bf16 v91, v44, v99, v91
    v_dot2_f32_bf16 v95, v44, v44, v95
    v_dot2_f32_bf16 v96, v64, v99, v96
    v_dot2_f32_bf16 v97, v68, v99, v97
    v_dot2_f32_bf16 v98, v72, v99, v98
    v_dot2_f32_bf16 v88, v33, v99, v88
    v_dot2_f32_bf16 v92, v33, v33, v92
    v_dot2_f32_bf16 v89, v37, v99, v89
    v_dot2_f32_bf16 v93, v37, v37, v93
    v_dot2_f32_bf16 v90, v41, v99, v90
    v_dot2_f32_bf16 v94, v41, v41, v94
    v_dot2_f32_bf16 v91, v45, v99, v91
    v_dot2_f32_bf16 v95, v45, v45, v95
    v_dot2_f32_bf16 v96, v65, v99, v96
    v_dot2_f32_bf16 v97, v69, v99, v97
    v_dot2_f32_bf16 v98, v73, v99, v98
    v_dot2_f32_bf16 v88, v34, v99, v88
    v_dot2_f32_bf16 v92, v34, v34, v92
    v_dot2_f32_bf16 v89, v38, v99, v89
    v_dot2_f32_bf16 v93, v38, v38, v93
    v_dot2_f32_bf16 v90, v42, v99, v90
    v_dot2_f32_bf16 v94, v42, v42, v94
    v_dot2_f32_bf16 v91, v46, v99, v91
    v_dot2_f32_bf16 v95, v46, v46, v95
    v_dot2_f32_bf16 v96, v66, v99, v96
    v_dot2_f32_bf16 v97, v70, v99, v97
    v_dot2_f32_bf16 v98, v74, v99, v98
    v_dot2_f32_bf16 v88, v35, v99, v88
    v_dot2_f32_bf16 v92, v35, v35, v92
    v_dot2_f32_bf16 v89, v39, v99, v89
    v_dot2_f32_bf16 v93, v39, v39, v93
    v_dot2_f32_bf16 v90, v43, v99, v90
    v_dot2_f32_bf16 v94, v43, v43, v94
    v_dot2_f32_bf16 v91, v47, v99, v91
    v_dot2_f32_bf16 v95, v47, v47, v95
    v_dot2_f32_bf16 v96, v67, v99, v96
    v_dot2_f32_bf16 v97, v71, v99, v97
    v_dot2_f32_bf16 v98, v75, v99, v98
    s_waitcnt lgkmcnt(0)
    v_mfma_f32_16x16x32_bf16 a[0:3], v[76:79], v[48:51], a[0:3]
    v_mfma_f32_16x16x32_bf16 a[4:7], v[80:83], v[48:51], a[4:7]
    v_mfma_f32_16x16x32_bf16 a[8:11], v[84:87], v[48:51], a[8:11]
    v_mfma_f32_16x16x32_bf16 a[12:15], v[76:79], v[52:55], a[12:15]
    v_mfma_f32_16x16x32_bf16 a[16:19], v[80:83], v[52:55], a[16:19]
    v_mfma_f32_16x16x32_bf16 a[20:23], v[84:87], v[52:55], a[20:23]
    v_mfma_f32_16x16x32_bf16 a[24:27], v[76:79], v[56:59], a[24:27]
    v_mfma_f32_16x16x32_bf16 a[28:31], v[80:83], v[56:59], a[28:31]
    v_mfma_f32_16x16x32_bf16 a[32:35], v[84:87], v[56:59], a[32:35]
    v_mfma_f32_16x16x32_bf16 a[36:39], v[76:79], v[60:63], a[36:39]
    v_mfma_f32_16x16x32_bf16 a[40:43], v[80:83], v[60:63], a[40:43]
    v_mfma_f32_16x16x32_bf16 a[44:47], v[84:87], v[60:63], a[44:47]
    v_dot2_f32_bf16 v88, v48, v99, v88
    v_dot2_f32_bf16 v92, v48, v48, v92
    v_dot2_f32_bf16 v89, v52, v99, v89
    v_dot2_f32_bf16 v93, v52, v52, v93
    v_dot2_f32_bf16 v90, v56, v99, v90
    v_dot2_f32_bf16 v94, v56, v56, v94
    v_dot2_f32_bf16 v91, v60, v99, v91
    v_dot2_f32_bf16 v95, v60, v60, v95
    v_dot2_f32_bf16 v96, v76, v99, v96
    v_dot2_f32_bf16 v97, v80, v99, v97
    v_dot2_f32_bf16 v98, v84, v99, v98
    v_dot2_f32_bf16 v88, v49, v99, v88
    v_dot2_f32_bf16 v92, v49, v49, v92
    v_dot2_f32_bf16 v89, v53, v99, v89
    v_dot2_f32_bf16 v93, v53, v53, v93
    v_dot2_f32_bf16 v90, v57, v99, v90
    v_dot2_f32_bf16 v94, v57, v57, v94
    v_dot2_f32_bf16 v91, v61, v99, v91
    v_dot2_f32_bf16 v95, v61, v61, v95
    v_dot2_f32_bf16 v96, v77, v99, v96
    v_dot2_f32_bf16 v97, v81, v99, v97
    v_dot2_f32_bf16 v98, v85, v99, v98
    v_dot2_f32_bf16 v88, v50, v99, v88
    v_dot2_f32_bf16 v92, v50, v50, v92
    v_dot2_f32_bf16 v89, v54, v99, v89
    v_dot2_f32_bf16 v93, v54, v54, v93
    v_dot2_f32_bf16 v90, v58, v99, v90
    v_dot2_f32_bf16 v94, v58, v58, v94
    v_dot2_f32_bf16 v91, v62, v99, v91
    v_dot2_f32_bf16 v95, v62, v62, v95
    v_dot2_f32_bf16 v96, v78, v99, v96
    v_dot2_f32_bf16 v97, v82, v99, v97
    v_dot2_f32_bf16 v98, v86, v99, v98
    v_dot2_f32_bf16 v88, v51, v99, v88
    v_dot2_f32_bf16 v92, v51, v51, v92
    v_dot2_f32_bf16 v89, v55, v99, v89
    v_dot2_f32_bf16 v93, v55, v55, v93
    v_dot2_f32_bf16 v90, v59, v99, v90
    v_dot2_f32_bf16 v94, v59, v59, v94
    v_dot2_f32_bf16 v91, v63, v99, v91
    v_dot2_f32_bf16 v95, v63, v63, v95
    v_dot2_f32_bf16 v96, v79, v99, v96
    v_dot2_f32_bf16 v97, v83, v99, v97
    v_dot2_f32_bf16 v98, v87, v99, v98
    s_waitcnt vmcnt(16)
    s_barrier
    ds_read_b128 v[32:35], v12 offset:0
    ds_read_b128 v[36:39], v12 offset:2048
    ds_read_b128 v[40:43], v12 offset:4096
    ds_read_b128 v[44:47], v12 offset:6144
    ds_read_b64_tr_b16 v[64:65], v20 offset:0
    ds_read_b64_tr_b16 v[66:67], v20 offset:1024
    ds_read_b64_tr_b16 v[68:69], v21 offset:0
    ds_read_b64_tr_b16 v[70:71], v21 offset:1024
    ds_read_b64_tr_b16 v[72:73], v22 offset:0
    ds_read_b64_tr_b16 v[74:75], v22 offset:1024
    ds_read_b128 v[48:51], v13 offset:0
    ds_read_b128 v[52:55], v13 offset:2048
    ds_read_b128 v[56:59], v13 offset:4096
    ds_read_b128 v[60:63], v13 offset:6144
    ds_read_b64_tr_b16 v[76:77], v20 offset:8192
    ds_read_b64_tr_b16 v[78:79], v20 offset:9216
    ds_read_b64_tr_b16 v[80:81], v21 offset:8192
    ds_read_b64_tr_b16 v[82:83], v21 offset:9216
    ds_read_b64_tr_b16 v[84:85], v22 offset:8192
    ds_read_b64_tr_b16 v[86:87], v22 offset:9216
    s_waitcnt lgkmcnt(10)
    v_mfma_f32_16x16x32_bf16 a[0:3], v[64:67], v[32:35], a[0:3]
    v_mfma_f32_16x16x32_bf16 a[4:7], v[68:71], v[32:35], a[4:7]
    v_mfma_f32_16x16x32_bf16 a[8:11], v[72:75], v[32:35], a[8:11]
    v_mfma_f32_16x16x32_bf16 a[12:15], v[64:67], v[36:39], a[12:15]
    v_mfma_f32_16x16x32_bf16 a[16:19], v[68:71], v[36:39], a[16:19]
    v_mfma_f32_16x16x32_bf16 a[20:23], v[72:75], v[36:39], a[20:23]
    v_mfma_f32_16x16x32_bf16 a[24:27], v[64:67], v[40:43], a[24:27]
    v_mfma_f32_16x16x32_bf16 a[28:31], v[68:71], v[40:43], a[28:31]
    v_mfma_f32_16x16x32_bf16 a[32:35], v[72:75], v[40:43], a[32:35]
    v_mfma_f32_16x16x32_bf16 a[36:39], v[64:67], v[44:47], a[36:39]
    v_mfma_f32_16x16x32_bf16 a[40:43], v[68:71], v[44:47], a[40:43]
    v_mfma_f32_16x16x32_bf16 a[44:47], v[72:75], v[44:47], a[44:47]
    v_dot2_f32_bf16 v88, v32, v99, v88
    v_dot2_f32_bf16 v92, v32, v32, v92
    v_dot2_f32_bf16 v89, v36, v99, v89
    v_dot2_f32_bf16 v93, v36, v36, v93
    v_dot2_f32_bf16 v90, v40, v99, v90
    v_dot2_f32_bf16 v94, v40, v40, v94
    v_dot2_f32_bf16 v91, v44, v99, v91
    v_dot2_f32_bf16 v95, v44, v44, v95
    v_dot2_f32_bf16 v96, v64, v99, v96
    v_dot2_f32_bf16 v97, v68, v99, v97
    v_dot2_f32_bf16 v98, v72, v99, v98
    v_dot2_f32_bf16 v88, v33, v99, v88
    v_dot2_f32_bf16 v92, v33, v33, v92
    v_dot2_f32_bf16 v89, v37, v99, v89
    v_dot2_f32_bf16 v93, v37, v37, v93
    v_dot2_f32_bf16 v90, v41, v99, v90
    v_dot2_f32_bf16 v94, v41, v41, v94
    v_dot2_f32_bf16 v91, v45, v99, v91
    v_dot2_f32_bf16 v95, v45, v45, v95
    v_dot2_f32_bf16 v96, v65, v99, v96
    v_dot2_f32_bf16 v97, v69, v99, v97
    v_dot2_f32_bf16 v98, v73, v99, v98
    v_dot2_f32_bf16 v88, v34, v99, v88
    v_dot2_f32_bf16 v92, v34, v34, v92
    v_dot2_f32_bf16 v89, v38, v99, v89
    v_dot2_f32_bf16 v93, v38, v38, v93
    v_dot2_f32_bf16 v90, v42, v99, v90
    v_dot2_f32_bf16 v94, v42, v42, v94
    v_dot2_f32_bf16 v91, v46, v99, v91
    v_dot2_f32_bf16 v95, v46, v46, v95
    v_dot2_f32_bf16 v96, v66, v99, v96
    v_dot2_f32_bf16 v97, v70, v99, v97
    v_dot2_f32_bf16 v98, v74, v99, v98
    v_dot2_f32_bf16 v88, v35, v99, v88
    v_dot2_f32_bf16 v92, v35, v35, v92
    v_dot2_f32_bf16 v89, v39, v99, v89
    v_dot2_f32_bf16 v93, v39, v39, v93
    v_dot2_f32_bf16 v90, v43, v99, v90
    v_dot2_f32_bf16 v94, v43, v43, v94
    v_dot2_f32_bf16 v91, v47, v99, v91
    v_dot2_f32_bf16 v95, v47, v47, v95
    v_dot2_f32_bf16 v96, v67, v99, v96
    v_dot2_f32_bf16 v97, v71, v99, v97
    v_dot2_f32_bf16 v98, v75, v99, v98
    s_waitcnt lgkmcnt(0)
    v_mfma_f32_16x16x32_bf16 a[0:3], v[76:79], v[48:51], a[0:3]
    v_mfma_f32_16x16x32_bf16 a[4:7], v[80:83], v[48:51], a[4:7]
    v_mfma_f32_16x16x32_bf16 a[8:11], v[84:87], v[48:51], a[8:11]
    v_mfma_f32_16x16x32_bf16 a[12:15], v[76:79], v[52:55], a[12:15]
    v_mfma_f32_16x16x32_bf16 a[16:19], v[80:83], v[52:55], a[16:19]
    v_mfma_f32_16x16x32_bf16 a[20:23], v[84:87], v[52:55], a[20:23]
    v_mfma_f32_16x16x32_bf16 a[24:27], v[76:79], v[56:59], a[24:27]
    v_mfma_f32_16x16x32_bf16 a[28:31], v[80:83], v[56:59], a[28:31]
    v_mfma_f32_16x16x32_bf16 a[32:35], v[84:87], v[56:59], a[32:35]
    v_mfma_f32_16x16x32_bf16 a[36:39], v[76:79], v[60:63], a[36:39]
    v_mfma_f32_16x16x32_bf16 a[40:43], v[80:83], v[60:63], a[40:43]
    v_mfma_f32_16x16x32_bf16 a[44:47], v[84:87], v[60:63], a[44:47]
    v_dot2_f32_bf16 v88, v48, v99, v88
    v_dot2_f32_bf16 v92, v48, v48, v92
    v_dot2_f32_bf16 v89, v52, v99, v89
    v_dot2_f32_bf16 v93, v52, v52, v93
    v_dot2_f32_bf16 v90, v56, v99, v90
    v_dot2_f32_bf16 v94, v56, v56, v94
    v_dot2_f32_bf16 v91, v60, v99, v91
    v_dot2_f32_bf16 v95, v60, v60, v95
    v_dot2_f32_bf16 v96, v76, v99, v96
    v_dot2_f32_bf16 v97, v80, v99, v97
    v_dot2_f32_bf16 v98, v84, v99, v98
    v_dot2_f32_bf16 v88, v49, v99, v88
    v_dot2_f32_bf16 v92, v49, v49, v92
    v_dot2_f32_bf16 v89, v53, v99, v89
    v_dot2_f32_bf16 v93, v53, v53, v93
    v_dot2_f32_bf16 v90, v57, v99, v90
    v_dot2_f32_bf16 v94, v57, v57, v94
    v_dot2_f32_bf16 v91, v61, v99, v91
    v_dot2_f32_bf16 v95, v61, v61, v95
    v_dot2_f32_bf16 v96, v77, v99, v96
    v_dot2_f32_bf16 v97, v81, v99, v97
    v_dot2_f32_bf16 v98, v85, v99, v98
    v_dot2_f32_bf16 v88, v50, v99, v88
    v_dot2_f32_bf16 v92, v50, v50, v92
    v_dot2_f32_bf16 v89, v54, v99, v89
    v_dot2_f32_bf16 v93, v54, v54, v93
    v_dot2_f32_bf16 v90, v58, v99, v90
    v_dot2_f32_bf16 v94, v58, v58, v94
    v_dot2_f32_bf16 v91, v62, v99, v91
    v_dot2_f32_bf16 v95, v62, v62, v95
    v_dot2_f32_bf16 v96, v78, v99, v96
    v_dot2_f32_bf16 v97, v82, v99, v97
    v_dot2_f32_bf16 v98, v86, v99, v98
    v_dot2_f32_bf16 v88, v51, v99, v88
    v_dot2_f32_bf16 v92, v51, v51, v92
    v_dot2_f32_bf16 v89, v55, v99, v89
    v_dot2_f32_bf16 v93, v55, v55, v93
    v_dot2_f32_bf16 v90, v59, v99, v90
    v_dot2_f32_bf16 v94, v59, v59, v94
    v_dot2_f32_bf16 v91, v63, v99, v91
    v_dot2_f32_bf16 v95, v63, v63, v95
    v_dot2_f32_bf16 v96, v79, v99, v96
    v_dot2_f32_bf16 v97, v83, v99, v97
    v_dot2_f32_bf16 v98, v87, v99, v98
    s_waitcnt vmcnt(8)
    s_barrier
    ds_read_b128 v[32:35], v14 offset:0
    ds_read_b128 v[36:39], v14 offset:2048
    ds_read_b128 v[40:43], v14 offset:4096
    ds_read_b128 v[44:47], v14 offset:6144
    ds_read_b64_tr_b16 v[64:65], v23 offset:0
    ds_read_b64_tr_b16 v[66:67], v23 offset:1024
    ds_read_b64_tr_b16 v[68:69], v24 offset:0
    ds_read_b64_tr_b16 v[70:71], v24 offset:1024
    ds_read_b64_tr_b16 v[72:73], v25 offset:0
    ds_read_b64_tr_b16 v[74:75], v25 offset:1024
    ds_read_b128 v[48:51], v15 offset:0
    ds_read_b128 v[52:55], v15 offset:2048
    ds_read_b128 v[56:59], v15 offset:4096
    ds_read_b128 v[60:63], v15 offset:6144
    ds_read_b64_tr_b16 v[76:77], v23 offset:8192
    ds_read_b64_tr_b16 v[78:79], v23 offset:9216
    ds_read_b64_tr_b16 v[80:81], v24 offset:8192
    ds_read_b64_tr_b16 v[82:83], v24 offset:9216
    ds_read_b64_tr_b16 v[84:85], v25 offset:8192
    ds_read_b64_tr_b16 v[86:87], v25 offset:9216
    s_waitcnt lgkmcnt(10)
    v_mfma_f32_16x16x32_bf16 a[0:3], v[64:67], v[32:35], a[0:3]
    v_mfma_f32_16x16x32_bf16 a[4:7], v[68:71], v[32:35], a[4:7]
    v_mfma_f32_16x16x32_bf16 a[8:11], v[72:75], v[32:35], a[8:11]
    v_mfma_f32_16x16x32_bf16 a[12:15], v[64:67], v[36:39], a[12:15]
    v_mfma_f32_16x16x32_bf16 a[16:19], v[68:71], v[36:39], a[16:19]
    v_mfma_f32_16x16x32_bf16 a[20:23], v[72:75], v[36:39], a[20:23]
    v_mfma_f32_16x16x32_bf16 a[24:27], v[64:67], v[40:43], a[24:27]
    v_mfma_f32_16x16x32_bf16 a[28:31], v[68:71], v[40:43], a[28:31]
    v_mfma_f32_16x16x32_bf16 a[32:35], v[72:75], v[40:43], a[32:35]
    v_mfma_f32_16x16x32_bf16 a[36:39], v[64:67], v[44:47], a[36:39]
    v_mfma_f32_16x16x32_bf16 a[40:43], v[68:71], v[44:47], a[40:43]
    v_mfma_f32_16x16x32_bf16 a[44:47], v[72:75], v[44:47], a[44:47]
    v_dot2_f32_bf16 v88, v32, v99, v88
    v_dot2_f32_bf16 v92, v32, v32, v92
    v_dot2_f32_bf16 v89, v36, v99, v89
    v_dot2_f32_bf16 v93, v36, v36, v93
    v_dot2_f32_bf16 v90, v40, v99, v90
    v_dot2_f32_bf16 v94, v40, v40, v94
    v_dot2_f32_bf16 v91, v44, v99, v91
    v_dot2_f32_bf16 v95, v44, v44, v95
    v_dot2_f32_bf16 v96, v64, v99, v96
    v_dot2_f32_bf16 v97, v68, v99, v97
    v_dot2_f32_bf16 v98, v72, v99, v98
    v_dot2_f32_bf16 v88, v33, v99, v88
    v_dot2_f32_bf16 v92, v33, v33, v92
    v_dot2_f32_bf16 v89, v37, v99, v89
    v_dot2_f32_bf16 v93, v37, v37, v93
    v_dot2_f32_bf16 v90, v41, v99, v90
    v_dot2_f32_bf16 v94, v41, v41, v94
    v_dot2_f32_bf16 v91, v45, v99, v91
    v_dot2_f32_bf16 v95, v45, v45, v95
    v_dot2_f32_bf16 v96, v65, v99, v96
    v_dot2_f32_bf16 v97, v69, v99, v97
    v_dot2_f32_bf16 v98, v73, v99, v98
    v_dot2_f32_bf16 v88, v34, v99, v88
    v_dot2_f32_bf16 v92, v34, v34, v92
    v_dot2_f32_bf16 v89, v38, v99, v89
    v_dot2_f32_bf16 v93, v38, v38, v93
    v_dot2_f32_bf16 v90, v42, v99, v90
    v_dot2_f32_bf16 v94, v42, v42, v94
    v_dot2_f32_bf16 v91, v46, v99, v91
    v_dot2_f32_bf16 v95, v46, v46, v95
    v_dot2_f32_bf16 v96, v66, v99, v96
    v_dot2_f32_bf16 v97, v70, v99, v97
    v_dot2_f32_bf16 v98, v74, v99, v98
    v_dot2_f32_bf16 v88, v35, v99, v88
    v_dot2_f32_bf16 v92, v35, v35, v92
    v_dot2_f32_bf16 v89, v39, v99, v89
    v_dot2_f32_bf16 v93, v39, v39, v93
    v_dot2_f32_bf16 v90, v43, v99, v90
    v_dot2_f32_bf16 v94, v43, v43, v94
    v_dot2_f32_bf16 v91, v47, v99, v91
    v_dot2_f32_bf16 v95, v47, v47, v95
    v_dot2_f32_bf16 v96, v67, v99, v96
    v_dot2_f32_bf16 v97, v71, v99, v97
    v_dot2_f32_bf16 v98, v75, v99, v98
    s_waitcnt lgkmcnt(0)
    v_mfma_f32_16x16x32_bf16 a[0:3], v[76:79], v[48:51], a[0:3]
    v_mfma_f32_16x16x32_bf16 a[4:7], v[80:83], v[48:51], a[4:7]
    v_mfma_f32_16x16x32_bf16 a[8:11], v[84:87], v[48:51], a[8:11]
    v_mfma_f32_16x16x32_bf16 a[12:15], v[76:79], v[52:55], a[12:15]
    v_mfma_f32_16x16x32_bf16 a[16:19], v[80:83], v[52:55], a[16:19]
    v_mfma_f32_16x16x32_bf16 a[20:23], v[84:87], v[52:55], a[20:23]
    v_mfma_f32_16x16x32_bf16 a[24:27], v[76:79], v[56:59], a[24:27]
    v_mfma_f32_16x16x32_bf16 a[28:31], v[80:83], v[56:59], a[28:31]
    v_mfma_f32_16x16x32_bf16 a[32:35], v[84:87], v[56:59], a[32:35]
    v_mfma_f32_16x16x32_bf16 a[36:39], v[76:79], v[60:63], a[36:39]
    v_mfma_f32_16x16x32_bf16 a[40:43], v[80:83], v[60:63], a[40:43]
    v_mfma_f32_16x16x32_bf16 a[44:47], v[84:87], v[60:63], a[44:47]
    v_dot2_f32_bf16 v88, v48, v99, v88
    v_dot2_f32_bf16 v92, v48, v48, v92
    v_dot2_f32_bf16 v89, v52, v99, v89
    v_dot2_f32_bf16 v93, v52, v52, v93
    v_dot2_f32_bf16 v90, v56, v99, v90
    v_dot2_f32_bf16 v94, v56, v56, v94
    v_dot2_f32_bf16 v91, v60, v99, v91
    v_dot2_f32_bf16 v95, v60, v60, v95
    v_dot2_f32_bf16 v96, v76, v99, v96
    v_dot2_f32_bf16 v97, v80, v99, v97
    v_dot2_f32_bf16 v98, v84, v99, v98
    v_dot2_f32_bf16 v88, v49, v99, v88
    v_dot2_f32_bf16 v92, v49, v49, v92
    v_dot2_f32_bf16 v89, v53, v99, v89
    v_dot2_f32_bf16 v93, v53, v53, v93
    v_dot2_f32_bf16 v90, v57, v99, v90
    v_dot2_f32_bf16 v94, v57, v57, v94
    v_dot2_f32_bf16 v91, v61, v99, v91
    v_dot2_f32_bf16 v95, v61, v61, v95
    v_dot2_f32_bf16 v96, v77, v99, v96
    v_dot2_f32_bf16 v97, v81, v99, v97
    v_dot2_f32_bf16 v98, v85, v99, v98
    v_dot2_f32_bf16 v88, v50, v99, v88
    v_dot2_f32_bf16 v92, v50, v50, v92
    v_dot2_f32_bf16 v89, v54, v99, v89
    v_dot2_f32_bf16 v93, v54, v54, v93
    v_dot2_f32_bf16 v90, v58, v99, v90
    v_dot2_f32_bf16 v94, v58, v58, v94
    v_dot2_f32_bf16 v91, v62, v99, v91
    v_dot2_f32_bf16 v95, v62, v62, v95
    v_dot2_f32_bf16 v96, v78, v99, v96
    v_dot2_f32_bf16 v97, v82, v99, v97
    v_dot2_f32_bf16 v98, v86, v99, v98
    v_dot2_f32_bf16 v88, v51, v99, v88
    v_dot2_f32_bf16 v92, v51, v51, v92
    v_dot2_f32_bf16 v89, v55, v99, v89
    v_dot2_f32_bf16 v93, v55, v55, v93
    v_dot2_f32_bf16 v90, v59, v99, v90
    v_dot2_f32_bf16 v94, v59, v59, v94
    v_dot2_f32_bf16 v91, v63, v99, v91
    v_dot2_f32_bf16 v95, v63, v63, v95
    v_dot2_f32_bf16 v96, v79, v99, v96
    v_dot2_f32_bf16 v97, v83, v99, v97
    v_dot2_f32_bf16 v98, v87, v99, v98
    s_waitcnt vmcnt(0)
    s_barrier
    ds_read_b128 v[32:35], v16 offset:0
    ds_read_b128 v[36:39], v16 offset:2048
    ds_read_b128 v[40:43], v16 offset:4096
    ds_read_b128 v[44:47], v16 offset:6144
    ds_read_b64_tr_b16 v[64:65], v26 offset:0
    ds_read_b64_tr_b16 v[66:67], v26 offset:1024
    ds_read_b64_tr_b16 v[68:69], v27 offset:0
    ds_read_b64_tr_b16 v[70:71], v27 offset:1024
    ds_read_b64_tr_b16 v[72:73], v28 offset:0
    ds_read_b64_tr_b16 v[74:75], v28 offset:1024
    ds_read_b128 v[48:51], v17 offset:0
    ds_read_b128 v[52:55], v17 offset:2048
    ds_read_b128 v[56:59], v17 offset:4096
    ds_read_b128 v[60:63], v17 offset:6144
    ds_read_b64_tr_b16 v[76:77], v26 offset:8192
    ds_read_b64_tr_b16 v[78:79], v26 offset:9216
    ds_read_b64_tr_b16 v[80:81], v27 offset:8192
    ds_read_b64_tr_b16 v[82:83], v27 offset:9216
    ds_read_b64_tr_b16 v[84:85], v28 offset:8192
    ds_read_b64_tr_b16 v[86:87], v28 offset:9216
    s_waitcnt lgkmcnt(10)
    v_mfma_f32_16x16x32_bf16 a[0:3], v[64:67], v[32:35], a[0:3]
    v_mfma_f32_16x16x32_bf16 a[4:7], v[68:71], v[32:35], a[4:7]
    v_mfma_f32_16x16x32_bf16 a[8:11], v[72:75], v[32:35], a[8:11]
    v_mfma_f32_16x16x32_bf16 a[12:15], v[64:67], v[36:39], a[12:15]
    v_mfma_f32_16x16x32_bf16 a[16:19], v[68:71], v[36:39], a[16:19]
    v_mfma_f32_16x16x32_bf16 a[20:23], v[72:75], v[36:39], a[20:23]
    v_mfma_f32_16x16x32_bf16 a[24:27], v[64:67], v[40:43], a[24:27]
    v_mfma_f32_16x16x32_bf16 a[28:31], v[68:71], v[40:43], a[28:31]
    v_mfma_f32_16x16x32_bf16 a[32:35], v[72:75], v[40:43], a[32:35]
    v_mfma_f32_16x16x32_bf16 a[36:39], v[64:67], v[44:47], a[36:39]
    v_mfma_f32_16x16x32_bf16 a[40:43], v[68:71], v[44:47], a[40:43]
    v_mfma_f32_16x16x32_bf16 a[44:47], v[72:75], v[44:47], a[44:47]
    v_dot2_f32_bf16 v88, v32, v99, v88
    v_dot2_f32_bf16 v92, v32, v32, v92
    v_dot2_f32_bf16 v89, v36, v99, v89
    v_dot2_f32_bf16 v93, v36, v36, v93
    v_dot2_f32_bf16 v90, v40, v99, v90
    v_dot2_f32_bf16 v94, v40, v40, v94
    v_dot2_f32_bf16 v91, v44, v99, v91
    v_dot2_f32_bf16 v95, v44, v44, v95
    v_dot2_f32_bf16 v96, v64, v99, v96
    v_dot2_f32_bf16 v97, v68, v99, v97
    v_dot2_f32_bf16 v98, v72, v99, v98
    v_dot2_f32_bf16 v88, v33, v99, v88
    v_dot2_f32_bf16 v92, v33, v33, v92
    v_dot2_f32_bf16 v89, v37, v99, v89
    v_dot2_f32_bf16 v93, v37, v37, v93
    v_dot2_f32_bf16 v90, v41, v99, v90
    v_dot2_f32_bf16 v94, v41, v41, v94
    v_dot2_f32_bf16 v91, v45, v99, v91
    v_dot2_f32_bf16 v95, v45, v45, v95
    v_dot2_f32_bf16 v96, v65, v99, v96
    v_dot2_f32_bf16 v97, v69, v99, v97
    v_dot2_f32_bf16 v98, v73, v99, v98
    v_dot2_f32_bf16 v88, v34, v99, v88
    v_dot2_f32_bf16 v92, v34, v34, v92
    v_dot2_f32_bf16 v89, v38, v99, v89
    v_dot2_f32_bf16 v93, v38, v38, v93
    v_dot2_f32_bf16 v90, v42, v99, v90
    v_dot2_f32_bf16 v94, v42, v42, v94
    v_dot2_f32_bf16 v91, v46, v99, v91
    v_dot2_f32_bf16 v95, v46, v46, v95
    v_dot2_f32_bf16 v96, v66, v99, v96
    v_dot2_f32_bf16 v97, v70, v99, v97
    v_dot2_f32_bf16 v98, v74, v99, v98
    v_dot2_f32_bf16 v88, v35, v99, v88
    v_dot2_f32_bf16 v92, v35, v35, v92
    v_dot2_f32_bf16 v89, v39, v99, v89
    v_dot2_f32_bf16 v93, v39, v39, v93
    v_dot2_f32_bf16 v90, v43, v99, v90
    v_dot2_f32_bf16 v94, v43, v43, v94
    v_dot2_f32_bf16 v91, v47, v99, v91
    v_dot2_f32_bf16 v95, v47, v47, v95
    v_dot2_f32_bf16 v96, v67, v99, v96
    v_dot2_f32_bf16 v97, v71, v99, v97
    v_dot2_f32_bf16 v98, v75, v99, v98
    s_waitcnt lgkmcnt(0)
    v_mfma_f32_16x16x32_bf16 a[0:3], v[76:79], v[48:51], a[0:3]
    v_mfma_f32_16x16x32_bf16 a[4:7], v[80:83], v[48:51], a[4:7]
    v_mfma_f32_16x16x32_bf16 a[8:11], v[84:87], v[48:51], a[8:11]
    v_mfma_f32_16x16x32_bf16 a[12:15], v[76:79], v[52:55], a[12:15]
    v_mfma_f32_16x16x32_bf16 a[16:19], v[80:83], v[52:55], a[16:19]
    v_mfma_f32_16x16x32_bf16 a[20:23], v[84:87], v[52:55], a[20:23]
    v_mfma_f32_16x16x32_bf16 a[24:27], v[76:79], v[56:59], a[24:27]
    v_mfma_f32_16x16x32_bf16 a[28:31], v[80:83], v[56:59], a[28:31]
    v_mfma_f32_16x16x32_bf16 a[32:35], v[84:87], v[56:59], a[32:35]
    v_mfma_f32_16x16x32_bf16 a[36:39], v[76:79], v[60:63], a[36:39]
    v_mfma_f32_16x16x32_bf16 a[40:43], v[80:83], v[60:63], a[40:43]
    v_mfma_f32_16x16x32_bf16 a[44:47], v[84:87], v[60:63], a[44:47]
    v_dot2_f32_bf16 v88, v48, v99, v88
    v_dot2_f32_bf16 v92, v48, v48, v92
    v_dot2_f32_bf16 v89, v52, v99, v89
    v_dot2_f32_bf16 v93, v52, v52, v93
    v_dot2_f32_bf16 v90, v56, v99, v90
    v_dot2_f32_bf16 v94, v56, v56, v94
    v_dot2_f32_bf16 v91, v60, v99, v91
    v_dot2_f32_bf16 v95, v60, v60, v95
    v_dot2_f32_bf16 v96, v76, v99, v96
    v_dot2_f32_bf16 v97, v80, v99, v97
    v_dot2_f32_bf16 v98, v84, v99, v98
    v_dot2_f32_bf16 v88, v49, v99, v88
    v_dot2_f32_bf16 v92, v49, v49, v92
    v_dot2_f32_bf16 v89, v53, v99, v89
    v_dot2_f32_bf16 v93, v53, v53, v93
    v_dot2_f32_bf16 v90, v57, v99, v90
    v_dot2_f32_bf16 v94, v57, v57, v94
    v_dot2_f32_bf16 v91, v61, v99, v91
    v_dot2_f32_bf16 v95, v61, v61, v95
    v_dot2_f32_bf16 v96, v77, v99, v96
    v_dot2_f32_bf16 v97, v81, v99, v97
    v_dot2_f32_bf16 v98, v85, v99, v98
    v_dot2_f32_bf16 v88, v50, v99, v88
    v_dot2_f32_bf16 v92, v50, v50, v92
    v_dot2_f32_bf16 v89, v54, v99, v89
    v_dot2_f32_bf16 v93, v54, v54, v93
    v_dot2_f32_bf16 v90, v58, v99, v90
    v_dot2_f32_bf16 v94, v58, v58, v94
    v_dot2_f32_bf16 v91, v62, v99, v91
    v_dot2_f32_bf16 v95, v62, v62, v95
    v_dot2_f32_bf16 v96, v78, v99, v96
    v_dot2_f32_bf16 v97, v82, v99, v97
    v_dot2_f32_bf16 v98, v86, v99, v98
    v_dot2_f32_bf16 v88, v51, v99, v88
    v_dot2_f32_bf16 v92, v51, v51, v92
    v_dot2_f32_bf16 v89, v55, v99, v89
    v_dot2_f32_bf16 v93, v55, v55, v93
    v_dot2_f32_bf16 v90, v59, v99, v90
    v_dot2_f32_bf16 v94, v59, v59, v94
    v_dot2_f32_bf16 v91, v63, v99, v91
    v_dot2_f32_bf16 v95, v63, v63, v95
    v_dot2_f32_bf16 v96, v79, v99, v96
    v_dot2_f32_bf16 v97, v83, v99, v97
    v_dot2_f32_bf16 v98, v87, v99, v98
    v_mov_b32 v2, v88
    s_nop 1
    v_permlane32_swap_b32 v88, v2
    v_add_f32 v88, v88, v2
    v_mov_b32 v2, v88
    s_nop 1
    v_permlane16_swap_b32 v88, v2
    v_add_f32 v88, v88, v2
    v_mov_b32 v2, v89
    s_nop 1
    v_permlane32_swap_b32 v89, v2
    v_add_f32 v89, v89, v2
    v_mov_b32 v2, v89
    s_nop 1
    v_permlane16_swap_b32 v89, v2
    v_add_f32 v89, v89, v2
    v_mov_b32 v2, v90
    s_nop 1
    v_permlane32_swap_b32 v90, v2
    v_add_f32 v90, v90, v2
    v_mov_b32 v2, v90
    s_nop 1
    v_permlane16_swap_b32 v90, v2
    v_add_f32 v90, v90, v2
    v_mov_b32 v2, v91
    s_nop 1
    v_permlane32_swap_b32 v91, v2
    v_add_f32 v91, v91, v2
    v_mov_b32 v2, v91
    s_nop 1
    v_permlane16_swap_b32 v91, v2
    v_add_f32 v91, v91, v2
    v_mov_b32 v2, v92
    s_nop 1
    v_permlane32_swap_b32 v92, v2
    v_add_f32 v92, v92, v2
    v_mov_b32 v2, v92
    s_nop 1
    v_permlane16_swap_b32 v92, v2
    v_add_f32 v92, v92, v2
    v_mov_b32 v2, v93
    s_nop 1
    v_permlane32_swap_b32 v93, v2
    v_add_f32 v93, v93, v2
    v_mov_b32 v2, v93
    s_nop 1
    v_permlane16_swap_b32 v93, v2
    v_add_f32 v93, v93, v2
    v_mov_b32 v2, v94
    s_nop 1
    v_permlane32_swap_b32 v94, v2
    v_add_f32 v94, v94, v2
    v_mov_b32 v2, v94
    s_nop 1
    v_permlane16_swap_b32 v94, v2
    v_add_f32 v94, v94, v2
    v_mov_b32 v2, v95
    s_nop 1
    v_permlane32_swap_b32 v95, v2
    v_add_f32 v95, v95, v2
    v_mov_b32 v2, v95
    s_nop 1
    v_permlane16_swap_b32 v95, v2
    v_add_f32 v95, v95, v2
    v_mov_b32 v2, v96
    s_nop 1
    v_permlane32_swap_b32 v96, v2
    v_add_f32 v96, v96, v2
    v_mov_b32 v2, v96
    s_nop 1
    v_permlane16_swap_b32 v96, v2
    v_add_f32 v96, v96, v2
    v_mov_b32 v2, v97
    s_nop 1
    v_permlane32_swap_b32 v97, v2
    v_add_f32 v97, v97, v2
    v_mov_b32 v2, v97
    s_nop 1
    v_permlane16_swap_b32 v97, v2
    v_add_f32 v97, v97, v2
    v_mov_b32 v2, v98
    s_nop 1
    v_permlane32_swap_b32 v98, v2
    v_add_f32 v98, v98, v2
    v_mov_b32 v2, v98
    s_nop 1
    v_permlane16_swap_b32 v98, v2
    v_add_f32 v98, v98, v2
    s_mov_b32 s44, 0x3b124925
    v_mul_f32 v88, s44, v88
    v_mul_f32 v92, s44, v92
    v_fma_f32 v92, -v88, v88, v92
    v_max_f32 v92, 0, v92
    v_add_f32 v92, 0x3727c5ac, v92
    v_rsq_f32 v92, v92
    v_mul_f32 v89, s44, v89
    v_mul_f32 v93, s44, v93
    v_fma_f32 v93, -v89, v89, v93
    v_max_f32 v93, 0, v93
    v_add_f32 v93, 0x3727c5ac, v93
    v_rsq_f32 v93, v93
    v_mul_f32 v90, s44, v90
    v_mul_f32 v94, s44, v94
    v_fma_f32 v94, -v90, v90, v94
    v_max_f32 v94, 0, v94
    v_add_f32 v94, 0x3727c5ac, v94
    v_rsq_f32 v94, v94
    v_mul_f32 v91, s44, v91
    v_mul_f32 v95, s44, v95
    v_fma_f32 v95, -v91, v91, v95
    v_max_f32 v95, 0, v95
    v_add_f32 v95, 0x3727c5ac, v95
    v_rsq_f32 v95, v95
    s_lshl_b32 s44, s51, 9
    v_lshlrev_b32 v2, 2, v6
    v_add_u32 v2, s44, v2
    v_add_u32 v2, 131072, v2
    v_lshlrev_b32 v3, 4, v7
    v_add_u32 v3, s44, v3
    v_add_u32 v3, 131072, v3
    ds_write_b32 v2, v96 offset:0
    ds_write_b32 v2, v97 offset:64
    ds_write_b32 v2, v98 offset:128
    s_waitcnt lgkmcnt(0)
    ds_read_b128 v[76:79], v3 offset:0
    ds_read_b128 v[80:83], v3 offset:64
    ds_read_b128 v[84:87], v3 offset:128
    s_waitcnt lgkmcnt(0)
    v_mov_b32 v102, 0x3f80
    v_add_u32 v2, 0, v101
    v_mul_u32_u24 v3, 2341, v2
    v_lshrrev_b32 v3, 16, v3
    v_mul_u32_u24 v4, 28, v3
    v_sub_u32 v4, v2, v4
    v_mov_b32 v109, v4
    v_lshlrev_b32 v103, 17, v3
    v_lshrrev_b32 v5, 3, v4
    v_lshlrev_b32 v5, 9, v5
    v_and_b32 v2, 7, v4
    v_lshl_add_u32 v5, v2, 1, v5
    v_lshlrev_b32 v2, 1, v4
    v_cmp_lt_u32 vcc, 31, v3
    s_nop 1
    v_cndmask_b32 v5, v5, v2, vcc
    v_add_u32 v103, v103, v5
    v_cndmask_b32 v106, 0, 1, vcc
    v_add_u32 v2, 16, v101
    v_mul_u32_u24 v3, 2341, v2
    v_lshrrev_b32 v3, 16, v3
    v_mul_u32_u24 v4, 28, v3
    v_sub_u32 v4, v2, v4
    v_mov_b32 v110, v4
    v_lshlrev_b32 v104, 17, v3
    v_lshrrev_b32 v5, 3, v4
    v_lshlrev_b32 v5, 9, v5
    v_and_b32 v2, 7, v4
    v_lshl_add_u32 v5, v2, 1, v5
    v_lshlrev_b32 v2, 1, v4
    v_cmp_lt_u32 vcc, 31, v3
    s_nop 1
    v_cndmask_b32 v5, v5, v2, vcc
    v_add_u32 v104, v104, v5
    v_cndmask_b32 v107, 0, 1, vcc
    v_add_u32 v2, 32, v101
    v_mul_u32_u24 v3, 2341, v2
    v_lshrrev_b32 v3, 16, v3
    v_mul_u32_u24 v4, 28, v3
    v_sub_u32 v4, v2, v4
    v_mov_b32 v111, v4
    v_lshlrev_b32 v105, 17, v3
    v_lshrrev_b32 v5, 3, v4
    v_lshlrev_b32 v5, 9, v5
    v_and_b32 v2, 7, v4
    v_lshl_add_u32 v5, v2, 1, v5
    v_lshlrev_b32 v2, 1, v4
    v_cmp_lt_u32 vcc, 31, v3
    s_nop 1
    v_cndmask_b32 v5, v5, v2, vcc
    v_add_u32 v105, v105, v5
    v_cndmask_b32 v108, 0, 1, vcc
    v_add_u32 v2, 0, v100
    v_lshrrev_b32 v5, 5, v2
    v_lshlrev_b32 v112, 11, v5
    v_and_b32 v5, 31, v2
    v_lshl_add_u32 v112, v5, 4, v112
    v_lshlrev_b32 v113, 6, v2
    v_accvgpr_read_b32 v32, a0
    v_accvgpr_read_b32 v33, a1
    v_accvgpr_read_b32 v34, a2
    v_accvgpr_read_b32 v35, a3
    v_fma_f32 v32, -v88, v76, v32
    v_mul_f32 v32, v92, v32
    v_fma_f32 v33, -v88, v77, v33
    v_mul_f32 v33, v92, v33
    v_fma_f32 v34, -v88, v78, v34
    v_mul_f32 v34, v92, v34
    v_fma_f32 v35, -v88, v79, v35
    v_mul_f32 v35, v92, v35
    v_cvt_pk_bf16_f32 v48, v32, v33
    v_cvt_pk_bf16_f32 v49, v34, v35
    v_cmp_eq_u32 vcc, 1, v106
    s_nop 1
    v_cndmask_b32 v3, v112, v113, vcc
    v_add_u32 v3, v3, v103
    buffer_store_dwordx2 v[48:49], v3, s[20:23], 0 offen
    v_cndmask_b32 v64, 0, v102, vcc
    v_mov_b32 v65, 0
    v_cmp_eq_u32 vcc, 24, v109
    s_and_saveexec_b64 s[42:43], vcc
    buffer_store_dwordx2 v[64:65], v3, s[20:23], 0 offen offset:8
    s_mov_b64 exec, s[42:43]
    v_accvgpr_read_b32 v32, a4
    v_accvgpr_read_b32 v33, a5
    v_accvgpr_read_b32 v34, a6
    v_accvgpr_read_b32 v35, a7
    v_fma_f32 v32, -v88, v80, v32
    v_mul_f32 v32, v92, v32
    v_fma_f32 v33, -v88, v81, v33
    v_mul_f32 v33, v92, v33
    v_fma_f32 v34, -v88, v82, v34
    v_mul_f32 v34, v92, v34
    v_fma_f32 v35, -v88, v83, v35
    v_mul_f32 v35, v92, v35
    v_cvt_pk_bf16_f32 v48, v32, v33
    v_cvt_pk_bf16_f32 v49, v34, v35
    v_cmp_eq_u32 vcc, 1, v107
    s_nop 1
    v_cndmask_b32 v3, v112, v113, vcc
    v_add_u32 v3, v3, v104
    buffer_store_dwordx2 v[48:49], v3, s[20:23], 0 offen
    v_cndmask_b32 v64, 0, v102, vcc
    v_mov_b32 v65, 0
    v_cmp_eq_u32 vcc, 24, v110
    s_and_saveexec_b64 s[42:43], vcc
    buffer_store_dwordx2 v[64:65], v3, s[20:23], 0 offen offset:8
    s_mov_b64 exec, s[42:43]
    v_accvgpr_read_b32 v32, a8
    v_accvgpr_read_b32 v33, a9
    v_accvgpr_read_b32 v34, a10
    v_accvgpr_read_b32 v35, a11
    v_fma_f32 v32, -v88, v84, v32
    v_mul_f32 v32, v92, v32
    v_fma_f32 v33, -v88, v85, v33
    v_mul_f32 v33, v92, v33
    v_fma_f32 v34, -v88, v86, v34
    v_mul_f32 v34, v92, v34
    v_fma_f32 v35, -v88, v87, v35
    v_mul_f32 v35, v92, v35
    v_cvt_pk_bf16_f32 v48, v32, v33
    v_cvt_pk_bf16_f32 v49, v34, v35
    v_cmp_eq_u32 vcc, 1, v108
    s_nop 1
    v_cndmask_b32 v3, v112, v113, vcc
    v_add_u32 v3, v3, v105
    buffer_store_dwordx2 v[48:49], v3, s[20:23], 0 offen
    v_cndmask_b32 v64, 0, v102, vcc
    v_mov_b32 v65, 0
    v_cmp_eq_u32 vcc, 24, v111
    s_and_saveexec_b64 s[42:43], vcc
    buffer_store_dwordx2 v[64:65], v3, s[20:23], 0 offen offset:8
    s_mov_b64 exec, s[42:43]
    v_add_u32 v2, 16, v100
    v_lshrrev_b32 v5, 5, v2
    v_lshlrev_b32 v112, 11, v5
    v_and_b32 v5, 31, v2
    v_lshl_add_u32 v112, v5, 4, v112
    v_lshlrev_b32 v113, 6, v2
    v_accvgpr_read_b32 v32, a12
    v_accvgpr_read_b32 v33, a13
    v_accvgpr_read_b32 v34, a14
    v_accvgpr_read_b32 v35, a15
    v_fma_f32 v32, -v89, v76, v32
    v_mul_f32 v32, v93, v32
    v_fma_f32 v33, -v89, v77, v33
    v_mul_f32 v33, v93, v33
    v_fma_f32 v34, -v89, v78, v34
    v_mul_f32 v34, v93, v34
    v_fma_f32 v35, -v89, v79, v35
    v_mul_f32 v35, v93, v35
    v_cvt_pk_bf16_f32 v48, v32, v33
    v_cvt_pk_bf16_f32 v49, v34, v35
    v_cmp_eq_u32 vcc, 1, v106
    s_nop 1
    v_cndmask_b32 v3, v112, v113, vcc
    v_add_u32 v3, v3, v103
    buffer_store_dwordx2 v[48:49], v3, s[20:23], 0 offen
    v_cndmask_b32 v64, 0, v102, vcc
    v_mov_b32 v65, 0
    v_cmp_eq_u32 vcc, 24, v109
    s_and_saveexec_b64 s[42:43], vcc
    buffer_store_dwordx2 v[64:65], v3, s[20:23], 0 offen offset:8
    s_mov_b64 exec, s[42:43]
    v_accvgpr_read_b32 v32, a16
    v_accvgpr_read_b32 v33, a17
    v_accvgpr_read_b32 v34, a18
    v_accvgpr_read_b32 v35, a19
    v_fma_f32 v32, -v89, v80, v32
    v_mul_f32 v32, v93, v32
    v_fma_f32 v33, -v89, v81, v33
    v_mul_f32 v33, v93, v33
    v_fma_f32 v34, -v89, v82, v34
    v_mul_f32 v34, v93, v34
    v_fma_f32 v35, -v89, v83, v35
    v_mul_f32 v35, v93, v35
    v_cvt_pk_bf16_f32 v48, v32, v33
    v_cvt_pk_bf16_f32 v49, v34, v35
    v_cmp_eq_u32 vcc, 1, v107
    s_nop 1
    v_cndmask_b32 v3, v112, v113, vcc
    v_add_u32 v3, v3, v104
    buffer_store_dwordx2 v[48:49], v3, s[20:23], 0 offen
    v_cndmask_b32 v64, 0, v102, vcc
    v_mov_b32 v65, 0
    v_cmp_eq_u32 vcc, 24, v110
    s_and_saveexec_b64 s[42:43], vcc
    buffer_store_dwordx2 v[64:65], v3, s[20:23], 0 offen offset:8
    s_mov_b64 exec, s[42:43]
    v_accvgpr_read_b32 v32, a20
    v_accvgpr_read_b32 v33, a21
    v_accvgpr_read_b32 v34, a22
    v_accvgpr_read_b32 v35, a23
    v_fma_f32 v32, -v89, v84, v32
    v_mul_f32 v32, v93, v32
    v_fma_f32 v33, -v89, v85, v33
    v_mul_f32 v33, v93, v33
    v_fma_f32 v34, -v89, v86, v34
    v_mul_f32 v34, v93, v34
    v_fma_f32 v35, -v89, v87, v35
    v_mul_f32 v35, v93, v35
    v_cvt_pk_bf16_f32 v48, v32, v33
    v_cvt_pk_bf16_f32 v49, v34, v35
    v_cmp_eq_u32 vcc, 1, v108
    s_nop 1
    v_cndmask_b32 v3, v112, v113, vcc
    v_add_u32 v3, v3, v105
    buffer_store_dwordx2 v[48:49], v3, s[20:23], 0 offen
    v_cndmask_b32 v64, 0, v102, vcc
    v_mov_b32 v65, 0
    v_cmp_eq_u32 vcc, 24, v111
    s_and_saveexec_b64 s[42:43], vcc
    buffer_store_dwordx2 v[64:65], v3, s[20:23], 0 offen offset:8
    s_mov_b64 exec, s[42:43]
    v_add_u32 v2, 32, v100
    v_lshrrev_b32 v5, 5, v2
    v_lshlrev_b32 v112, 11, v5
    v_and_b32 v5, 31, v2
    v_lshl_add_u32 v112, v5, 4, v112
    v_lshlrev_b32 v113, 6, v2
    v_accvgpr_read_b32 v32, a24
    v_accvgpr_read_b32 v33, a25
    v_accvgpr_read_b32 v34, a26
    v_accvgpr_read_b32 v35, a27
    v_fma_f32 v32, -v90, v76, v32
    v_mul_f32 v32, v94, v32
    v_fma_f32 v33, -v90, v77, v33
    v_mul_f32 v33, v94, v33
    v_fma_f32 v34, -v90, v78, v34
    v_mul_f32 v34, v94, v34
    v_fma_f32 v35, -v90, v79, v35
    v_mul_f32 v35, v94, v35
    v_cvt_pk_bf16_f32 v48, v32, v33
    v_cvt_pk_bf16_f32 v49, v34, v35
    v_cmp_eq_u32 vcc, 1, v106
    s_nop 1
    v_cndmask_b32 v3, v112, v113, vcc
    v_add_u32 v3, v3, v103
    buffer_store_dwordx2 v[48:49], v3, s[20:23], 0 offen
    v_cndmask_b32 v64, 0, v102, vcc
    v_mov_b32 v65, 0
    v_cmp_eq_u32 vcc, 24, v109
    s_and_saveexec_b64 s[42:43], vcc
    buffer_store_dwordx2 v[64:65], v3, s[20:23], 0 offen offset:8
    s_mov_b64 exec, s[42:43]
    v_accvgpr_read_b32 v32, a28
    v_accvgpr_read_b32 v33, a29
    v_accvgpr_read_b32 v34, a30
    v_accvgpr_read_b32 v35, a31
    v_fma_f32 v32, -v90, v80, v32
    v_mul_f32 v32, v94, v32
    v_fma_f32 v33, -v90, v81, v33
    v_mul_f32 v33, v94, v33
    v_fma_f32 v34, -v90, v82, v34
    v_mul_f32 v34, v94, v34
    v_fma_f32 v35, -v90, v83, v35
    v_mul_f32 v35, v94, v35
    v_cvt_pk_bf16_f32 v48, v32, v33
    v_cvt_pk_bf16_f32 v49, v34, v35
    v_cmp_eq_u32 vcc, 1, v107
    s_nop 1
    v_cndmask_b32 v3, v112, v113, vcc
    v_add_u32 v3, v3, v104
    buffer_store_dwordx2 v[48:49], v3, s[20:23], 0 offen
    v_cndmask_b32 v64, 0, v102, vcc
    v_mov_b32 v65, 0
    v_cmp_eq_u32 vcc, 24, v110
    s_and_saveexec_b64 s[42:43], vcc
    buffer_store_dwordx2 v[64:65], v3, s[20:23], 0 offen offset:8
    s_mov_b64 exec, s[42:43]
    v_accvgpr_read_b32 v32, a32
    v_accvgpr_read_b32 v33, a33
    v_accvgpr_read_b32 v34, a34
    v_accvgpr_read_b32 v35, a35
    v_fma_f32 v32, -v90, v84, v32
    v_mul_f32 v32, v94, v32
    v_fma_f32 v33, -v90, v85, v33
    v_mul_f32 v33, v94, v33
    v_fma_f32 v34, -v90, v86, v34
    v_mul_f32 v34, v94, v34
    v_fma_f32 v35, -v90, v87, v35
    v_mul_f32 v35, v94, v35
    v_cvt_pk_bf16_f32 v48, v32, v33
    v_cvt_pk_bf16_f32 v49, v34, v35
    v_cmp_eq_u32 vcc, 1, v108
    s_nop 1
    v_cndmask_b32 v3, v112, v113, vcc
    v_add_u32 v3, v3, v105
    buffer_store_dwordx2 v[48:49], v3, s[20:23], 0 offen
    v_cndmask_b32 v64, 0, v102, vcc
    v_mov_b32 v65, 0
    v_cmp_eq_u32 vcc, 24, v111
    s_and_saveexec_b64 s[42:43], vcc
    buffer_store_dwordx2 v[64:65], v3, s[20:23], 0 offen offset:8
    s_mov_b64 exec, s[42:43]
    v_add_u32 v2, 48, v100
    v_lshrrev_b32 v5, 5, v2
    v_lshlrev_b32 v112, 11, v5
    v_and_b32 v5, 31, v2
    v_lshl_add_u32 v112, v5, 4, v112
    v_lshlrev_b32 v113, 6, v2
    v_accvgpr_read_b32 v32, a36
    v_accvgpr_read_b32 v33, a37
    v_accvgpr_read_b32 v34, a38
    v_accvgpr_read_b32 v35, a39
    v_fma_f32 v32, -v91, v76, v32
    v_mul_f32 v32, v95, v32
    v_fma_f32 v33, -v91, v77, v33
    v_mul_f32 v33, v95, v33
    v_fma_f32 v34, -v91, v78, v34
    v_mul_f32 v34, v95, v34
    v_fma_f32 v35, -v91, v79, v35
    v_mul_f32 v35, v95, v35
    v_cvt_pk_bf16_f32 v48, v32, v33
    v_cvt_pk_bf16_f32 v49, v34, v35
    v_cmp_eq_u32 vcc, 1, v106
    s_nop 1
    v_cndmask_b32 v3, v112, v113, vcc
    v_add_u32 v3, v3, v103
    buffer_store_dwordx2 v[48:49], v3, s[20:23], 0 offen
    v_cndmask_b32 v64, 0, v102, vcc
    v_mov_b32 v65, 0
    v_cmp_eq_u32 vcc, 24, v109
    s_and_saveexec_b64 s[42:43], vcc
    buffer_store_dwordx2 v[64:65], v3, s[20:23], 0 offen offset:8
    s_mov_b64 exec, s[42:43]
    v_accvgpr_read_b32 v32, a40
    v_accvgpr_read_b32 v33, a41
    v_accvgpr_read_b32 v34, a42
    v_accvgpr_read_b32 v35, a43
    v_fma_f32 v32, -v91, v80, v32
    v_mul_f32 v32, v95, v32
    v_fma_f32 v33, -v91, v81, v33
    v_mul_f32 v33, v95, v33
    v_fma_f32 v34, -v91, v82, v34
    v_mul_f32 v34, v95, v34
    v_fma_f32 v35, -v91, v83, v35
    v_mul_f32 v35, v95, v35
    v_cvt_pk_bf16_f32 v48, v32, v33
    v_cvt_pk_bf16_f32 v49, v34, v35
    v_cmp_eq_u32 vcc, 1, v107
    s_nop 1
    v_cndmask_b32 v3, v112, v113, vcc
    v_add_u32 v3, v3, v104
    buffer_store_dwordx2 v[48:49], v3, s[20:23], 0 offen
    v_cndmask_b32 v64, 0, v102, vcc
    v_mov_b32 v65, 0
    v_cmp_eq_u32 vcc, 24, v110
    s_and_saveexec_b64 s[42:43], vcc
    buffer_store_dwordx2 v[64:65], v3, s[20:23], 0 offen offset:8
    s_mov_b64 exec, s[42:43]
    v_accvgpr_read_b32 v32, a44
    v_accvgpr_read_b32 v33, a45
    v_accvgpr_read_b32 v34, a46
    v_accvgpr_read_b32 v35, a47
    v_fma_f32 v32, -v91, v84, v32
    v_mul_f32 v32, v95, v32
    v_fma_f32 v33, -v91, v85, v33
    v_mul_f32 v33, v95, v33
    v_fma_f32 v34, -v91, v86, v34
    v_mul_f32 v34, v95, v34
    v_fma_f32 v35, -v91, v87, v35
    v_mul_f32 v35, v95, v35
    v_cvt_pk_bf16_f32 v48, v32, v33
    v_cvt_pk_bf16_f32 v49, v34, v35
    v_cmp_eq_u32 vcc, 1, v108
    s_nop 1
    v_cndmask_b32 v3, v112, v113, vcc
    v_add_u32 v3, v3, v105
    buffer_store_dwordx2 v[48:49], v3, s[20:23], 0 offen
    v_cndmask_b32 v64, 0, v102, vcc
    v_mov_b32 v65, 0
    v_cmp_eq_u32 vcc, 24, v111
    s_and_saveexec_b64 s[42:43], vcc
    buffer_store_dwordx2 v[64:65], v3, s[20:23], 0 offen offset:8
    s_mov_b64 exec, s[42:43]
L_qkv0_kernel_end:
    s_endpgm
.globl attn_kernel
.p2align 8
.type attn_kernel,@function
attn_kernel:
    s_cmp_ge_u32 s2, 256
    s_cbranch_scc1 L_attn_kernel_end
    s_load_dwordx2 s[4:5], s[0:1], 72
    s_and_b32 s16, s2, 7
    s_lshl_b32 s16, s16, 1
    s_bfe_u32 s18, s2, 0x10003
    s_add_u32 s16, s16, s18
    s_lshr_b32 s18, s2, 4
    v_lshrrev_b32 v1, 6, v0
    s_nop 0
    v_readfirstlane_b32 s23, v1
    s_lshr_b32 s26, s23, 2
    s_and_b32 s23, s23, 3
    s_lshl_b32 s17, s18, 2
    s_add_u32 s17, s17, s23
    s_mov_b32 s22, 0x3e8b97f6
    s_waitcnt lgkmcnt(0)
    s_add_u32 s8, s4, 0x400000
    s_addc_u32 s9, s5, 0
    s_mov_b32 s10, 0x600000
    s_mov_b32 s11, 0x00020000
    s_add_u32 s12, s4, 0xa00000
    s_addc_u32 s13, s5, 0
    s_mov_b32 s14, 0x1c0000
    s_mov_b32 s15, 0x00020000
    v_and_b32 v6, 63, v0
    s_lshl_b32 s18, s16, 17
    s_lshl_b32 s19, s17, 11
    s_add_u32 s18, s18, s19
    v_lshlrev_b32 v1, 4, v6
    buffer_load_dwordx4 v[36:39], v1, s[8:11], s18 offen
    buffer_load_dwordx4 v[40:43], v1, s[8:11], s18 offen offset:1024
    v_and_b32 v1, 255, v0
    v_lshlrev_b32 v1, 4, v1
    v_lshrrev_b32 v2, 8, v0
    v_lshl_add_u32 v7, v2, 16, v1
    v_add_u32 v8, 4096, v7
    s_lshl_b32 s18, s26, 14
    v_lshlrev_b32 v9, 4, v6
    v_add_u32 v9, s18, v9
    v_add_u32 v10, 32768, v9
    v_add_u32 v11, 65536, v9
    v_add_u32 v12, 98304, v9
    v_bfe_u32 v1, v6, 5, 1
    v_bfe_u32 v2, v6, 2, 2
    v_lshl_add_u32 v1, v1, 2, v2
    v_lshlrev_b32 v1, 6, v1
    v_bfe_u32 v2, v6, 4, 1
    v_lshl_add_u32 v1, v2, 5, v1
    v_and_b32 v2, 3, v6
    v_lshl_add_u32 v1, v2, 3, v1
    v_add_u32 v1, s18, v1
    v_add_u32 v13, 8192, v1
    v_add_u32 v14, 40960, v1
    v_add_u32 v15, 73728, v1
    v_add_u32 v16, 106496, v1
    v_lshlrev_b32 v8, 4, v6
    s_lshl_b32 s27, s26, 16
    s_lshl_b32 s28, s23, 10
    s_add_u32 s27, s27, s28
    s_lshl_b32 s29, s26, 14
    s_add_u32 s29, s29, s28
    s_add_u32 s18, s16, 16
    s_lshl_b32 s19, s18, 17
    s_add_u32 s18, s16, 32
    s_lshl_b32 s20, s18, 17
    v_mov_b32 v124, 0xf149f2ca
    v_mov_b32 v100, 0
    v_mov_b32 v101, 0
    v_mov_b32 v102, 0
    v_mov_b32 v103, 0
    v_mov_b32 v104, 0
    v_mov_b32 v105, 0
    v_mov_b32 v106, 0
    v_mov_b32 v107, 0
    v_mov_b32 v108, 0
    v_mov_b32 v109, 0
    v_mov_b32 v110, 0
    v_mov_b32 v111, 0
    v_mov_b32 v112, 0
    v_mov_b32 v113, 0
    v_mov_b32 v114, 0
    v_mov_b32 v115, 0
    s_add_u32 s30, s19, s27
    s_add_u32 m0, s29, 0
    s_nop 0
    buffer_load_dwordx4 v8, s[8:11], s30 offen lds
    s_add_u32 s30, s19, s27
    s_add_u32 s30, s30, 4096
    s_add_u32 m0, s29, 4096
    s_nop 0
    buffer_load_dwordx4 v8, s[8:11], s30 offen lds
    s_add_u32 s30, s20, s27
    s_add_u32 m0, s29, 8192
    s_nop 0
    buffer_load_dwordx4 v8, s[8:11], s30 offen lds
    s_add_u32 s30, s20, s27
    s_add_u32 s30, s30, 4096
    s_add_u32 m0, s29, 12288
    s_nop 0
    buffer_load_dwordx4 v8, s[8:11], s30 offen lds
    s_add_u32 s19, s19, 8192
    s_add_u32 s20, s20, 8192
    s_add_u32 s30, s19, s27
    s_add_u32 m0, s29, 32768
    s_nop 0
    buffer_load_dwordx4 v8, s[8:11], s30 offen lds
    s_add_u32 s30, s19, s27
    s_add_u32 s30, s30, 4096
    s_add_u32 m0, s29, 36864
    s_nop 0
    buffer_load_dwordx4 v8, s[8:11], s30 offen lds
    s_add_u32 s30, s20, s27
    s_add_u32 m0, s29, 40960
    s_nop 0
    buffer_load_dwordx4 v8, s[8:11], s30 offen lds
    s_add_u32 s30, s20, s27
    s_add_u32 s30, s30, 4096
    s_add_u32 m0, s29, 45056
    s_nop 0
    buffer_load_dwordx4 v8, s[8:11], s30 offen lds
    s_add_u32 s19, s19, 8192
    s_add_u32 s20, s20, 8192
    s_add_u32 s30, s19, s27
    s_add_u32 m0, s29, 65536
    s_nop 0
    buffer_load_dwordx4 v8, s[8:11], s30 offen lds
    s_add_u32 s30, s19, s27
    s_add_u32 s30, s30, 4096
    s_add_u32 m0, s29, 69632
    s_nop 0
    buffer_load_dwordx4 v8, s[8:11], s30 offen lds
    s_add_u32 s30, s20, s27
    s_add_u32 m0, s29, 73728
    s_nop 0
    buffer_load_dwordx4 v8, s[8:11], s30 offen lds
    s_add_u32 s30, s20, s27
    s_add_u32 s30, s30, 4096
    s_add_u32 m0, s29, 77824
    s_nop 0
    buffer_load_dwordx4 v8, s[8:11], s30 offen lds
    s_add_u32 s19, s19, 8192
    s_add_u32 s20, s20, 8192
    s_mov_b32 s21, 0
L_attn_kernel_loop:
    s_waitcnt vmcnt(8)
    s_barrier
    s_add_u32 s30, s19, s27
    s_add_u32 m0, s29, 98304
    s_nop 0
    buffer_load_dwordx4 v8, s[8:11], s30 offen lds
    s_add_u32 s30, s19, s27
    s_add_u32 s30, s30, 4096
    s_add_u32 m0, s29, 102400
    s_nop 0
    buffer_load_dwordx4 v8, s[8:11], s30 offen lds
    s_add_u32 s30, s20, s27
    s_add_u32 m0, s29, 106496
    s_nop 0
    buffer_load_dwordx4 v8, s[8:11], s30 offen lds
    s_add_u32 s30, s20, s27
    s_add_u32 s30, s30, 4096
    s_add_u32 m0, s29, 110592
    s_nop 0
    buffer_load_dwordx4 v8, s[8:11], s30 offen lds
    s_add_u32 s19, s19, 8192
    s_add_u32 s20, s20, 8192
    ds_read_b128 v[44:47], v9 offset:0
    ds_read_b128 v[48:51], v9 offset:1024
    ds_read_b128 v[52:55], v9 offset:2048
    ds_read_b128 v[56:59], v9 offset:3072
    s_waitcnt lgkmcnt(2)
    v_mfma_f32_32x32x16_bf16 v[68:83], v[44:47], v[36:39], 0
    v_mfma_f32_32x32x16_bf16 v[68:83], v[48:51], v[40:43], v[68:83]
    ds_read_b64_tr_b16 v[60:61], v13 offset:0
    ds_read_b64_tr_b16 v[62:63], v13 offset:512
    ds_read_b64_tr_b16 v[64:65], v13 offset:1024
    ds_read_b64_tr_b16 v[66:67], v13 offset:1536
    s_waitcnt lgkmcnt(4)
    v_mfma_f32_32x32x16_bf16 v[84:99], v[52:55], v[36:39], 0
    v_mfma_f32_32x32x16_bf16 v[84:99], v[56:59], v[40:43], v[84:99]
    ds_read_b128 v[44:47], v9 offset:4096
    ds_read_b128 v[48:51], v9 offset:5120
    s_nop 2
    v_max3_f32 v125, v68, v69, v70
    v_max3_f32 v125, v125, v71, v72
    v_max3_f32 v125, v125, v73, v74
    v_max3_f32 v125, v125, v75, v76
    v_max3_f32 v125, v125, v77, v78
    v_max3_f32 v125, v125, v79, v80
    v_max3_f32 v125, v125, v81, v82
    v_max_f32 v125, v125, v83
    v_mov_b32 v126, v125
    s_nop 1
    v_permlane32_swap_b32 v125, v126
    v_max_f32 v125, v125, v126
    v_mul_f32 v125, s22, v125
    v_max_f32 v125, v125, v124
    v_sub_f32 v128, v124, v125
    v_exp_f32 v128, v128
    v_mov_b32 v124, v125
    v_fma_f32 v68, v68, s22, -v124
    v_exp_f32 v68, v68
    v_fma_f32 v69, v69, s22, -v124
    v_exp_f32 v69, v69
    v_fma_f32 v70, v70, s22, -v124
    v_exp_f32 v70, v70
    v_fma_f32 v71, v71, s22, -v124
    v_exp_f32 v71, v71
    v_fma_f32 v72, v72, s22, -v124
    v_exp_f32 v72, v72
    v_fma_f32 v73, v73, s22, -v124
    v_exp_f32 v73, v73
    v_fma_f32 v74, v74, s22, -v124
    v_exp_f32 v74, v74
    v_fma_f32 v75, v75, s22, -v124
    v_exp_f32 v75, v75
    v_fma_f32 v76, v76, s22, -v124
    v_exp_f32 v76, v76
    v_fma_f32 v77, v77, s22, -v124
    v_exp_f32 v77, v77
    v_fma_f32 v78, v78, s22, -v124
    v_exp_f32 v78, v78
    v_fma_f32 v79, v79, s22, -v124
    v_exp_f32 v79, v79
    v_fma_f32 v80, v80, s22, -v124
    v_exp_f32 v80, v80
    v_fma_f32 v81, v81, s22, -v124
    v_exp_f32 v81, v81
    v_fma_f32 v82, v82, s22, -v124
    v_exp_f32 v82, v82
    v_fma_f32 v83, v83, s22, -v124
    v_exp_f32 v83, v83
    v_mov_b32 v129, v128
    v_cvt_pk_bf16_f32 v116, v68, v69
    v_cvt_pk_bf16_f32 v117, v70, v71
    v_cvt_pk_bf16_f32 v118, v72, v73
    v_cvt_pk_bf16_f32 v119, v74, v75
    v_cvt_pk_bf16_f32 v120, v76, v77
    v_cvt_pk_bf16_f32 v121, v78, v79
    v_cvt_pk_bf16_f32 v122, v80, v81
    v_cvt_pk_bf16_f32 v123, v82, v83
    v_pk_mul_f32 v[100:101], v[100:101], v[128:129]
    v_pk_mul_f32 v[102:103], v[102:103], v[128:129]
    v_pk_mul_f32 v[104:105], v[104:105], v[128:129]
    v_pk_mul_f32 v[106:107], v[106:107], v[128:129]
    v_pk_mul_f32 v[108:109], v[108:109], v[128:129]
    v_pk_mul_f32 v[110:111], v[110:111], v[128:129]
    v_pk_mul_f32 v[112:113], v[112:113], v[128:129]
    v_pk_mul_f32 v[114:115], v[114:115], v[128:129]
    s_waitcnt lgkmcnt(2)
    s_nop 0
    v_mfma_f32_32x32x16_bf16 v[100:115], v[60:63], v[116:119], v[100:115]
    v_mfma_f32_32x32x16_bf16 v[100:115], v[64:67], v[120:123], v[100:115]
    ds_read_b64_tr_b16 v[60:61], v13 offset:2048
    ds_read_b64_tr_b16 v[62:63], v13 offset:2560
    ds_read_b64_tr_b16 v[64:65], v13 offset:3072
    ds_read_b64_tr_b16 v[66:67], v13 offset:3584
    s_waitcnt lgkmcnt(4)
    v_mfma_f32_32x32x16_bf16 v[68:83], v[44:47], v[36:39], 0
    v_mfma_f32_32x32x16_bf16 v[68:83], v[48:51], v[40:43], v[68:83]
    ds_read_b128 v[52:55], v9 offset:6144
    ds_read_b128 v[56:59], v9 offset:7168
    v_max3_f32 v125, v84, v85, v86
    v_max3_f32 v125, v125, v87, v88
    v_max3_f32 v125, v125, v89, v90
    v_max3_f32 v125, v125, v91, v92
    v_max3_f32 v125, v125, v93, v94
    v_max3_f32 v125, v125, v95, v96
    v_max3_f32 v125, v125, v97, v98
    v_max_f32 v125, v125, v99
    v_mov_b32 v126, v125
    s_nop 1
    v_permlane32_swap_b32 v125, v126
    v_max_f32 v125, v125, v126
    v_mul_f32 v125, s22, v125
    v_max_f32 v125, v125, v124
    v_sub_f32 v128, v124, v125
    v_exp_f32 v128, v128
    v_mov_b32 v124, v125
    v_fma_f32 v84, v84, s22, -v124
    v_exp_f32 v84, v84
    v_fma_f32 v85, v85, s22, -v124
    v_exp_f32 v85, v85
    v_fma_f32 v86, v86, s22, -v124
    v_exp_f32 v86, v86
    v_fma_f32 v87, v87, s22, -v124
    v_exp_f32 v87, v87
    v_fma_f32 v88, v88, s22, -v124
    v_exp_f32 v88, v88
    v_fma_f32 v89, v89, s22, -v124
    v_exp_f32 v89, v89
    v_fma_f32 v90, v90, s22, -v124
    v_exp_f32 v90, v90
    v_fma_f32 v91, v91, s22, -v124
    v_exp_f32 v91, v91
    v_fma_f32 v92, v92, s22, -v124
    v_exp_f32 v92, v92
    v_fma_f32 v93, v93, s22, -v124
    v_exp_f32 v93, v93
    v_fma_f32 v94, v94, s22, -v124
    v_exp_f32 v94, v94
    v_fma_f32 v95, v95, s22, -v124
    v_exp_f32 v95, v95
    v_fma_f32 v96, v96, s22, -v124
    v_exp_f32 v96, v96
    v_fma_f32 v97, v97, s22, -v124
    v_exp_f32 v97, v97
    v_fma_f32 v98, v98, s22, -v124
    v_exp_f32 v98, v98
    v_fma_f32 v99, v99, s22, -v124
    v_exp_f32 v99, v99
    v_mov_b32 v129, v128
    v_cvt_pk_bf16_f32 v116, v84, v85
    v_cvt_pk_bf16_f32 v117, v86, v87
    v_cvt_pk_bf16_f32 v118, v88, v89
    v_cvt_pk_bf16_f32 v119, v90, v91
    v_cvt_pk_bf16_f32 v120, v92, v93
    v_cvt_pk_bf16_f32 v121, v94, v95
    v_cvt_pk_bf16_f32 v122, v96, v97
    v_cvt_pk_bf16_f32 v123, v98, v99
    v_pk_mul_f32 v[100:101], v[100:101], v[128:129]
    v_pk_mul_f32 v[102:103], v[102:103], v[128:129]
    v_pk_mul_f32 v[104:105], v[104:105], v[128:129]
    v_pk_mul_f32 v[106:107], v[106:107], v[128:129]
    v_pk_mul_f32 v[108:109], v[108:109], v[128:129]
    v_pk_mul_f32 v[110:111], v[110:111], v[128:129]
    v_pk_mul_f32 v[112:113], v[112:113], v[128:129]
    v_pk_mul_f32 v[114:115], v[114:115], v[128:129]
    s_waitcnt lgkmcnt(2)
    s_nop 0
    v_mfma_f32_32x32x16_bf16 v[100:115], v[60:63], v[116:119], v[100:115]
    v_mfma_f32_32x32x16_bf16 v[100:115], v[64:67], v[120:123], v[100:115]
    ds_read_b64_tr_b16 v[60:61], v13 offset:4096
    ds_read_b64_tr_b16 v[62:63], v13 offset:4608
    ds_read_b64_tr_b16 v[64:65], v13 offset:5120
    ds_read_b64_tr_b16 v[66:67], v13 offset:5632
    s_waitcnt lgkmcnt(4)
    v_mfma_f32_32x32x16_bf16 v[84:99], v[52:55], v[36:39], 0
    v_mfma_f32_32x32x16_bf16 v[84:99], v[56:59], v[40:43], v[84:99]
    v_max3_f32 v125, v68, v69, v70
    v_max3_f32 v125, v125, v71, v72
    v_max3_f32 v125, v125, v73, v74
    v_max3_f32 v125, v125, v75, v76
    v_max3_f32 v125, v125, v77, v78
    v_max3_f32 v125, v125, v79, v80
    v_max3_f32 v125, v125, v81, v82
    v_max_f32 v125, v125, v83
    v_mov_b32 v126, v125
    s_nop 1
    v_permlane32_swap_b32 v125, v126
    v_max_f32 v125, v125, v126
    v_mul_f32 v125, s22, v125
    v_max_f32 v125, v125, v124
    v_sub_f32 v128, v124, v125
    v_exp_f32 v128, v128
    v_mov_b32 v124, v125
    v_fma_f32 v68, v68, s22, -v124
    v_exp_f32 v68, v68
    v_fma_f32 v69, v69, s22, -v124
    v_exp_f32 v69, v69
    v_fma_f32 v70, v70, s22, -v124
    v_exp_f32 v70, v70
    v_fma_f32 v71, v71, s22, -v124
    v_exp_f32 v71, v71
    v_fma_f32 v72, v72, s22, -v124
    v_exp_f32 v72, v72
    v_fma_f32 v73, v73, s22, -v124
    v_exp_f32 v73, v73
    v_fma_f32 v74, v74, s22, -v124
    v_exp_f32 v74, v74
    v_fma_f32 v75, v75, s22, -v124
    v_exp_f32 v75, v75
    v_fma_f32 v76, v76, s22, -v124
    v_exp_f32 v76, v76
    v_fma_f32 v77, v77, s22, -v124
    v_exp_f32 v77, v77
    v_fma_f32 v78, v78, s22, -v124
    v_exp_f32 v78, v78
    v_fma_f32 v79, v79, s22, -v124
    v_exp_f32 v79, v79
    v_fma_f32 v80, v80, s22, -v124
    v_exp_f32 v80, v80
    v_fma_f32 v81, v81, s22, -v124
    v_exp_f32 v81, v81
    v_fma_f32 v82, v82, s22, -v124
    v_exp_f32 v82, v82
    v_fma_f32 v83, v83, s22, -v124
    v_exp_f32 v83, v83
    v_mov_b32 v129, v128
    v_cvt_pk_bf16_f32 v116, v68, v69
    v_cvt_pk_bf16_f32 v117, v70, v71
    v_cvt_pk_bf16_f32 v118, v72, v73
    v_cvt_pk_bf16_f32 v119, v74, v75
    v_cvt_pk_bf16_f32 v120, v76, v77
    v_cvt_pk_bf16_f32 v121, v78, v79
    v_cvt_pk_bf16_f32 v122, v80, v81
    v_cvt_pk_bf16_f32 v123, v82, v83
    v_pk_mul_f32 v[100:101], v[100:101], v[128:129]
    v_pk_mul_f32 v[102:103], v[102:103], v[128:129]
    v_pk_mul_f32 v[104:105], v[104:105], v[128:129]
    v_pk_mul_f32 v[106:107], v[106:107], v[128:129]
    v_pk_mul_f32 v[108:109], v[108:109], v[128:129]
    v_pk_mul_f32 v[110:111], v[110:111], v[128:129]
    v_pk_mul_f32 v[112:113], v[112:113], v[128:129]
    v_pk_mul_f32 v[114:115], v[114:115], v[128:129]
    s_waitcnt lgkmcnt(0)
    s_nop 0
    v_mfma_f32_32x32x16_bf16 v[100:115], v[60:63], v[116:119], v[100:115]
    v_mfma_f32_32x32x16_bf16 v[100:115], v[64:67], v[120:123], v[100:115]
    ds_read_b64_tr_b16 v[60:61], v13 offset:6144
    ds_read_b64_tr_b16 v[62:63], v13 offset:6656
    ds_read_b64_tr_b16 v[64:65], v13 offset:7168
    ds_read_b64_tr_b16 v[66:67], v13 offset:7680
    v_max3_f32 v125, v84, v85, v86
    v_max3_f32 v125, v125, v87, v88
    v_max3_f32 v125, v125, v89, v90
    v_max3_f32 v125, v125, v91, v92
    v_max3_f32 v125, v125, v93, v94
    v_max3_f32 v125, v125, v95, v96
    v_max3_f32 v125, v125, v97, v98
    v_max_f32 v125, v125, v99
    v_mov_b32 v126, v125
    s_nop 1
    v_permlane32_swap_b32 v125, v126
    v_max_f32 v125, v125, v126
    v_mul_f32 v125, s22, v125
    v_max_f32 v125, v125, v124
    v_sub_f32 v128, v124, v125
    v_exp_f32 v128, v128
    v_mov_b32 v124, v125
    v_fma_f32 v84, v84, s22, -v124
    v_exp_f32 v84, v84
    v_fma_f32 v85, v85, s22, -v124
    v_exp_f32 v85, v85
    v_fma_f32 v86, v86, s22, -v124
    v_exp_f32 v86, v86
    v_fma_f32 v87, v87, s22, -v124
    v_exp_f32 v87, v87
    v_fma_f32 v88, v88, s22, -v124
    v_exp_f32 v88, v88
    v_fma_f32 v89, v89, s22, -v124
    v_exp_f32 v89, v89
    v_fma_f32 v90, v90, s22, -v124
    v_exp_f32 v90, v90
    v_fma_f32 v91, v91, s22, -v124
    v_exp_f32 v91, v91
    v_fma_f32 v92, v92, s22, -v124
    v_exp_f32 v92, v92
    v_fma_f32 v93, v93, s22, -v124
    v_exp_f32 v93, v93
    v_fma_f32 v94, v94, s22, -v124
    v_exp_f32 v94, v94
    v_fma_f32 v95, v95, s22, -v124
    v_exp_f32 v95, v95
    v_fma_f32 v96, v96, s22, -v124
    v_exp_f32 v96, v96
    v_fma_f32 v97, v97, s22, -v124
    v_exp_f32 v97, v97
    v_fma_f32 v98, v98, s22, -v124
    v_exp_f32 v98, v98
    v_fma_f32 v99, v99, s22, -v124
    v_exp_f32 v99, v99
    v_mov_b32 v129, v128
    v_cvt_pk_bf16_f32 v116, v84, v85
    v_cvt_pk_bf16_f32 v117, v86, v87
    v_cvt_pk_bf16_f32 v118, v88, v89
    v_cvt_pk_bf16_f32 v119, v90, v91
    v_cvt_pk_bf16_f32 v120, v92, v93
    v_cvt_pk_bf16_f32 v121, v94, v95
    v_cvt_pk_bf16_f32 v122, v96, v97
    v_cvt_pk_bf16_f32 v123, v98, v99
    v_pk_mul_f32 v[100:101], v[100:101], v[128:129]
    v_pk_mul_f32 v[102:103], v[102:103], v[128:129]
    v_pk_mul_f32 v[104:105], v[104:105], v[128:129]
    v_pk_mul_f32 v[106:107], v[106:107], v[128:129]
    v_pk_mul_f32 v[108:109], v[108:109], v[128:129]
    v_pk_mul_f32 v[110:111], v[110:111], v[128:129]
    v_pk_mul_f32 v[112:113], v[112:113], v[128:129]
    v_pk_mul_f32 v[114:115], v[114:115], v[128:129]
    s_waitcnt lgkmcnt(0)
    s_nop 0
    v_mfma_f32_32x32x16_bf16 v[100:115], v[60:63], v[116:119], v[100:115]
    v_mfma_f32_32x32x16_bf16 v[100:115], v[64:67], v[120:123], v[100:115]
    s_waitcnt vmcnt(8)
    s_barrier
    s_add_u32 s30, s19, s27
    s_add_u32 m0, s29, 0
    s_nop 0
    buffer_load_dwordx4 v8, s[8:11], s30 offen lds
    s_add_u32 s30, s19, s27
    s_add_u32 s30, s30, 4096
    s_add_u32 m0, s29, 4096
    s_nop 0
    buffer_load_dwordx4 v8, s[8:11], s30 offen lds
    s_add_u32 s30, s20, s27
    s_add_u32 m0, s29, 8192
    s_nop 0
    buffer_load_dwordx4 v8, s[8:11], s30 offen lds
    s_add_u32 s30, s20, s27
    s_add_u32 s30, s30, 4096
    s_add_u32 m0, s29, 12288
    s_nop 0
    buffer_load_dwordx4 v8, s[8:11], s30 offen lds
    s_add_u32 s19, s19, 8192
    s_add_u32 s20, s20, 8192
    ds_read_b128 v[44:47], v10 offset:0
    ds_read_b128 v[48:51], v10 offset:1024
    ds_read_b128 v[52:55], v10 offset:2048
    ds_read_b128 v[56:59], v10 offset:3072
    s_waitcnt lgkmcnt(2)
    v_mfma_f32_32x32x16_bf16 v[68:83], v[44:47], v[36:39], 0
    v_mfma_f32_32x32x16_bf16 v[68:83], v[48:51], v[40:43], v[68:83]
    ds_read_b64_tr_b16 v[60:61], v14 offset:0
    ds_read_b64_tr_b16 v[62:63], v14 offset:512
    ds_read_b64_tr_b16 v[64:65], v14 offset:1024
    ds_read_b64_tr_b16 v[66:67], v14 offset:1536
    s_waitcnt lgkmcnt(4)
    v_mfma_f32_32x32x16_bf16 v[84:99], v[52:55], v[36:39], 0
    v_mfma_f32_32x32x16_bf16 v[84:99], v[56:59], v[40:43], v[84:99]
    ds_read_b128 v[44:47], v10 offset:4096
    ds_read_b128 v[48:51], v10 offset:5120
    s_nop 2
    v_max3_f32 v125, v68, v69, v70
    v_max3_f32 v125, v125, v71, v72
    v_max3_f32 v125, v125, v73, v74
    v_max3_f32 v125, v125, v75, v76
    v_max3_f32 v125, v125, v77, v78
    v_max3_f32 v125, v125, v79, v80
    v_max3_f32 v125, v125, v81, v82
    v_max_f32 v125, v125, v83
    v_mov_b32 v126, v125
    s_nop 1
    v_permlane32_swap_b32 v125, v126
    v_max_f32 v125, v125, v126
    v_mul_f32 v125, s22, v125
    v_max_f32 v125, v125, v124
    v_sub_f32 v128, v124, v125
    v_exp_f32 v128, v128
    v_mov_b32 v124, v125
    v_fma_f32 v68, v68, s22, -v124
    v_exp_f32 v68, v68
    v_fma_f32 v69, v69, s22, -v124
    v_exp_f32 v69, v69
    v_fma_f32 v70, v70, s22, -v124
    v_exp_f32 v70, v70
    v_fma_f32 v71, v71, s22, -v124
    v_exp_f32 v71, v71
    v_fma_f32 v72, v72, s22, -v124
    v_exp_f32 v72, v72
    v_fma_f32 v73, v73, s22, -v124
    v_exp_f32 v73, v73
    v_fma_f32 v74, v74, s22, -v124
    v_exp_f32 v74, v74
    v_fma_f32 v75, v75, s22, -v124
    v_exp_f32 v75, v75
    v_fma_f32 v76, v76, s22, -v124
    v_exp_f32 v76, v76
    v_fma_f32 v77, v77, s22, -v124
    v_exp_f32 v77, v77
    v_fma_f32 v78, v78, s22, -v124
    v_exp_f32 v78, v78
    v_fma_f32 v79, v79, s22, -v124
    v_exp_f32 v79, v79
    v_fma_f32 v80, v80, s22, -v124
    v_exp_f32 v80, v80
    v_fma_f32 v81, v81, s22, -v124
    v_exp_f32 v81, v81
    v_fma_f32 v82, v82, s22, -v124
    v_exp_f32 v82, v82
    v_fma_f32 v83, v83, s22, -v124
    v_exp_f32 v83, v83
    v_mov_b32 v129, v128
    v_cvt_pk_bf16_f32 v116, v68, v69
    v_cvt_pk_bf16_f32 v117, v70, v71
    v_cvt_pk_bf16_f32 v118, v72, v73
    v_cvt_pk_bf16_f32 v119, v74, v75
    v_cvt_pk_bf16_f32 v120, v76, v77
    v_cvt_pk_bf16_f32 v121, v78, v79
    v_cvt_pk_bf16_f32 v122, v80, v81
    v_cvt_pk_bf16_f32 v123, v82, v83
    v_pk_mul_f32 v[100:101], v[100:101], v[128:129]
    v_pk_mul_f32 v[102:103], v[102:103], v[128:129]
    v_pk_mul_f32 v[104:105], v[104:105], v[128:129]
    v_pk_mul_f32 v[106:107], v[106:107], v[128:129]
    v_pk_mul_f32 v[108:109], v[108:109], v[128:129]
    v_pk_mul_f32 v[110:111], v[110:111], v[128:129]
    v_pk_mul_f32 v[112:113], v[112:113], v[128:129]
    v_pk_mul_f32 v[114:115], v[114:115], v[128:129]
    s_waitcnt lgkmcnt(2)
    s_nop 0
    v_mfma_f32_32x32x16_bf16 v[100:115], v[60:63], v[116:119], v[100:115]
    v_mfma_f32_32x32x16_bf16 v[100:115], v[64:67], v[120:123], v[100:115]
    ds_read_b64_tr_b16 v[60:61], v14 offset:2048
    ds_read_b64_tr_b16 v[62:63], v14 offset:2560
    ds_read_b64_tr_b16 v[64:65], v14 offset:3072
    ds_read_b64_tr_b16 v[66:67], v14 offset:3584
    s_waitcnt lgkmcnt(4)
    v_mfma_f32_32x32x16_bf16 v[68:83], v[44:47], v[36:39], 0
    v_mfma_f32_32x32x16_bf16 v[68:83], v[48:51], v[40:43], v[68:83]
    ds_read_b128 v[52:55], v10 offset:6144
    ds_read_b128 v[56:59], v10 offset:7168
    v_max3_f32 v125, v84, v85, v86
    v_max3_f32 v125, v125, v87, v88
    v_max3_f32 v125, v125, v89, v90
    v_max3_f32 v125, v125, v91, v92
    v_max3_f32 v125, v125, v93, v94
    v_max3_f32 v125, v125, v95, v96
    v_max3_f32 v125, v125, v97, v98
    v_max_f32 v125, v125, v99
    v_mov_b32 v126, v125
    s_nop 1
    v_permlane32_swap_b32 v125, v126
    v_max_f32 v125, v125, v126
    v_mul_f32 v125, s22, v125
    v_max_f32 v125, v125, v124
    v_sub_f32 v128, v124, v125
    v_exp_f32 v128, v128
    v_mov_b32 v124, v125
    v_fma_f32 v84, v84, s22, -v124
    v_exp_f32 v84, v84
    v_fma_f32 v85, v85, s22, -v124
    v_exp_f32 v85, v85
    v_fma_f32 v86, v86, s22, -v124
    v_exp_f32 v86, v86
    v_fma_f32 v87, v87, s22, -v124
    v_exp_f32 v87, v87
    v_fma_f32 v88, v88, s22, -v124
    v_exp_f32 v88, v88
    v_fma_f32 v89, v89, s22, -v124
    v_exp_f32 v89, v89
    v_fma_f32 v90, v90, s22, -v124
    v_exp_f32 v90, v90
    v_fma_f32 v91, v91, s22, -v124
    v_exp_f32 v91, v91
    v_fma_f32 v92, v92, s22, -v124
    v_exp_f32 v92, v92
    v_fma_f32 v93, v93, s22, -v124
    v_exp_f32 v93, v93
    v_fma_f32 v94, v94, s22, -v124
    v_exp_f32 v94, v94
    v_fma_f32 v95, v95, s22, -v124
    v_exp_f32 v95, v95
    v_fma_f32 v96, v96, s22, -v124
    v_exp_f32 v96, v96
    v_fma_f32 v97, v97, s22, -v124
    v_exp_f32 v97, v97
    v_fma_f32 v98, v98, s22, -v124
    v_exp_f32 v98, v98
    v_fma_f32 v99, v99, s22, -v124
    v_exp_f32 v99, v99
    v_mov_b32 v129, v128
    v_cvt_pk_bf16_f32 v116, v84, v85
    v_cvt_pk_bf16_f32 v117, v86, v87
    v_cvt_pk_bf16_f32 v118, v88, v89
    v_cvt_pk_bf16_f32 v119, v90, v91
    v_cvt_pk_bf16_f32 v120, v92, v93
    v_cvt_pk_bf16_f32 v121, v94, v95
    v_cvt_pk_bf16_f32 v122, v96, v97
    v_cvt_pk_bf16_f32 v123, v98, v99
    v_pk_mul_f32 v[100:101], v[100:101], v[128:129]
    v_pk_mul_f32 v[102:103], v[102:103], v[128:129]
    v_pk_mul_f32 v[104:105], v[104:105], v[128:129]
    v_pk_mul_f32 v[106:107], v[106:107], v[128:129]
    v_pk_mul_f32 v[108:109], v[108:109], v[128:129]
    v_pk_mul_f32 v[110:111], v[110:111], v[128:129]
    v_pk_mul_f32 v[112:113], v[112:113], v[128:129]
    v_pk_mul_f32 v[114:115], v[114:115], v[128:129]
    s_waitcnt lgkmcnt(2)
    s_nop 0
    v_mfma_f32_32x32x16_bf16 v[100:115], v[60:63], v[116:119], v[100:115]
    v_mfma_f32_32x32x16_bf16 v[100:115], v[64:67], v[120:123], v[100:115]
    ds_read_b64_tr_b16 v[60:61], v14 offset:4096
    ds_read_b64_tr_b16 v[62:63], v14 offset:4608
    ds_read_b64_tr_b16 v[64:65], v14 offset:5120
    ds_read_b64_tr_b16 v[66:67], v14 offset:5632
    s_waitcnt lgkmcnt(4)
    v_mfma_f32_32x32x16_bf16 v[84:99], v[52:55], v[36:39], 0
    v_mfma_f32_32x32x16_bf16 v[84:99], v[56:59], v[40:43], v[84:99]
    v_max3_f32 v125, v68, v69, v70
    v_max3_f32 v125, v125, v71, v72
    v_max3_f32 v125, v125, v73, v74
    v_max3_f32 v125, v125, v75, v76
    v_max3_f32 v125, v125, v77, v78
    v_max3_f32 v125, v125, v79, v80
    v_max3_f32 v125, v125, v81, v82
    v_max_f32 v125, v125, v83
    v_mov_b32 v126, v125
    s_nop 1
    v_permlane32_swap_b32 v125, v126
    v_max_f32 v125, v125, v126
    v_mul_f32 v125, s22, v125
    v_max_f32 v125, v125, v124
    v_sub_f32 v128, v124, v125
    v_exp_f32 v128, v128
    v_mov_b32 v124, v125
    v_fma_f32 v68, v68, s22, -v124
    v_exp_f32 v68, v68
    v_fma_f32 v69, v69, s22, -v124
    v_exp_f32 v69, v69
    v_fma_f32 v70, v70, s22, -v124
    v_exp_f32 v70, v70
    v_fma_f32 v71, v71, s22, -v124
    v_exp_f32 v71, v71
    v_fma_f32 v72, v72, s22, -v124
    v_exp_f32 v72, v72
    v_fma_f32 v73, v73, s22, -v124
    v_exp_f32 v73, v73
    v_fma_f32 v74, v74, s22, -v124
    v_exp_f32 v74, v74
    v_fma_f32 v75, v75, s22, -v124
    v_exp_f32 v75, v75
    v_fma_f32 v76, v76, s22, -v124
    v_exp_f32 v76, v76
    v_fma_f32 v77, v77, s22, -v124
    v_exp_f32 v77, v77
    v_fma_f32 v78, v78, s22, -v124
    v_exp_f32 v78, v78
    v_fma_f32 v79, v79, s22, -v124
    v_exp_f32 v79, v79
    v_fma_f32 v80, v80, s22, -v124
    v_exp_f32 v80, v80
    v_fma_f32 v81, v81, s22, -v124
    v_exp_f32 v81, v81
    v_fma_f32 v82, v82, s22, -v124
    v_exp_f32 v82, v82
    v_fma_f32 v83, v83, s22, -v124
    v_exp_f32 v83, v83
    v_mov_b32 v129, v128
    v_cvt_pk_bf16_f32 v116, v68, v69
    v_cvt_pk_bf16_f32 v117, v70, v71
    v_cvt_pk_bf16_f32 v118, v72, v73
    v_cvt_pk_bf16_f32 v119, v74, v75
    v_cvt_pk_bf16_f32 v120, v76, v77
    v_cvt_pk_bf16_f32 v121, v78, v79
    v_cvt_pk_bf16_f32 v122, v80, v81
    v_cvt_pk_bf16_f32 v123, v82, v83
    v_pk_mul_f32 v[100:101], v[100:101], v[128:129]
    v_pk_mul_f32 v[102:103], v[102:103], v[128:129]
    v_pk_mul_f32 v[104:105], v[104:105], v[128:129]
    v_pk_mul_f32 v[106:107], v[106:107], v[128:129]
    v_pk_mul_f32 v[108:109], v[108:109], v[128:129]
    v_pk_mul_f32 v[110:111], v[110:111], v[128:129]
    v_pk_mul_f32 v[112:113], v[112:113], v[128:129]
    v_pk_mul_f32 v[114:115], v[114:115], v[128:129]
    s_waitcnt lgkmcnt(0)
    s_nop 0
    v_mfma_f32_32x32x16_bf16 v[100:115], v[60:63], v[116:119], v[100:115]
    v_mfma_f32_32x32x16_bf16 v[100:115], v[64:67], v[120:123], v[100:115]
    ds_read_b64_tr_b16 v[60:61], v14 offset:6144
    ds_read_b64_tr_b16 v[62:63], v14 offset:6656
    ds_read_b64_tr_b16 v[64:65], v14 offset:7168
    ds_read_b64_tr_b16 v[66:67], v14 offset:7680
    v_max3_f32 v125, v84, v85, v86
    v_max3_f32 v125, v125, v87, v88
    v_max3_f32 v125, v125, v89, v90
    v_max3_f32 v125, v125, v91, v92
    v_max3_f32 v125, v125, v93, v94
    v_max3_f32 v125, v125, v95, v96
    v_max3_f32 v125, v125, v97, v98
    v_max_f32 v125, v125, v99
    v_mov_b32 v126, v125
    s_nop 1
    v_permlane32_swap_b32 v125, v126
    v_max_f32 v125, v125, v126
    v_mul_f32 v125, s22, v125
    v_max_f32 v125, v125, v124
    v_sub_f32 v128, v124, v125
    v_exp_f32 v128, v128
    v_mov_b32 v124, v125
    v_fma_f32 v84, v84, s22, -v124
    v_exp_f32 v84, v84
    v_fma_f32 v85, v85, s22, -v124
    v_exp_f32 v85, v85
    v_fma_f32 v86, v86, s22, -v124
    v_exp_f32 v86, v86
    v_fma_f32 v87, v87, s22, -v124
    v_exp_f32 v87, v87
    v_fma_f32 v88, v88, s22, -v124
    v_exp_f32 v88, v88
    v_fma_f32 v89, v89, s22, -v124
    v_exp_f32 v89, v89
    v_fma_f32 v90, v90, s22, -v124
    v_exp_f32 v90, v90
    v_fma_f32 v91, v91, s22, -v124
    v_exp_f32 v91, v91
    v_fma_f32 v92, v92, s22, -v124
    v_exp_f32 v92, v92
    v_fma_f32 v93, v93, s22, -v124
    v_exp_f32 v93, v93
    v_fma_f32 v94, v94, s22, -v124
    v_exp_f32 v94, v94
    v_fma_f32 v95, v95, s22, -v124
    v_exp_f32 v95, v95
    v_fma_f32 v96, v96, s22, -v124
    v_exp_f32 v96, v96
    v_fma_f32 v97, v97, s22, -v124
    v_exp_f32 v97, v97
    v_fma_f32 v98, v98, s22, -v124
    v_exp_f32 v98, v98
    v_fma_f32 v99, v99, s22, -v124
    v_exp_f32 v99, v99
    v_mov_b32 v129, v128
    v_cvt_pk_bf16_f32 v116, v84, v85
    v_cvt_pk_bf16_f32 v117, v86, v87
    v_cvt_pk_bf16_f32 v118, v88, v89
    v_cvt_pk_bf16_f32 v119, v90, v91
    v_cvt_pk_bf16_f32 v120, v92, v93
    v_cvt_pk_bf16_f32 v121, v94, v95
    v_cvt_pk_bf16_f32 v122, v96, v97
    v_cvt_pk_bf16_f32 v123, v98, v99
    v_pk_mul_f32 v[100:101], v[100:101], v[128:129]
    v_pk_mul_f32 v[102:103], v[102:103], v[128:129]
    v_pk_mul_f32 v[104:105], v[104:105], v[128:129]
    v_pk_mul_f32 v[106:107], v[106:107], v[128:129]
    v_pk_mul_f32 v[108:109], v[108:109], v[128:129]
    v_pk_mul_f32 v[110:111], v[110:111], v[128:129]
    v_pk_mul_f32 v[112:113], v[112:113], v[128:129]
    v_pk_mul_f32 v[114:115], v[114:115], v[128:129]
    s_waitcnt lgkmcnt(0)
    s_nop 0
    v_mfma_f32_32x32x16_bf16 v[100:115], v[60:63], v[116:119], v[100:115]
    v_mfma_f32_32x32x16_bf16 v[100:115], v[64:67], v[120:123], v[100:115]
    s_waitcnt vmcnt(8)
    s_barrier
    s_add_u32 s30, s19, s27
    s_add_u32 m0, s29, 32768
    s_nop 0
    buffer_load_dwordx4 v8, s[8:11], s30 offen lds
    s_add_u32 s30, s19, s27
    s_add_u32 s30, s30, 4096
    s_add_u32 m0, s29, 36864
    s_nop 0
    buffer_load_dwordx4 v8, s[8:11], s30 offen lds
    s_add_u32 s30, s20, s27
    s_add_u32 m0, s29, 40960
    s_nop 0
    buffer_load_dwordx4 v8, s[8:11], s30 offen lds
    s_add_u32 s30, s20, s27
    s_add_u32 s30, s30, 4096
    s_add_u32 m0, s29, 45056
    s_nop 0
    buffer_load_dwordx4 v8, s[8:11], s30 offen lds
    s_add_u32 s19, s19, 8192
    s_add_u32 s20, s20, 8192
    ds_read_b128 v[44:47], v11 offset:0
    ds_read_b128 v[48:51], v11 offset:1024
    ds_read_b128 v[52:55], v11 offset:2048
    ds_read_b128 v[56:59], v11 offset:3072
    s_waitcnt lgkmcnt(2)
    v_mfma_f32_32x32x16_bf16 v[68:83], v[44:47], v[36:39], 0
    v_mfma_f32_32x32x16_bf16 v[68:83], v[48:51], v[40:43], v[68:83]
    ds_read_b64_tr_b16 v[60:61], v15 offset:0
    ds_read_b64_tr_b16 v[62:63], v15 offset:512
    ds_read_b64_tr_b16 v[64:65], v15 offset:1024
    ds_read_b64_tr_b16 v[66:67], v15 offset:1536
    s_waitcnt lgkmcnt(4)
    v_mfma_f32_32x32x16_bf16 v[84:99], v[52:55], v[36:39], 0
    v_mfma_f32_32x32x16_bf16 v[84:99], v[56:59], v[40:43], v[84:99]
    ds_read_b128 v[44:47], v11 offset:4096
    ds_read_b128 v[48:51], v11 offset:5120
    s_nop 2
    v_max3_f32 v125, v68, v69, v70
    v_max3_f32 v125, v125, v71, v72
    v_max3_f32 v125, v125, v73, v74
    v_max3_f32 v125, v125, v75, v76
    v_max3_f32 v125, v125, v77, v78
    v_max3_f32 v125, v125, v79, v80
    v_max3_f32 v125, v125, v81, v82
    v_max_f32 v125, v125, v83
    v_mov_b32 v126, v125
    s_nop 1
    v_permlane32_swap_b32 v125, v126
    v_max_f32 v125, v125, v126
    v_mul_f32 v125, s22, v125
    v_max_f32 v125, v125, v124
    v_sub_f32 v128, v124, v125
    v_exp_f32 v128, v128
    v_mov_b32 v124, v125
    v_fma_f32 v68, v68, s22, -v124
    v_exp_f32 v68, v68
    v_fma_f32 v69, v69, s22, -v124
    v_exp_f32 v69, v69
    v_fma_f32 v70, v70, s22, -v124
    v_exp_f32 v70, v70
    v_fma_f32 v71, v71, s22, -v124
    v_exp_f32 v71, v71
    v_fma_f32 v72, v72, s22, -v124
    v_exp_f32 v72, v72
    v_fma_f32 v73, v73, s22, -v124
    v_exp_f32 v73, v73
    v_fma_f32 v74, v74, s22, -v124
    v_exp_f32 v74, v74
    v_fma_f32 v75, v75, s22, -v124
    v_exp_f32 v75, v75
    v_fma_f32 v76, v76, s22, -v124
    v_exp_f32 v76, v76
    v_fma_f32 v77, v77, s22, -v124
    v_exp_f32 v77, v77
    v_fma_f32 v78, v78, s22, -v124
    v_exp_f32 v78, v78
    v_fma_f32 v79, v79, s22, -v124
    v_exp_f32 v79, v79
    v_fma_f32 v80, v80, s22, -v124
    v_exp_f32 v80, v80
    v_fma_f32 v81, v81, s22, -v124
    v_exp_f32 v81, v81
    v_fma_f32 v82, v82, s22, -v124
    v_exp_f32 v82, v82
    v_fma_f32 v83, v83, s22, -v124
    v_exp_f32 v83, v83
    v_mov_b32 v129, v128
    v_cvt_pk_bf16_f32 v116, v68, v69
    v_cvt_pk_bf16_f32 v117, v70, v71
    v_cvt_pk_bf16_f32 v118, v72, v73
    v_cvt_pk_bf16_f32 v119, v74, v75
    v_cvt_pk_bf16_f32 v120, v76, v77
    v_cvt_pk_bf16_f32 v121, v78, v79
    v_cvt_pk_bf16_f32 v122, v80, v81
    v_cvt_pk_bf16_f32 v123, v82, v83
    v_pk_mul_f32 v[100:101], v[100:101], v[128:129]
    v_pk_mul_f32 v[102:103], v[102:103], v[128:129]
    v_pk_mul_f32 v[104:105], v[104:105], v[128:129]
    v_pk_mul_f32 v[106:107], v[106:107], v[128:129]
    v_pk_mul_f32 v[108:109], v[108:109], v[128:129]
    v_pk_mul_f32 v[110:111], v[110:111], v[128:129]
    v_pk_mul_f32 v[112:113], v[112:113], v[128:129]
    v_pk_mul_f32 v[114:115], v[114:115], v[128:129]
    s_waitcnt lgkmcnt(2)
    s_nop 0
    v_mfma_f32_32x32x16_bf16 v[100:115], v[60:63], v[116:119], v[100:115]
    v_mfma_f32_32x32x16_bf16 v[100:115], v[64:67], v[120:123], v[100:115]
    ds_read_b64_tr_b16 v[60:61], v15 offset:2048
    ds_read_b64_tr_b16 v[62:63], v15 offset:2560
    ds_read_b64_tr_b16 v[64:65], v15 offset:3072
    ds_read_b64_tr_b16 v[66:67], v15 offset:3584
    s_waitcnt lgkmcnt(4)
    v_mfma_f32_32x32x16_bf16 v[68:83], v[44:47], v[36:39], 0
    v_mfma_f32_32x32x16_bf16 v[68:83], v[48:51], v[40:43], v[68:83]
    ds_read_b128 v[52:55], v11 offset:6144
    ds_read_b128 v[56:59], v11 offset:7168
    v_max3_f32 v125, v84, v85, v86
    v_max3_f32 v125, v125, v87, v88
    v_max3_f32 v125, v125, v89, v90
    v_max3_f32 v125, v125, v91, v92
    v_max3_f32 v125, v125, v93, v94
    v_max3_f32 v125, v125, v95, v96
    v_max3_f32 v125, v125, v97, v98
    v_max_f32 v125, v125, v99
    v_mov_b32 v126, v125
    s_nop 1
    v_permlane32_swap_b32 v125, v126
    v_max_f32 v125, v125, v126
    v_mul_f32 v125, s22, v125
    v_max_f32 v125, v125, v124
    v_sub_f32 v128, v124, v125
    v_exp_f32 v128, v128
    v_mov_b32 v124, v125
    v_fma_f32 v84, v84, s22, -v124
    v_exp_f32 v84, v84
    v_fma_f32 v85, v85, s22, -v124
    v_exp_f32 v85, v85
    v_fma_f32 v86, v86, s22, -v124
    v_exp_f32 v86, v86
    v_fma_f32 v87, v87, s22, -v124
    v_exp_f32 v87, v87
    v_fma_f32 v88, v88, s22, -v124
    v_exp_f32 v88, v88
    v_fma_f32 v89, v89, s22, -v124
    v_exp_f32 v89, v89
    v_fma_f32 v90, v90, s22, -v124
    v_exp_f32 v90, v90
    v_fma_f32 v91, v91, s22, -v124
    v_exp_f32 v91, v91
    v_fma_f32 v92, v92, s22, -v124
    v_exp_f32 v92, v92
    v_fma_f32 v93, v93, s22, -v124
    v_exp_f32 v93, v93
    v_fma_f32 v94, v94, s22, -v124
    v_exp_f32 v94, v94
    v_fma_f32 v95, v95, s22, -v124
    v_exp_f32 v95, v95
    v_fma_f32 v96, v96, s22, -v124
    v_exp_f32 v96, v96
    v_fma_f32 v97, v97, s22, -v124
    v_exp_f32 v97, v97
    v_fma_f32 v98, v98, s22, -v124
    v_exp_f32 v98, v98
    v_fma_f32 v99, v99, s22, -v124
    v_exp_f32 v99, v99
    v_mov_b32 v129, v128
    v_cvt_pk_bf16_f32 v116, v84, v85
    v_cvt_pk_bf16_f32 v117, v86, v87
    v_cvt_pk_bf16_f32 v118, v88, v89
    v_cvt_pk_bf16_f32 v119, v90, v91
    v_cvt_pk_bf16_f32 v120, v92, v93
    v_cvt_pk_bf16_f32 v121, v94, v95
    v_cvt_pk_bf16_f32 v122, v96, v97
    v_cvt_pk_bf16_f32 v123, v98, v99
    v_pk_mul_f32 v[100:101], v[100:101], v[128:129]
    v_pk_mul_f32 v[102:103], v[102:103], v[128:129]
    v_pk_mul_f32 v[104:105], v[104:105], v[128:129]
    v_pk_mul_f32 v[106:107], v[106:107], v[128:129]
    v_pk_mul_f32 v[108:109], v[108:109], v[128:129]
    v_pk_mul_f32 v[110:111], v[110:111], v[128:129]
    v_pk_mul_f32 v[112:113], v[112:113], v[128:129]
    v_pk_mul_f32 v[114:115], v[114:115], v[128:129]
    s_waitcnt lgkmcnt(2)
    s_nop 0
    v_mfma_f32_32x32x16_bf16 v[100:115], v[60:63], v[116:119], v[100:115]
    v_mfma_f32_32x32x16_bf16 v[100:115], v[64:67], v[120:123], v[100:115]
    ds_read_b64_tr_b16 v[60:61], v15 offset:4096
    ds_read_b64_tr_b16 v[62:63], v15 offset:4608
    ds_read_b64_tr_b16 v[64:65], v15 offset:5120
    ds_read_b64_tr_b16 v[66:67], v15 offset:5632
    s_waitcnt lgkmcnt(4)
    v_mfma_f32_32x32x16_bf16 v[84:99], v[52:55], v[36:39], 0
    v_mfma_f32_32x32x16_bf16 v[84:99], v[56:59], v[40:43], v[84:99]
    v_max3_f32 v125, v68, v69, v70
    v_max3_f32 v125, v125, v71, v72
    v_max3_f32 v125, v125, v73, v74
    v_max3_f32 v125, v125, v75, v76
    v_max3_f32 v125, v125, v77, v78
    v_max3_f32 v125, v125, v79, v80
    v_max3_f32 v125, v125, v81, v82
    v_max_f32 v125, v125, v83
    v_mov_b32 v126, v125
    s_nop 1
    v_permlane32_swap_b32 v125, v126
    v_max_f32 v125, v125, v126
    v_mul_f32 v125, s22, v125
    v_max_f32 v125, v125, v124
    v_sub_f32 v128, v124, v125
    v_exp_f32 v128, v128
    v_mov_b32 v124, v125
    v_fma_f32 v68, v68, s22, -v124
    v_exp_f32 v68, v68
    v_fma_f32 v69, v69, s22, -v124
    v_exp_f32 v69, v69
    v_fma_f32 v70, v70, s22, -v124
    v_exp_f32 v70, v70
    v_fma_f32 v71, v71, s22, -v124
    v_exp_f32 v71, v71
    v_fma_f32 v72, v72, s22, -v124
    v_exp_f32 v72, v72
    v_fma_f32 v73, v73, s22, -v124
    v_exp_f32 v73, v73
    v_fma_f32 v74, v74, s22, -v124
    v_exp_f32 v74, v74
    v_fma_f32 v75, v75, s22, -v124
    v_exp_f32 v75, v75
    v_fma_f32 v76, v76, s22, -v124
    v_exp_f32 v76, v76
    v_fma_f32 v77, v77, s22, -v124
    v_exp_f32 v77, v77
    v_fma_f32 v78, v78, s22, -v124
    v_exp_f32 v78, v78
    v_fma_f32 v79, v79, s22, -v124
    v_exp_f32 v79, v79
    v_fma_f32 v80, v80, s22, -v124
    v_exp_f32 v80, v80
    v_fma_f32 v81, v81, s22, -v124
    v_exp_f32 v81, v81
    v_fma_f32 v82, v82, s22, -v124
    v_exp_f32 v82, v82
    v_fma_f32 v83, v83, s22, -v124
    v_exp_f32 v83, v83
    v_mov_b32 v129, v128
    v_cvt_pk_bf16_f32 v116, v68, v69
    v_cvt_pk_bf16_f32 v117, v70, v71
    v_cvt_pk_bf16_f32 v118, v72, v73
    v_cvt_pk_bf16_f32 v119, v74, v75
    v_cvt_pk_bf16_f32 v120, v76, v77
    v_cvt_pk_bf16_f32 v121, v78, v79
    v_cvt_pk_bf16_f32 v122, v80, v81
    v_cvt_pk_bf16_f32 v123, v82, v83
    v_pk_mul_f32 v[100:101], v[100:101], v[128:129]
    v_pk_mul_f32 v[102:103], v[102:103], v[128:129]
    v_pk_mul_f32 v[104:105], v[104:105], v[128:129]
    v_pk_mul_f32 v[106:107], v[106:107], v[128:129]
    v_pk_mul_f32 v[108:109], v[108:109], v[128:129]
    v_pk_mul_f32 v[110:111], v[110:111], v[128:129]
    v_pk_mul_f32 v[112:113], v[112:113], v[128:129]
    v_pk_mul_f32 v[114:115], v[114:115], v[128:129]
    s_waitcnt lgkmcnt(0)
    s_nop 0
    v_mfma_f32_32x32x16_bf16 v[100:115], v[60:63], v[116:119], v[100:115]
    v_mfma_f32_32x32x16_bf16 v[100:115], v[64:67], v[120:123], v[100:115]
    ds_read_b64_tr_b16 v[60:61], v15 offset:6144
    ds_read_b64_tr_b16 v[62:63], v15 offset:6656
    ds_read_b64_tr_b16 v[64:65], v15 offset:7168
    ds_read_b64_tr_b16 v[66:67], v15 offset:7680
    v_max3_f32 v125, v84, v85, v86
    v_max3_f32 v125, v125, v87, v88
    v_max3_f32 v125, v125, v89, v90
    v_max3_f32 v125, v125, v91, v92
    v_max3_f32 v125, v125, v93, v94
    v_max3_f32 v125, v125, v95, v96
    v_max3_f32 v125, v125, v97, v98
    v_max_f32 v125, v125, v99
    v_mov_b32 v126, v125
    s_nop 1
    v_permlane32_swap_b32 v125, v126
    v_max_f32 v125, v125, v126
    v_mul_f32 v125, s22, v125
    v_max_f32 v125, v125, v124
    v_sub_f32 v128, v124, v125
    v_exp_f32 v128, v128
    v_mov_b32 v124, v125
    v_fma_f32 v84, v84, s22, -v124
    v_exp_f32 v84, v84
    v_fma_f32 v85, v85, s22, -v124
    v_exp_f32 v85, v85
    v_fma_f32 v86, v86, s22, -v124
    v_exp_f32 v86, v86
    v_fma_f32 v87, v87, s22, -v124
    v_exp_f32 v87, v87
    v_fma_f32 v88, v88, s22, -v124
    v_exp_f32 v88, v88
    v_fma_f32 v89, v89, s22, -v124
    v_exp_f32 v89, v89
    v_fma_f32 v90, v90, s22, -v124
    v_exp_f32 v90, v90
    v_fma_f32 v91, v91, s22, -v124
    v_exp_f32 v91, v91
    v_fma_f32 v92, v92, s22, -v124
    v_exp_f32 v92, v92
    v_fma_f32 v93, v93, s22, -v124
    v_exp_f32 v93, v93
    v_fma_f32 v94, v94, s22, -v124
    v_exp_f32 v94, v94
    v_fma_f32 v95, v95, s22, -v124
    v_exp_f32 v95, v95
    v_fma_f32 v96, v96, s22, -v124
    v_exp_f32 v96, v96
    v_fma_f32 v97, v97, s22, -v124
    v_exp_f32 v97, v97
    v_fma_f32 v98, v98, s22, -v124
    v_exp_f32 v98, v98
    v_fma_f32 v99, v99, s22, -v124
    v_exp_f32 v99, v99
    v_mov_b32 v129, v128
    v_cvt_pk_bf16_f32 v116, v84, v85
    v_cvt_pk_bf16_f32 v117, v86, v87
    v_cvt_pk_bf16_f32 v118, v88, v89
    v_cvt_pk_bf16_f32 v119, v90, v91
    v_cvt_pk_bf16_f32 v120, v92, v93
    v_cvt_pk_bf16_f32 v121, v94, v95
    v_cvt_pk_bf16_f32 v122, v96, v97
    v_cvt_pk_bf16_f32 v123, v98, v99
    v_pk_mul_f32 v[100:101], v[100:101], v[128:129]
    v_pk_mul_f32 v[102:103], v[102:103], v[128:129]
    v_pk_mul_f32 v[104:105], v[104:105], v[128:129]
    v_pk_mul_f32 v[106:107], v[106:107], v[128:129]
    v_pk_mul_f32 v[108:109], v[108:109], v[128:129]
    v_pk_mul_f32 v[110:111], v[110:111], v[128:129]
    v_pk_mul_f32 v[112:113], v[112:113], v[128:129]
    v_pk_mul_f32 v[114:115], v[114:115], v[128:129]
    s_waitcnt lgkmcnt(0)
    s_nop 0
    v_mfma_f32_32x32x16_bf16 v[100:115], v[60:63], v[116:119], v[100:115]
    v_mfma_f32_32x32x16_bf16 v[100:115], v[64:67], v[120:123], v[100:115]
    s_waitcnt vmcnt(8)
    s_barrier
    s_add_u32 s30, s19, s27
    s_add_u32 m0, s29, 65536
    s_nop 0
    buffer_load_dwordx4 v8, s[8:11], s30 offen lds
    s_add_u32 s30, s19, s27
    s_add_u32 s30, s30, 4096
    s_add_u32 m0, s29, 69632
    s_nop 0
    buffer_load_dwordx4 v8, s[8:11], s30 offen lds
    s_add_u32 s30, s20, s27
    s_add_u32 m0, s29, 73728
    s_nop 0
    buffer_load_dwordx4 v8, s[8:11], s30 offen lds
    s_add_u32 s30, s20, s27
    s_add_u32 s30, s30, 4096
    s_add_u32 m0, s29, 77824
    s_nop 0
    buffer_load_dwordx4 v8, s[8:11], s30 offen lds
    s_add_u32 s19, s19, 8192
    s_add_u32 s20, s20, 8192
    ds_read_b128 v[44:47], v12 offset:0
    ds_read_b128 v[48:51], v12 offset:1024
    ds_read_b128 v[52:55], v12 offset:2048
    ds_read_b128 v[56:59], v12 offset:3072
    s_waitcnt lgkmcnt(2)
    v_mfma_f32_32x32x16_bf16 v[68:83], v[44:47], v[36:39], 0
    v_mfma_f32_32x32x16_bf16 v[68:83], v[48:51], v[40:43], v[68:83]
    ds_read_b64_tr_b16 v[60:61], v16 offset:0
    ds_read_b64_tr_b16 v[62:63], v16 offset:512
    ds_read_b64_tr_b16 v[64:65], v16 offset:1024
    ds_read_b64_tr_b16 v[66:67], v16 offset:1536
    s_waitcnt lgkmcnt(4)
    v_mfma_f32_32x32x16_bf16 v[84:99], v[52:55], v[36:39], 0
    v_mfma_f32_32x32x16_bf16 v[84:99], v[56:59], v[40:43], v[84:99]
    ds_read_b128 v[44:47], v12 offset:4096
    ds_read_b128 v[48:51], v12 offset:5120
    s_nop 2
    v_max3_f32 v125, v68, v69, v70
    v_max3_f32 v125, v125, v71, v72
    v_max3_f32 v125, v125, v73, v74
    v_max3_f32 v125, v125, v75, v76
    v_max3_f32 v125, v125, v77, v78
    v_max3_f32 v125, v125, v79, v80
    v_max3_f32 v125, v125, v81, v82
    v_max_f32 v125, v125, v83
    v_mov_b32 v126, v125
    s_nop 1
    v_permlane32_swap_b32 v125, v126
    v_max_f32 v125, v125, v126
    v_mul_f32 v125, s22, v125
    v_max_f32 v125, v125, v124
    v_sub_f32 v128, v124, v125
    v_exp_f32 v128, v128
    v_mov_b32 v124, v125
    v_fma_f32 v68, v68, s22, -v124
    v_exp_f32 v68, v68
    v_fma_f32 v69, v69, s22, -v124
    v_exp_f32 v69, v69
    v_fma_f32 v70, v70, s22, -v124
    v_exp_f32 v70, v70
    v_fma_f32 v71, v71, s22, -v124
    v_exp_f32 v71, v71
    v_fma_f32 v72, v72, s22, -v124
    v_exp_f32 v72, v72
    v_fma_f32 v73, v73, s22, -v124
    v_exp_f32 v73, v73
    v_fma_f32 v74, v74, s22, -v124
    v_exp_f32 v74, v74
    v_fma_f32 v75, v75, s22, -v124
    v_exp_f32 v75, v75
    v_fma_f32 v76, v76, s22, -v124
    v_exp_f32 v76, v76
    v_fma_f32 v77, v77, s22, -v124
    v_exp_f32 v77, v77
    v_fma_f32 v78, v78, s22, -v124
    v_exp_f32 v78, v78
    v_fma_f32 v79, v79, s22, -v124
    v_exp_f32 v79, v79
    v_fma_f32 v80, v80, s22, -v124
    v_exp_f32 v80, v80
    v_fma_f32 v81, v81, s22, -v124
    v_exp_f32 v81, v81
    v_fma_f32 v82, v82, s22, -v124
    v_exp_f32 v82, v82
    v_fma_f32 v83, v83, s22, -v124
    v_exp_f32 v83, v83
    v_mov_b32 v129, v128
    v_cvt_pk_bf16_f32 v116, v68, v69
    v_cvt_pk_bf16_f32 v117, v70, v71
    v_cvt_pk_bf16_f32 v118, v72, v73
    v_cvt_pk_bf16_f32 v119, v74, v75
    v_cvt_pk_bf16_f32 v120, v76, v77
    v_cvt_pk_bf16_f32 v121, v78, v79
    v_cvt_pk_bf16_f32 v122, v80, v81
    v_cvt_pk_bf16_f32 v123, v82, v83
    v_pk_mul_f32 v[100:101], v[100:101], v[128:129]
    v_pk_mul_f32 v[102:103], v[102:103], v[128:129]
    v_pk_mul_f32 v[104:105], v[104:105], v[128:129]
    v_pk_mul_f32 v[106:107], v[106:107], v[128:129]
    v_pk_mul_f32 v[108:109], v[108:109], v[128:129]
    v_pk_mul_f32 v[110:111], v[110:111], v[128:129]
    v_pk_mul_f32 v[112:113], v[112:113], v[128:129]
    v_pk_mul_f32 v[114:115], v[114:115], v[128:129]
    s_waitcnt lgkmcnt(2)
    s_nop 0
    v_mfma_f32_32x32x16_bf16 v[100:115], v[60:63], v[116:119], v[100:115]
    v_mfma_f32_32x32x16_bf16 v[100:115], v[64:67], v[120:123], v[100:115]
    ds_read_b64_tr_b16 v[60:61], v16 offset:2048
    ds_read_b64_tr_b16 v[62:63], v16 offset:2560
    ds_read_b64_tr_b16 v[64:65], v16 offset:3072
    ds_read_b64_tr_b16 v[66:67], v16 offset:3584
    s_waitcnt lgkmcnt(4)
    v_mfma_f32_32x32x16_bf16 v[68:83], v[44:47], v[36:39], 0
    v_mfma_f32_32x32x16_bf16 v[68:83], v[48:51], v[40:43], v[68:83]
    ds_read_b128 v[52:55], v12 offset:6144
    ds_read_b128 v[56:59], v12 offset:7168
    v_max3_f32 v125, v84, v85, v86
    v_max3_f32 v125, v125, v87, v88
    v_max3_f32 v125, v125, v89, v90
    v_max3_f32 v125, v125, v91, v92
    v_max3_f32 v125, v125, v93, v94
    v_max3_f32 v125, v125, v95, v96
    v_max3_f32 v125, v125, v97, v98
    v_max_f32 v125, v125, v99
    v_mov_b32 v126, v125
    s_nop 1
    v_permlane32_swap_b32 v125, v126
    v_max_f32 v125, v125, v126
    v_mul_f32 v125, s22, v125
    v_max_f32 v125, v125, v124
    v_sub_f32 v128, v124, v125
    v_exp_f32 v128, v128
    v_mov_b32 v124, v125
    v_fma_f32 v84, v84, s22, -v124
    v_exp_f32 v84, v84
    v_fma_f32 v85, v85, s22, -v124
    v_exp_f32 v85, v85
    v_fma_f32 v86, v86, s22, -v124
    v_exp_f32 v86, v86
    v_fma_f32 v87, v87, s22, -v124
    v_exp_f32 v87, v87
    v_fma_f32 v88, v88, s22, -v124
    v_exp_f32 v88, v88
    v_fma_f32 v89, v89, s22, -v124
    v_exp_f32 v89, v89
    v_fma_f32 v90, v90, s22, -v124
    v_exp_f32 v90, v90
    v_fma_f32 v91, v91, s22, -v124
    v_exp_f32 v91, v91
    v_fma_f32 v92, v92, s22, -v124
    v_exp_f32 v92, v92
    v_fma_f32 v93, v93, s22, -v124
    v_exp_f32 v93, v93
    v_fma_f32 v94, v94, s22, -v124
    v_exp_f32 v94, v94
    v_fma_f32 v95, v95, s22, -v124
    v_exp_f32 v95, v95
    v_fma_f32 v96, v96, s22, -v124
    v_exp_f32 v96, v96
    v_fma_f32 v97, v97, s22, -v124
    v_exp_f32 v97, v97
    v_fma_f32 v98, v98, s22, -v124
    v_exp_f32 v98, v98
    v_fma_f32 v99, v99, s22, -v124
    v_exp_f32 v99, v99
    v_mov_b32 v129, v128
    v_cvt_pk_bf16_f32 v116, v84, v85
    v_cvt_pk_bf16_f32 v117, v86, v87
    v_cvt_pk_bf16_f32 v118, v88, v89
    v_cvt_pk_bf16_f32 v119, v90, v91
    v_cvt_pk_bf16_f32 v120, v92, v93
    v_cvt_pk_bf16_f32 v121, v94, v95
    v_cvt_pk_bf16_f32 v122, v96, v97
    v_cvt_pk_bf16_f32 v123, v98, v99
    v_pk_mul_f32 v[100:101], v[100:101], v[128:129]
    v_pk_mul_f32 v[102:103], v[102:103], v[128:129]
    v_pk_mul_f32 v[104:105], v[104:105], v[128:129]
    v_pk_mul_f32 v[106:107], v[106:107], v[128:129]
    v_pk_mul_f32 v[108:109], v[108:109], v[128:129]
    v_pk_mul_f32 v[110:111], v[110:111], v[128:129]
    v_pk_mul_f32 v[112:113], v[112:113], v[128:129]
    v_pk_mul_f32 v[114:115], v[114:115], v[128:129]
    s_waitcnt lgkmcnt(2)
    s_nop 0
    v_mfma_f32_32x32x16_bf16 v[100:115], v[60:63], v[116:119], v[100:115]
    v_mfma_f32_32x32x16_bf16 v[100:115], v[64:67], v[120:123], v[100:115]
    ds_read_b64_tr_b16 v[60:61], v16 offset:4096
    ds_read_b64_tr_b16 v[62:63], v16 offset:4608
    ds_read_b64_tr_b16 v[64:65], v16 offset:5120
    ds_read_b64_tr_b16 v[66:67], v16 offset:5632
    s_waitcnt lgkmcnt(4)
    v_mfma_f32_32x32x16_bf16 v[84:99], v[52:55], v[36:39], 0
    v_mfma_f32_32x32x16_bf16 v[84:99], v[56:59], v[40:43], v[84:99]
    v_max3_f32 v125, v68, v69, v70
    v_max3_f32 v125, v125, v71, v72
    v_max3_f32 v125, v125, v73, v74
    v_max3_f32 v125, v125, v75, v76
    v_max3_f32 v125, v125, v77, v78
    v_max3_f32 v125, v125, v79, v80
    v_max3_f32 v125, v125, v81, v82
    v_max_f32 v125, v125, v83
    v_mov_b32 v126, v125
    s_nop 1
    v_permlane32_swap_b32 v125, v126
    v_max_f32 v125, v125, v126
    v_mul_f32 v125, s22, v125
    v_max_f32 v125, v125, v124
    v_sub_f32 v128, v124, v125
    v_exp_f32 v128, v128
    v_mov_b32 v124, v125
    v_fma_f32 v68, v68, s22, -v124
    v_exp_f32 v68, v68
    v_fma_f32 v69, v69, s22, -v124
    v_exp_f32 v69, v69
    v_fma_f32 v70, v70, s22, -v124
    v_exp_f32 v70, v70
    v_fma_f32 v71, v71, s22, -v124
    v_exp_f32 v71, v71
    v_fma_f32 v72, v72, s22, -v124
    v_exp_f32 v72, v72
    v_fma_f32 v73, v73, s22, -v124
    v_exp_f32 v73, v73
    v_fma_f32 v74, v74, s22, -v124
    v_exp_f32 v74, v74
    v_fma_f32 v75, v75, s22, -v124
    v_exp_f32 v75, v75
    v_fma_f32 v76, v76, s22, -v124
    v_exp_f32 v76, v76
    v_fma_f32 v77, v77, s22, -v124
    v_exp_f32 v77, v77
    v_fma_f32 v78, v78, s22, -v124
    v_exp_f32 v78, v78
    v_fma_f32 v79, v79, s22, -v124
    v_exp_f32 v79, v79
    v_fma_f32 v80, v80, s22, -v124
    v_exp_f32 v80, v80
    v_fma_f32 v81, v81, s22, -v124
    v_exp_f32 v81, v81
    v_fma_f32 v82, v82, s22, -v124
    v_exp_f32 v82, v82
    v_fma_f32 v83, v83, s22, -v124
    v_exp_f32 v83, v83
    v_mov_b32 v129, v128
    v_cvt_pk_bf16_f32 v116, v68, v69
    v_cvt_pk_bf16_f32 v117, v70, v71
    v_cvt_pk_bf16_f32 v118, v72, v73
    v_cvt_pk_bf16_f32 v119, v74, v75
    v_cvt_pk_bf16_f32 v120, v76, v77
    v_cvt_pk_bf16_f32 v121, v78, v79
    v_cvt_pk_bf16_f32 v122, v80, v81
    v_cvt_pk_bf16_f32 v123, v82, v83
    v_pk_mul_f32 v[100:101], v[100:101], v[128:129]
    v_pk_mul_f32 v[102:103], v[102:103], v[128:129]
    v_pk_mul_f32 v[104:105], v[104:105], v[128:129]
    v_pk_mul_f32 v[106:107], v[106:107], v[128:129]
    v_pk_mul_f32 v[108:109], v[108:109], v[128:129]
    v_pk_mul_f32 v[110:111], v[110:111], v[128:129]
    v_pk_mul_f32 v[112:113], v[112:113], v[128:129]
    v_pk_mul_f32 v[114:115], v[114:115], v[128:129]
    s_waitcnt lgkmcnt(0)
    s_nop 0
    v_mfma_f32_32x32x16_bf16 v[100:115], v[60:63], v[116:119], v[100:115]
    v_mfma_f32_32x32x16_bf16 v[100:115], v[64:67], v[120:123], v[100:115]
    ds_read_b64_tr_b16 v[60:61], v16 offset:6144
    ds_read_b64_tr_b16 v[62:63], v16 offset:6656
    ds_read_b64_tr_b16 v[64:65], v16 offset:7168
    ds_read_b64_tr_b16 v[66:67], v16 offset:7680
    v_max3_f32 v125, v84, v85, v86
    v_max3_f32 v125, v125, v87, v88
    v_max3_f32 v125, v125, v89, v90
    v_max3_f32 v125, v125, v91, v92
    v_max3_f32 v125, v125, v93, v94
    v_max3_f32 v125, v125, v95, v96
    v_max3_f32 v125, v125, v97, v98
    v_max_f32 v125, v125, v99
    v_mov_b32 v126, v125
    s_nop 1
    v_permlane32_swap_b32 v125, v126
    v_max_f32 v125, v125, v126
    v_mul_f32 v125, s22, v125
    v_max_f32 v125, v125, v124
    v_sub_f32 v128, v124, v125
    v_exp_f32 v128, v128
    v_mov_b32 v124, v125
    v_fma_f32 v84, v84, s22, -v124
    v_exp_f32 v84, v84
    v_fma_f32 v85, v85, s22, -v124
    v_exp_f32 v85, v85
    v_fma_f32 v86, v86, s22, -v124
    v_exp_f32 v86, v86
    v_fma_f32 v87, v87, s22, -v124
    v_exp_f32 v87, v87
    v_fma_f32 v88, v88, s22, -v124
    v_exp_f32 v88, v88
    v_fma_f32 v89, v89, s22, -v124
    v_exp_f32 v89, v89
    v_fma_f32 v90, v90, s22, -v124
    v_exp_f32 v90, v90
    v_fma_f32 v91, v91, s22, -v124
    v_exp_f32 v91, v91
    v_fma_f32 v92, v92, s22, -v124
    v_exp_f32 v92, v92
    v_fma_f32 v93, v93, s22, -v124
    v_exp_f32 v93, v93
    v_fma_f32 v94, v94, s22, -v124
    v_exp_f32 v94, v94
    v_fma_f32 v95, v95, s22, -v124
    v_exp_f32 v95, v95
    v_fma_f32 v96, v96, s22, -v124
    v_exp_f32 v96, v96
    v_fma_f32 v97, v97, s22, -v124
    v_exp_f32 v97, v97
    v_fma_f32 v98, v98, s22, -v124
    v_exp_f32 v98, v98
    v_fma_f32 v99, v99, s22, -v124
    v_exp_f32 v99, v99
    v_mov_b32 v129, v128
    v_cvt_pk_bf16_f32 v116, v84, v85
    v_cvt_pk_bf16_f32 v117, v86, v87
    v_cvt_pk_bf16_f32 v118, v88, v89
    v_cvt_pk_bf16_f32 v119, v90, v91
    v_cvt_pk_bf16_f32 v120, v92, v93
    v_cvt_pk_bf16_f32 v121, v94, v95
    v_cvt_pk_bf16_f32 v122, v96, v97
    v_cvt_pk_bf16_f32 v123, v98, v99
    v_pk_mul_f32 v[100:101], v[100:101], v[128:129]
    v_pk_mul_f32 v[102:103], v[102:103], v[128:129]
    v_pk_mul_f32 v[104:105], v[104:105], v[128:129]
    v_pk_mul_f32 v[106:107], v[106:107], v[128:129]
    v_pk_mul_f32 v[108:109], v[108:109], v[128:129]
    v_pk_mul_f32 v[110:111], v[110:111], v[128:129]
    v_pk_mul_f32 v[112:113], v[112:113], v[128:129]
    v_pk_mul_f32 v[114:115], v[114:115], v[128:129]
    s_waitcnt lgkmcnt(0)
    s_nop 0
    v_mfma_f32_32x32x16_bf16 v[100:115], v[60:63], v[116:119], v[100:115]
    v_mfma_f32_32x32x16_bf16 v[100:115], v[64:67], v[120:123], v[100:115]
    s_add_u32 s21, s21, 4
    s_cmp_lt_u32 s21, 8
    s_cbranch_scc1 L_attn_kernel_loop
    s_waitcnt vmcnt(0)
    s_barrier
    v_lshlrev_b32 v1, 2, v6
    s_mul_i32 s18, s23, 4352
    v_add_u32 v1, s18, v1
    s_cmp_eq_u32 s26, 0
    s_cbranch_scc1 L_attn_kernel_lo
    s_nop 1
    ds_write_b32 v1, v100 offset:0
    ds_write_b32 v1, v101 offset:256
    ds_write_b32 v1, v102 offset:512
    ds_write_b32 v1, v103 offset:768
    ds_write_b32 v1, v104 offset:1024
    ds_write_b32 v1, v105 offset:1280
    ds_write_b32 v1, v106 offset:1536
    ds_write_b32 v1, v107 offset:1792
    ds_write_b32 v1, v108 offset:2048
    ds_write_b32 v1, v109 offset:2304
    ds_write_b32 v1, v110 offset:2560
    ds_write_b32 v1, v111 offset:2816
    ds_write_b32 v1, v112 offset:3072
    ds_write_b32 v1, v113 offset:3328
    ds_write_b32 v1, v114 offset:3584
    ds_write_b32 v1, v115 offset:3840
    ds_write_b32 v1, v124 offset:4096
    s_waitcnt lgkmcnt(0)
    s_barrier
    s_branch L_attn_kernel_end
L_attn_kernel_lo:
    s_barrier
    ds_read_b32 v68, v1 offset:0
    ds_read_b32 v69, v1 offset:256
    ds_read_b32 v70, v1 offset:512
    ds_read_b32 v71, v1 offset:768
    ds_read_b32 v72, v1 offset:1024
    ds_read_b32 v73, v1 offset:1280
    ds_read_b32 v74, v1 offset:1536
    ds_read_b32 v75, v1 offset:1792
    ds_read_b32 v76, v1 offset:2048
    ds_read_b32 v77, v1 offset:2304
    ds_read_b32 v78, v1 offset:2560
    ds_read_b32 v79, v1 offset:2816
    ds_read_b32 v80, v1 offset:3072
    ds_read_b32 v81, v1 offset:3328
    ds_read_b32 v82, v1 offset:3584
    ds_read_b32 v83, v1 offset:3840
    ds_read_b32 v125, v1 offset:4096
    s_waitcnt lgkmcnt(0)
    v_max_f32 v126, v125, v124
    v_sub_f32 v124, v124, v126
    v_sub_f32 v125, v125, v126
    v_exp_f32 v124, v124
    v_exp_f32 v125, v125
    v_mul_f32 v100, v124, v100
    v_fmac_f32 v100, v125, v68
    v_mul_f32 v101, v124, v101
    v_fmac_f32 v101, v125, v69
    v_mul_f32 v102, v124, v102
    v_fmac_f32 v102, v125, v70
    v_mul_f32 v103, v124, v103
    v_fmac_f32 v103, v125, v71
    v_mul_f32 v104, v124, v104
    v_fmac_f32 v104, v125, v72
    v_mul_f32 v105, v124, v105
    v_fmac_f32 v105, v125, v73
    v_mul_f32 v106, v124, v106
    v_fmac_f32 v106, v125, v74
    v_mul_f32 v107, v124, v107
    v_fmac_f32 v107, v125, v75
    v_mul_f32 v108, v124, v108
    v_fmac_f32 v108, v125, v76
    v_mul_f32 v109, v124, v109
    v_fmac_f32 v109, v125, v77
    v_mul_f32 v110, v124, v110
    v_fmac_f32 v110, v125, v78
    v_mul_f32 v111, v124, v111
    v_fmac_f32 v111, v125, v79
    v_mul_f32 v112, v124, v112
    v_fmac_f32 v112, v125, v80
    v_mul_f32 v113, v124, v113
    v_fmac_f32 v113, v125, v81
    v_mul_f32 v114, v124, v114
    v_fmac_f32 v114, v125, v82
    v_mul_f32 v115, v124, v115
    v_fmac_f32 v115, v125, v83
    v_mov_b32 v125, v112
    v_mov_b32 v126, v112
    s_nop 1
    v_permlane32_swap_b32 v125, v126
    v_rcp_f32 v128, v126
    v_and_b32 v1, 31, v6
    s_lshl_b32 s18, s17, 5
    v_add_u32 v1, s18, v1
    v_mul_u32_u24 v1, 896, v1
    v_bfe_u32 v2, v6, 5, 1
    v_lshl_add_u32 v1, v2, 3, v1
    s_mul_i32 s18, s16, 56
    v_add_u32 v1, s18, v1
    v_mul_f32 v100, v128, v100
    v_mul_f32 v101, v128, v101
    v_mul_f32 v102, v128, v102
    v_mul_f32 v103, v128, v103
    v_cvt_pk_bf16_f32 v116, v100, v101
    v_cvt_pk_bf16_f32 v117, v102, v103
    buffer_store_dwordx2 v[116:117], v1, s[12:15], 0 offen offset:0
    v_mul_f32 v104, v128, v104
    v_mul_f32 v105, v128, v105
    v_mul_f32 v106, v128, v106
    v_mul_f32 v107, v128, v107
    v_cvt_pk_bf16_f32 v116, v104, v105
    v_cvt_pk_bf16_f32 v117, v106, v107
    buffer_store_dwordx2 v[116:117], v1, s[12:15], 0 offen offset:16
    v_mul_f32 v108, v128, v108
    v_mul_f32 v109, v128, v109
    v_mul_f32 v110, v128, v110
    v_mul_f32 v111, v128, v111
    v_cvt_pk_bf16_f32 v116, v108, v109
    v_cvt_pk_bf16_f32 v117, v110, v111
    buffer_store_dwordx2 v[116:117], v1, s[12:15], 0 offen offset:32
    v_mul_f32 v112, v128, v112
    v_mul_f32 v113, v128, v113
    v_mul_f32 v114, v128, v114
    v_mul_f32 v115, v128, v115
    v_cvt_pk_bf16_f32 v116, v112, v113
    v_cvt_pk_bf16_f32 v117, v114, v115
    v_cmp_gt_u32 vcc, 32, v6
    s_and_saveexec_b64 s[24:25], vcc
    buffer_store_dwordx2 v[116:117], v1, s[12:15], 0 offen offset:48
    s_mov_b64 exec, s[24:25]
L_attn_kernel_end:
    s_endpgm
.globl wo0_kernel
.p2align 8
.type wo0_kernel,@function
wo0_kernel:
    s_cmp_ge_u32 s2, 224
    s_cbranch_scc1 L_wo0_kernel_end
    s_load_dwordx2 s[4:5], s[0:1], 72
    s_load_dwordx2 s[34:35], s[0:1], 16
    s_load_dwordx2 s[40:41], s[0:1], 0
    s_lshr_b32 s45, s2, 3
    s_mov_b32 s44, 0x24924925
    s_mul_hi_u32 s28, s45, s44
    s_mul_i32 s44, s28, 7
    s_sub_u32 s29, s45, s44
    s_and_b32 s44, s2, 7
    s_mul_i32 s44, s44, 4
    s_add_u32 s28, s28, s44
    s_mov_b32 s50, 0x3f803f80
    v_lshrrev_b32 v2, 6, v0
    s_nop 0
    v_readfirstlane_b32 s51, v2
    v_and_b32 v9, 63, v0
    s_and_b32 s44, s51, 1
    s_lshl_b32 s44, s44, 2
    v_lshrrev_b32 v2, 4, v9
    v_add_u32 v2, s44, v2
    v_and_b32 v2, 7, v2
    v_and_b32 v3, 7, v9
    v_xor_b32 v2, v2, v3
    v_lshrrev_b32 v3, 3, v9
    v_mul_u32_u24 v3, 896, v3
    v_lshl_add_u32 v10, v2, 4, v3
    s_and_b32 s44, s51, 1
    s_lshl_b32 s44, s44, 1
    v_lshrrev_b32 v2, 3, v9
    v_bfe_u32 v3, v9, 4, 1
    v_or_b32 v3, s44, v3
    v_bfe_u32 v4, v9, 1, 2
    v_xor_b32 v3, v3, v4
    v_and_b32 v4, 1, v9
    v_lshl_add_u32 v3, v3, 1, v4
    v_mul_u32_u24 v2, 896, v2
    v_lshl_add_u32 v2, v3, 4, v2
    v_mov_b32 v11, v2
    s_waitcnt lgkmcnt(0)
    s_add_u32 s8, s4, 0xa00000
    s_addc_u32 s9, s5, 0
    s_mov_b32 s10, 0x1c0000
    s_mov_b32 s11, 0x00020000
    s_mov_b32 s12, s34
    s_mov_b32 s13, s35
    s_mov_b32 s14, 0x62000
    s_mov_b32 s15, 0x00020000
    s_mul_i32 s52, s28, 57344
    s_mul_i32 s44, s51, 7168
    s_add_u32 s52, s52, s44
    s_mul_i32 s53, s29, 128
    s_mul_i32 s44, s51, 7168
    s_add_u32 s53, s53, s44
    s_lshl_b32 s54, s51, 10
    s_add_u32 s55, s52, 0
    s_add_u32 m0, s54, 0
    s_nop 0
    buffer_load_dwordx4 v10, s[8:11], s55 offen lds
    s_add_u32 s55, s52, 28672
    s_add_u32 m0, s54, 4096
    s_nop 0
    buffer_load_dwordx4 v10, s[8:11], s55 offen lds
    s_add_u32 s55, s53, 0
    s_add_u32 m0, s54, 8192
    s_nop 0
    buffer_load_dwordx4 v11, s[12:15], s55 offen lds
    s_add_u32 s55, s53, 28672
    s_add_u32 m0, s54, 12288
    s_nop 0
    buffer_load_dwordx4 v11, s[12:15], s55 offen lds
    s_add_u32 s55, s52, 128
    s_add_u32 m0, s54, 16384
    s_nop 0
    buffer_load_dwordx4 v10, s[8:11], s55 offen lds
    s_add_u32 s55, s52, 28800
    s_add_u32 m0, s54, 20480
    s_nop 0
    buffer_load_dwordx4 v10, s[8:11], s55 offen lds
    s_add_u32 s55, s53, 57344
    s_add_u32 m0, s54, 24576
    s_nop 0
    buffer_load_dwordx4 v11, s[12:15], s55 offen lds
    s_add_u32 s55, s53, 86016
    s_add_u32 m0, s54, 28672
    s_nop 0
    buffer_load_dwordx4 v11, s[12:15], s55 offen lds
    s_add_u32 s55, s52, 256
    s_add_u32 m0, s54, 32768
    s_nop 0
    buffer_load_dwordx4 v10, s[8:11], s55 offen lds
    s_add_u32 s55, s52, 28928
    s_add_u32 m0, s54, 36864
    s_nop 0
    buffer_load_dwordx4 v10, s[8:11], s55 offen lds
    s_add_u32 s55, s53, 114688
    s_add_u32 m0, s54, 40960
    s_nop 0
    buffer_load_dwordx4 v11, s[12:15], s55 offen lds
    s_add_u32 s55, s53, 143360
    s_add_u32 m0, s54, 45056
    s_nop 0
    buffer_load_dwordx4 v11, s[12:15], s55 offen lds
    s_add_u32 s55, s52, 384
    s_add_u32 m0, s54, 49152
    s_nop 0
    buffer_load_dwordx4 v10, s[8:11], s55 offen lds
    s_add_u32 s55, s52, 29056
    s_add_u32 m0, s54, 53248
    s_nop 0
    buffer_load_dwordx4 v10, s[8:11], s55 offen lds
    s_add_u32 s55, s53, 172032
    s_add_u32 m0, s54, 57344
    s_nop 0
    buffer_load_dwordx4 v11, s[12:15], s55 offen lds
    s_add_u32 s55, s53, 200704
    s_add_u32 m0, s54, 61440
    s_nop 0
    buffer_load_dwordx4 v11, s[12:15], s55 offen lds
    s_add_u32 s55, s52, 512
    s_add_u32 m0, s54, 65536
    s_nop 0
    buffer_load_dwordx4 v10, s[8:11], s55 offen lds
    s_add_u32 s55, s52, 29184
    s_add_u32 m0, s54, 69632
    s_nop 0
    buffer_load_dwordx4 v10, s[8:11], s55 offen lds
    s_add_u32 s55, s53, 229376
    s_add_u32 m0, s54, 73728
    s_nop 0
    buffer_load_dwordx4 v11, s[12:15], s55 offen lds
    s_add_u32 s55, s53, 258048
    s_add_u32 m0, s54, 77824
    s_nop 0
    buffer_load_dwordx4 v11, s[12:15], s55 offen lds
    s_add_u32 s55, s52, 640
    s_add_u32 m0, s54, 81920
    s_nop 0
    buffer_load_dwordx4 v10, s[8:11], s55 offen lds
    s_add_u32 s55, s52, 29312
    s_add_u32 m0, s54, 86016
    s_nop 0
    buffer_load_dwordx4 v10, s[8:11], s55 offen lds
    s_add_u32 s55, s53, 286720
    s_add_u32 m0, s54, 90112
    s_nop 0
    buffer_load_dwordx4 v11, s[12:15], s55 offen lds
    s_add_u32 s55, s53, 315392
    s_add_u32 m0, s54, 94208
    s_nop 0
    buffer_load_dwordx4 v11, s[12:15], s55 offen lds
    s_mov_b32 s20, s4
    s_mov_b32 s21, s5
    s_mov_b32 s22, 0x1c0000
    s_mov_b32 s23, 0x00020000
    s_mov_b32 s24, s40
    s_mov_b32 s25, s41
    s_mov_b32 s26, 0x1c0000
    s_mov_b32 s27, 0x00020000
    v_and_b32 v6, 15, v0
    v_bfe_u32 v7, v0, 4, 2
    s_lshr_b32 s44, s51, 1
    s_mul_i32 s44, s44, 32
    s_mul_i32 s45, s28, 64
    s_add_u32 s44, s44, s45
    v_add_u32 v80, s44, v6
    s_and_b32 s44, s51, 1
    s_mul_i32 s44, s44, 32
    s_mul_i32 s45, s29, 64
    s_add_u32 s44, s44, s45
    v_lshlrev_b32 v81, 2, v7
    v_add_u32 v81, s44, v81
    v_mul_u32_u24 v82, 896, v80
    v_lshl_add_u32 v82, v81, 1, v82
    v_add_u32 v83, 0, v82
    v_add_u32 v84, 14336, v82
    buffer_load_dwordx2 v[72:73], v83, s[24:27], 0 offen offset:0
    buffer_load_dwordx2 v[74:75], v83, s[24:27], 0 offen offset:32
    buffer_load_dwordx2 v[76:77], v84, s[24:27], 0 offen offset:0
    buffer_load_dwordx2 v[78:79], v84, s[24:27], 0 offen offset:32
    s_lshr_b32 s44, s51, 1
    s_mul_i32 s44, s44, 4096
    v_bfe_u32 v2, v6, 1, 3
    v_mul_u32_u24 v3, 128, v6
    v_add_u32 v3, s44, v3
    v_add_u32 v4, 0, v7
    v_xor_b32 v4, v4, v2
    v_lshl_add_u32 v4, v4, 4, v3
    v_add_u32 v12, 0, v4
    v_add_u32 v14, 16384, v4
    v_add_u32 v16, 32768, v4
    v_add_u32 v18, 49152, v4
    v_add_u32 v20, 65536, v4
    v_add_u32 v22, 81920, v4
    v_add_u32 v24, 98304, v4
    v_add_u32 v4, 4, v7
    v_xor_b32 v4, v4, v2
    v_lshl_add_u32 v4, v4, 4, v3
    v_add_u32 v13, 0, v4
    v_add_u32 v15, 16384, v4
    v_add_u32 v17, 32768, v4
    v_add_u32 v19, 49152, v4
    v_add_u32 v21, 65536, v4
    v_add_u32 v23, 81920, v4
    v_add_u32 v25, 98304, v4
    v_lshrrev_b32 v2, 2, v6
    v_lshl_add_u32 v3, v7, 3, v2
    v_mul_u32_u24 v3, 128, v3
    v_and_b32 v4, 3, v6
    v_lshl_add_u32 v3, v4, 3, v3
    v_bfe_u32 v2, v6, 3, 1
    v_and_b32 v4, 1, v7
    v_lshl_or_b32 v2, v4, 1, v2
    s_and_b32 s44, s51, 1
    s_mul_i32 s45, s44, 2
    s_add_u32 s45, s45, 0
    v_xor_b32 v4, s45, v2
    v_lshl_add_u32 v4, v4, 5, v3
    v_add_u32 v26, 8192, v4
    v_add_u32 v28, 24576, v4
    v_add_u32 v30, 40960, v4
    v_add_u32 v32, 57344, v4
    v_add_u32 v34, 73728, v4
    v_add_u32 v36, 90112, v4
    v_add_u32 v38, 106496, v4
    s_mul_i32 s45, s44, 2
    s_add_u32 s45, s45, 1
    v_xor_b32 v4, s45, v2
    v_lshl_add_u32 v4, v4, 5, v3
    v_add_u32 v27, 8192, v4
    v_add_u32 v29, 24576, v4
    v_add_u32 v31, 40960, v4
    v_add_u32 v33, 57344, v4
    v_add_u32 v35, 73728, v4
    v_add_u32 v37, 90112, v4
    v_add_u32 v39, 106496, v4
    s_waitcnt vmcnt(24)
    s_barrier
    s_add_u32 s55, s52, 768
    s_add_u32 m0, s54, 98304
    s_nop 0
    buffer_load_dwordx4 v10, s[8:11], s55 offen lds
    s_add_u32 s55, s52, 29440
    s_add_u32 m0, s54, 102400
    s_nop 0
    buffer_load_dwordx4 v10, s[8:11], s55 offen lds
    s_add_u32 s55, s53, 344064
    s_add_u32 m0, s54, 106496
    s_nop 0
    buffer_load_dwordx4 v11, s[12:15], s55 offen lds
    s_add_u32 s55, s53, 372736
    s_add_u32 m0, s54, 110592
    s_nop 0
    buffer_load_dwordx4 v11, s[12:15], s55 offen lds
    ds_read_b128 v[40:43], v12 offset:0
    ds_read_b128 v[44:47], v12 offset:2048
    ds_read_b64_tr_b16 v[56:57], v26 offset:0
    ds_read_b64_tr_b16 v[58:59], v26 offset:512
    ds_read_b64_tr_b16 v[60:61], v27 offset:0
    ds_read_b64_tr_b16 v[62:63], v27 offset:512
    ds_read_b128 v[48:51], v13 offset:0
    ds_read_b128 v[52:55], v13 offset:2048
    ds_read_b64_tr_b16 v[64:65], v26 offset:4096
    ds_read_b64_tr_b16 v[66:67], v26 offset:4608
    ds_read_b64_tr_b16 v[68:69], v27 offset:4096
    ds_read_b64_tr_b16 v[70:71], v27 offset:4608
    s_waitcnt lgkmcnt(6)
    v_mfma_f32_16x16x32_bf16 a[0:3], v[56:59], v[40:43], 0
    v_mfma_f32_16x16x32_bf16 a[4:7], v[60:63], v[40:43], 0
    v_mfma_f32_16x16x32_bf16 a[8:11], v[56:59], v[44:47], 0
    v_mfma_f32_16x16x32_bf16 a[12:15], v[60:63], v[44:47], 0
    s_waitcnt lgkmcnt(0)
    v_mfma_f32_16x16x32_bf16 a[0:3], v[64:67], v[48:51], a[0:3]
    v_mfma_f32_16x16x32_bf16 a[4:7], v[68:71], v[48:51], a[4:7]
    v_mfma_f32_16x16x32_bf16 a[8:11], v[64:67], v[52:55], a[8:11]
    v_mfma_f32_16x16x32_bf16 a[12:15], v[68:71], v[52:55], a[12:15]
    s_waitcnt vmcnt(24)
    s_barrier
    ds_read_b128 v[40:43], v14 offset:0
    ds_read_b128 v[44:47], v14 offset:2048
    ds_read_b64_tr_b16 v[56:57], v28 offset:0
    ds_read_b64_tr_b16 v[58:59], v28 offset:512
    ds_read_b64_tr_b16 v[60:61], v29 offset:0
    ds_read_b64_tr_b16 v[62:63], v29 offset:512
    ds_read_b128 v[48:51], v15 offset:0
    ds_read_b128 v[52:55], v15 offset:2048
    ds_read_b64_tr_b16 v[64:65], v28 offset:4096
    ds_read_b64_tr_b16 v[66:67], v28 offset:4608
    ds_read_b64_tr_b16 v[68:69], v29 offset:4096
    ds_read_b64_tr_b16 v[70:71], v29 offset:4608
    s_waitcnt lgkmcnt(6)
    v_mfma_f32_16x16x32_bf16 a[0:3], v[56:59], v[40:43], a[0:3]
    v_mfma_f32_16x16x32_bf16 a[4:7], v[60:63], v[40:43], a[4:7]
    v_mfma_f32_16x16x32_bf16 a[8:11], v[56:59], v[44:47], a[8:11]
    v_mfma_f32_16x16x32_bf16 a[12:15], v[60:63], v[44:47], a[12:15]
    s_waitcnt lgkmcnt(0)
    v_mfma_f32_16x16x32_bf16 a[0:3], v[64:67], v[48:51], a[0:3]
    v_mfma_f32_16x16x32_bf16 a[4:7], v[68:71], v[48:51], a[4:7]
    v_mfma_f32_16x16x32_bf16 a[8:11], v[64:67], v[52:55], a[8:11]
    v_mfma_f32_16x16x32_bf16 a[12:15], v[68:71], v[52:55], a[12:15]
    s_waitcnt vmcnt(20)
    s_barrier
    ds_read_b128 v[40:43], v16 offset:0
    ds_read_b128 v[44:47], v16 offset:2048
    ds_read_b64_tr_b16 v[56:57], v30 offset:0
    ds_read_b64_tr_b16 v[58:59], v30 offset:512
    ds_read_b64_tr_b16 v[60:61], v31 offset:0
    ds_read_b64_tr_b16 v[62:63], v31 offset:512
    ds_read_b128 v[48:51], v17 offset:0
    ds_read_b128 v[52:55], v17 offset:2048
    ds_read_b64_tr_b16 v[64:65], v30 offset:4096
    ds_read_b64_tr_b16 v[66:67], v30 offset:4608
    ds_read_b64_tr_b16 v[68:69], v31 offset:4096
    ds_read_b64_tr_b16 v[70:71], v31 offset:4608
    s_waitcnt lgkmcnt(6)
    v_mfma_f32_16x16x32_bf16 a[0:3], v[56:59], v[40:43], a[0:3]
    v_mfma_f32_16x16x32_bf16 a[4:7], v[60:63], v[40:43], a[4:7]
    v_mfma_f32_16x16x32_bf16 a[8:11], v[56:59], v[44:47], a[8:11]
    v_mfma_f32_16x16x32_bf16 a[12:15], v[60:63], v[44:47], a[12:15]
    s_waitcnt lgkmcnt(0)
    v_mfma_f32_16x16x32_bf16 a[0:3], v[64:67], v[48:51], a[0:3]
    v_mfma_f32_16x16x32_bf16 a[4:7], v[68:71], v[48:51], a[4:7]
    v_mfma_f32_16x16x32_bf16 a[8:11], v[64:67], v[52:55], a[8:11]
    v_mfma_f32_16x16x32_bf16 a[12:15], v[68:71], v[52:55], a[12:15]
    s_waitcnt vmcnt(16)
    s_barrier
    ds_read_b128 v[40:43], v18 offset:0
    ds_read_b128 v[44:47], v18 offset:2048
    ds_read_b64_tr_b16 v[56:57], v32 offset:0
    ds_read_b64_tr_b16 v[58:59], v32 offset:512
    ds_read_b64_tr_b16 v[60:61], v33 offset:0
    ds_read_b64_tr_b16 v[62:63], v33 offset:512
    ds_read_b128 v[48:51], v19 offset:0
    ds_read_b128 v[52:55], v19 offset:2048
    ds_read_b64_tr_b16 v[64:65], v32 offset:4096
    ds_read_b64_tr_b16 v[66:67], v32 offset:4608
    ds_read_b64_tr_b16 v[68:69], v33 offset:4096
    ds_read_b64_tr_b16 v[70:71], v33 offset:4608
    s_waitcnt lgkmcnt(6)
    v_mfma_f32_16x16x32_bf16 a[0:3], v[56:59], v[40:43], a[0:3]
    v_mfma_f32_16x16x32_bf16 a[4:7], v[60:63], v[40:43], a[4:7]
    v_mfma_f32_16x16x32_bf16 a[8:11], v[56:59], v[44:47], a[8:11]
    v_mfma_f32_16x16x32_bf16 a[12:15], v[60:63], v[44:47], a[12:15]
    s_waitcnt lgkmcnt(0)
    v_mfma_f32_16x16x32_bf16 a[0:3], v[64:67], v[48:51], a[0:3]
    v_mfma_f32_16x16x32_bf16 a[4:7], v[68:71], v[48:51], a[4:7]
    v_mfma_f32_16x16x32_bf16 a[8:11], v[64:67], v[52:55], a[8:11]
    v_mfma_f32_16x16x32_bf16 a[12:15], v[68:71], v[52:55], a[12:15]
    s_waitcnt vmcnt(12)
    s_barrier
    ds_read_b128 v[40:43], v20 offset:0
    ds_read_b128 v[44:47], v20 offset:2048
    ds_read_b64_tr_b16 v[56:57], v34 offset:0
    ds_read_b64_tr_b16 v[58:59], v34 offset:512
    ds_read_b64_tr_b16 v[60:61], v35 offset:0
    ds_read_b64_tr_b16 v[62:63], v35 offset:512
    ds_read_b128 v[48:51], v21 offset:0
    ds_read_b128 v[52:55], v21 offset:2048
    ds_read_b64_tr_b16 v[64:65], v34 offset:4096
    ds_read_b64_tr_b16 v[66:67], v34 offset:4608
    ds_read_b64_tr_b16 v[68:69], v35 offset:4096
    ds_read_b64_tr_b16 v[70:71], v35 offset:4608
    s_waitcnt lgkmcnt(6)
    v_mfma_f32_16x16x32_bf16 a[0:3], v[56:59], v[40:43], a[0:3]
    v_mfma_f32_16x16x32_bf16 a[4:7], v[60:63], v[40:43], a[4:7]
    v_mfma_f32_16x16x32_bf16 a[8:11], v[56:59], v[44:47], a[8:11]
    v_mfma_f32_16x16x32_bf16 a[12:15], v[60:63], v[44:47], a[12:15]
    s_waitcnt lgkmcnt(0)
    v_mfma_f32_16x16x32_bf16 a[0:3], v[64:67], v[48:51], a[0:3]
    v_mfma_f32_16x16x32_bf16 a[4:7], v[68:71], v[48:51], a[4:7]
    v_mfma_f32_16x16x32_bf16 a[8:11], v[64:67], v[52:55], a[8:11]
    v_mfma_f32_16x16x32_bf16 a[12:15], v[68:71], v[52:55], a[12:15]
    s_waitcnt vmcnt(8)
    s_barrier
    ds_read_b128 v[40:43], v22 offset:0
    ds_read_b128 v[44:47], v22 offset:2048
    ds_read_b64_tr_b16 v[56:57], v36 offset:0
    ds_read_b64_tr_b16 v[58:59], v36 offset:512
    ds_read_b64_tr_b16 v[60:61], v37 offset:0
    ds_read_b64_tr_b16 v[62:63], v37 offset:512
    ds_read_b128 v[48:51], v23 offset:0
    ds_read_b128 v[52:55], v23 offset:2048
    ds_read_b64_tr_b16 v[64:65], v36 offset:4096
    ds_read_b64_tr_b16 v[66:67], v36 offset:4608
    ds_read_b64_tr_b16 v[68:69], v37 offset:4096
    ds_read_b64_tr_b16 v[70:71], v37 offset:4608
    s_waitcnt lgkmcnt(6)
    v_mfma_f32_16x16x32_bf16 a[0:3], v[56:59], v[40:43], a[0:3]
    v_mfma_f32_16x16x32_bf16 a[4:7], v[60:63], v[40:43], a[4:7]
    v_mfma_f32_16x16x32_bf16 a[8:11], v[56:59], v[44:47], a[8:11]
    v_mfma_f32_16x16x32_bf16 a[12:15], v[60:63], v[44:47], a[12:15]
    s_waitcnt lgkmcnt(0)
    v_mfma_f32_16x16x32_bf16 a[0:3], v[64:67], v[48:51], a[0:3]
    v_mfma_f32_16x16x32_bf16 a[4:7], v[68:71], v[48:51], a[4:7]
    v_mfma_f32_16x16x32_bf16 a[8:11], v[64:67], v[52:55], a[8:11]
    v_mfma_f32_16x16x32_bf16 a[12:15], v[68:71], v[52:55], a[12:15]
    s_waitcnt vmcnt(0)
    s_barrier
    ds_read_b128 v[40:43], v24 offset:0
    ds_read_b128 v[44:47], v24 offset:2048
    ds_read_b64_tr_b16 v[56:57], v38 offset:0
    ds_read_b64_tr_b16 v[58:59], v38 offset:512
    ds_read_b64_tr_b16 v[60:61], v39 offset:0
    ds_read_b64_tr_b16 v[62:63], v39 offset:512
    ds_read_b128 v[48:51], v25 offset:0
    ds_read_b128 v[52:55], v25 offset:2048
    ds_read_b64_tr_b16 v[64:65], v38 offset:4096
    ds_read_b64_tr_b16 v[66:67], v38 offset:4608
    ds_read_b64_tr_b16 v[68:69], v39 offset:4096
    ds_read_b64_tr_b16 v[70:71], v39 offset:4608
    s_waitcnt lgkmcnt(6)
    v_mfma_f32_16x16x32_bf16 a[0:3], v[56:59], v[40:43], a[0:3]
    v_mfma_f32_16x16x32_bf16 a[4:7], v[60:63], v[40:43], a[4:7]
    v_mfma_f32_16x16x32_bf16 a[8:11], v[56:59], v[44:47], a[8:11]
    v_mfma_f32_16x16x32_bf16 a[12:15], v[60:63], v[44:47], a[12:15]
    s_waitcnt lgkmcnt(0)
    v_mfma_f32_16x16x32_bf16 a[0:3], v[64:67], v[48:51], a[0:3]
    v_mfma_f32_16x16x32_bf16 a[4:7], v[68:71], v[48:51], a[4:7]
    v_mfma_f32_16x16x32_bf16 a[8:11], v[64:67], v[52:55], a[8:11]
    v_mfma_f32_16x16x32_bf16 a[12:15], v[68:71], v[52:55], a[12:15]
    s_waitcnt vmcnt(0)
    s_nop 3
    v_accvgpr_read_b32 v40, a0
    v_accvgpr_read_b32 v41, a1
    v_accvgpr_read_b32 v42, a2
    v_accvgpr_read_b32 v43, a3
    v_lshlrev_b32 v48, 16, v72
    v_and_b32 v49, 0xffff0000, v72
    v_lshlrev_b32 v50, 16, v73
    v_and_b32 v51, 0xffff0000, v73
    v_add_f32 v40, v40, v48
    v_add_f32 v41, v41, v49
    v_add_f32 v42, v42, v50
    v_add_f32 v43, v43, v51
    v_cvt_pk_bf16_f32 v48, v40, v41
    v_cvt_pk_bf16_f32 v49, v42, v43
    buffer_store_dwordx2 v[48:49], v83, s[20:23], 0 offen offset:0
    v_accvgpr_read_b32 v40, a4
    v_accvgpr_read_b32 v41, a5
    v_accvgpr_read_b32 v42, a6
    v_accvgpr_read_b32 v43, a7
    v_lshlrev_b32 v48, 16, v74
    v_and_b32 v49, 0xffff0000, v74
    v_lshlrev_b32 v50, 16, v75
    v_and_b32 v51, 0xffff0000, v75
    v_add_f32 v40, v40, v48
    v_add_f32 v41, v41, v49
    v_add_f32 v42, v42, v50
    v_add_f32 v43, v43, v51
    v_cvt_pk_bf16_f32 v48, v40, v41
    v_cvt_pk_bf16_f32 v49, v42, v43
    buffer_store_dwordx2 v[48:49], v83, s[20:23], 0 offen offset:32
    v_accvgpr_read_b32 v40, a8
    v_accvgpr_read_b32 v41, a9
    v_accvgpr_read_b32 v42, a10
    v_accvgpr_read_b32 v43, a11
    v_lshlrev_b32 v48, 16, v76
    v_and_b32 v49, 0xffff0000, v76
    v_lshlrev_b32 v50, 16, v77
    v_and_b32 v51, 0xffff0000, v77
    v_add_f32 v40, v40, v48
    v_add_f32 v41, v41, v49
    v_add_f32 v42, v42, v50
    v_add_f32 v43, v43, v51
    v_cvt_pk_bf16_f32 v48, v40, v41
    v_cvt_pk_bf16_f32 v49, v42, v43
    buffer_store_dwordx2 v[48:49], v84, s[20:23], 0 offen offset:0
    v_accvgpr_read_b32 v40, a12
    v_accvgpr_read_b32 v41, a13
    v_accvgpr_read_b32 v42, a14
    v_accvgpr_read_b32 v43, a15
    v_lshlrev_b32 v48, 16, v78
    v_and_b32 v49, 0xffff0000, v78
    v_lshlrev_b32 v50, 16, v79
    v_and_b32 v51, 0xffff0000, v79
    v_add_f32 v40, v40, v48
    v_add_f32 v41, v41, v49
    v_add_f32 v42, v42, v50
    v_add_f32 v43, v43, v51
    v_cvt_pk_bf16_f32 v48, v40, v41
    v_cvt_pk_bf16_f32 v49, v42, v43
    buffer_store_dwordx2 v[48:49], v84, s[20:23], 0 offen offset:32
L_wo0_kernel_end:
    s_endpgm
.globl ffn1_kernel
.p2align 8
.type ffn1_kernel,@function
ffn1_kernel:
    s_cmp_ge_u32 s2, 224
    s_cbranch_scc1 L_ffn1_kernel_end
    s_load_dwordx2 s[4:5], s[0:1], 72
    s_load_dwordx2 s[34:35], s[0:1], 32
    s_load_dwordx2 s[36:37], s[0:1], 40
    s_lshr_b32 s45, s2, 3
    s_mov_b32 s44, 0x12492493
    s_mul_hi_u32 s28, s45, s44
    s_mul_i32 s44, s28, 14
    s_sub_u32 s29, s45, s44
    s_and_b32 s44, s2, 7
    s_mul_i32 s44, s44, 2
    s_add_u32 s28, s28, s44
    s_mov_b32 s50, 0x3f803f80
    v_lshrrev_b32 v2, 6, v0
    s_nop 0
    v_readfirstlane_b32 s51, v2
    v_and_b32 v9, 63, v0
    s_and_b32 s44, s51, 1
    s_lshl_b32 s44, s44, 2
    v_lshrrev_b32 v2, 4, v9
    v_add_u32 v2, s44, v2
    v_and_b32 v2, 7, v2
    v_and_b32 v3, 7, v9
    v_xor_b32 v2, v2, v3
    v_lshrrev_b32 v3, 3, v9
    v_mul_u32_u24 v3, 896, v3
    v_lshl_add_u32 v10, v2, 4, v3
    s_lshr_b32 s44, s51, 1
    s_lshl_b32 s44, s44, 2
    v_lshrrev_b32 v2, 4, v9
    v_or_b32 v3, s44, v2
    v_bfe_u32 v4, v9, 1, 3
    v_xor_b32 v3, v3, v4
    v_and_b32 v4, 1, v9
    v_lshl_add_u32 v3, v3, 1, v4
    v_mul_u32_u24 v2, 3584, v2
    v_lshl_add_u32 v2, v3, 4, v2
    v_mov_b32 v11, v2
    v_mov_b32 v12, v2
    s_waitcnt lgkmcnt(0)
    s_mov_b32 s8, s4
    s_mov_b32 s9, s5
    s_mov_b32 s10, 0x1c0000
    s_mov_b32 s11, 0x00020000
    s_mov_b32 s12, s34
    s_mov_b32 s13, s35
    s_mov_b32 s14, 0x188000
    s_mov_b32 s15, 0x00020000
    s_mov_b32 s16, s36
    s_mov_b32 s17, s37
    s_mov_b32 s18, 0x188000
    s_mov_b32 s19, 0x00020000
    s_mul_i32 s52, s28, 114688
    s_mul_i32 s44, s51, 7168
    s_add_u32 s52, s52, s44
    s_mul_i32 s53, s29, 256
    s_mul_i32 s44, s51, 14336
    s_add_u32 s53, s53, s44
    s_lshl_b32 s54, s51, 10
    s_add_u32 s55, s52, 0
    s_add_u32 m0, s54, 0
    s_nop 0
    buffer_load_dwordx4 v10, s[8:11], s55 offen lds
    s_add_u32 s55, s52, 28672
    s_add_u32 m0, s54, 4096
    s_nop 0
    buffer_load_dwordx4 v10, s[8:11], s55 offen lds
    s_add_u32 s55, s52, 57344
    s_add_u32 m0, s54, 8192
    s_nop 0
    buffer_load_dwordx4 v10, s[8:11], s55 offen lds
    s_add_u32 s55, s52, 86016
    s_add_u32 m0, s54, 12288
    s_nop 0
    buffer_load_dwordx4 v10, s[8:11], s55 offen lds
    s_add_u32 s55, s53, 0
    s_add_u32 m0, s54, 16384
    s_nop 0
    buffer_load_dwordx4 v11, s[12:15], s55 offen lds
    s_add_u32 s55, s53, 57344
    s_add_u32 m0, s54, 20480
    s_nop 0
    buffer_load_dwordx4 v11, s[12:15], s55 offen lds
    s_add_u32 s55, s53, 114688
    s_add_u32 m0, s54, 24576
    s_nop 0
    buffer_load_dwordx4 v11, s[12:15], s55 offen lds
    s_add_u32 s55, s53, 172032
    s_add_u32 m0, s54, 28672
    s_nop 0
    buffer_load_dwordx4 v11, s[12:15], s55 offen lds
    s_add_u32 s55, s53, 0
    s_add_u32 m0, s54, 32768
    s_nop 0
    buffer_load_dwordx4 v12, s[16:19], s55 offen lds
    s_add_u32 s55, s53, 57344
    s_add_u32 m0, s54, 36864
    s_nop 0
    buffer_load_dwordx4 v12, s[16:19], s55 offen lds
    s_add_u32 s55, s53, 114688
    s_add_u32 m0, s54, 40960
    s_nop 0
    buffer_load_dwordx4 v12, s[16:19], s55 offen lds
    s_add_u32 s55, s53, 172032
    s_add_u32 m0, s54, 45056
    s_nop 0
    buffer_load_dwordx4 v12, s[16:19], s55 offen lds
    s_add_u32 s55, s52, 128
    s_add_u32 m0, s54, 49152
    s_nop 0
    buffer_load_dwordx4 v10, s[8:11], s55 offen lds
    s_add_u32 s55, s52, 28800
    s_add_u32 m0, s54, 53248
    s_nop 0
    buffer_load_dwordx4 v10, s[8:11], s55 offen lds
    s_add_u32 s55, s52, 57472
    s_add_u32 m0, s54, 57344
    s_nop 0
    buffer_load_dwordx4 v10, s[8:11], s55 offen lds
    s_add_u32 s55, s52, 86144
    s_add_u32 m0, s54, 61440
    s_nop 0
    buffer_load_dwordx4 v10, s[8:11], s55 offen lds
    s_add_u32 s55, s53, 229376
    s_add_u32 m0, s54, 65536
    s_nop 0
    buffer_load_dwordx4 v11, s[12:15], s55 offen lds
    s_add_u32 s55, s53, 286720
    s_add_u32 m0, s54, 69632
    s_nop 0
    buffer_load_dwordx4 v11, s[12:15], s55 offen lds
    s_add_u32 s55, s53, 344064
    s_add_u32 m0, s54, 73728
    s_nop 0
    buffer_load_dwordx4 v11, s[12:15], s55 offen lds
    s_add_u32 s55, s53, 401408
    s_add_u32 m0, s54, 77824
    s_nop 0
    buffer_load_dwordx4 v11, s[12:15], s55 offen lds
    s_add_u32 s55, s53, 229376
    s_add_u32 m0, s54, 81920
    s_nop 0
    buffer_load_dwordx4 v12, s[16:19], s55 offen lds
    s_add_u32 s55, s53, 286720
    s_add_u32 m0, s54, 86016
    s_nop 0
    buffer_load_dwordx4 v12, s[16:19], s55 offen lds
    s_add_u32 s55, s53, 344064
    s_add_u32 m0, s54, 90112
    s_nop 0
    buffer_load_dwordx4 v12, s[16:19], s55 offen lds
    s_add_u32 s55, s53, 401408
    s_add_u32 m0, s54, 94208
    s_nop 0
    buffer_load_dwordx4 v12, s[16:19], s55 offen lds
    s_add_u32 s20, s4, 0xc00000
    s_addc_u32 s21, s5, 0
    s_mov_b32 s22, 0x700000
    s_mov_b32 s23, 0x00020000
    v_and_b32 v6, 15, v0
    v_bfe_u32 v7, v0, 4, 2
    s_lshr_b32 s44, s51, 1
    s_mul_i32 s44, s44, 64
    s_mul_i32 s45, s28, 128
    s_add_u32 s44, s44, s45
    v_add_u32 v157, s44, v6
    s_and_b32 s44, s51, 1
    s_mul_i32 s44, s44, 64
    s_mul_i32 s45, s29, 128
    s_add_u32 s44, s44, s45
    v_lshlrev_b32 v158, 2, v7
    v_add_u32 v158, s44, v158
    v_mul_u32_u24 v159, 3584, v157
    v_lshl_add_u32 v159, v158, 1, v159
    v_add_u32 v160, 0, v159
    v_add_u32 v161, 57344, v159
    v_add_u32 v162, 114688, v159
    v_add_u32 v163, 172032, v159
    s_lshr_b32 s44, s51, 1
    s_mul_i32 s44, s44, 8192
    v_bfe_u32 v2, v6, 1, 3
    v_mul_u32_u24 v3, 128, v6
    v_add_u32 v3, s44, v3
    v_add_u32 v4, 0, v7
    v_xor_b32 v4, v4, v2
    v_lshl_add_u32 v4, v4, 4, v3
    v_add_u32 v13, 0, v4
    v_add_u32 v15, 49152, v4
    v_add_u32 v17, 98304, v4
    v_add_u32 v4, 4, v7
    v_xor_b32 v4, v4, v2
    v_lshl_add_u32 v4, v4, 4, v3
    v_add_u32 v14, 0, v4
    v_add_u32 v16, 49152, v4
    v_add_u32 v18, 98304, v4
    v_lshrrev_b32 v2, 2, v6
    v_lshl_add_u32 v3, v7, 3, v2
    v_mul_u32_u24 v3, 256, v3
    v_and_b32 v4, 3, v6
    v_lshl_add_u32 v3, v4, 3, v3
    v_and_b32 v4, 1, v7
    v_lshl_or_b32 v2, v4, 2, v2
    s_and_b32 s44, s51, 1
    s_mul_i32 s45, s44, 4
    s_add_u32 s45, s45, 0
    v_xor_b32 v4, s45, v2
    v_lshl_add_u32 v4, v4, 5, v3
    v_add_u32 v19, 16384, v4
    v_add_u32 v27, 65536, v4
    v_add_u32 v35, 114688, v4
    s_mul_i32 s45, s44, 4
    s_add_u32 s45, s45, 1
    v_xor_b32 v4, s45, v2
    v_lshl_add_u32 v4, v4, 5, v3
    v_add_u32 v20, 16384, v4
    v_add_u32 v28, 65536, v4
    v_add_u32 v36, 114688, v4
    s_mul_i32 s45, s44, 4
    s_add_u32 s45, s45, 2
    v_xor_b32 v4, s45, v2
    v_lshl_add_u32 v4, v4, 5, v3
    v_add_u32 v21, 16384, v4
    v_add_u32 v29, 65536, v4
    v_add_u32 v37, 114688, v4
    s_mul_i32 s45, s44, 4
    s_add_u32 s45, s45, 3
    v_xor_b32 v4, s45, v2
    v_lshl_add_u32 v4, v4, 5, v3
    v_add_u32 v22, 16384, v4
    v_add_u32 v30, 65536, v4
    v_add_u32 v38, 114688, v4
    s_mul_i32 s45, s44, 4
    s_add_u32 s45, s45, 0
    v_xor_b32 v4, s45, v2
    v_lshl_add_u32 v4, v4, 5, v3
    v_add_u32 v23, 32768, v4
    v_add_u32 v31, 81920, v4
    v_add_u32 v39, 131072, v4
    s_mul_i32 s45, s44, 4
    s_add_u32 s45, s45, 1
    v_xor_b32 v4, s45, v2
    v_lshl_add_u32 v4, v4, 5, v3
    v_add_u32 v24, 32768, v4
    v_add_u32 v32, 81920, v4
    v_add_u32 v40, 131072, v4
    s_mul_i32 s45, s44, 4
    s_add_u32 s45, s45, 2
    v_xor_b32 v4, s45, v2
    v_lshl_add_u32 v4, v4, 5, v3
    v_add_u32 v25, 32768, v4
    v_add_u32 v33, 81920, v4
    v_add_u32 v41, 131072, v4
    s_mul_i32 s45, s44, 4
    s_add_u32 s45, s45, 3
    v_xor_b32 v4, s45, v2
    v_lshl_add_u32 v4, v4, 5, v3
    v_add_u32 v26, 32768, v4
    v_add_u32 v34, 81920, v4
    v_add_u32 v42, 131072, v4
    v_mov_b32 v156, s50
    v_mov_b32 v140, 0
    v_mov_b32 v144, 0
    v_mov_b32 v141, 0
    v_mov_b32 v145, 0
    v_mov_b32 v142, 0
    v_mov_b32 v146, 0
    v_mov_b32 v143, 0
    v_mov_b32 v147, 0
    v_mov_b32 v148, 0
    v_mov_b32 v149, 0
    v_mov_b32 v150, 0
    v_mov_b32 v151, 0
    v_mov_b32 v152, 0
    v_mov_b32 v153, 0
    v_mov_b32 v154, 0
    v_mov_b32 v155, 0
    s_waitcnt vmcnt(12)
    s_barrier
    s_add_u32 s55, s52, 256
    s_add_u32 m0, s54, 98304
    s_nop 0
    buffer_load_dwordx4 v10, s[8:11], s55 offen lds
    s_add_u32 s55, s52, 28928
    s_add_u32 m0, s54, 102400
    s_nop 0
    buffer_load_dwordx4 v10, s[8:11], s55 offen lds
    s_add_u32 s55, s52, 57600
    s_add_u32 m0, s54, 106496
    s_nop 0
    buffer_load_dwordx4 v10, s[8:11], s55 offen lds
    s_add_u32 s55, s52, 86272
    s_add_u32 m0, s54, 110592
    s_nop 0
    buffer_load_dwordx4 v10, s[8:11], s55 offen lds
    s_add_u32 s55, s53, 458752
    s_add_u32 m0, s54, 114688
    s_nop 0
    buffer_load_dwordx4 v11, s[12:15], s55 offen lds
    s_add_u32 s55, s53, 516096
    s_add_u32 m0, s54, 118784
    s_nop 0
    buffer_load_dwordx4 v11, s[12:15], s55 offen lds
    s_add_u32 s55, s53, 573440
    s_add_u32 m0, s54, 122880
    s_nop 0
    buffer_load_dwordx4 v11, s[12:15], s55 offen lds
    s_add_u32 s55, s53, 630784
    s_add_u32 m0, s54, 126976
    s_nop 0
    buffer_load_dwordx4 v11, s[12:15], s55 offen lds
    s_add_u32 s55, s53, 458752
    s_add_u32 m0, s54, 131072
    s_nop 0
    buffer_load_dwordx4 v12, s[16:19], s55 offen lds
    s_add_u32 s55, s53, 516096
    s_add_u32 m0, s54, 135168
    s_nop 0
    buffer_load_dwordx4 v12, s[16:19], s55 offen lds
    s_add_u32 s55, s53, 573440
    s_add_u32 m0, s54, 139264
    s_nop 0
    buffer_load_dwordx4 v12, s[16:19], s55 offen lds
    s_add_u32 s55, s53, 630784
    s_add_u32 m0, s54, 143360
    s_nop 0
    buffer_load_dwordx4 v12, s[16:19], s55 offen lds
    ds_read_b128 v[44:47], v13 offset:0
    ds_read_b128 v[48:51], v13 offset:2048
    ds_read_b128 v[52:55], v13 offset:4096
    ds_read_b128 v[56:59], v13 offset:6144
    ds_read_b64_tr_b16 v[76:77], v19 offset:0
    ds_read_b64_tr_b16 v[78:79], v19 offset:1024
    ds_read_b64_tr_b16 v[80:81], v20 offset:0
    ds_read_b64_tr_b16 v[82:83], v20 offset:1024
    ds_read_b64_tr_b16 v[84:85], v21 offset:0
    ds_read_b64_tr_b16 v[86:87], v21 offset:1024
    ds_read_b64_tr_b16 v[88:89], v22 offset:0
    ds_read_b64_tr_b16 v[90:91], v22 offset:1024
    ds_read_b64_tr_b16 v[92:93], v23 offset:0
    ds_read_b64_tr_b16 v[94:95], v23 offset:1024
    ds_read_b64_tr_b16 v[96:97], v24 offset:0
    ds_read_b64_tr_b16 v[98:99], v24 offset:1024
    ds_read_b64_tr_b16 v[100:101], v25 offset:0
    ds_read_b64_tr_b16 v[102:103], v25 offset:1024
    ds_read_b64_tr_b16 v[104:105], v26 offset:0
    ds_read_b64_tr_b16 v[106:107], v26 offset:1024
    ds_read_b128 v[60:63], v14 offset:0
    ds_read_b128 v[64:67], v14 offset:2048
    ds_read_b128 v[68:71], v14 offset:4096
    ds_read_b128 v[72:75], v14 offset:6144
    ds_read_b64_tr_b16 v[108:109], v19 offset:8192
    ds_read_b64_tr_b16 v[110:111], v19 offset:9216
    ds_read_b64_tr_b16 v[112:113], v20 offset:8192
    ds_read_b64_tr_b16 v[114:115], v20 offset:9216
    ds_read_b64_tr_b16 v[116:117], v21 offset:8192
    ds_read_b64_tr_b16 v[118:119], v21 offset:9216
    ds_read_b64_tr_b16 v[120:121], v22 offset:8192
    ds_read_b64_tr_b16 v[122:123], v22 offset:9216
    ds_read_b64_tr_b16 v[124:125], v23 offset:8192
    ds_read_b64_tr_b16 v[126:127], v23 offset:9216
    ds_read_b64_tr_b16 v[128:129], v24 offset:8192
    ds_read_b64_tr_b16 v[130:131], v24 offset:9216
    ds_read_b64_tr_b16 v[132:133], v25 offset:8192
    ds_read_b64_tr_b16 v[134:135], v25 offset:9216
    ds_read_b64_tr_b16 v[136:137], v26 offset:8192
    ds_read_b64_tr_b16 v[138:139], v26 offset:9216
    s_waitcnt lgkmcnt(15)
    v_mfma_f32_16x16x32_bf16 a[0:3], v[76:79], v[44:47], 0
    v_mfma_f32_16x16x32_bf16 a[4:7], v[80:83], v[44:47], 0
    v_mfma_f32_16x16x32_bf16 a[8:11], v[84:87], v[44:47], 0
    v_mfma_f32_16x16x32_bf16 a[12:15], v[88:91], v[44:47], 0
    v_mfma_f32_16x16x32_bf16 a[16:19], v[92:95], v[44:47], 0
    v_mfma_f32_16x16x32_bf16 a[20:23], v[96:99], v[44:47], 0
    v_mfma_f32_16x16x32_bf16 a[24:27], v[100:103], v[44:47], 0
    v_mfma_f32_16x16x32_bf16 a[28:31], v[104:107], v[44:47], 0
    v_mfma_f32_16x16x32_bf16 a[32:35], v[76:79], v[48:51], 0
    v_mfma_f32_16x16x32_bf16 a[36:39], v[80:83], v[48:51], 0
    v_mfma_f32_16x16x32_bf16 a[40:43], v[84:87], v[48:51], 0
    v_mfma_f32_16x16x32_bf16 a[44:47], v[88:91], v[48:51], 0
    v_mfma_f32_16x16x32_bf16 a[48:51], v[92:95], v[48:51], 0
    v_mfma_f32_16x16x32_bf16 a[52:55], v[96:99], v[48:51], 0
    v_mfma_f32_16x16x32_bf16 a[56:59], v[100:103], v[48:51], 0
    v_mfma_f32_16x16x32_bf16 a[60:63], v[104:107], v[48:51], 0
    v_mfma_f32_16x16x32_bf16 a[64:67], v[76:79], v[52:55], 0
    v_mfma_f32_16x16x32_bf16 a[68:71], v[80:83], v[52:55], 0
    v_mfma_f32_16x16x32_bf16 a[72:75], v[84:87], v[52:55], 0
    v_mfma_f32_16x16x32_bf16 a[76:79], v[88:91], v[52:55], 0
    v_mfma_f32_16x16x32_bf16 a[80:83], v[92:95], v[52:55], 0
    v_mfma_f32_16x16x32_bf16 a[84:87], v[96:99], v[52:55], 0
    v_mfma_f32_16x16x32_bf16 a[88:91], v[100:103], v[52:55], 0
    v_mfma_f32_16x16x32_bf16 a[92:95], v[104:107], v[52:55], 0
    v_mfma_f32_16x16x32_bf16 a[96:99], v[76:79], v[56:59], 0
    v_mfma_f32_16x16x32_bf16 a[100:103], v[80:83], v[56:59], 0
    v_mfma_f32_16x16x32_bf16 a[104:107], v[84:87], v[56:59], 0
    v_mfma_f32_16x16x32_bf16 a[108:111], v[88:91], v[56:59], 0
    v_mfma_f32_16x16x32_bf16 a[112:115], v[92:95], v[56:59], 0
    v_mfma_f32_16x16x32_bf16 a[116:119], v[96:99], v[56:59], 0
    v_mfma_f32_16x16x32_bf16 a[120:123], v[100:103], v[56:59], 0
    v_mfma_f32_16x16x32_bf16 a[124:127], v[104:107], v[56:59], 0
    v_dot2_f32_bf16 v140, v44, v156, v140
    v_dot2_f32_bf16 v144, v44, v44, v144
    v_dot2_f32_bf16 v141, v48, v156, v141
    v_dot2_f32_bf16 v145, v48, v48, v145
    v_dot2_f32_bf16 v142, v52, v156, v142
    v_dot2_f32_bf16 v146, v52, v52, v146
    v_dot2_f32_bf16 v143, v56, v156, v143
    v_dot2_f32_bf16 v147, v56, v56, v147
    v_dot2_f32_bf16 v148, v76, v156, v148
    v_dot2_f32_bf16 v149, v80, v156, v149
    v_dot2_f32_bf16 v150, v84, v156, v150
    v_dot2_f32_bf16 v151, v88, v156, v151
    v_dot2_f32_bf16 v152, v92, v156, v152
    v_dot2_f32_bf16 v153, v96, v156, v153
    v_dot2_f32_bf16 v154, v100, v156, v154
    v_dot2_f32_bf16 v155, v104, v156, v155
    v_dot2_f32_bf16 v140, v45, v156, v140
    v_dot2_f32_bf16 v144, v45, v45, v144
    v_dot2_f32_bf16 v141, v49, v156, v141
    v_dot2_f32_bf16 v145, v49, v49, v145
    v_dot2_f32_bf16 v142, v53, v156, v142
    v_dot2_f32_bf16 v146, v53, v53, v146
    v_dot2_f32_bf16 v143, v57, v156, v143
    v_dot2_f32_bf16 v147, v57, v57, v147
    v_dot2_f32_bf16 v148, v77, v156, v148
    v_dot2_f32_bf16 v149, v81, v156, v149
    v_dot2_f32_bf16 v150, v85, v156, v150
    v_dot2_f32_bf16 v151, v89, v156, v151
    v_dot2_f32_bf16 v152, v93, v156, v152
    v_dot2_f32_bf16 v153, v97, v156, v153
    v_dot2_f32_bf16 v154, v101, v156, v154
    v_dot2_f32_bf16 v155, v105, v156, v155
    v_dot2_f32_bf16 v140, v46, v156, v140
    v_dot2_f32_bf16 v144, v46, v46, v144
    v_dot2_f32_bf16 v141, v50, v156, v141
    v_dot2_f32_bf16 v145, v50, v50, v145
    v_dot2_f32_bf16 v142, v54, v156, v142
    v_dot2_f32_bf16 v146, v54, v54, v146
    v_dot2_f32_bf16 v143, v58, v156, v143
    v_dot2_f32_bf16 v147, v58, v58, v147
    v_dot2_f32_bf16 v148, v78, v156, v148
    v_dot2_f32_bf16 v149, v82, v156, v149
    v_dot2_f32_bf16 v150, v86, v156, v150
    v_dot2_f32_bf16 v151, v90, v156, v151
    v_dot2_f32_bf16 v152, v94, v156, v152
    v_dot2_f32_bf16 v153, v98, v156, v153
    v_dot2_f32_bf16 v154, v102, v156, v154
    v_dot2_f32_bf16 v155, v106, v156, v155
    v_dot2_f32_bf16 v140, v47, v156, v140
    v_dot2_f32_bf16 v144, v47, v47, v144
    v_dot2_f32_bf16 v141, v51, v156, v141
    v_dot2_f32_bf16 v145, v51, v51, v145
    v_dot2_f32_bf16 v142, v55, v156, v142
    v_dot2_f32_bf16 v146, v55, v55, v146
    v_dot2_f32_bf16 v143, v59, v156, v143
    v_dot2_f32_bf16 v147, v59, v59, v147
    v_dot2_f32_bf16 v148, v79, v156, v148
    v_dot2_f32_bf16 v149, v83, v156, v149
    v_dot2_f32_bf16 v150, v87, v156, v150
    v_dot2_f32_bf16 v151, v91, v156, v151
    v_dot2_f32_bf16 v152, v95, v156, v152
    v_dot2_f32_bf16 v153, v99, v156, v153
    v_dot2_f32_bf16 v154, v103, v156, v154
    v_dot2_f32_bf16 v155, v107, v156, v155
    s_waitcnt lgkmcnt(0)
    v_mfma_f32_16x16x32_bf16 a[0:3], v[108:111], v[60:63], a[0:3]
    v_mfma_f32_16x16x32_bf16 a[4:7], v[112:115], v[60:63], a[4:7]
    v_mfma_f32_16x16x32_bf16 a[8:11], v[116:119], v[60:63], a[8:11]
    v_mfma_f32_16x16x32_bf16 a[12:15], v[120:123], v[60:63], a[12:15]
    v_mfma_f32_16x16x32_bf16 a[16:19], v[124:127], v[60:63], a[16:19]
    v_mfma_f32_16x16x32_bf16 a[20:23], v[128:131], v[60:63], a[20:23]
    v_mfma_f32_16x16x32_bf16 a[24:27], v[132:135], v[60:63], a[24:27]
    v_mfma_f32_16x16x32_bf16 a[28:31], v[136:139], v[60:63], a[28:31]
    v_mfma_f32_16x16x32_bf16 a[32:35], v[108:111], v[64:67], a[32:35]
    v_mfma_f32_16x16x32_bf16 a[36:39], v[112:115], v[64:67], a[36:39]
    v_mfma_f32_16x16x32_bf16 a[40:43], v[116:119], v[64:67], a[40:43]
    v_mfma_f32_16x16x32_bf16 a[44:47], v[120:123], v[64:67], a[44:47]
    v_mfma_f32_16x16x32_bf16 a[48:51], v[124:127], v[64:67], a[48:51]
    v_mfma_f32_16x16x32_bf16 a[52:55], v[128:131], v[64:67], a[52:55]
    v_mfma_f32_16x16x32_bf16 a[56:59], v[132:135], v[64:67], a[56:59]
    v_mfma_f32_16x16x32_bf16 a[60:63], v[136:139], v[64:67], a[60:63]
    v_mfma_f32_16x16x32_bf16 a[64:67], v[108:111], v[68:71], a[64:67]
    v_mfma_f32_16x16x32_bf16 a[68:71], v[112:115], v[68:71], a[68:71]
    v_mfma_f32_16x16x32_bf16 a[72:75], v[116:119], v[68:71], a[72:75]
    v_mfma_f32_16x16x32_bf16 a[76:79], v[120:123], v[68:71], a[76:79]
    v_mfma_f32_16x16x32_bf16 a[80:83], v[124:127], v[68:71], a[80:83]
    v_mfma_f32_16x16x32_bf16 a[84:87], v[128:131], v[68:71], a[84:87]
    v_mfma_f32_16x16x32_bf16 a[88:91], v[132:135], v[68:71], a[88:91]
    v_mfma_f32_16x16x32_bf16 a[92:95], v[136:139], v[68:71], a[92:95]
    v_mfma_f32_16x16x32_bf16 a[96:99], v[108:111], v[72:75], a[96:99]
    v_mfma_f32_16x16x32_bf16 a[100:103], v[112:115], v[72:75], a[100:103]
    v_mfma_f32_16x16x32_bf16 a[104:107], v[116:119], v[72:75], a[104:107]
    v_mfma_f32_16x16x32_bf16 a[108:111], v[120:123], v[72:75], a[108:111]
    v_mfma_f32_16x16x32_bf16 a[112:115], v[124:127], v[72:75], a[112:115]
    v_mfma_f32_16x16x32_bf16 a[116:119], v[128:131], v[72:75], a[116:119]
    v_mfma_f32_16x16x32_bf16 a[120:123], v[132:135], v[72:75], a[120:123]
    v_mfma_f32_16x16x32_bf16 a[124:127], v[136:139], v[72:75], a[124:127]
    v_dot2_f32_bf16 v140, v60, v156, v140
    v_dot2_f32_bf16 v144, v60, v60, v144
    v_dot2_f32_bf16 v141, v64, v156, v141
    v_dot2_f32_bf16 v145, v64, v64, v145
    v_dot2_f32_bf16 v142, v68, v156, v142
    v_dot2_f32_bf16 v146, v68, v68, v146
    v_dot2_f32_bf16 v143, v72, v156, v143
    v_dot2_f32_bf16 v147, v72, v72, v147
    v_dot2_f32_bf16 v148, v108, v156, v148
    v_dot2_f32_bf16 v149, v112, v156, v149
    v_dot2_f32_bf16 v150, v116, v156, v150
    v_dot2_f32_bf16 v151, v120, v156, v151
    v_dot2_f32_bf16 v152, v124, v156, v152
    v_dot2_f32_bf16 v153, v128, v156, v153
    v_dot2_f32_bf16 v154, v132, v156, v154
    v_dot2_f32_bf16 v155, v136, v156, v155
    v_dot2_f32_bf16 v140, v61, v156, v140
    v_dot2_f32_bf16 v144, v61, v61, v144
    v_dot2_f32_bf16 v141, v65, v156, v141
    v_dot2_f32_bf16 v145, v65, v65, v145
    v_dot2_f32_bf16 v142, v69, v156, v142
    v_dot2_f32_bf16 v146, v69, v69, v146
    v_dot2_f32_bf16 v143, v73, v156, v143
    v_dot2_f32_bf16 v147, v73, v73, v147
    v_dot2_f32_bf16 v148, v109, v156, v148
    v_dot2_f32_bf16 v149, v113, v156, v149
    v_dot2_f32_bf16 v150, v117, v156, v150
    v_dot2_f32_bf16 v151, v121, v156, v151
    v_dot2_f32_bf16 v152, v125, v156, v152
    v_dot2_f32_bf16 v153, v129, v156, v153
    v_dot2_f32_bf16 v154, v133, v156, v154
    v_dot2_f32_bf16 v155, v137, v156, v155
    v_dot2_f32_bf16 v140, v62, v156, v140
    v_dot2_f32_bf16 v144, v62, v62, v144
    v_dot2_f32_bf16 v141, v66, v156, v141
    v_dot2_f32_bf16 v145, v66, v66, v145
    v_dot2_f32_bf16 v142, v70, v156, v142
    v_dot2_f32_bf16 v146, v70, v70, v146
    v_dot2_f32_bf16 v143, v74, v156, v143
    v_dot2_f32_bf16 v147, v74, v74, v147
    v_dot2_f32_bf16 v148, v110, v156, v148
    v_dot2_f32_bf16 v149, v114, v156, v149
    v_dot2_f32_bf16 v150, v118, v156, v150
    v_dot2_f32_bf16 v151, v122, v156, v151
    v_dot2_f32_bf16 v152, v126, v156, v152
    v_dot2_f32_bf16 v153, v130, v156, v153
    v_dot2_f32_bf16 v154, v134, v156, v154
    v_dot2_f32_bf16 v155, v138, v156, v155
    v_dot2_f32_bf16 v140, v63, v156, v140
    v_dot2_f32_bf16 v144, v63, v63, v144
    v_dot2_f32_bf16 v141, v67, v156, v141
    v_dot2_f32_bf16 v145, v67, v67, v145
    v_dot2_f32_bf16 v142, v71, v156, v142
    v_dot2_f32_bf16 v146, v71, v71, v146
    v_dot2_f32_bf16 v143, v75, v156, v143
    v_dot2_f32_bf16 v147, v75, v75, v147
    v_dot2_f32_bf16 v148, v111, v156, v148
    v_dot2_f32_bf16 v149, v115, v156, v149
    v_dot2_f32_bf16 v150, v119, v156, v150
    v_dot2_f32_bf16 v151, v123, v156, v151
    v_dot2_f32_bf16 v152, v127, v156, v152
    v_dot2_f32_bf16 v153, v131, v156, v153
    v_dot2_f32_bf16 v154, v135, v156, v154
    v_dot2_f32_bf16 v155, v139, v156, v155
    s_waitcnt vmcnt(12)
    s_barrier
    s_add_u32 s55, s52, 384
    s_add_u32 m0, s54, 0
    s_nop 0
    buffer_load_dwordx4 v10, s[8:11], s55 offen lds
    s_add_u32 s55, s52, 29056
    s_add_u32 m0, s54, 4096
    s_nop 0
    buffer_load_dwordx4 v10, s[8:11], s55 offen lds
    s_add_u32 s55, s52, 57728
    s_add_u32 m0, s54, 8192
    s_nop 0
    buffer_load_dwordx4 v10, s[8:11], s55 offen lds
    s_add_u32 s55, s52, 86400
    s_add_u32 m0, s54, 12288
    s_nop 0
    buffer_load_dwordx4 v10, s[8:11], s55 offen lds
    s_add_u32 s55, s53, 688128
    s_add_u32 m0, s54, 16384
    s_nop 0
    buffer_load_dwordx4 v11, s[12:15], s55 offen lds
    s_add_u32 s55, s53, 745472
    s_add_u32 m0, s54, 20480
    s_nop 0
    buffer_load_dwordx4 v11, s[12:15], s55 offen lds
    s_add_u32 s55, s53, 802816
    s_add_u32 m0, s54, 24576
    s_nop 0
    buffer_load_dwordx4 v11, s[12:15], s55 offen lds
    s_add_u32 s55, s53, 860160
    s_add_u32 m0, s54, 28672
    s_nop 0
    buffer_load_dwordx4 v11, s[12:15], s55 offen lds
    s_add_u32 s55, s53, 688128
    s_add_u32 m0, s54, 32768
    s_nop 0
    buffer_load_dwordx4 v12, s[16:19], s55 offen lds
    s_add_u32 s55, s53, 745472
    s_add_u32 m0, s54, 36864
    s_nop 0
    buffer_load_dwordx4 v12, s[16:19], s55 offen lds
    s_add_u32 s55, s53, 802816
    s_add_u32 m0, s54, 40960
    s_nop 0
    buffer_load_dwordx4 v12, s[16:19], s55 offen lds
    s_add_u32 s55, s53, 860160
    s_add_u32 m0, s54, 45056
    s_nop 0
    buffer_load_dwordx4 v12, s[16:19], s55 offen lds
    ds_read_b128 v[44:47], v15 offset:0
    ds_read_b128 v[48:51], v15 offset:2048
    ds_read_b128 v[52:55], v15 offset:4096
    ds_read_b128 v[56:59], v15 offset:6144
    ds_read_b64_tr_b16 v[76:77], v27 offset:0
    ds_read_b64_tr_b16 v[78:79], v27 offset:1024
    ds_read_b64_tr_b16 v[80:81], v28 offset:0
    ds_read_b64_tr_b16 v[82:83], v28 offset:1024
    ds_read_b64_tr_b16 v[84:85], v29 offset:0
    ds_read_b64_tr_b16 v[86:87], v29 offset:1024
    ds_read_b64_tr_b16 v[88:89], v30 offset:0
    ds_read_b64_tr_b16 v[90:91], v30 offset:1024
    ds_read_b64_tr_b16 v[92:93], v31 offset:0
    ds_read_b64_tr_b16 v[94:95], v31 offset:1024
    ds_read_b64_tr_b16 v[96:97], v32 offset:0
    ds_read_b64_tr_b16 v[98:99], v32 offset:1024
    ds_read_b64_tr_b16 v[100:101], v33 offset:0
    ds_read_b64_tr_b16 v[102:103], v33 offset:1024
    ds_read_b64_tr_b16 v[104:105], v34 offset:0
    ds_read_b64_tr_b16 v[106:107], v34 offset:1024
    ds_read_b128 v[60:63], v16 offset:0
    ds_read_b128 v[64:67], v16 offset:2048
    ds_read_b128 v[68:71], v16 offset:4096
    ds_read_b128 v[72:75], v16 offset:6144
    ds_read_b64_tr_b16 v[108:109], v27 offset:8192
    ds_read_b64_tr_b16 v[110:111], v27 offset:9216
    ds_read_b64_tr_b16 v[112:113], v28 offset:8192
    ds_read_b64_tr_b16 v[114:115], v28 offset:9216
    ds_read_b64_tr_b16 v[116:117], v29 offset:8192
    ds_read_b64_tr_b16 v[118:119], v29 offset:9216
    ds_read_b64_tr_b16 v[120:121], v30 offset:8192
    ds_read_b64_tr_b16 v[122:123], v30 offset:9216
    ds_read_b64_tr_b16 v[124:125], v31 offset:8192
    ds_read_b64_tr_b16 v[126:127], v31 offset:9216
    ds_read_b64_tr_b16 v[128:129], v32 offset:8192
    ds_read_b64_tr_b16 v[130:131], v32 offset:9216
    ds_read_b64_tr_b16 v[132:133], v33 offset:8192
    ds_read_b64_tr_b16 v[134:135], v33 offset:9216
    ds_read_b64_tr_b16 v[136:137], v34 offset:8192
    ds_read_b64_tr_b16 v[138:139], v34 offset:9216
    s_waitcnt lgkmcnt(15)
    v_mfma_f32_16x16x32_bf16 a[0:3], v[76:79], v[44:47], a[0:3]
    v_mfma_f32_16x16x32_bf16 a[4:7], v[80:83], v[44:47], a[4:7]
    v_mfma_f32_16x16x32_bf16 a[8:11], v[84:87], v[44:47], a[8:11]
    v_mfma_f32_16x16x32_bf16 a[12:15], v[88:91], v[44:47], a[12:15]
    v_mfma_f32_16x16x32_bf16 a[16:19], v[92:95], v[44:47], a[16:19]
    v_mfma_f32_16x16x32_bf16 a[20:23], v[96:99], v[44:47], a[20:23]
    v_mfma_f32_16x16x32_bf16 a[24:27], v[100:103], v[44:47], a[24:27]
    v_mfma_f32_16x16x32_bf16 a[28:31], v[104:107], v[44:47], a[28:31]
    v_mfma_f32_16x16x32_bf16 a[32:35], v[76:79], v[48:51], a[32:35]
    v_mfma_f32_16x16x32_bf16 a[36:39], v[80:83], v[48:51], a[36:39]
    v_mfma_f32_16x16x32_bf16 a[40:43], v[84:87], v[48:51], a[40:43]
    v_mfma_f32_16x16x32_bf16 a[44:47], v[88:91], v[48:51], a[44:47]
    v_mfma_f32_16x16x32_bf16 a[48:51], v[92:95], v[48:51], a[48:51]
    v_mfma_f32_16x16x32_bf16 a[52:55], v[96:99], v[48:51], a[52:55]
    v_mfma_f32_16x16x32_bf16 a[56:59], v[100:103], v[48:51], a[56:59]
    v_mfma_f32_16x16x32_bf16 a[60:63], v[104:107], v[48:51], a[60:63]
    v_mfma_f32_16x16x32_bf16 a[64:67], v[76:79], v[52:55], a[64:67]
    v_mfma_f32_16x16x32_bf16 a[68:71], v[80:83], v[52:55], a[68:71]
    v_mfma_f32_16x16x32_bf16 a[72:75], v[84:87], v[52:55], a[72:75]
    v_mfma_f32_16x16x32_bf16 a[76:79], v[88:91], v[52:55], a[76:79]
    v_mfma_f32_16x16x32_bf16 a[80:83], v[92:95], v[52:55], a[80:83]
    v_mfma_f32_16x16x32_bf16 a[84:87], v[96:99], v[52:55], a[84:87]
    v_mfma_f32_16x16x32_bf16 a[88:91], v[100:103], v[52:55], a[88:91]
    v_mfma_f32_16x16x32_bf16 a[92:95], v[104:107], v[52:55], a[92:95]
    v_mfma_f32_16x16x32_bf16 a[96:99], v[76:79], v[56:59], a[96:99]
    v_mfma_f32_16x16x32_bf16 a[100:103], v[80:83], v[56:59], a[100:103]
    v_mfma_f32_16x16x32_bf16 a[104:107], v[84:87], v[56:59], a[104:107]
    v_mfma_f32_16x16x32_bf16 a[108:111], v[88:91], v[56:59], a[108:111]
    v_mfma_f32_16x16x32_bf16 a[112:115], v[92:95], v[56:59], a[112:115]
    v_mfma_f32_16x16x32_bf16 a[116:119], v[96:99], v[56:59], a[116:119]
    v_mfma_f32_16x16x32_bf16 a[120:123], v[100:103], v[56:59], a[120:123]
    v_mfma_f32_16x16x32_bf16 a[124:127], v[104:107], v[56:59], a[124:127]
    v_dot2_f32_bf16 v140, v44, v156, v140
    v_dot2_f32_bf16 v144, v44, v44, v144
    v_dot2_f32_bf16 v141, v48, v156, v141
    v_dot2_f32_bf16 v145, v48, v48, v145
    v_dot2_f32_bf16 v142, v52, v156, v142
    v_dot2_f32_bf16 v146, v52, v52, v146
    v_dot2_f32_bf16 v143, v56, v156, v143
    v_dot2_f32_bf16 v147, v56, v56, v147
    v_dot2_f32_bf16 v148, v76, v156, v148
    v_dot2_f32_bf16 v149, v80, v156, v149
    v_dot2_f32_bf16 v150, v84, v156, v150
    v_dot2_f32_bf16 v151, v88, v156, v151
    v_dot2_f32_bf16 v152, v92, v156, v152
    v_dot2_f32_bf16 v153, v96, v156, v153
    v_dot2_f32_bf16 v154, v100, v156, v154
    v_dot2_f32_bf16 v155, v104, v156, v155
    v_dot2_f32_bf16 v140, v45, v156, v140
    v_dot2_f32_bf16 v144, v45, v45, v144
    v_dot2_f32_bf16 v141, v49, v156, v141
    v_dot2_f32_bf16 v145, v49, v49, v145
    v_dot2_f32_bf16 v142, v53, v156, v142
    v_dot2_f32_bf16 v146, v53, v53, v146
    v_dot2_f32_bf16 v143, v57, v156, v143
    v_dot2_f32_bf16 v147, v57, v57, v147
    v_dot2_f32_bf16 v148, v77, v156, v148
    v_dot2_f32_bf16 v149, v81, v156, v149
    v_dot2_f32_bf16 v150, v85, v156, v150
    v_dot2_f32_bf16 v151, v89, v156, v151
    v_dot2_f32_bf16 v152, v93, v156, v152
    v_dot2_f32_bf16 v153, v97, v156, v153
    v_dot2_f32_bf16 v154, v101, v156, v154
    v_dot2_f32_bf16 v155, v105, v156, v155
    v_dot2_f32_bf16 v140, v46, v156, v140
    v_dot2_f32_bf16 v144, v46, v46, v144
    v_dot2_f32_bf16 v141, v50, v156, v141
    v_dot2_f32_bf16 v145, v50, v50, v145
    v_dot2_f32_bf16 v142, v54, v156, v142
    v_dot2_f32_bf16 v146, v54, v54, v146
    v_dot2_f32_bf16 v143, v58, v156, v143
    v_dot2_f32_bf16 v147, v58, v58, v147
    v_dot2_f32_bf16 v148, v78, v156, v148
    v_dot2_f32_bf16 v149, v82, v156, v149
    v_dot2_f32_bf16 v150, v86, v156, v150
    v_dot2_f32_bf16 v151, v90, v156, v151
    v_dot2_f32_bf16 v152, v94, v156, v152
    v_dot2_f32_bf16 v153, v98, v156, v153
    v_dot2_f32_bf16 v154, v102, v156, v154
    v_dot2_f32_bf16 v155, v106, v156, v155
    v_dot2_f32_bf16 v140, v47, v156, v140
    v_dot2_f32_bf16 v144, v47, v47, v144
    v_dot2_f32_bf16 v141, v51, v156, v141
    v_dot2_f32_bf16 v145, v51, v51, v145
    v_dot2_f32_bf16 v142, v55, v156, v142
    v_dot2_f32_bf16 v146, v55, v55, v146
    v_dot2_f32_bf16 v143, v59, v156, v143
    v_dot2_f32_bf16 v147, v59, v59, v147
    v_dot2_f32_bf16 v148, v79, v156, v148
    v_dot2_f32_bf16 v149, v83, v156, v149
    v_dot2_f32_bf16 v150, v87, v156, v150
    v_dot2_f32_bf16 v151, v91, v156, v151
    v_dot2_f32_bf16 v152, v95, v156, v152
    v_dot2_f32_bf16 v153, v99, v156, v153
    v_dot2_f32_bf16 v154, v103, v156, v154
    v_dot2_f32_bf16 v155, v107, v156, v155
    s_waitcnt lgkmcnt(0)
    v_mfma_f32_16x16x32_bf16 a[0:3], v[108:111], v[60:63], a[0:3]
    v_mfma_f32_16x16x32_bf16 a[4:7], v[112:115], v[60:63], a[4:7]
    v_mfma_f32_16x16x32_bf16 a[8:11], v[116:119], v[60:63], a[8:11]
    v_mfma_f32_16x16x32_bf16 a[12:15], v[120:123], v[60:63], a[12:15]
    v_mfma_f32_16x16x32_bf16 a[16:19], v[124:127], v[60:63], a[16:19]
    v_mfma_f32_16x16x32_bf16 a[20:23], v[128:131], v[60:63], a[20:23]
    v_mfma_f32_16x16x32_bf16 a[24:27], v[132:135], v[60:63], a[24:27]
    v_mfma_f32_16x16x32_bf16 a[28:31], v[136:139], v[60:63], a[28:31]
    v_mfma_f32_16x16x32_bf16 a[32:35], v[108:111], v[64:67], a[32:35]
    v_mfma_f32_16x16x32_bf16 a[36:39], v[112:115], v[64:67], a[36:39]
    v_mfma_f32_16x16x32_bf16 a[40:43], v[116:119], v[64:67], a[40:43]
    v_mfma_f32_16x16x32_bf16 a[44:47], v[120:123], v[64:67], a[44:47]
    v_mfma_f32_16x16x32_bf16 a[48:51], v[124:127], v[64:67], a[48:51]
    v_mfma_f32_16x16x32_bf16 a[52:55], v[128:131], v[64:67], a[52:55]
    v_mfma_f32_16x16x32_bf16 a[56:59], v[132:135], v[64:67], a[56:59]
    v_mfma_f32_16x16x32_bf16 a[60:63], v[136:139], v[64:67], a[60:63]
    v_mfma_f32_16x16x32_bf16 a[64:67], v[108:111], v[68:71], a[64:67]
    v_mfma_f32_16x16x32_bf16 a[68:71], v[112:115], v[68:71], a[68:71]
    v_mfma_f32_16x16x32_bf16 a[72:75], v[116:119], v[68:71], a[72:75]
    v_mfma_f32_16x16x32_bf16 a[76:79], v[120:123], v[68:71], a[76:79]
    v_mfma_f32_16x16x32_bf16 a[80:83], v[124:127], v[68:71], a[80:83]
    v_mfma_f32_16x16x32_bf16 a[84:87], v[128:131], v[68:71], a[84:87]
    v_mfma_f32_16x16x32_bf16 a[88:91], v[132:135], v[68:71], a[88:91]
    v_mfma_f32_16x16x32_bf16 a[92:95], v[136:139], v[68:71], a[92:95]
    v_mfma_f32_16x16x32_bf16 a[96:99], v[108:111], v[72:75], a[96:99]
    v_mfma_f32_16x16x32_bf16 a[100:103], v[112:115], v[72:75], a[100:103]
    v_mfma_f32_16x16x32_bf16 a[104:107], v[116:119], v[72:75], a[104:107]
    v_mfma_f32_16x16x32_bf16 a[108:111], v[120:123], v[72:75], a[108:111]
    v_mfma_f32_16x16x32_bf16 a[112:115], v[124:127], v[72:75], a[112:115]
    v_mfma_f32_16x16x32_bf16 a[116:119], v[128:131], v[72:75], a[116:119]
    v_mfma_f32_16x16x32_bf16 a[120:123], v[132:135], v[72:75], a[120:123]
    v_mfma_f32_16x16x32_bf16 a[124:127], v[136:139], v[72:75], a[124:127]
    v_dot2_f32_bf16 v140, v60, v156, v140
    v_dot2_f32_bf16 v144, v60, v60, v144
    v_dot2_f32_bf16 v141, v64, v156, v141
    v_dot2_f32_bf16 v145, v64, v64, v145
    v_dot2_f32_bf16 v142, v68, v156, v142
    v_dot2_f32_bf16 v146, v68, v68, v146
    v_dot2_f32_bf16 v143, v72, v156, v143
    v_dot2_f32_bf16 v147, v72, v72, v147
    v_dot2_f32_bf16 v148, v108, v156, v148
    v_dot2_f32_bf16 v149, v112, v156, v149
    v_dot2_f32_bf16 v150, v116, v156, v150
    v_dot2_f32_bf16 v151, v120, v156, v151
    v_dot2_f32_bf16 v152, v124, v156, v152
    v_dot2_f32_bf16 v153, v128, v156, v153
    v_dot2_f32_bf16 v154, v132, v156, v154
    v_dot2_f32_bf16 v155, v136, v156, v155
    v_dot2_f32_bf16 v140, v61, v156, v140
    v_dot2_f32_bf16 v144, v61, v61, v144
    v_dot2_f32_bf16 v141, v65, v156, v141
    v_dot2_f32_bf16 v145, v65, v65, v145
    v_dot2_f32_bf16 v142, v69, v156, v142
    v_dot2_f32_bf16 v146, v69, v69, v146
    v_dot2_f32_bf16 v143, v73, v156, v143
    v_dot2_f32_bf16 v147, v73, v73, v147
    v_dot2_f32_bf16 v148, v109, v156, v148
    v_dot2_f32_bf16 v149, v113, v156, v149
    v_dot2_f32_bf16 v150, v117, v156, v150
    v_dot2_f32_bf16 v151, v121, v156, v151
    v_dot2_f32_bf16 v152, v125, v156, v152
    v_dot2_f32_bf16 v153, v129, v156, v153
    v_dot2_f32_bf16 v154, v133, v156, v154
    v_dot2_f32_bf16 v155, v137, v156, v155
    v_dot2_f32_bf16 v140, v62, v156, v140
    v_dot2_f32_bf16 v144, v62, v62, v144
    v_dot2_f32_bf16 v141, v66, v156, v141
    v_dot2_f32_bf16 v145, v66, v66, v145
    v_dot2_f32_bf16 v142, v70, v156, v142
    v_dot2_f32_bf16 v146, v70, v70, v146
    v_dot2_f32_bf16 v143, v74, v156, v143
    v_dot2_f32_bf16 v147, v74, v74, v147
    v_dot2_f32_bf16 v148, v110, v156, v148
    v_dot2_f32_bf16 v149, v114, v156, v149
    v_dot2_f32_bf16 v150, v118, v156, v150
    v_dot2_f32_bf16 v151, v122, v156, v151
    v_dot2_f32_bf16 v152, v126, v156, v152
    v_dot2_f32_bf16 v153, v130, v156, v153
    v_dot2_f32_bf16 v154, v134, v156, v154
    v_dot2_f32_bf16 v155, v138, v156, v155
    v_dot2_f32_bf16 v140, v63, v156, v140
    v_dot2_f32_bf16 v144, v63, v63, v144
    v_dot2_f32_bf16 v141, v67, v156, v141
    v_dot2_f32_bf16 v145, v67, v67, v145
    v_dot2_f32_bf16 v142, v71, v156, v142
    v_dot2_f32_bf16 v146, v71, v71, v146
    v_dot2_f32_bf16 v143, v75, v156, v143
    v_dot2_f32_bf16 v147, v75, v75, v147
    v_dot2_f32_bf16 v148, v111, v156, v148
    v_dot2_f32_bf16 v149, v115, v156, v149
    v_dot2_f32_bf16 v150, v119, v156, v150
    v_dot2_f32_bf16 v151, v123, v156, v151
    v_dot2_f32_bf16 v152, v127, v156, v152
    v_dot2_f32_bf16 v153, v131, v156, v153
    v_dot2_f32_bf16 v154, v135, v156, v154
    v_dot2_f32_bf16 v155, v139, v156, v155
    s_waitcnt vmcnt(12)
    s_barrier
    s_add_u32 s55, s52, 512
    s_add_u32 m0, s54, 49152
    s_nop 0
    buffer_load_dwordx4 v10, s[8:11], s55 offen lds
    s_add_u32 s55, s52, 29184
    s_add_u32 m0, s54, 53248
    s_nop 0
    buffer_load_dwordx4 v10, s[8:11], s55 offen lds
    s_add_u32 s55, s52, 57856
    s_add_u32 m0, s54, 57344
    s_nop 0
    buffer_load_dwordx4 v10, s[8:11], s55 offen lds
    s_add_u32 s55, s52, 86528
    s_add_u32 m0, s54, 61440
    s_nop 0
    buffer_load_dwordx4 v10, s[8:11], s55 offen lds
    s_add_u32 s55, s53, 917504
    s_add_u32 m0, s54, 65536
    s_nop 0
    buffer_load_dwordx4 v11, s[12:15], s55 offen lds
    s_add_u32 s55, s53, 974848
    s_add_u32 m0, s54, 69632
    s_nop 0
    buffer_load_dwordx4 v11, s[12:15], s55 offen lds
    s_add_u32 s55, s53, 1032192
    s_add_u32 m0, s54, 73728
    s_nop 0
    buffer_load_dwordx4 v11, s[12:15], s55 offen lds
    s_add_u32 s55, s53, 1089536
    s_add_u32 m0, s54, 77824
    s_nop 0
    buffer_load_dwordx4 v11, s[12:15], s55 offen lds
    s_add_u32 s55, s53, 917504
    s_add_u32 m0, s54, 81920
    s_nop 0
    buffer_load_dwordx4 v12, s[16:19], s55 offen lds
    s_add_u32 s55, s53, 974848
    s_add_u32 m0, s54, 86016
    s_nop 0
    buffer_load_dwordx4 v12, s[16:19], s55 offen lds
    s_add_u32 s55, s53, 1032192
    s_add_u32 m0, s54, 90112
    s_nop 0
    buffer_load_dwordx4 v12, s[16:19], s55 offen lds
    s_add_u32 s55, s53, 1089536
    s_add_u32 m0, s54, 94208
    s_nop 0
    buffer_load_dwordx4 v12, s[16:19], s55 offen lds
    ds_read_b128 v[44:47], v17 offset:0
    ds_read_b128 v[48:51], v17 offset:2048
    ds_read_b128 v[52:55], v17 offset:4096
    ds_read_b128 v[56:59], v17 offset:6144
    ds_read_b64_tr_b16 v[76:77], v35 offset:0
    ds_read_b64_tr_b16 v[78:79], v35 offset:1024
    ds_read_b64_tr_b16 v[80:81], v36 offset:0
    ds_read_b64_tr_b16 v[82:83], v36 offset:1024
    ds_read_b64_tr_b16 v[84:85], v37 offset:0
    ds_read_b64_tr_b16 v[86:87], v37 offset:1024
    ds_read_b64_tr_b16 v[88:89], v38 offset:0
    ds_read_b64_tr_b16 v[90:91], v38 offset:1024
    ds_read_b64_tr_b16 v[92:93], v39 offset:0
    ds_read_b64_tr_b16 v[94:95], v39 offset:1024
    ds_read_b64_tr_b16 v[96:97], v40 offset:0
    ds_read_b64_tr_b16 v[98:99], v40 offset:1024
    ds_read_b64_tr_b16 v[100:101], v41 offset:0
    ds_read_b64_tr_b16 v[102:103], v41 offset:1024
    ds_read_b64_tr_b16 v[104:105], v42 offset:0
    ds_read_b64_tr_b16 v[106:107], v42 offset:1024
    ds_read_b128 v[60:63], v18 offset:0
    ds_read_b128 v[64:67], v18 offset:2048
    ds_read_b128 v[68:71], v18 offset:4096
    ds_read_b128 v[72:75], v18 offset:6144
    ds_read_b64_tr_b16 v[108:109], v35 offset:8192
    ds_read_b64_tr_b16 v[110:111], v35 offset:9216
    ds_read_b64_tr_b16 v[112:113], v36 offset:8192
    ds_read_b64_tr_b16 v[114:115], v36 offset:9216
    ds_read_b64_tr_b16 v[116:117], v37 offset:8192
    ds_read_b64_tr_b16 v[118:119], v37 offset:9216
    ds_read_b64_tr_b16 v[120:121], v38 offset:8192
    ds_read_b64_tr_b16 v[122:123], v38 offset:9216
    ds_read_b64_tr_b16 v[124:125], v39 offset:8192
    ds_read_b64_tr_b16 v[126:127], v39 offset:9216
    ds_read_b64_tr_b16 v[128:129], v40 offset:8192
    ds_read_b64_tr_b16 v[130:131], v40 offset:9216
    ds_read_b64_tr_b16 v[132:133], v41 offset:8192
    ds_read_b64_tr_b16 v[134:135], v41 offset:9216
    ds_read_b64_tr_b16 v[136:137], v42 offset:8192
    ds_read_b64_tr_b16 v[138:139], v42 offset:9216
    s_waitcnt lgkmcnt(15)
    v_mfma_f32_16x16x32_bf16 a[0:3], v[76:79], v[44:47], a[0:3]
    v_mfma_f32_16x16x32_bf16 a[4:7], v[80:83], v[44:47], a[4:7]
    v_mfma_f32_16x16x32_bf16 a[8:11], v[84:87], v[44:47], a[8:11]
    v_mfma_f32_16x16x32_bf16 a[12:15], v[88:91], v[44:47], a[12:15]
    v_mfma_f32_16x16x32_bf16 a[16:19], v[92:95], v[44:47], a[16:19]
    v_mfma_f32_16x16x32_bf16 a[20:23], v[96:99], v[44:47], a[20:23]
    v_mfma_f32_16x16x32_bf16 a[24:27], v[100:103], v[44:47], a[24:27]
    v_mfma_f32_16x16x32_bf16 a[28:31], v[104:107], v[44:47], a[28:31]
    v_mfma_f32_16x16x32_bf16 a[32:35], v[76:79], v[48:51], a[32:35]
    v_mfma_f32_16x16x32_bf16 a[36:39], v[80:83], v[48:51], a[36:39]
    v_mfma_f32_16x16x32_bf16 a[40:43], v[84:87], v[48:51], a[40:43]
    v_mfma_f32_16x16x32_bf16 a[44:47], v[88:91], v[48:51], a[44:47]
    v_mfma_f32_16x16x32_bf16 a[48:51], v[92:95], v[48:51], a[48:51]
    v_mfma_f32_16x16x32_bf16 a[52:55], v[96:99], v[48:51], a[52:55]
    v_mfma_f32_16x16x32_bf16 a[56:59], v[100:103], v[48:51], a[56:59]
    v_mfma_f32_16x16x32_bf16 a[60:63], v[104:107], v[48:51], a[60:63]
    v_mfma_f32_16x16x32_bf16 a[64:67], v[76:79], v[52:55], a[64:67]
    v_mfma_f32_16x16x32_bf16 a[68:71], v[80:83], v[52:55], a[68:71]
    v_mfma_f32_16x16x32_bf16 a[72:75], v[84:87], v[52:55], a[72:75]
    v_mfma_f32_16x16x32_bf16 a[76:79], v[88:91], v[52:55], a[76:79]
    v_mfma_f32_16x16x32_bf16 a[80:83], v[92:95], v[52:55], a[80:83]
    v_mfma_f32_16x16x32_bf16 a[84:87], v[96:99], v[52:55], a[84:87]
    v_mfma_f32_16x16x32_bf16 a[88:91], v[100:103], v[52:55], a[88:91]
    v_mfma_f32_16x16x32_bf16 a[92:95], v[104:107], v[52:55], a[92:95]
    v_mfma_f32_16x16x32_bf16 a[96:99], v[76:79], v[56:59], a[96:99]
    v_mfma_f32_16x16x32_bf16 a[100:103], v[80:83], v[56:59], a[100:103]
    v_mfma_f32_16x16x32_bf16 a[104:107], v[84:87], v[56:59], a[104:107]
    v_mfma_f32_16x16x32_bf16 a[108:111], v[88:91], v[56:59], a[108:111]
    v_mfma_f32_16x16x32_bf16 a[112:115], v[92:95], v[56:59], a[112:115]
    v_mfma_f32_16x16x32_bf16 a[116:119], v[96:99], v[56:59], a[116:119]
    v_mfma_f32_16x16x32_bf16 a[120:123], v[100:103], v[56:59], a[120:123]
    v_mfma_f32_16x16x32_bf16 a[124:127], v[104:107], v[56:59], a[124:127]
    v_dot2_f32_bf16 v140, v44, v156, v140
    v_dot2_f32_bf16 v144, v44, v44, v144
    v_dot2_f32_bf16 v141, v48, v156, v141
    v_dot2_f32_bf16 v145, v48, v48, v145
    v_dot2_f32_bf16 v142, v52, v156, v142
    v_dot2_f32_bf16 v146, v52, v52, v146
    v_dot2_f32_bf16 v143, v56, v156, v143
    v_dot2_f32_bf16 v147, v56, v56, v147
    v_dot2_f32_bf16 v148, v76, v156, v148
    v_dot2_f32_bf16 v149, v80, v156, v149
    v_dot2_f32_bf16 v150, v84, v156, v150
    v_dot2_f32_bf16 v151, v88, v156, v151
    v_dot2_f32_bf16 v152, v92, v156, v152
    v_dot2_f32_bf16 v153, v96, v156, v153
    v_dot2_f32_bf16 v154, v100, v156, v154
    v_dot2_f32_bf16 v155, v104, v156, v155
    v_dot2_f32_bf16 v140, v45, v156, v140
    v_dot2_f32_bf16 v144, v45, v45, v144
    v_dot2_f32_bf16 v141, v49, v156, v141
    v_dot2_f32_bf16 v145, v49, v49, v145
    v_dot2_f32_bf16 v142, v53, v156, v142
    v_dot2_f32_bf16 v146, v53, v53, v146
    v_dot2_f32_bf16 v143, v57, v156, v143
    v_dot2_f32_bf16 v147, v57, v57, v147
    v_dot2_f32_bf16 v148, v77, v156, v148
    v_dot2_f32_bf16 v149, v81, v156, v149
    v_dot2_f32_bf16 v150, v85, v156, v150
    v_dot2_f32_bf16 v151, v89, v156, v151
    v_dot2_f32_bf16 v152, v93, v156, v152
    v_dot2_f32_bf16 v153, v97, v156, v153
    v_dot2_f32_bf16 v154, v101, v156, v154
    v_dot2_f32_bf16 v155, v105, v156, v155
    v_dot2_f32_bf16 v140, v46, v156, v140
    v_dot2_f32_bf16 v144, v46, v46, v144
    v_dot2_f32_bf16 v141, v50, v156, v141
    v_dot2_f32_bf16 v145, v50, v50, v145
    v_dot2_f32_bf16 v142, v54, v156, v142
    v_dot2_f32_bf16 v146, v54, v54, v146
    v_dot2_f32_bf16 v143, v58, v156, v143
    v_dot2_f32_bf16 v147, v58, v58, v147
    v_dot2_f32_bf16 v148, v78, v156, v148
    v_dot2_f32_bf16 v149, v82, v156, v149
    v_dot2_f32_bf16 v150, v86, v156, v150
    v_dot2_f32_bf16 v151, v90, v156, v151
    v_dot2_f32_bf16 v152, v94, v156, v152
    v_dot2_f32_bf16 v153, v98, v156, v153
    v_dot2_f32_bf16 v154, v102, v156, v154
    v_dot2_f32_bf16 v155, v106, v156, v155
    v_dot2_f32_bf16 v140, v47, v156, v140
    v_dot2_f32_bf16 v144, v47, v47, v144
    v_dot2_f32_bf16 v141, v51, v156, v141
    v_dot2_f32_bf16 v145, v51, v51, v145
    v_dot2_f32_bf16 v142, v55, v156, v142
    v_dot2_f32_bf16 v146, v55, v55, v146
    v_dot2_f32_bf16 v143, v59, v156, v143
    v_dot2_f32_bf16 v147, v59, v59, v147
    v_dot2_f32_bf16 v148, v79, v156, v148
    v_dot2_f32_bf16 v149, v83, v156, v149
    v_dot2_f32_bf16 v150, v87, v156, v150
    v_dot2_f32_bf16 v151, v91, v156, v151
    v_dot2_f32_bf16 v152, v95, v156, v152
    v_dot2_f32_bf16 v153, v99, v156, v153
    v_dot2_f32_bf16 v154, v103, v156, v154
    v_dot2_f32_bf16 v155, v107, v156, v155
    s_waitcnt lgkmcnt(0)
    v_mfma_f32_16x16x32_bf16 a[0:3], v[108:111], v[60:63], a[0:3]
    v_mfma_f32_16x16x32_bf16 a[4:7], v[112:115], v[60:63], a[4:7]
    v_mfma_f32_16x16x32_bf16 a[8:11], v[116:119], v[60:63], a[8:11]
    v_mfma_f32_16x16x32_bf16 a[12:15], v[120:123], v[60:63], a[12:15]
    v_mfma_f32_16x16x32_bf16 a[16:19], v[124:127], v[60:63], a[16:19]
    v_mfma_f32_16x16x32_bf16 a[20:23], v[128:131], v[60:63], a[20:23]
    v_mfma_f32_16x16x32_bf16 a[24:27], v[132:135], v[60:63], a[24:27]
    v_mfma_f32_16x16x32_bf16 a[28:31], v[136:139], v[60:63], a[28:31]
    v_mfma_f32_16x16x32_bf16 a[32:35], v[108:111], v[64:67], a[32:35]
    v_mfma_f32_16x16x32_bf16 a[36:39], v[112:115], v[64:67], a[36:39]
    v_mfma_f32_16x16x32_bf16 a[40:43], v[116:119], v[64:67], a[40:43]
    v_mfma_f32_16x16x32_bf16 a[44:47], v[120:123], v[64:67], a[44:47]
    v_mfma_f32_16x16x32_bf16 a[48:51], v[124:127], v[64:67], a[48:51]
    v_mfma_f32_16x16x32_bf16 a[52:55], v[128:131], v[64:67], a[52:55]
    v_mfma_f32_16x16x32_bf16 a[56:59], v[132:135], v[64:67], a[56:59]
    v_mfma_f32_16x16x32_bf16 a[60:63], v[136:139], v[64:67], a[60:63]
    v_mfma_f32_16x16x32_bf16 a[64:67], v[108:111], v[68:71], a[64:67]
    v_mfma_f32_16x16x32_bf16 a[68:71], v[112:115], v[68:71], a[68:71]
    v_mfma_f32_16x16x32_bf16 a[72:75], v[116:119], v[68:71], a[72:75]
    v_mfma_f32_16x16x32_bf16 a[76:79], v[120:123], v[68:71], a[76:79]
    v_mfma_f32_16x16x32_bf16 a[80:83], v[124:127], v[68:71], a[80:83]
    v_mfma_f32_16x16x32_bf16 a[84:87], v[128:131], v[68:71], a[84:87]
    v_mfma_f32_16x16x32_bf16 a[88:91], v[132:135], v[68:71], a[88:91]
    v_mfma_f32_16x16x32_bf16 a[92:95], v[136:139], v[68:71], a[92:95]
    v_mfma_f32_16x16x32_bf16 a[96:99], v[108:111], v[72:75], a[96:99]
    v_mfma_f32_16x16x32_bf16 a[100:103], v[112:115], v[72:75], a[100:103]
    v_mfma_f32_16x16x32_bf16 a[104:107], v[116:119], v[72:75], a[104:107]
    v_mfma_f32_16x16x32_bf16 a[108:111], v[120:123], v[72:75], a[108:111]
    v_mfma_f32_16x16x32_bf16 a[112:115], v[124:127], v[72:75], a[112:115]
    v_mfma_f32_16x16x32_bf16 a[116:119], v[128:131], v[72:75], a[116:119]
    v_mfma_f32_16x16x32_bf16 a[120:123], v[132:135], v[72:75], a[120:123]
    v_mfma_f32_16x16x32_bf16 a[124:127], v[136:139], v[72:75], a[124:127]
    v_dot2_f32_bf16 v140, v60, v156, v140
    v_dot2_f32_bf16 v144, v60, v60, v144
    v_dot2_f32_bf16 v141, v64, v156, v141
    v_dot2_f32_bf16 v145, v64, v64, v145
    v_dot2_f32_bf16 v142, v68, v156, v142
    v_dot2_f32_bf16 v146, v68, v68, v146
    v_dot2_f32_bf16 v143, v72, v156, v143
    v_dot2_f32_bf16 v147, v72, v72, v147
    v_dot2_f32_bf16 v148, v108, v156, v148
    v_dot2_f32_bf16 v149, v112, v156, v149
    v_dot2_f32_bf16 v150, v116, v156, v150
    v_dot2_f32_bf16 v151, v120, v156, v151
    v_dot2_f32_bf16 v152, v124, v156, v152
    v_dot2_f32_bf16 v153, v128, v156, v153
    v_dot2_f32_bf16 v154, v132, v156, v154
    v_dot2_f32_bf16 v155, v136, v156, v155
    v_dot2_f32_bf16 v140, v61, v156, v140
    v_dot2_f32_bf16 v144, v61, v61, v144
    v_dot2_f32_bf16 v141, v65, v156, v141
    v_dot2_f32_bf16 v145, v65, v65, v145
    v_dot2_f32_bf16 v142, v69, v156, v142
    v_dot2_f32_bf16 v146, v69, v69, v146
    v_dot2_f32_bf16 v143, v73, v156, v143
    v_dot2_f32_bf16 v147, v73, v73, v147
    v_dot2_f32_bf16 v148, v109, v156, v148
    v_dot2_f32_bf16 v149, v113, v156, v149
    v_dot2_f32_bf16 v150, v117, v156, v150
    v_dot2_f32_bf16 v151, v121, v156, v151
    v_dot2_f32_bf16 v152, v125, v156, v152
    v_dot2_f32_bf16 v153, v129, v156, v153
    v_dot2_f32_bf16 v154, v133, v156, v154
    v_dot2_f32_bf16 v155, v137, v156, v155
    v_dot2_f32_bf16 v140, v62, v156, v140
    v_dot2_f32_bf16 v144, v62, v62, v144
    v_dot2_f32_bf16 v141, v66, v156, v141
    v_dot2_f32_bf16 v145, v66, v66, v145
    v_dot2_f32_bf16 v142, v70, v156, v142
    v_dot2_f32_bf16 v146, v70, v70, v146
    v_dot2_f32_bf16 v143, v74, v156, v143
    v_dot2_f32_bf16 v147, v74, v74, v147
    v_dot2_f32_bf16 v148, v110, v156, v148
    v_dot2_f32_bf16 v149, v114, v156, v149
    v_dot2_f32_bf16 v150, v118, v156, v150
    v_dot2_f32_bf16 v151, v122, v156, v151
    v_dot2_f32_bf16 v152, v126, v156, v152
    v_dot2_f32_bf16 v153, v130, v156, v153
    v_dot2_f32_bf16 v154, v134, v156, v154
    v_dot2_f32_bf16 v155, v138, v156, v155
    v_dot2_f32_bf16 v140, v63, v156, v140
    v_dot2_f32_bf16 v144, v63, v63, v144
    v_dot2_f32_bf16 v141, v67, v156, v141
    v_dot2_f32_bf16 v145, v67, v67, v145
    v_dot2_f32_bf16 v142, v71, v156, v142
    v_dot2_f32_bf16 v146, v71, v71, v146
    v_dot2_f32_bf16 v143, v75, v156, v143
    v_dot2_f32_bf16 v147, v75, v75, v147
    v_dot2_f32_bf16 v148, v111, v156, v148
    v_dot2_f32_bf16 v149, v115, v156, v149
    v_dot2_f32_bf16 v150, v119, v156, v150
    v_dot2_f32_bf16 v151, v123, v156, v151
    v_dot2_f32_bf16 v152, v127, v156, v152
    v_dot2_f32_bf16 v153, v131, v156, v153
    v_dot2_f32_bf16 v154, v135, v156, v154
    v_dot2_f32_bf16 v155, v139, v156, v155
    s_waitcnt vmcnt(12)
    s_barrier
    s_add_u32 s55, s52, 640
    s_add_u32 m0, s54, 98304
    s_nop 0
    buffer_load_dwordx4 v10, s[8:11], s55 offen lds
    s_add_u32 s55, s52, 29312
    s_add_u32 m0, s54, 102400
    s_nop 0
    buffer_load_dwordx4 v10, s[8:11], s55 offen lds
    s_add_u32 s55, s52, 57984
    s_add_u32 m0, s54, 106496
    s_nop 0
    buffer_load_dwordx4 v10, s[8:11], s55 offen lds
    s_add_u32 s55, s52, 86656
    s_add_u32 m0, s54, 110592
    s_nop 0
    buffer_load_dwordx4 v10, s[8:11], s55 offen lds
    s_add_u32 s55, s53, 1146880
    s_add_u32 m0, s54, 114688
    s_nop 0
    buffer_load_dwordx4 v11, s[12:15], s55 offen lds
    s_add_u32 s55, s53, 1204224
    s_add_u32 m0, s54, 118784
    s_nop 0
    buffer_load_dwordx4 v11, s[12:15], s55 offen lds
    s_add_u32 s55, s53, 1261568
    s_add_u32 m0, s54, 122880
    s_nop 0
    buffer_load_dwordx4 v11, s[12:15], s55 offen lds
    s_add_u32 s55, s53, 1318912
    s_add_u32 m0, s54, 126976
    s_nop 0
    buffer_load_dwordx4 v11, s[12:15], s55 offen lds
    s_add_u32 s55, s53, 1146880
    s_add_u32 m0, s54, 131072
    s_nop 0
    buffer_load_dwordx4 v12, s[16:19], s55 offen lds
    s_add_u32 s55, s53, 1204224
    s_add_u32 m0, s54, 135168
    s_nop 0
    buffer_load_dwordx4 v12, s[16:19], s55 offen lds
    s_add_u32 s55, s53, 1261568
    s_add_u32 m0, s54, 139264
    s_nop 0
    buffer_load_dwordx4 v12, s[16:19], s55 offen lds
    s_add_u32 s55, s53, 1318912
    s_add_u32 m0, s54, 143360
    s_nop 0
    buffer_load_dwordx4 v12, s[16:19], s55 offen lds
    ds_read_b128 v[44:47], v13 offset:0
    ds_read_b128 v[48:51], v13 offset:2048
    ds_read_b128 v[52:55], v13 offset:4096
    ds_read_b128 v[56:59], v13 offset:6144
    ds_read_b64_tr_b16 v[76:77], v19 offset:0
    ds_read_b64_tr_b16 v[78:79], v19 offset:1024
    ds_read_b64_tr_b16 v[80:81], v20 offset:0
    ds_read_b64_tr_b16 v[82:83], v20 offset:1024
    ds_read_b64_tr_b16 v[84:85], v21 offset:0
    ds_read_b64_tr_b16 v[86:87], v21 offset:1024
    ds_read_b64_tr_b16 v[88:89], v22 offset:0
    ds_read_b64_tr_b16 v[90:91], v22 offset:1024
    ds_read_b64_tr_b16 v[92:93], v23 offset:0
    ds_read_b64_tr_b16 v[94:95], v23 offset:1024
    ds_read_b64_tr_b16 v[96:97], v24 offset:0
    ds_read_b64_tr_b16 v[98:99], v24 offset:1024
    ds_read_b64_tr_b16 v[100:101], v25 offset:0
    ds_read_b64_tr_b16 v[102:103], v25 offset:1024
    ds_read_b64_tr_b16 v[104:105], v26 offset:0
    ds_read_b64_tr_b16 v[106:107], v26 offset:1024
    ds_read_b128 v[60:63], v14 offset:0
    ds_read_b128 v[64:67], v14 offset:2048
    ds_read_b128 v[68:71], v14 offset:4096
    ds_read_b128 v[72:75], v14 offset:6144
    ds_read_b64_tr_b16 v[108:109], v19 offset:8192
    ds_read_b64_tr_b16 v[110:111], v19 offset:9216
    ds_read_b64_tr_b16 v[112:113], v20 offset:8192
    ds_read_b64_tr_b16 v[114:115], v20 offset:9216
    ds_read_b64_tr_b16 v[116:117], v21 offset:8192
    ds_read_b64_tr_b16 v[118:119], v21 offset:9216
    ds_read_b64_tr_b16 v[120:121], v22 offset:8192
    ds_read_b64_tr_b16 v[122:123], v22 offset:9216
    ds_read_b64_tr_b16 v[124:125], v23 offset:8192
    ds_read_b64_tr_b16 v[126:127], v23 offset:9216
    ds_read_b64_tr_b16 v[128:129], v24 offset:8192
    ds_read_b64_tr_b16 v[130:131], v24 offset:9216
    ds_read_b64_tr_b16 v[132:133], v25 offset:8192
    ds_read_b64_tr_b16 v[134:135], v25 offset:9216
    ds_read_b64_tr_b16 v[136:137], v26 offset:8192
    ds_read_b64_tr_b16 v[138:139], v26 offset:9216
    s_waitcnt lgkmcnt(15)
    v_mfma_f32_16x16x32_bf16 a[0:3], v[76:79], v[44:47], a[0:3]
    v_mfma_f32_16x16x32_bf16 a[4:7], v[80:83], v[44:47], a[4:7]
    v_mfma_f32_16x16x32_bf16 a[8:11], v[84:87], v[44:47], a[8:11]
    v_mfma_f32_16x16x32_bf16 a[12:15], v[88:91], v[44:47], a[12:15]
    v_mfma_f32_16x16x32_bf16 a[16:19], v[92:95], v[44:47], a[16:19]
    v_mfma_f32_16x16x32_bf16 a[20:23], v[96:99], v[44:47], a[20:23]
    v_mfma_f32_16x16x32_bf16 a[24:27], v[100:103], v[44:47], a[24:27]
    v_mfma_f32_16x16x32_bf16 a[28:31], v[104:107], v[44:47], a[28:31]
    v_mfma_f32_16x16x32_bf16 a[32:35], v[76:79], v[48:51], a[32:35]
    v_mfma_f32_16x16x32_bf16 a[36:39], v[80:83], v[48:51], a[36:39]
    v_mfma_f32_16x16x32_bf16 a[40:43], v[84:87], v[48:51], a[40:43]
    v_mfma_f32_16x16x32_bf16 a[44:47], v[88:91], v[48:51], a[44:47]
    v_mfma_f32_16x16x32_bf16 a[48:51], v[92:95], v[48:51], a[48:51]
    v_mfma_f32_16x16x32_bf16 a[52:55], v[96:99], v[48:51], a[52:55]
    v_mfma_f32_16x16x32_bf16 a[56:59], v[100:103], v[48:51], a[56:59]
    v_mfma_f32_16x16x32_bf16 a[60:63], v[104:107], v[48:51], a[60:63]
    v_mfma_f32_16x16x32_bf16 a[64:67], v[76:79], v[52:55], a[64:67]
    v_mfma_f32_16x16x32_bf16 a[68:71], v[80:83], v[52:55], a[68:71]
    v_mfma_f32_16x16x32_bf16 a[72:75], v[84:87], v[52:55], a[72:75]
    v_mfma_f32_16x16x32_bf16 a[76:79], v[88:91], v[52:55], a[76:79]
    v_mfma_f32_16x16x32_bf16 a[80:83], v[92:95], v[52:55], a[80:83]
    v_mfma_f32_16x16x32_bf16 a[84:87], v[96:99], v[52:55], a[84:87]
    v_mfma_f32_16x16x32_bf16 a[88:91], v[100:103], v[52:55], a[88:91]
    v_mfma_f32_16x16x32_bf16 a[92:95], v[104:107], v[52:55], a[92:95]
    v_mfma_f32_16x16x32_bf16 a[96:99], v[76:79], v[56:59], a[96:99]
    v_mfma_f32_16x16x32_bf16 a[100:103], v[80:83], v[56:59], a[100:103]
    v_mfma_f32_16x16x32_bf16 a[104:107], v[84:87], v[56:59], a[104:107]
    v_mfma_f32_16x16x32_bf16 a[108:111], v[88:91], v[56:59], a[108:111]
    v_mfma_f32_16x16x32_bf16 a[112:115], v[92:95], v[56:59], a[112:115]
    v_mfma_f32_16x16x32_bf16 a[116:119], v[96:99], v[56:59], a[116:119]
    v_mfma_f32_16x16x32_bf16 a[120:123], v[100:103], v[56:59], a[120:123]
    v_mfma_f32_16x16x32_bf16 a[124:127], v[104:107], v[56:59], a[124:127]
    v_dot2_f32_bf16 v140, v44, v156, v140
    v_dot2_f32_bf16 v144, v44, v44, v144
    v_dot2_f32_bf16 v141, v48, v156, v141
    v_dot2_f32_bf16 v145, v48, v48, v145
    v_dot2_f32_bf16 v142, v52, v156, v142
    v_dot2_f32_bf16 v146, v52, v52, v146
    v_dot2_f32_bf16 v143, v56, v156, v143
    v_dot2_f32_bf16 v147, v56, v56, v147
    v_dot2_f32_bf16 v148, v76, v156, v148
    v_dot2_f32_bf16 v149, v80, v156, v149
    v_dot2_f32_bf16 v150, v84, v156, v150
    v_dot2_f32_bf16 v151, v88, v156, v151
    v_dot2_f32_bf16 v152, v92, v156, v152
    v_dot2_f32_bf16 v153, v96, v156, v153
    v_dot2_f32_bf16 v154, v100, v156, v154
    v_dot2_f32_bf16 v155, v104, v156, v155
    v_dot2_f32_bf16 v140, v45, v156, v140
    v_dot2_f32_bf16 v144, v45, v45, v144
    v_dot2_f32_bf16 v141, v49, v156, v141
    v_dot2_f32_bf16 v145, v49, v49, v145
    v_dot2_f32_bf16 v142, v53, v156, v142
    v_dot2_f32_bf16 v146, v53, v53, v146
    v_dot2_f32_bf16 v143, v57, v156, v143
    v_dot2_f32_bf16 v147, v57, v57, v147
    v_dot2_f32_bf16 v148, v77, v156, v148
    v_dot2_f32_bf16 v149, v81, v156, v149
    v_dot2_f32_bf16 v150, v85, v156, v150
    v_dot2_f32_bf16 v151, v89, v156, v151
    v_dot2_f32_bf16 v152, v93, v156, v152
    v_dot2_f32_bf16 v153, v97, v156, v153
    v_dot2_f32_bf16 v154, v101, v156, v154
    v_dot2_f32_bf16 v155, v105, v156, v155
    v_dot2_f32_bf16 v140, v46, v156, v140
    v_dot2_f32_bf16 v144, v46, v46, v144
    v_dot2_f32_bf16 v141, v50, v156, v141
    v_dot2_f32_bf16 v145, v50, v50, v145
    v_dot2_f32_bf16 v142, v54, v156, v142
    v_dot2_f32_bf16 v146, v54, v54, v146
    v_dot2_f32_bf16 v143, v58, v156, v143
    v_dot2_f32_bf16 v147, v58, v58, v147
    v_dot2_f32_bf16 v148, v78, v156, v148
    v_dot2_f32_bf16 v149, v82, v156, v149
    v_dot2_f32_bf16 v150, v86, v156, v150
    v_dot2_f32_bf16 v151, v90, v156, v151
    v_dot2_f32_bf16 v152, v94, v156, v152
    v_dot2_f32_bf16 v153, v98, v156, v153
    v_dot2_f32_bf16 v154, v102, v156, v154
    v_dot2_f32_bf16 v155, v106, v156, v155
    v_dot2_f32_bf16 v140, v47, v156, v140
    v_dot2_f32_bf16 v144, v47, v47, v144
    v_dot2_f32_bf16 v141, v51, v156, v141
    v_dot2_f32_bf16 v145, v51, v51, v145
    v_dot2_f32_bf16 v142, v55, v156, v142
    v_dot2_f32_bf16 v146, v55, v55, v146
    v_dot2_f32_bf16 v143, v59, v156, v143
    v_dot2_f32_bf16 v147, v59, v59, v147
    v_dot2_f32_bf16 v148, v79, v156, v148
    v_dot2_f32_bf16 v149, v83, v156, v149
    v_dot2_f32_bf16 v150, v87, v156, v150
    v_dot2_f32_bf16 v151, v91, v156, v151
    v_dot2_f32_bf16 v152, v95, v156, v152
    v_dot2_f32_bf16 v153, v99, v156, v153
    v_dot2_f32_bf16 v154, v103, v156, v154
    v_dot2_f32_bf16 v155, v107, v156, v155
    s_waitcnt lgkmcnt(0)
    v_mfma_f32_16x16x32_bf16 a[0:3], v[108:111], v[60:63], a[0:3]
    v_mfma_f32_16x16x32_bf16 a[4:7], v[112:115], v[60:63], a[4:7]
    v_mfma_f32_16x16x32_bf16 a[8:11], v[116:119], v[60:63], a[8:11]
    v_mfma_f32_16x16x32_bf16 a[12:15], v[120:123], v[60:63], a[12:15]
    v_mfma_f32_16x16x32_bf16 a[16:19], v[124:127], v[60:63], a[16:19]
    v_mfma_f32_16x16x32_bf16 a[20:23], v[128:131], v[60:63], a[20:23]
    v_mfma_f32_16x16x32_bf16 a[24:27], v[132:135], v[60:63], a[24:27]
    v_mfma_f32_16x16x32_bf16 a[28:31], v[136:139], v[60:63], a[28:31]
    v_mfma_f32_16x16x32_bf16 a[32:35], v[108:111], v[64:67], a[32:35]
    v_mfma_f32_16x16x32_bf16 a[36:39], v[112:115], v[64:67], a[36:39]
    v_mfma_f32_16x16x32_bf16 a[40:43], v[116:119], v[64:67], a[40:43]
    v_mfma_f32_16x16x32_bf16 a[44:47], v[120:123], v[64:67], a[44:47]
    v_mfma_f32_16x16x32_bf16 a[48:51], v[124:127], v[64:67], a[48:51]
    v_mfma_f32_16x16x32_bf16 a[52:55], v[128:131], v[64:67], a[52:55]
    v_mfma_f32_16x16x32_bf16 a[56:59], v[132:135], v[64:67], a[56:59]
    v_mfma_f32_16x16x32_bf16 a[60:63], v[136:139], v[64:67], a[60:63]
    v_mfma_f32_16x16x32_bf16 a[64:67], v[108:111], v[68:71], a[64:67]
    v_mfma_f32_16x16x32_bf16 a[68:71], v[112:115], v[68:71], a[68:71]
    v_mfma_f32_16x16x32_bf16 a[72:75], v[116:119], v[68:71], a[72:75]
    v_mfma_f32_16x16x32_bf16 a[76:79], v[120:123], v[68:71], a[76:79]
    v_mfma_f32_16x16x32_bf16 a[80:83], v[124:127], v[68:71], a[80:83]
    v_mfma_f32_16x16x32_bf16 a[84:87], v[128:131], v[68:71], a[84:87]
    v_mfma_f32_16x16x32_bf16 a[88:91], v[132:135], v[68:71], a[88:91]
    v_mfma_f32_16x16x32_bf16 a[92:95], v[136:139], v[68:71], a[92:95]
    v_mfma_f32_16x16x32_bf16 a[96:99], v[108:111], v[72:75], a[96:99]
    v_mfma_f32_16x16x32_bf16 a[100:103], v[112:115], v[72:75], a[100:103]
    v_mfma_f32_16x16x32_bf16 a[104:107], v[116:119], v[72:75], a[104:107]
    v_mfma_f32_16x16x32_bf16 a[108:111], v[120:123], v[72:75], a[108:111]
    v_mfma_f32_16x16x32_bf16 a[112:115], v[124:127], v[72:75], a[112:115]
    v_mfma_f32_16x16x32_bf16 a[116:119], v[128:131], v[72:75], a[116:119]
    v_mfma_f32_16x16x32_bf16 a[120:123], v[132:135], v[72:75], a[120:123]
    v_mfma_f32_16x16x32_bf16 a[124:127], v[136:139], v[72:75], a[124:127]
    v_dot2_f32_bf16 v140, v60, v156, v140
    v_dot2_f32_bf16 v144, v60, v60, v144
    v_dot2_f32_bf16 v141, v64, v156, v141
    v_dot2_f32_bf16 v145, v64, v64, v145
    v_dot2_f32_bf16 v142, v68, v156, v142
    v_dot2_f32_bf16 v146, v68, v68, v146
    v_dot2_f32_bf16 v143, v72, v156, v143
    v_dot2_f32_bf16 v147, v72, v72, v147
    v_dot2_f32_bf16 v148, v108, v156, v148
    v_dot2_f32_bf16 v149, v112, v156, v149
    v_dot2_f32_bf16 v150, v116, v156, v150
    v_dot2_f32_bf16 v151, v120, v156, v151
    v_dot2_f32_bf16 v152, v124, v156, v152
    v_dot2_f32_bf16 v153, v128, v156, v153
    v_dot2_f32_bf16 v154, v132, v156, v154
    v_dot2_f32_bf16 v155, v136, v156, v155
    v_dot2_f32_bf16 v140, v61, v156, v140
    v_dot2_f32_bf16 v144, v61, v61, v144
    v_dot2_f32_bf16 v141, v65, v156, v141
    v_dot2_f32_bf16 v145, v65, v65, v145
    v_dot2_f32_bf16 v142, v69, v156, v142
    v_dot2_f32_bf16 v146, v69, v69, v146
    v_dot2_f32_bf16 v143, v73, v156, v143
    v_dot2_f32_bf16 v147, v73, v73, v147
    v_dot2_f32_bf16 v148, v109, v156, v148
    v_dot2_f32_bf16 v149, v113, v156, v149
    v_dot2_f32_bf16 v150, v117, v156, v150
    v_dot2_f32_bf16 v151, v121, v156, v151
    v_dot2_f32_bf16 v152, v125, v156, v152
    v_dot2_f32_bf16 v153, v129, v156, v153
    v_dot2_f32_bf16 v154, v133, v156, v154
    v_dot2_f32_bf16 v155, v137, v156, v155
    v_dot2_f32_bf16 v140, v62, v156, v140
    v_dot2_f32_bf16 v144, v62, v62, v144
    v_dot2_f32_bf16 v141, v66, v156, v141
    v_dot2_f32_bf16 v145, v66, v66, v145
    v_dot2_f32_bf16 v142, v70, v156, v142
    v_dot2_f32_bf16 v146, v70, v70, v146
    v_dot2_f32_bf16 v143, v74, v156, v143
    v_dot2_f32_bf16 v147, v74, v74, v147
    v_dot2_f32_bf16 v148, v110, v156, v148
    v_dot2_f32_bf16 v149, v114, v156, v149
    v_dot2_f32_bf16 v150, v118, v156, v150
    v_dot2_f32_bf16 v151, v122, v156, v151
    v_dot2_f32_bf16 v152, v126, v156, v152
    v_dot2_f32_bf16 v153, v130, v156, v153
    v_dot2_f32_bf16 v154, v134, v156, v154
    v_dot2_f32_bf16 v155, v138, v156, v155
    v_dot2_f32_bf16 v140, v63, v156, v140
    v_dot2_f32_bf16 v144, v63, v63, v144
    v_dot2_f32_bf16 v141, v67, v156, v141
    v_dot2_f32_bf16 v145, v67, v67, v145
    v_dot2_f32_bf16 v142, v71, v156, v142
    v_dot2_f32_bf16 v146, v71, v71, v146
    v_dot2_f32_bf16 v143, v75, v156, v143
    v_dot2_f32_bf16 v147, v75, v75, v147
    v_dot2_f32_bf16 v148, v111, v156, v148
    v_dot2_f32_bf16 v149, v115, v156, v149
    v_dot2_f32_bf16 v150, v119, v156, v150
    v_dot2_f32_bf16 v151, v123, v156, v151
    v_dot2_f32_bf16 v152, v127, v156, v152
    v_dot2_f32_bf16 v153, v131, v156, v153
    v_dot2_f32_bf16 v154, v135, v156, v154
    v_dot2_f32_bf16 v155, v139, v156, v155
    s_waitcnt vmcnt(12)
    s_barrier
    s_add_u32 s55, s52, 768
    s_add_u32 m0, s54, 0
    s_nop 0
    buffer_load_dwordx4 v10, s[8:11], s55 offen lds
    s_add_u32 s55, s52, 29440
    s_add_u32 m0, s54, 4096
    s_nop 0
    buffer_load_dwordx4 v10, s[8:11], s55 offen lds
    s_add_u32 s55, s52, 58112
    s_add_u32 m0, s54, 8192
    s_nop 0
    buffer_load_dwordx4 v10, s[8:11], s55 offen lds
    s_add_u32 s55, s52, 86784
    s_add_u32 m0, s54, 12288
    s_nop 0
    buffer_load_dwordx4 v10, s[8:11], s55 offen lds
    s_add_u32 s55, s53, 1376256
    s_add_u32 m0, s54, 16384
    s_nop 0
    buffer_load_dwordx4 v11, s[12:15], s55 offen lds
    s_add_u32 s55, s53, 1433600
    s_add_u32 m0, s54, 20480
    s_nop 0
    buffer_load_dwordx4 v11, s[12:15], s55 offen lds
    s_add_u32 s55, s53, 1490944
    s_add_u32 m0, s54, 24576
    s_nop 0
    buffer_load_dwordx4 v11, s[12:15], s55 offen lds
    s_add_u32 s55, s53, 1548288
    s_add_u32 m0, s54, 28672
    s_nop 0
    buffer_load_dwordx4 v11, s[12:15], s55 offen lds
    s_add_u32 s55, s53, 1376256
    s_add_u32 m0, s54, 32768
    s_nop 0
    buffer_load_dwordx4 v12, s[16:19], s55 offen lds
    s_add_u32 s55, s53, 1433600
    s_add_u32 m0, s54, 36864
    s_nop 0
    buffer_load_dwordx4 v12, s[16:19], s55 offen lds
    s_add_u32 s55, s53, 1490944
    s_add_u32 m0, s54, 40960
    s_nop 0
    buffer_load_dwordx4 v12, s[16:19], s55 offen lds
    s_add_u32 s55, s53, 1548288
    s_add_u32 m0, s54, 45056
    s_nop 0
    buffer_load_dwordx4 v12, s[16:19], s55 offen lds
    ds_read_b128 v[44:47], v15 offset:0
    ds_read_b128 v[48:51], v15 offset:2048
    ds_read_b128 v[52:55], v15 offset:4096
    ds_read_b128 v[56:59], v15 offset:6144
    ds_read_b64_tr_b16 v[76:77], v27 offset:0
    ds_read_b64_tr_b16 v[78:79], v27 offset:1024
    ds_read_b64_tr_b16 v[80:81], v28 offset:0
    ds_read_b64_tr_b16 v[82:83], v28 offset:1024
    ds_read_b64_tr_b16 v[84:85], v29 offset:0
    ds_read_b64_tr_b16 v[86:87], v29 offset:1024
    ds_read_b64_tr_b16 v[88:89], v30 offset:0
    ds_read_b64_tr_b16 v[90:91], v30 offset:1024
    ds_read_b64_tr_b16 v[92:93], v31 offset:0
    ds_read_b64_tr_b16 v[94:95], v31 offset:1024
    ds_read_b64_tr_b16 v[96:97], v32 offset:0
    ds_read_b64_tr_b16 v[98:99], v32 offset:1024
    ds_read_b64_tr_b16 v[100:101], v33 offset:0
    ds_read_b64_tr_b16 v[102:103], v33 offset:1024
    ds_read_b64_tr_b16 v[104:105], v34 offset:0
    ds_read_b64_tr_b16 v[106:107], v34 offset:1024
    ds_read_b128 v[60:63], v16 offset:0
    ds_read_b128 v[64:67], v16 offset:2048
    ds_read_b128 v[68:71], v16 offset:4096
    ds_read_b128 v[72:75], v16 offset:6144
    ds_read_b64_tr_b16 v[108:109], v27 offset:8192
    ds_read_b64_tr_b16 v[110:111], v27 offset:9216
    ds_read_b64_tr_b16 v[112:113], v28 offset:8192
    ds_read_b64_tr_b16 v[114:115], v28 offset:9216
    ds_read_b64_tr_b16 v[116:117], v29 offset:8192
    ds_read_b64_tr_b16 v[118:119], v29 offset:9216
    ds_read_b64_tr_b16 v[120:121], v30 offset:8192
    ds_read_b64_tr_b16 v[122:123], v30 offset:9216
    ds_read_b64_tr_b16 v[124:125], v31 offset:8192
    ds_read_b64_tr_b16 v[126:127], v31 offset:9216
    ds_read_b64_tr_b16 v[128:129], v32 offset:8192
    ds_read_b64_tr_b16 v[130:131], v32 offset:9216
    ds_read_b64_tr_b16 v[132:133], v33 offset:8192
    ds_read_b64_tr_b16 v[134:135], v33 offset:9216
    ds_read_b64_tr_b16 v[136:137], v34 offset:8192
    ds_read_b64_tr_b16 v[138:139], v34 offset:9216
    s_waitcnt lgkmcnt(15)
    v_mfma_f32_16x16x32_bf16 a[0:3], v[76:79], v[44:47], a[0:3]
    v_mfma_f32_16x16x32_bf16 a[4:7], v[80:83], v[44:47], a[4:7]
    v_mfma_f32_16x16x32_bf16 a[8:11], v[84:87], v[44:47], a[8:11]
    v_mfma_f32_16x16x32_bf16 a[12:15], v[88:91], v[44:47], a[12:15]
    v_mfma_f32_16x16x32_bf16 a[16:19], v[92:95], v[44:47], a[16:19]
    v_mfma_f32_16x16x32_bf16 a[20:23], v[96:99], v[44:47], a[20:23]
    v_mfma_f32_16x16x32_bf16 a[24:27], v[100:103], v[44:47], a[24:27]
    v_mfma_f32_16x16x32_bf16 a[28:31], v[104:107], v[44:47], a[28:31]
    v_mfma_f32_16x16x32_bf16 a[32:35], v[76:79], v[48:51], a[32:35]
    v_mfma_f32_16x16x32_bf16 a[36:39], v[80:83], v[48:51], a[36:39]
    v_mfma_f32_16x16x32_bf16 a[40:43], v[84:87], v[48:51], a[40:43]
    v_mfma_f32_16x16x32_bf16 a[44:47], v[88:91], v[48:51], a[44:47]
    v_mfma_f32_16x16x32_bf16 a[48:51], v[92:95], v[48:51], a[48:51]
    v_mfma_f32_16x16x32_bf16 a[52:55], v[96:99], v[48:51], a[52:55]
    v_mfma_f32_16x16x32_bf16 a[56:59], v[100:103], v[48:51], a[56:59]
    v_mfma_f32_16x16x32_bf16 a[60:63], v[104:107], v[48:51], a[60:63]
    v_mfma_f32_16x16x32_bf16 a[64:67], v[76:79], v[52:55], a[64:67]
    v_mfma_f32_16x16x32_bf16 a[68:71], v[80:83], v[52:55], a[68:71]
    v_mfma_f32_16x16x32_bf16 a[72:75], v[84:87], v[52:55], a[72:75]
    v_mfma_f32_16x16x32_bf16 a[76:79], v[88:91], v[52:55], a[76:79]
    v_mfma_f32_16x16x32_bf16 a[80:83], v[92:95], v[52:55], a[80:83]
    v_mfma_f32_16x16x32_bf16 a[84:87], v[96:99], v[52:55], a[84:87]
    v_mfma_f32_16x16x32_bf16 a[88:91], v[100:103], v[52:55], a[88:91]
    v_mfma_f32_16x16x32_bf16 a[92:95], v[104:107], v[52:55], a[92:95]
    v_mfma_f32_16x16x32_bf16 a[96:99], v[76:79], v[56:59], a[96:99]
    v_mfma_f32_16x16x32_bf16 a[100:103], v[80:83], v[56:59], a[100:103]
    v_mfma_f32_16x16x32_bf16 a[104:107], v[84:87], v[56:59], a[104:107]
    v_mfma_f32_16x16x32_bf16 a[108:111], v[88:91], v[56:59], a[108:111]
    v_mfma_f32_16x16x32_bf16 a[112:115], v[92:95], v[56:59], a[112:115]
    v_mfma_f32_16x16x32_bf16 a[116:119], v[96:99], v[56:59], a[116:119]
    v_mfma_f32_16x16x32_bf16 a[120:123], v[100:103], v[56:59], a[120:123]
    v_mfma_f32_16x16x32_bf16 a[124:127], v[104:107], v[56:59], a[124:127]
    v_dot2_f32_bf16 v140, v44, v156, v140
    v_dot2_f32_bf16 v144, v44, v44, v144
    v_dot2_f32_bf16 v141, v48, v156, v141
    v_dot2_f32_bf16 v145, v48, v48, v145
    v_dot2_f32_bf16 v142, v52, v156, v142
    v_dot2_f32_bf16 v146, v52, v52, v146
    v_dot2_f32_bf16 v143, v56, v156, v143
    v_dot2_f32_bf16 v147, v56, v56, v147
    v_dot2_f32_bf16 v148, v76, v156, v148
    v_dot2_f32_bf16 v149, v80, v156, v149
    v_dot2_f32_bf16 v150, v84, v156, v150
    v_dot2_f32_bf16 v151, v88, v156, v151
    v_dot2_f32_bf16 v152, v92, v156, v152
    v_dot2_f32_bf16 v153, v96, v156, v153
    v_dot2_f32_bf16 v154, v100, v156, v154
    v_dot2_f32_bf16 v155, v104, v156, v155
    v_dot2_f32_bf16 v140, v45, v156, v140
    v_dot2_f32_bf16 v144, v45, v45, v144
    v_dot2_f32_bf16 v141, v49, v156, v141
    v_dot2_f32_bf16 v145, v49, v49, v145
    v_dot2_f32_bf16 v142, v53, v156, v142
    v_dot2_f32_bf16 v146, v53, v53, v146
    v_dot2_f32_bf16 v143, v57, v156, v143
    v_dot2_f32_bf16 v147, v57, v57, v147
    v_dot2_f32_bf16 v148, v77, v156, v148
    v_dot2_f32_bf16 v149, v81, v156, v149
    v_dot2_f32_bf16 v150, v85, v156, v150
    v_dot2_f32_bf16 v151, v89, v156, v151
    v_dot2_f32_bf16 v152, v93, v156, v152
    v_dot2_f32_bf16 v153, v97, v156, v153
    v_dot2_f32_bf16 v154, v101, v156, v154
    v_dot2_f32_bf16 v155, v105, v156, v155
    v_dot2_f32_bf16 v140, v46, v156, v140
    v_dot2_f32_bf16 v144, v46, v46, v144
    v_dot2_f32_bf16 v141, v50, v156, v141
    v_dot2_f32_bf16 v145, v50, v50, v145
    v_dot2_f32_bf16 v142, v54, v156, v142
    v_dot2_f32_bf16 v146, v54, v54, v146
    v_dot2_f32_bf16 v143, v58, v156, v143
    v_dot2_f32_bf16 v147, v58, v58, v147
    v_dot2_f32_bf16 v148, v78, v156, v148
    v_dot2_f32_bf16 v149, v82, v156, v149
    v_dot2_f32_bf16 v150, v86, v156, v150
    v_dot2_f32_bf16 v151, v90, v156, v151
    v_dot2_f32_bf16 v152, v94, v156, v152
    v_dot2_f32_bf16 v153, v98, v156, v153
    v_dot2_f32_bf16 v154, v102, v156, v154
    v_dot2_f32_bf16 v155, v106, v156, v155
    v_dot2_f32_bf16 v140, v47, v156, v140
    v_dot2_f32_bf16 v144, v47, v47, v144
    v_dot2_f32_bf16 v141, v51, v156, v141
    v_dot2_f32_bf16 v145, v51, v51, v145
    v_dot2_f32_bf16 v142, v55, v156, v142
    v_dot2_f32_bf16 v146, v55, v55, v146
    v_dot2_f32_bf16 v143, v59, v156, v143
    v_dot2_f32_bf16 v147, v59, v59, v147
    v_dot2_f32_bf16 v148, v79, v156, v148
    v_dot2_f32_bf16 v149, v83, v156, v149
    v_dot2_f32_bf16 v150, v87, v156, v150
    v_dot2_f32_bf16 v151, v91, v156, v151
    v_dot2_f32_bf16 v152, v95, v156, v152
    v_dot2_f32_bf16 v153, v99, v156, v153
    v_dot2_f32_bf16 v154, v103, v156, v154
    v_dot2_f32_bf16 v155, v107, v156, v155
    s_waitcnt lgkmcnt(0)
    v_mfma_f32_16x16x32_bf16 a[0:3], v[108:111], v[60:63], a[0:3]
    v_mfma_f32_16x16x32_bf16 a[4:7], v[112:115], v[60:63], a[4:7]
    v_mfma_f32_16x16x32_bf16 a[8:11], v[116:119], v[60:63], a[8:11]
    v_mfma_f32_16x16x32_bf16 a[12:15], v[120:123], v[60:63], a[12:15]
    v_mfma_f32_16x16x32_bf16 a[16:19], v[124:127], v[60:63], a[16:19]
    v_mfma_f32_16x16x32_bf16 a[20:23], v[128:131], v[60:63], a[20:23]
    v_mfma_f32_16x16x32_bf16 a[24:27], v[132:135], v[60:63], a[24:27]
    v_mfma_f32_16x16x32_bf16 a[28:31], v[136:139], v[60:63], a[28:31]
    v_mfma_f32_16x16x32_bf16 a[32:35], v[108:111], v[64:67], a[32:35]
    v_mfma_f32_16x16x32_bf16 a[36:39], v[112:115], v[64:67], a[36:39]
    v_mfma_f32_16x16x32_bf16 a[40:43], v[116:119], v[64:67], a[40:43]
    v_mfma_f32_16x16x32_bf16 a[44:47], v[120:123], v[64:67], a[44:47]
    v_mfma_f32_16x16x32_bf16 a[48:51], v[124:127], v[64:67], a[48:51]
    v_mfma_f32_16x16x32_bf16 a[52:55], v[128:131], v[64:67], a[52:55]
    v_mfma_f32_16x16x32_bf16 a[56:59], v[132:135], v[64:67], a[56:59]
    v_mfma_f32_16x16x32_bf16 a[60:63], v[136:139], v[64:67], a[60:63]
    v_mfma_f32_16x16x32_bf16 a[64:67], v[108:111], v[68:71], a[64:67]
    v_mfma_f32_16x16x32_bf16 a[68:71], v[112:115], v[68:71], a[68:71]
    v_mfma_f32_16x16x32_bf16 a[72:75], v[116:119], v[68:71], a[72:75]
    v_mfma_f32_16x16x32_bf16 a[76:79], v[120:123], v[68:71], a[76:79]
    v_mfma_f32_16x16x32_bf16 a[80:83], v[124:127], v[68:71], a[80:83]
    v_mfma_f32_16x16x32_bf16 a[84:87], v[128:131], v[68:71], a[84:87]
    v_mfma_f32_16x16x32_bf16 a[88:91], v[132:135], v[68:71], a[88:91]
    v_mfma_f32_16x16x32_bf16 a[92:95], v[136:139], v[68:71], a[92:95]
    v_mfma_f32_16x16x32_bf16 a[96:99], v[108:111], v[72:75], a[96:99]
    v_mfma_f32_16x16x32_bf16 a[100:103], v[112:115], v[72:75], a[100:103]
    v_mfma_f32_16x16x32_bf16 a[104:107], v[116:119], v[72:75], a[104:107]
    v_mfma_f32_16x16x32_bf16 a[108:111], v[120:123], v[72:75], a[108:111]
    v_mfma_f32_16x16x32_bf16 a[112:115], v[124:127], v[72:75], a[112:115]
    v_mfma_f32_16x16x32_bf16 a[116:119], v[128:131], v[72:75], a[116:119]
    v_mfma_f32_16x16x32_bf16 a[120:123], v[132:135], v[72:75], a[120:123]
    v_mfma_f32_16x16x32_bf16 a[124:127], v[136:139], v[72:75], a[124:127]
    v_dot2_f32_bf16 v140, v60, v156, v140
    v_dot2_f32_bf16 v144, v60, v60, v144
    v_dot2_f32_bf16 v141, v64, v156, v141
    v_dot2_f32_bf16 v145, v64, v64, v145
    v_dot2_f32_bf16 v142, v68, v156, v142
    v_dot2_f32_bf16 v146, v68, v68, v146
    v_dot2_f32_bf16 v143, v72, v156, v143
    v_dot2_f32_bf16 v147, v72, v72, v147
    v_dot2_f32_bf16 v148, v108, v156, v148
    v_dot2_f32_bf16 v149, v112, v156, v149
    v_dot2_f32_bf16 v150, v116, v156, v150
    v_dot2_f32_bf16 v151, v120, v156, v151
    v_dot2_f32_bf16 v152, v124, v156, v152
    v_dot2_f32_bf16 v153, v128, v156, v153
    v_dot2_f32_bf16 v154, v132, v156, v154
    v_dot2_f32_bf16 v155, v136, v156, v155
    v_dot2_f32_bf16 v140, v61, v156, v140
    v_dot2_f32_bf16 v144, v61, v61, v144
    v_dot2_f32_bf16 v141, v65, v156, v141
    v_dot2_f32_bf16 v145, v65, v65, v145
    v_dot2_f32_bf16 v142, v69, v156, v142
    v_dot2_f32_bf16 v146, v69, v69, v146
    v_dot2_f32_bf16 v143, v73, v156, v143
    v_dot2_f32_bf16 v147, v73, v73, v147
    v_dot2_f32_bf16 v148, v109, v156, v148
    v_dot2_f32_bf16 v149, v113, v156, v149
    v_dot2_f32_bf16 v150, v117, v156, v150
    v_dot2_f32_bf16 v151, v121, v156, v151
    v_dot2_f32_bf16 v152, v125, v156, v152
    v_dot2_f32_bf16 v153, v129, v156, v153
    v_dot2_f32_bf16 v154, v133, v156, v154
    v_dot2_f32_bf16 v155, v137, v156, v155
    v_dot2_f32_bf16 v140, v62, v156, v140
    v_dot2_f32_bf16 v144, v62, v62, v144
    v_dot2_f32_bf16 v141, v66, v156, v141
    v_dot2_f32_bf16 v145, v66, v66, v145
    v_dot2_f32_bf16 v142, v70, v156, v142
    v_dot2_f32_bf16 v146, v70, v70, v146
    v_dot2_f32_bf16 v143, v74, v156, v143
    v_dot2_f32_bf16 v147, v74, v74, v147
    v_dot2_f32_bf16 v148, v110, v156, v148
    v_dot2_f32_bf16 v149, v114, v156, v149
    v_dot2_f32_bf16 v150, v118, v156, v150
    v_dot2_f32_bf16 v151, v122, v156, v151
    v_dot2_f32_bf16 v152, v126, v156, v152
    v_dot2_f32_bf16 v153, v130, v156, v153
    v_dot2_f32_bf16 v154, v134, v156, v154
    v_dot2_f32_bf16 v155, v138, v156, v155
    v_dot2_f32_bf16 v140, v63, v156, v140
    v_dot2_f32_bf16 v144, v63, v63, v144
    v_dot2_f32_bf16 v141, v67, v156, v141
    v_dot2_f32_bf16 v145, v67, v67, v145
    v_dot2_f32_bf16 v142, v71, v156, v142
    v_dot2_f32_bf16 v146, v71, v71, v146
    v_dot2_f32_bf16 v143, v75, v156, v143
    v_dot2_f32_bf16 v147, v75, v75, v147
    v_dot2_f32_bf16 v148, v111, v156, v148
    v_dot2_f32_bf16 v149, v115, v156, v149
    v_dot2_f32_bf16 v150, v119, v156, v150
    v_dot2_f32_bf16 v151, v123, v156, v151
    v_dot2_f32_bf16 v152, v127, v156, v152
    v_dot2_f32_bf16 v153, v131, v156, v153
    v_dot2_f32_bf16 v154, v135, v156, v154
    v_dot2_f32_bf16 v155, v139, v156, v155
    s_waitcnt vmcnt(12)
    s_barrier
    ds_read_b128 v[44:47], v17 offset:0
    ds_read_b128 v[48:51], v17 offset:2048
    ds_read_b128 v[52:55], v17 offset:4096
    ds_read_b128 v[56:59], v17 offset:6144
    ds_read_b64_tr_b16 v[76:77], v35 offset:0
    ds_read_b64_tr_b16 v[78:79], v35 offset:1024
    ds_read_b64_tr_b16 v[80:81], v36 offset:0
    ds_read_b64_tr_b16 v[82:83], v36 offset:1024
    ds_read_b64_tr_b16 v[84:85], v37 offset:0
    ds_read_b64_tr_b16 v[86:87], v37 offset:1024
    ds_read_b64_tr_b16 v[88:89], v38 offset:0
    ds_read_b64_tr_b16 v[90:91], v38 offset:1024
    ds_read_b64_tr_b16 v[92:93], v39 offset:0
    ds_read_b64_tr_b16 v[94:95], v39 offset:1024
    ds_read_b64_tr_b16 v[96:97], v40 offset:0
    ds_read_b64_tr_b16 v[98:99], v40 offset:1024
    ds_read_b64_tr_b16 v[100:101], v41 offset:0
    ds_read_b64_tr_b16 v[102:103], v41 offset:1024
    ds_read_b64_tr_b16 v[104:105], v42 offset:0
    ds_read_b64_tr_b16 v[106:107], v42 offset:1024
    ds_read_b128 v[60:63], v18 offset:0
    ds_read_b128 v[64:67], v18 offset:2048
    ds_read_b128 v[68:71], v18 offset:4096
    ds_read_b128 v[72:75], v18 offset:6144
    ds_read_b64_tr_b16 v[108:109], v35 offset:8192
    ds_read_b64_tr_b16 v[110:111], v35 offset:9216
    ds_read_b64_tr_b16 v[112:113], v36 offset:8192
    ds_read_b64_tr_b16 v[114:115], v36 offset:9216
    ds_read_b64_tr_b16 v[116:117], v37 offset:8192
    ds_read_b64_tr_b16 v[118:119], v37 offset:9216
    ds_read_b64_tr_b16 v[120:121], v38 offset:8192
    ds_read_b64_tr_b16 v[122:123], v38 offset:9216
    ds_read_b64_tr_b16 v[124:125], v39 offset:8192
    ds_read_b64_tr_b16 v[126:127], v39 offset:9216
    ds_read_b64_tr_b16 v[128:129], v40 offset:8192
    ds_read_b64_tr_b16 v[130:131], v40 offset:9216
    ds_read_b64_tr_b16 v[132:133], v41 offset:8192
    ds_read_b64_tr_b16 v[134:135], v41 offset:9216
    ds_read_b64_tr_b16 v[136:137], v42 offset:8192
    ds_read_b64_tr_b16 v[138:139], v42 offset:9216
    s_waitcnt lgkmcnt(15)
    v_mfma_f32_16x16x32_bf16 a[0:3], v[76:79], v[44:47], a[0:3]
    v_mfma_f32_16x16x32_bf16 a[4:7], v[80:83], v[44:47], a[4:7]
    v_mfma_f32_16x16x32_bf16 a[8:11], v[84:87], v[44:47], a[8:11]
    v_mfma_f32_16x16x32_bf16 a[12:15], v[88:91], v[44:47], a[12:15]
    v_mfma_f32_16x16x32_bf16 a[16:19], v[92:95], v[44:47], a[16:19]
    v_mfma_f32_16x16x32_bf16 a[20:23], v[96:99], v[44:47], a[20:23]
    v_mfma_f32_16x16x32_bf16 a[24:27], v[100:103], v[44:47], a[24:27]
    v_mfma_f32_16x16x32_bf16 a[28:31], v[104:107], v[44:47], a[28:31]
    v_mfma_f32_16x16x32_bf16 a[32:35], v[76:79], v[48:51], a[32:35]
    v_mfma_f32_16x16x32_bf16 a[36:39], v[80:83], v[48:51], a[36:39]
    v_mfma_f32_16x16x32_bf16 a[40:43], v[84:87], v[48:51], a[40:43]
    v_mfma_f32_16x16x32_bf16 a[44:47], v[88:91], v[48:51], a[44:47]
    v_mfma_f32_16x16x32_bf16 a[48:51], v[92:95], v[48:51], a[48:51]
    v_mfma_f32_16x16x32_bf16 a[52:55], v[96:99], v[48:51], a[52:55]
    v_mfma_f32_16x16x32_bf16 a[56:59], v[100:103], v[48:51], a[56:59]
    v_mfma_f32_16x16x32_bf16 a[60:63], v[104:107], v[48:51], a[60:63]
    v_mfma_f32_16x16x32_bf16 a[64:67], v[76:79], v[52:55], a[64:67]
    v_mfma_f32_16x16x32_bf16 a[68:71], v[80:83], v[52:55], a[68:71]
    v_mfma_f32_16x16x32_bf16 a[72:75], v[84:87], v[52:55], a[72:75]
    v_mfma_f32_16x16x32_bf16 a[76:79], v[88:91], v[52:55], a[76:79]
    v_mfma_f32_16x16x32_bf16 a[80:83], v[92:95], v[52:55], a[80:83]
    v_mfma_f32_16x16x32_bf16 a[84:87], v[96:99], v[52:55], a[84:87]
    v_mfma_f32_16x16x32_bf16 a[88:91], v[100:103], v[52:55], a[88:91]
    v_mfma_f32_16x16x32_bf16 a[92:95], v[104:107], v[52:55], a[92:95]
    v_mfma_f32_16x16x32_bf16 a[96:99], v[76:79], v[56:59], a[96:99]
    v_mfma_f32_16x16x32_bf16 a[100:103], v[80:83], v[56:59], a[100:103]
    v_mfma_f32_16x16x32_bf16 a[104:107], v[84:87], v[56:59], a[104:107]
    v_mfma_f32_16x16x32_bf16 a[108:111], v[88:91], v[56:59], a[108:111]
    v_mfma_f32_16x16x32_bf16 a[112:115], v[92:95], v[56:59], a[112:115]
    v_mfma_f32_16x16x32_bf16 a[116:119], v[96:99], v[56:59], a[116:119]
    v_mfma_f32_16x16x32_bf16 a[120:123], v[100:103], v[56:59], a[120:123]
    v_mfma_f32_16x16x32_bf16 a[124:127], v[104:107], v[56:59], a[124:127]
    v_dot2_f32_bf16 v140, v44, v156, v140
    v_dot2_f32_bf16 v144, v44, v44, v144
    v_dot2_f32_bf16 v141, v48, v156, v141
    v_dot2_f32_bf16 v145, v48, v48, v145
    v_dot2_f32_bf16 v142, v52, v156, v142
    v_dot2_f32_bf16 v146, v52, v52, v146
    v_dot2_f32_bf16 v143, v56, v156, v143
    v_dot2_f32_bf16 v147, v56, v56, v147
    v_dot2_f32_bf16 v148, v76, v156, v148
    v_dot2_f32_bf16 v149, v80, v156, v149
    v_dot2_f32_bf16 v150, v84, v156, v150
    v_dot2_f32_bf16 v151, v88, v156, v151
    v_dot2_f32_bf16 v152, v92, v156, v152
    v_dot2_f32_bf16 v153, v96, v156, v153
    v_dot2_f32_bf16 v154, v100, v156, v154
    v_dot2_f32_bf16 v155, v104, v156, v155
    v_dot2_f32_bf16 v140, v45, v156, v140
    v_dot2_f32_bf16 v144, v45, v45, v144
    v_dot2_f32_bf16 v141, v49, v156, v141
    v_dot2_f32_bf16 v145, v49, v49, v145
    v_dot2_f32_bf16 v142, v53, v156, v142
    v_dot2_f32_bf16 v146, v53, v53, v146
    v_dot2_f32_bf16 v143, v57, v156, v143
    v_dot2_f32_bf16 v147, v57, v57, v147
    v_dot2_f32_bf16 v148, v77, v156, v148
    v_dot2_f32_bf16 v149, v81, v156, v149
    v_dot2_f32_bf16 v150, v85, v156, v150
    v_dot2_f32_bf16 v151, v89, v156, v151
    v_dot2_f32_bf16 v152, v93, v156, v152
    v_dot2_f32_bf16 v153, v97, v156, v153
    v_dot2_f32_bf16 v154, v101, v156, v154
    v_dot2_f32_bf16 v155, v105, v156, v155
    v_dot2_f32_bf16 v140, v46, v156, v140
    v_dot2_f32_bf16 v144, v46, v46, v144
    v_dot2_f32_bf16 v141, v50, v156, v141
    v_dot2_f32_bf16 v145, v50, v50, v145
    v_dot2_f32_bf16 v142, v54, v156, v142
    v_dot2_f32_bf16 v146, v54, v54, v146
    v_dot2_f32_bf16 v143, v58, v156, v143
    v_dot2_f32_bf16 v147, v58, v58, v147
    v_dot2_f32_bf16 v148, v78, v156, v148
    v_dot2_f32_bf16 v149, v82, v156, v149
    v_dot2_f32_bf16 v150, v86, v156, v150
    v_dot2_f32_bf16 v151, v90, v156, v151
    v_dot2_f32_bf16 v152, v94, v156, v152
    v_dot2_f32_bf16 v153, v98, v156, v153
    v_dot2_f32_bf16 v154, v102, v156, v154
    v_dot2_f32_bf16 v155, v106, v156, v155
    v_dot2_f32_bf16 v140, v47, v156, v140
    v_dot2_f32_bf16 v144, v47, v47, v144
    v_dot2_f32_bf16 v141, v51, v156, v141
    v_dot2_f32_bf16 v145, v51, v51, v145
    v_dot2_f32_bf16 v142, v55, v156, v142
    v_dot2_f32_bf16 v146, v55, v55, v146
    v_dot2_f32_bf16 v143, v59, v156, v143
    v_dot2_f32_bf16 v147, v59, v59, v147
    v_dot2_f32_bf16 v148, v79, v156, v148
    v_dot2_f32_bf16 v149, v83, v156, v149
    v_dot2_f32_bf16 v150, v87, v156, v150
    v_dot2_f32_bf16 v151, v91, v156, v151
    v_dot2_f32_bf16 v152, v95, v156, v152
    v_dot2_f32_bf16 v153, v99, v156, v153
    v_dot2_f32_bf16 v154, v103, v156, v154
    v_dot2_f32_bf16 v155, v107, v156, v155
    s_waitcnt lgkmcnt(0)
    v_mfma_f32_16x16x32_bf16 a[0:3], v[108:111], v[60:63], a[0:3]
    v_mfma_f32_16x16x32_bf16 a[4:7], v[112:115], v[60:63], a[4:7]
    v_mfma_f32_16x16x32_bf16 a[8:11], v[116:119], v[60:63], a[8:11]
    v_mfma_f32_16x16x32_bf16 a[12:15], v[120:123], v[60:63], a[12:15]
    v_mfma_f32_16x16x32_bf16 a[16:19], v[124:127], v[60:63], a[16:19]
    v_mfma_f32_16x16x32_bf16 a[20:23], v[128:131], v[60:63], a[20:23]
    v_mfma_f32_16x16x32_bf16 a[24:27], v[132:135], v[60:63], a[24:27]
    v_mfma_f32_16x16x32_bf16 a[28:31], v[136:139], v[60:63], a[28:31]
    v_mfma_f32_16x16x32_bf16 a[32:35], v[108:111], v[64:67], a[32:35]
    v_mfma_f32_16x16x32_bf16 a[36:39], v[112:115], v[64:67], a[36:39]
    v_mfma_f32_16x16x32_bf16 a[40:43], v[116:119], v[64:67], a[40:43]
    v_mfma_f32_16x16x32_bf16 a[44:47], v[120:123], v[64:67], a[44:47]
    v_mfma_f32_16x16x32_bf16 a[48:51], v[124:127], v[64:67], a[48:51]
    v_mfma_f32_16x16x32_bf16 a[52:55], v[128:131], v[64:67], a[52:55]
    v_mfma_f32_16x16x32_bf16 a[56:59], v[132:135], v[64:67], a[56:59]
    v_mfma_f32_16x16x32_bf16 a[60:63], v[136:139], v[64:67], a[60:63]
    v_mfma_f32_16x16x32_bf16 a[64:67], v[108:111], v[68:71], a[64:67]
    v_mfma_f32_16x16x32_bf16 a[68:71], v[112:115], v[68:71], a[68:71]
    v_mfma_f32_16x16x32_bf16 a[72:75], v[116:119], v[68:71], a[72:75]
    v_mfma_f32_16x16x32_bf16 a[76:79], v[120:123], v[68:71], a[76:79]
    v_mfma_f32_16x16x32_bf16 a[80:83], v[124:127], v[68:71], a[80:83]
    v_mfma_f32_16x16x32_bf16 a[84:87], v[128:131], v[68:71], a[84:87]
    v_mfma_f32_16x16x32_bf16 a[88:91], v[132:135], v[68:71], a[88:91]
    v_mfma_f32_16x16x32_bf16 a[92:95], v[136:139], v[68:71], a[92:95]
    v_mfma_f32_16x16x32_bf16 a[96:99], v[108:111], v[72:75], a[96:99]
    v_mfma_f32_16x16x32_bf16 a[100:103], v[112:115], v[72:75], a[100:103]
    v_mfma_f32_16x16x32_bf16 a[104:107], v[116:119], v[72:75], a[104:107]
    v_mfma_f32_16x16x32_bf16 a[108:111], v[120:123], v[72:75], a[108:111]
    v_mfma_f32_16x16x32_bf16 a[112:115], v[124:127], v[72:75], a[112:115]
    v_mfma_f32_16x16x32_bf16 a[116:119], v[128:131], v[72:75], a[116:119]
    v_mfma_f32_16x16x32_bf16 a[120:123], v[132:135], v[72:75], a[120:123]
    v_mfma_f32_16x16x32_bf16 a[124:127], v[136:139], v[72:75], a[124:127]
    v_dot2_f32_bf16 v140, v60, v156, v140
    v_dot2_f32_bf16 v144, v60, v60, v144
    v_dot2_f32_bf16 v141, v64, v156, v141
    v_dot2_f32_bf16 v145, v64, v64, v145
    v_dot2_f32_bf16 v142, v68, v156, v142
    v_dot2_f32_bf16 v146, v68, v68, v146
    v_dot2_f32_bf16 v143, v72, v156, v143
    v_dot2_f32_bf16 v147, v72, v72, v147
    v_dot2_f32_bf16 v148, v108, v156, v148
    v_dot2_f32_bf16 v149, v112, v156, v149
    v_dot2_f32_bf16 v150, v116, v156, v150
    v_dot2_f32_bf16 v151, v120, v156, v151
    v_dot2_f32_bf16 v152, v124, v156, v152
    v_dot2_f32_bf16 v153, v128, v156, v153
    v_dot2_f32_bf16 v154, v132, v156, v154
    v_dot2_f32_bf16 v155, v136, v156, v155
    v_dot2_f32_bf16 v140, v61, v156, v140
    v_dot2_f32_bf16 v144, v61, v61, v144
    v_dot2_f32_bf16 v141, v65, v156, v141
    v_dot2_f32_bf16 v145, v65, v65, v145
    v_dot2_f32_bf16 v142, v69, v156, v142
    v_dot2_f32_bf16 v146, v69, v69, v146
    v_dot2_f32_bf16 v143, v73, v156, v143
    v_dot2_f32_bf16 v147, v73, v73, v147
    v_dot2_f32_bf16 v148, v109, v156, v148
    v_dot2_f32_bf16 v149, v113, v156, v149
    v_dot2_f32_bf16 v150, v117, v156, v150
    v_dot2_f32_bf16 v151, v121, v156, v151
    v_dot2_f32_bf16 v152, v125, v156, v152
    v_dot2_f32_bf16 v153, v129, v156, v153
    v_dot2_f32_bf16 v154, v133, v156, v154
    v_dot2_f32_bf16 v155, v137, v156, v155
    v_dot2_f32_bf16 v140, v62, v156, v140
    v_dot2_f32_bf16 v144, v62, v62, v144
    v_dot2_f32_bf16 v141, v66, v156, v141
    v_dot2_f32_bf16 v145, v66, v66, v145
    v_dot2_f32_bf16 v142, v70, v156, v142
    v_dot2_f32_bf16 v146, v70, v70, v146
    v_dot2_f32_bf16 v143, v74, v156, v143
    v_dot2_f32_bf16 v147, v74, v74, v147
    v_dot2_f32_bf16 v148, v110, v156, v148
    v_dot2_f32_bf16 v149, v114, v156, v149
    v_dot2_f32_bf16 v150, v118, v156, v150
    v_dot2_f32_bf16 v151, v122, v156, v151
    v_dot2_f32_bf16 v152, v126, v156, v152
    v_dot2_f32_bf16 v153, v130, v156, v153
    v_dot2_f32_bf16 v154, v134, v156, v154
    v_dot2_f32_bf16 v155, v138, v156, v155
    v_dot2_f32_bf16 v140, v63, v156, v140
    v_dot2_f32_bf16 v144, v63, v63, v144
    v_dot2_f32_bf16 v141, v67, v156, v141
    v_dot2_f32_bf16 v145, v67, v67, v145
    v_dot2_f32_bf16 v142, v71, v156, v142
    v_dot2_f32_bf16 v146, v71, v71, v146
    v_dot2_f32_bf16 v143, v75, v156, v143
    v_dot2_f32_bf16 v147, v75, v75, v147
    v_dot2_f32_bf16 v148, v111, v156, v148
    v_dot2_f32_bf16 v149, v115, v156, v149
    v_dot2_f32_bf16 v150, v119, v156, v150
    v_dot2_f32_bf16 v151, v123, v156, v151
    v_dot2_f32_bf16 v152, v127, v156, v152
    v_dot2_f32_bf16 v153, v131, v156, v153
    v_dot2_f32_bf16 v154, v135, v156, v154
    v_dot2_f32_bf16 v155, v139, v156, v155
    s_waitcnt vmcnt(0)
    s_barrier
    ds_read_b128 v[44:47], v13 offset:0
    ds_read_b128 v[48:51], v13 offset:2048
    ds_read_b128 v[52:55], v13 offset:4096
    ds_read_b128 v[56:59], v13 offset:6144
    ds_read_b64_tr_b16 v[76:77], v19 offset:0
    ds_read_b64_tr_b16 v[78:79], v19 offset:1024
    ds_read_b64_tr_b16 v[80:81], v20 offset:0
    ds_read_b64_tr_b16 v[82:83], v20 offset:1024
    ds_read_b64_tr_b16 v[84:85], v21 offset:0
    ds_read_b64_tr_b16 v[86:87], v21 offset:1024
    ds_read_b64_tr_b16 v[88:89], v22 offset:0
    ds_read_b64_tr_b16 v[90:91], v22 offset:1024
    ds_read_b64_tr_b16 v[92:93], v23 offset:0
    ds_read_b64_tr_b16 v[94:95], v23 offset:1024
    ds_read_b64_tr_b16 v[96:97], v24 offset:0
    ds_read_b64_tr_b16 v[98:99], v24 offset:1024
    ds_read_b64_tr_b16 v[100:101], v25 offset:0
    ds_read_b64_tr_b16 v[102:103], v25 offset:1024
    ds_read_b64_tr_b16 v[104:105], v26 offset:0
    ds_read_b64_tr_b16 v[106:107], v26 offset:1024
    ds_read_b128 v[60:63], v14 offset:0
    ds_read_b128 v[64:67], v14 offset:2048
    ds_read_b128 v[68:71], v14 offset:4096
    ds_read_b128 v[72:75], v14 offset:6144
    ds_read_b64_tr_b16 v[108:109], v19 offset:8192
    ds_read_b64_tr_b16 v[110:111], v19 offset:9216
    ds_read_b64_tr_b16 v[112:113], v20 offset:8192
    ds_read_b64_tr_b16 v[114:115], v20 offset:9216
    ds_read_b64_tr_b16 v[116:117], v21 offset:8192
    ds_read_b64_tr_b16 v[118:119], v21 offset:9216
    ds_read_b64_tr_b16 v[120:121], v22 offset:8192
    ds_read_b64_tr_b16 v[122:123], v22 offset:9216
    ds_read_b64_tr_b16 v[124:125], v23 offset:8192
    ds_read_b64_tr_b16 v[126:127], v23 offset:9216
    ds_read_b64_tr_b16 v[128:129], v24 offset:8192
    ds_read_b64_tr_b16 v[130:131], v24 offset:9216
    ds_read_b64_tr_b16 v[132:133], v25 offset:8192
    ds_read_b64_tr_b16 v[134:135], v25 offset:9216
    ds_read_b64_tr_b16 v[136:137], v26 offset:8192
    ds_read_b64_tr_b16 v[138:139], v26 offset:9216
    s_waitcnt lgkmcnt(15)
    v_mfma_f32_16x16x32_bf16 a[0:3], v[76:79], v[44:47], a[0:3]
    v_mfma_f32_16x16x32_bf16 a[4:7], v[80:83], v[44:47], a[4:7]
    v_mfma_f32_16x16x32_bf16 a[8:11], v[84:87], v[44:47], a[8:11]
    v_mfma_f32_16x16x32_bf16 a[12:15], v[88:91], v[44:47], a[12:15]
    v_mfma_f32_16x16x32_bf16 a[16:19], v[92:95], v[44:47], a[16:19]
    v_mfma_f32_16x16x32_bf16 a[20:23], v[96:99], v[44:47], a[20:23]
    v_mfma_f32_16x16x32_bf16 a[24:27], v[100:103], v[44:47], a[24:27]
    v_mfma_f32_16x16x32_bf16 a[28:31], v[104:107], v[44:47], a[28:31]
    v_mfma_f32_16x16x32_bf16 a[32:35], v[76:79], v[48:51], a[32:35]
    v_mfma_f32_16x16x32_bf16 a[36:39], v[80:83], v[48:51], a[36:39]
    v_mfma_f32_16x16x32_bf16 a[40:43], v[84:87], v[48:51], a[40:43]
    v_mfma_f32_16x16x32_bf16 a[44:47], v[88:91], v[48:51], a[44:47]
    v_mfma_f32_16x16x32_bf16 a[48:51], v[92:95], v[48:51], a[48:51]
    v_mfma_f32_16x16x32_bf16 a[52:55], v[96:99], v[48:51], a[52:55]
    v_mfma_f32_16x16x32_bf16 a[56:59], v[100:103], v[48:51], a[56:59]
    v_mfma_f32_16x16x32_bf16 a[60:63], v[104:107], v[48:51], a[60:63]
    v_mfma_f32_16x16x32_bf16 a[64:67], v[76:79], v[52:55], a[64:67]
    v_mfma_f32_16x16x32_bf16 a[68:71], v[80:83], v[52:55], a[68:71]
    v_mfma_f32_16x16x32_bf16 a[72:75], v[84:87], v[52:55], a[72:75]
    v_mfma_f32_16x16x32_bf16 a[76:79], v[88:91], v[52:55], a[76:79]
    v_mfma_f32_16x16x32_bf16 a[80:83], v[92:95], v[52:55], a[80:83]
    v_mfma_f32_16x16x32_bf16 a[84:87], v[96:99], v[52:55], a[84:87]
    v_mfma_f32_16x16x32_bf16 a[88:91], v[100:103], v[52:55], a[88:91]
    v_mfma_f32_16x16x32_bf16 a[92:95], v[104:107], v[52:55], a[92:95]
    v_mfma_f32_16x16x32_bf16 a[96:99], v[76:79], v[56:59], a[96:99]
    v_mfma_f32_16x16x32_bf16 a[100:103], v[80:83], v[56:59], a[100:103]
    v_mfma_f32_16x16x32_bf16 a[104:107], v[84:87], v[56:59], a[104:107]
    v_mfma_f32_16x16x32_bf16 a[108:111], v[88:91], v[56:59], a[108:111]
    v_mfma_f32_16x16x32_bf16 a[112:115], v[92:95], v[56:59], a[112:115]
    v_mfma_f32_16x16x32_bf16 a[116:119], v[96:99], v[56:59], a[116:119]
    v_mfma_f32_16x16x32_bf16 a[120:123], v[100:103], v[56:59], a[120:123]
    v_mfma_f32_16x16x32_bf16 a[124:127], v[104:107], v[56:59], a[124:127]
    v_dot2_f32_bf16 v140, v44, v156, v140
    v_dot2_f32_bf16 v144, v44, v44, v144
    v_dot2_f32_bf16 v141, v48, v156, v141
    v_dot2_f32_bf16 v145, v48, v48, v145
    v_dot2_f32_bf16 v142, v52, v156, v142
    v_dot2_f32_bf16 v146, v52, v52, v146
    v_dot2_f32_bf16 v143, v56, v156, v143
    v_dot2_f32_bf16 v147, v56, v56, v147
    v_dot2_f32_bf16 v148, v76, v156, v148
    v_dot2_f32_bf16 v149, v80, v156, v149
    v_dot2_f32_bf16 v150, v84, v156, v150
    v_dot2_f32_bf16 v151, v88, v156, v151
    v_dot2_f32_bf16 v152, v92, v156, v152
    v_dot2_f32_bf16 v153, v96, v156, v153
    v_dot2_f32_bf16 v154, v100, v156, v154
    v_dot2_f32_bf16 v155, v104, v156, v155
    v_dot2_f32_bf16 v140, v45, v156, v140
    v_dot2_f32_bf16 v144, v45, v45, v144
    v_dot2_f32_bf16 v141, v49, v156, v141
    v_dot2_f32_bf16 v145, v49, v49, v145
    v_dot2_f32_bf16 v142, v53, v156, v142
    v_dot2_f32_bf16 v146, v53, v53, v146
    v_dot2_f32_bf16 v143, v57, v156, v143
    v_dot2_f32_bf16 v147, v57, v57, v147
    v_dot2_f32_bf16 v148, v77, v156, v148
    v_dot2_f32_bf16 v149, v81, v156, v149
    v_dot2_f32_bf16 v150, v85, v156, v150
    v_dot2_f32_bf16 v151, v89, v156, v151
    v_dot2_f32_bf16 v152, v93, v156, v152
    v_dot2_f32_bf16 v153, v97, v156, v153
    v_dot2_f32_bf16 v154, v101, v156, v154
    v_dot2_f32_bf16 v155, v105, v156, v155
    v_dot2_f32_bf16 v140, v46, v156, v140
    v_dot2_f32_bf16 v144, v46, v46, v144
    v_dot2_f32_bf16 v141, v50, v156, v141
    v_dot2_f32_bf16 v145, v50, v50, v145
    v_dot2_f32_bf16 v142, v54, v156, v142
    v_dot2_f32_bf16 v146, v54, v54, v146
    v_dot2_f32_bf16 v143, v58, v156, v143
    v_dot2_f32_bf16 v147, v58, v58, v147
    v_dot2_f32_bf16 v148, v78, v156, v148
    v_dot2_f32_bf16 v149, v82, v156, v149
    v_dot2_f32_bf16 v150, v86, v156, v150
    v_dot2_f32_bf16 v151, v90, v156, v151
    v_dot2_f32_bf16 v152, v94, v156, v152
    v_dot2_f32_bf16 v153, v98, v156, v153
    v_dot2_f32_bf16 v154, v102, v156, v154
    v_dot2_f32_bf16 v155, v106, v156, v155
    v_dot2_f32_bf16 v140, v47, v156, v140
    v_dot2_f32_bf16 v144, v47, v47, v144
    v_dot2_f32_bf16 v141, v51, v156, v141
    v_dot2_f32_bf16 v145, v51, v51, v145
    v_dot2_f32_bf16 v142, v55, v156, v142
    v_dot2_f32_bf16 v146, v55, v55, v146
    v_dot2_f32_bf16 v143, v59, v156, v143
    v_dot2_f32_bf16 v147, v59, v59, v147
    v_dot2_f32_bf16 v148, v79, v156, v148
    v_dot2_f32_bf16 v149, v83, v156, v149
    v_dot2_f32_bf16 v150, v87, v156, v150
    v_dot2_f32_bf16 v151, v91, v156, v151
    v_dot2_f32_bf16 v152, v95, v156, v152
    v_dot2_f32_bf16 v153, v99, v156, v153
    v_dot2_f32_bf16 v154, v103, v156, v154
    v_dot2_f32_bf16 v155, v107, v156, v155
    s_waitcnt lgkmcnt(0)
    v_mfma_f32_16x16x32_bf16 a[0:3], v[108:111], v[60:63], a[0:3]
    v_mfma_f32_16x16x32_bf16 a[4:7], v[112:115], v[60:63], a[4:7]
    v_mfma_f32_16x16x32_bf16 a[8:11], v[116:119], v[60:63], a[8:11]
    v_mfma_f32_16x16x32_bf16 a[12:15], v[120:123], v[60:63], a[12:15]
    v_mfma_f32_16x16x32_bf16 a[16:19], v[124:127], v[60:63], a[16:19]
    v_mfma_f32_16x16x32_bf16 a[20:23], v[128:131], v[60:63], a[20:23]
    v_mfma_f32_16x16x32_bf16 a[24:27], v[132:135], v[60:63], a[24:27]
    v_mfma_f32_16x16x32_bf16 a[28:31], v[136:139], v[60:63], a[28:31]
    v_mfma_f32_16x16x32_bf16 a[32:35], v[108:111], v[64:67], a[32:35]
    v_mfma_f32_16x16x32_bf16 a[36:39], v[112:115], v[64:67], a[36:39]
    v_mfma_f32_16x16x32_bf16 a[40:43], v[116:119], v[64:67], a[40:43]
    v_mfma_f32_16x16x32_bf16 a[44:47], v[120:123], v[64:67], a[44:47]
    v_mfma_f32_16x16x32_bf16 a[48:51], v[124:127], v[64:67], a[48:51]
    v_mfma_f32_16x16x32_bf16 a[52:55], v[128:131], v[64:67], a[52:55]
    v_mfma_f32_16x16x32_bf16 a[56:59], v[132:135], v[64:67], a[56:59]
    v_mfma_f32_16x16x32_bf16 a[60:63], v[136:139], v[64:67], a[60:63]
    v_mfma_f32_16x16x32_bf16 a[64:67], v[108:111], v[68:71], a[64:67]
    v_mfma_f32_16x16x32_bf16 a[68:71], v[112:115], v[68:71], a[68:71]
    v_mfma_f32_16x16x32_bf16 a[72:75], v[116:119], v[68:71], a[72:75]
    v_mfma_f32_16x16x32_bf16 a[76:79], v[120:123], v[68:71], a[76:79]
    v_mfma_f32_16x16x32_bf16 a[80:83], v[124:127], v[68:71], a[80:83]
    v_mfma_f32_16x16x32_bf16 a[84:87], v[128:131], v[68:71], a[84:87]
    v_mfma_f32_16x16x32_bf16 a[88:91], v[132:135], v[68:71], a[88:91]
    v_mfma_f32_16x16x32_bf16 a[92:95], v[136:139], v[68:71], a[92:95]
    v_mfma_f32_16x16x32_bf16 a[96:99], v[108:111], v[72:75], a[96:99]
    v_mfma_f32_16x16x32_bf16 a[100:103], v[112:115], v[72:75], a[100:103]
    v_mfma_f32_16x16x32_bf16 a[104:107], v[116:119], v[72:75], a[104:107]
    v_mfma_f32_16x16x32_bf16 a[108:111], v[120:123], v[72:75], a[108:111]
    v_mfma_f32_16x16x32_bf16 a[112:115], v[124:127], v[72:75], a[112:115]
    v_mfma_f32_16x16x32_bf16 a[116:119], v[128:131], v[72:75], a[116:119]
    v_mfma_f32_16x16x32_bf16 a[120:123], v[132:135], v[72:75], a[120:123]
    v_mfma_f32_16x16x32_bf16 a[124:127], v[136:139], v[72:75], a[124:127]
    v_dot2_f32_bf16 v140, v60, v156, v140
    v_dot2_f32_bf16 v144, v60, v60, v144
    v_dot2_f32_bf16 v141, v64, v156, v141
    v_dot2_f32_bf16 v145, v64, v64, v145
    v_dot2_f32_bf16 v142, v68, v156, v142
    v_dot2_f32_bf16 v146, v68, v68, v146
    v_dot2_f32_bf16 v143, v72, v156, v143
    v_dot2_f32_bf16 v147, v72, v72, v147
    v_dot2_f32_bf16 v148, v108, v156, v148
    v_dot2_f32_bf16 v149, v112, v156, v149
    v_dot2_f32_bf16 v150, v116, v156, v150
    v_dot2_f32_bf16 v151, v120, v156, v151
    v_dot2_f32_bf16 v152, v124, v156, v152
    v_dot2_f32_bf16 v153, v128, v156, v153
    v_dot2_f32_bf16 v154, v132, v156, v154
    v_dot2_f32_bf16 v155, v136, v156, v155
    v_dot2_f32_bf16 v140, v61, v156, v140
    v_dot2_f32_bf16 v144, v61, v61, v144
    v_dot2_f32_bf16 v141, v65, v156, v141
    v_dot2_f32_bf16 v145, v65, v65, v145
    v_dot2_f32_bf16 v142, v69, v156, v142
    v_dot2_f32_bf16 v146, v69, v69, v146
    v_dot2_f32_bf16 v143, v73, v156, v143
    v_dot2_f32_bf16 v147, v73, v73, v147
    v_dot2_f32_bf16 v148, v109, v156, v148
    v_dot2_f32_bf16 v149, v113, v156, v149
    v_dot2_f32_bf16 v150, v117, v156, v150
    v_dot2_f32_bf16 v151, v121, v156, v151
    v_dot2_f32_bf16 v152, v125, v156, v152
    v_dot2_f32_bf16 v153, v129, v156, v153
    v_dot2_f32_bf16 v154, v133, v156, v154
    v_dot2_f32_bf16 v155, v137, v156, v155
    v_dot2_f32_bf16 v140, v62, v156, v140
    v_dot2_f32_bf16 v144, v62, v62, v144
    v_dot2_f32_bf16 v141, v66, v156, v141
    v_dot2_f32_bf16 v145, v66, v66, v145
    v_dot2_f32_bf16 v142, v70, v156, v142
    v_dot2_f32_bf16 v146, v70, v70, v146
    v_dot2_f32_bf16 v143, v74, v156, v143
    v_dot2_f32_bf16 v147, v74, v74, v147
    v_dot2_f32_bf16 v148, v110, v156, v148
    v_dot2_f32_bf16 v149, v114, v156, v149
    v_dot2_f32_bf16 v150, v118, v156, v150
    v_dot2_f32_bf16 v151, v122, v156, v151
    v_dot2_f32_bf16 v152, v126, v156, v152
    v_dot2_f32_bf16 v153, v130, v156, v153
    v_dot2_f32_bf16 v154, v134, v156, v154
    v_dot2_f32_bf16 v155, v138, v156, v155
    v_dot2_f32_bf16 v140, v63, v156, v140
    v_dot2_f32_bf16 v144, v63, v63, v144
    v_dot2_f32_bf16 v141, v67, v156, v141
    v_dot2_f32_bf16 v145, v67, v67, v145
    v_dot2_f32_bf16 v142, v71, v156, v142
    v_dot2_f32_bf16 v146, v71, v71, v146
    v_dot2_f32_bf16 v143, v75, v156, v143
    v_dot2_f32_bf16 v147, v75, v75, v147
    v_dot2_f32_bf16 v148, v111, v156, v148
    v_dot2_f32_bf16 v149, v115, v156, v149
    v_dot2_f32_bf16 v150, v119, v156, v150
    v_dot2_f32_bf16 v151, v123, v156, v151
    v_dot2_f32_bf16 v152, v127, v156, v152
    v_dot2_f32_bf16 v153, v131, v156, v153
    v_dot2_f32_bf16 v154, v135, v156, v154
    v_dot2_f32_bf16 v155, v139, v156, v155
    v_mov_b32 v2, v140
    s_nop 1
    v_permlane32_swap_b32 v140, v2
    v_add_f32 v140, v140, v2
    v_mov_b32 v2, v140
    s_nop 1
    v_permlane16_swap_b32 v140, v2
    v_add_f32 v140, v140, v2
    v_mov_b32 v2, v141
    s_nop 1
    v_permlane32_swap_b32 v141, v2
    v_add_f32 v141, v141, v2
    v_mov_b32 v2, v141
    s_nop 1
    v_permlane16_swap_b32 v141, v2
    v_add_f32 v141, v141, v2
    v_mov_b32 v2, v142
    s_nop 1
    v_permlane32_swap_b32 v142, v2
    v_add_f32 v142, v142, v2
    v_mov_b32 v2, v142
    s_nop 1
    v_permlane16_swap_b32 v142, v2
    v_add_f32 v142, v142, v2
    v_mov_b32 v2, v143
    s_nop 1
    v_permlane32_swap_b32 v143, v2
    v_add_f32 v143, v143, v2
    v_mov_b32 v2, v143
    s_nop 1
    v_permlane16_swap_b32 v143, v2
    v_add_f32 v143, v143, v2
    v_mov_b32 v2, v144
    s_nop 1
    v_permlane32_swap_b32 v144, v2
    v_add_f32 v144, v144, v2
    v_mov_b32 v2, v144
    s_nop 1
    v_permlane16_swap_b32 v144, v2
    v_add_f32 v144, v144, v2
    v_mov_b32 v2, v145
    s_nop 1
    v_permlane32_swap_b32 v145, v2
    v_add_f32 v145, v145, v2
    v_mov_b32 v2, v145
    s_nop 1
    v_permlane16_swap_b32 v145, v2
    v_add_f32 v145, v145, v2
    v_mov_b32 v2, v146
    s_nop 1
    v_permlane32_swap_b32 v146, v2
    v_add_f32 v146, v146, v2
    v_mov_b32 v2, v146
    s_nop 1
    v_permlane16_swap_b32 v146, v2
    v_add_f32 v146, v146, v2
    v_mov_b32 v2, v147
    s_nop 1
    v_permlane32_swap_b32 v147, v2
    v_add_f32 v147, v147, v2
    v_mov_b32 v2, v147
    s_nop 1
    v_permlane16_swap_b32 v147, v2
    v_add_f32 v147, v147, v2
    v_mov_b32 v2, v148
    s_nop 1
    v_permlane32_swap_b32 v148, v2
    v_add_f32 v148, v148, v2
    v_mov_b32 v2, v148
    s_nop 1
    v_permlane16_swap_b32 v148, v2
    v_add_f32 v148, v148, v2
    v_mov_b32 v2, v149
    s_nop 1
    v_permlane32_swap_b32 v149, v2
    v_add_f32 v149, v149, v2
    v_mov_b32 v2, v149
    s_nop 1
    v_permlane16_swap_b32 v149, v2
    v_add_f32 v149, v149, v2
    v_mov_b32 v2, v150
    s_nop 1
    v_permlane32_swap_b32 v150, v2
    v_add_f32 v150, v150, v2
    v_mov_b32 v2, v150
    s_nop 1
    v_permlane16_swap_b32 v150, v2
    v_add_f32 v150, v150, v2
    v_mov_b32 v2, v151
    s_nop 1
    v_permlane32_swap_b32 v151, v2
    v_add_f32 v151, v151, v2
    v_mov_b32 v2, v151
    s_nop 1
    v_permlane16_swap_b32 v151, v2
    v_add_f32 v151, v151, v2
    v_mov_b32 v2, v152
    s_nop 1
    v_permlane32_swap_b32 v152, v2
    v_add_f32 v152, v152, v2
    v_mov_b32 v2, v152
    s_nop 1
    v_permlane16_swap_b32 v152, v2
    v_add_f32 v152, v152, v2
    v_mov_b32 v2, v153
    s_nop 1
    v_permlane32_swap_b32 v153, v2
    v_add_f32 v153, v153, v2
    v_mov_b32 v2, v153
    s_nop 1
    v_permlane16_swap_b32 v153, v2
    v_add_f32 v153, v153, v2
    v_mov_b32 v2, v154
    s_nop 1
    v_permlane32_swap_b32 v154, v2
    v_add_f32 v154, v154, v2
    v_mov_b32 v2, v154
    s_nop 1
    v_permlane16_swap_b32 v154, v2
    v_add_f32 v154, v154, v2
    v_mov_b32 v2, v155
    s_nop 1
    v_permlane32_swap_b32 v155, v2
    v_add_f32 v155, v155, v2
    v_mov_b32 v2, v155
    s_nop 1
    v_permlane16_swap_b32 v155, v2
    v_add_f32 v155, v155, v2
    s_mov_b32 s44, 0x3b124925
    v_mul_f32 v140, s44, v140
    v_mul_f32 v144, s44, v144
    v_fma_f32 v144, -v140, v140, v144
    v_max_f32 v144, 0, v144
    v_add_f32 v144, 0x3727c5ac, v144
    v_rsq_f32 v144, v144
    v_mul_f32 v141, s44, v141
    v_mul_f32 v145, s44, v145
    v_fma_f32 v145, -v141, v141, v145
    v_max_f32 v145, 0, v145
    v_add_f32 v145, 0x3727c5ac, v145
    v_rsq_f32 v145, v145
    v_mul_f32 v142, s44, v142
    v_mul_f32 v146, s44, v146
    v_fma_f32 v146, -v142, v142, v146
    v_max_f32 v146, 0, v146
    v_add_f32 v146, 0x3727c5ac, v146
    v_rsq_f32 v146, v146
    v_mul_f32 v143, s44, v143
    v_mul_f32 v147, s44, v147
    v_fma_f32 v147, -v143, v143, v147
    v_max_f32 v147, 0, v147
    v_add_f32 v147, 0x3727c5ac, v147
    v_rsq_f32 v147, v147
    s_lshl_b32 s44, s51, 9
    v_lshlrev_b32 v2, 2, v6
    v_add_u32 v2, s44, v2
    v_add_u32 v2, 147456, v2
    v_lshlrev_b32 v3, 4, v7
    v_add_u32 v3, s44, v3
    v_add_u32 v3, 147456, v3
    ds_write_b32 v2, v148 offset:0
    ds_write_b32 v2, v149 offset:64
    ds_write_b32 v2, v150 offset:128
    ds_write_b32 v2, v151 offset:192
    ds_write_b32 v2, v152 offset:256
    ds_write_b32 v2, v153 offset:320
    ds_write_b32 v2, v154 offset:384
    ds_write_b32 v2, v155 offset:448
    s_waitcnt lgkmcnt(0)
    ds_read_b128 v[108:111], v3 offset:0
    ds_read_b128 v[112:115], v3 offset:64
    ds_read_b128 v[116:119], v3 offset:128
    ds_read_b128 v[120:123], v3 offset:192
    ds_read_b128 v[124:127], v3 offset:256
    ds_read_b128 v[128:131], v3 offset:320
    ds_read_b128 v[132:135], v3 offset:384
    ds_read_b128 v[136:139], v3 offset:448
    s_waitcnt lgkmcnt(0)
    v_accvgpr_read_b32 v44, a0
    v_accvgpr_read_b32 v45, a1
    v_accvgpr_read_b32 v46, a2
    v_accvgpr_read_b32 v47, a3
    v_fma_f32 v44, -v140, v108, v44
    v_mul_f32 v44, v144, v44
    v_fma_f32 v45, -v140, v109, v45
    v_mul_f32 v45, v144, v45
    v_fma_f32 v46, -v140, v110, v46
    v_mul_f32 v46, v144, v46
    v_fma_f32 v47, -v140, v111, v47
    v_mul_f32 v47, v144, v47
    v_accvgpr_read_b32 v76, a16
    v_accvgpr_read_b32 v77, a17
    v_accvgpr_read_b32 v78, a18
    v_accvgpr_read_b32 v79, a19
    v_fma_f32 v76, -v140, v124, v76
    v_mul_f32 v76, v144, v76
    v_fma_f32 v77, -v140, v125, v77
    v_mul_f32 v77, v144, v77
    v_fma_f32 v78, -v140, v126, v78
    v_mul_f32 v78, v144, v78
    v_fma_f32 v79, -v140, v127, v79
    v_mul_f32 v79, v144, v79
    v_mul_f32 v60, 0xbfb8aa3b, v44
    v_exp_f32 v60, v60
    s_nop 0
    v_add_f32 v60, 1.0, v60
    v_rcp_f32 v60, v60
    v_mul_f32 v44, v44, v76
    v_mul_f32 v44, v44, v60
    v_mul_f32 v60, 0xbfb8aa3b, v45
    v_exp_f32 v60, v60
    s_nop 0
    v_add_f32 v60, 1.0, v60
    v_rcp_f32 v60, v60
    v_mul_f32 v45, v45, v77
    v_mul_f32 v45, v45, v60
    v_mul_f32 v60, 0xbfb8aa3b, v46
    v_exp_f32 v60, v60
    s_nop 0
    v_add_f32 v60, 1.0, v60
    v_rcp_f32 v60, v60
    v_mul_f32 v46, v46, v78
    v_mul_f32 v46, v46, v60
    v_mul_f32 v60, 0xbfb8aa3b, v47
    v_exp_f32 v60, v60
    s_nop 0
    v_add_f32 v60, 1.0, v60
    v_rcp_f32 v60, v60
    v_mul_f32 v47, v47, v79
    v_mul_f32 v47, v47, v60
    v_cvt_pk_bf16_f32 v60, v44, v45
    v_cvt_pk_bf16_f32 v61, v46, v47
    buffer_store_dwordx2 v[60:61], v160, s[20:23], 0 offen offset:0
    v_accvgpr_read_b32 v44, a4
    v_accvgpr_read_b32 v45, a5
    v_accvgpr_read_b32 v46, a6
    v_accvgpr_read_b32 v47, a7
    v_fma_f32 v44, -v140, v112, v44
    v_mul_f32 v44, v144, v44
    v_fma_f32 v45, -v140, v113, v45
    v_mul_f32 v45, v144, v45
    v_fma_f32 v46, -v140, v114, v46
    v_mul_f32 v46, v144, v46
    v_fma_f32 v47, -v140, v115, v47
    v_mul_f32 v47, v144, v47
    v_accvgpr_read_b32 v76, a20
    v_accvgpr_read_b32 v77, a21
    v_accvgpr_read_b32 v78, a22
    v_accvgpr_read_b32 v79, a23
    v_fma_f32 v76, -v140, v128, v76
    v_mul_f32 v76, v144, v76
    v_fma_f32 v77, -v140, v129, v77
    v_mul_f32 v77, v144, v77
    v_fma_f32 v78, -v140, v130, v78
    v_mul_f32 v78, v144, v78
    v_fma_f32 v79, -v140, v131, v79
    v_mul_f32 v79, v144, v79
    v_mul_f32 v60, 0xbfb8aa3b, v44
    v_exp_f32 v60, v60
    s_nop 0
    v_add_f32 v60, 1.0, v60
    v_rcp_f32 v60, v60
    v_mul_f32 v44, v44, v76
    v_mul_f32 v44, v44, v60
    v_mul_f32 v60, 0xbfb8aa3b, v45
    v_exp_f32 v60, v60
    s_nop 0
    v_add_f32 v60, 1.0, v60
    v_rcp_f32 v60, v60
    v_mul_f32 v45, v45, v77
    v_mul_f32 v45, v45, v60
    v_mul_f32 v60, 0xbfb8aa3b, v46
    v_exp_f32 v60, v60
    s_nop 0
    v_add_f32 v60, 1.0, v60
    v_rcp_f32 v60, v60
    v_mul_f32 v46, v46, v78
    v_mul_f32 v46, v46, v60
    v_mul_f32 v60, 0xbfb8aa3b, v47
    v_exp_f32 v60, v60
    s_nop 0
    v_add_f32 v60, 1.0, v60
    v_rcp_f32 v60, v60
    v_mul_f32 v47, v47, v79
    v_mul_f32 v47, v47, v60
    v_cvt_pk_bf16_f32 v60, v44, v45
    v_cvt_pk_bf16_f32 v61, v46, v47
    buffer_store_dwordx2 v[60:61], v160, s[20:23], 0 offen offset:32
    v_accvgpr_read_b32 v44, a8
    v_accvgpr_read_b32 v45, a9
    v_accvgpr_read_b32 v46, a10
    v_accvgpr_read_b32 v47, a11
    v_fma_f32 v44, -v140, v116, v44
    v_mul_f32 v44, v144, v44
    v_fma_f32 v45, -v140, v117, v45
    v_mul_f32 v45, v144, v45
    v_fma_f32 v46, -v140, v118, v46
    v_mul_f32 v46, v144, v46
    v_fma_f32 v47, -v140, v119, v47
    v_mul_f32 v47, v144, v47
    v_accvgpr_read_b32 v76, a24
    v_accvgpr_read_b32 v77, a25
    v_accvgpr_read_b32 v78, a26
    v_accvgpr_read_b32 v79, a27
    v_fma_f32 v76, -v140, v132, v76
    v_mul_f32 v76, v144, v76
    v_fma_f32 v77, -v140, v133, v77
    v_mul_f32 v77, v144, v77
    v_fma_f32 v78, -v140, v134, v78
    v_mul_f32 v78, v144, v78
    v_fma_f32 v79, -v140, v135, v79
    v_mul_f32 v79, v144, v79
    v_mul_f32 v60, 0xbfb8aa3b, v44
    v_exp_f32 v60, v60
    s_nop 0
    v_add_f32 v60, 1.0, v60
    v_rcp_f32 v60, v60
    v_mul_f32 v44, v44, v76
    v_mul_f32 v44, v44, v60
    v_mul_f32 v60, 0xbfb8aa3b, v45
    v_exp_f32 v60, v60
    s_nop 0
    v_add_f32 v60, 1.0, v60
    v_rcp_f32 v60, v60
    v_mul_f32 v45, v45, v77
    v_mul_f32 v45, v45, v60
    v_mul_f32 v60, 0xbfb8aa3b, v46
    v_exp_f32 v60, v60
    s_nop 0
    v_add_f32 v60, 1.0, v60
    v_rcp_f32 v60, v60
    v_mul_f32 v46, v46, v78
    v_mul_f32 v46, v46, v60
    v_mul_f32 v60, 0xbfb8aa3b, v47
    v_exp_f32 v60, v60
    s_nop 0
    v_add_f32 v60, 1.0, v60
    v_rcp_f32 v60, v60
    v_mul_f32 v47, v47, v79
    v_mul_f32 v47, v47, v60
    v_cvt_pk_bf16_f32 v60, v44, v45
    v_cvt_pk_bf16_f32 v61, v46, v47
    buffer_store_dwordx2 v[60:61], v160, s[20:23], 0 offen offset:64
    v_accvgpr_read_b32 v44, a12
    v_accvgpr_read_b32 v45, a13
    v_accvgpr_read_b32 v46, a14
    v_accvgpr_read_b32 v47, a15
    v_fma_f32 v44, -v140, v120, v44
    v_mul_f32 v44, v144, v44
    v_fma_f32 v45, -v140, v121, v45
    v_mul_f32 v45, v144, v45
    v_fma_f32 v46, -v140, v122, v46
    v_mul_f32 v46, v144, v46
    v_fma_f32 v47, -v140, v123, v47
    v_mul_f32 v47, v144, v47
    v_accvgpr_read_b32 v76, a28
    v_accvgpr_read_b32 v77, a29
    v_accvgpr_read_b32 v78, a30
    v_accvgpr_read_b32 v79, a31
    v_fma_f32 v76, -v140, v136, v76
    v_mul_f32 v76, v144, v76
    v_fma_f32 v77, -v140, v137, v77
    v_mul_f32 v77, v144, v77
    v_fma_f32 v78, -v140, v138, v78
    v_mul_f32 v78, v144, v78
    v_fma_f32 v79, -v140, v139, v79
    v_mul_f32 v79, v144, v79
    v_mul_f32 v60, 0xbfb8aa3b, v44
    v_exp_f32 v60, v60
    s_nop 0
    v_add_f32 v60, 1.0, v60
    v_rcp_f32 v60, v60
    v_mul_f32 v44, v44, v76
    v_mul_f32 v44, v44, v60
    v_mul_f32 v60, 0xbfb8aa3b, v45
    v_exp_f32 v60, v60
    s_nop 0
    v_add_f32 v60, 1.0, v60
    v_rcp_f32 v60, v60
    v_mul_f32 v45, v45, v77
    v_mul_f32 v45, v45, v60
    v_mul_f32 v60, 0xbfb8aa3b, v46
    v_exp_f32 v60, v60
    s_nop 0
    v_add_f32 v60, 1.0, v60
    v_rcp_f32 v60, v60
    v_mul_f32 v46, v46, v78
    v_mul_f32 v46, v46, v60
    v_mul_f32 v60, 0xbfb8aa3b, v47
    v_exp_f32 v60, v60
    s_nop 0
    v_add_f32 v60, 1.0, v60
    v_rcp_f32 v60, v60
    v_mul_f32 v47, v47, v79
    v_mul_f32 v47, v47, v60
    v_cvt_pk_bf16_f32 v60, v44, v45
    v_cvt_pk_bf16_f32 v61, v46, v47
    buffer_store_dwordx2 v[60:61], v160, s[20:23], 0 offen offset:96
    v_accvgpr_read_b32 v44, a32
    v_accvgpr_read_b32 v45, a33
    v_accvgpr_read_b32 v46, a34
    v_accvgpr_read_b32 v47, a35
    v_fma_f32 v44, -v141, v108, v44
    v_mul_f32 v44, v145, v44
    v_fma_f32 v45, -v141, v109, v45
    v_mul_f32 v45, v145, v45
    v_fma_f32 v46, -v141, v110, v46
    v_mul_f32 v46, v145, v46
    v_fma_f32 v47, -v141, v111, v47
    v_mul_f32 v47, v145, v47
    v_accvgpr_read_b32 v76, a48
    v_accvgpr_read_b32 v77, a49
    v_accvgpr_read_b32 v78, a50
    v_accvgpr_read_b32 v79, a51
    v_fma_f32 v76, -v141, v124, v76
    v_mul_f32 v76, v145, v76
    v_fma_f32 v77, -v141, v125, v77
    v_mul_f32 v77, v145, v77
    v_fma_f32 v78, -v141, v126, v78
    v_mul_f32 v78, v145, v78
    v_fma_f32 v79, -v141, v127, v79
    v_mul_f32 v79, v145, v79
    v_mul_f32 v60, 0xbfb8aa3b, v44
    v_exp_f32 v60, v60
    s_nop 0
    v_add_f32 v60, 1.0, v60
    v_rcp_f32 v60, v60
    v_mul_f32 v44, v44, v76
    v_mul_f32 v44, v44, v60
    v_mul_f32 v60, 0xbfb8aa3b, v45
    v_exp_f32 v60, v60
    s_nop 0
    v_add_f32 v60, 1.0, v60
    v_rcp_f32 v60, v60
    v_mul_f32 v45, v45, v77
    v_mul_f32 v45, v45, v60
    v_mul_f32 v60, 0xbfb8aa3b, v46
    v_exp_f32 v60, v60
    s_nop 0
    v_add_f32 v60, 1.0, v60
    v_rcp_f32 v60, v60
    v_mul_f32 v46, v46, v78
    v_mul_f32 v46, v46, v60
    v_mul_f32 v60, 0xbfb8aa3b, v47
    v_exp_f32 v60, v60
    s_nop 0
    v_add_f32 v60, 1.0, v60
    v_rcp_f32 v60, v60
    v_mul_f32 v47, v47, v79
    v_mul_f32 v47, v47, v60
    v_cvt_pk_bf16_f32 v60, v44, v45
    v_cvt_pk_bf16_f32 v61, v46, v47
    buffer_store_dwordx2 v[60:61], v161, s[20:23], 0 offen offset:0
    v_accvgpr_read_b32 v44, a36
    v_accvgpr_read_b32 v45, a37
    v_accvgpr_read_b32 v46, a38
    v_accvgpr_read_b32 v47, a39
    v_fma_f32 v44, -v141, v112, v44
    v_mul_f32 v44, v145, v44
    v_fma_f32 v45, -v141, v113, v45
    v_mul_f32 v45, v145, v45
    v_fma_f32 v46, -v141, v114, v46
    v_mul_f32 v46, v145, v46
    v_fma_f32 v47, -v141, v115, v47
    v_mul_f32 v47, v145, v47
    v_accvgpr_read_b32 v76, a52
    v_accvgpr_read_b32 v77, a53
    v_accvgpr_read_b32 v78, a54
    v_accvgpr_read_b32 v79, a55
    v_fma_f32 v76, -v141, v128, v76
    v_mul_f32 v76, v145, v76
    v_fma_f32 v77, -v141, v129, v77
    v_mul_f32 v77, v145, v77
    v_fma_f32 v78, -v141, v130, v78
    v_mul_f32 v78, v145, v78
    v_fma_f32 v79, -v141, v131, v79
    v_mul_f32 v79, v145, v79
    v_mul_f32 v60, 0xbfb8aa3b, v44
    v_exp_f32 v60, v60
    s_nop 0
    v_add_f32 v60, 1.0, v60
    v_rcp_f32 v60, v60
    v_mul_f32 v44, v44, v76
    v_mul_f32 v44, v44, v60
    v_mul_f32 v60, 0xbfb8aa3b, v45
    v_exp_f32 v60, v60
    s_nop 0
    v_add_f32 v60, 1.0, v60
    v_rcp_f32 v60, v60
    v_mul_f32 v45, v45, v77
    v_mul_f32 v45, v45, v60
    v_mul_f32 v60, 0xbfb8aa3b, v46
    v_exp_f32 v60, v60
    s_nop 0
    v_add_f32 v60, 1.0, v60
    v_rcp_f32 v60, v60
    v_mul_f32 v46, v46, v78
    v_mul_f32 v46, v46, v60
    v_mul_f32 v60, 0xbfb8aa3b, v47
    v_exp_f32 v60, v60
    s_nop 0
    v_add_f32 v60, 1.0, v60
    v_rcp_f32 v60, v60
    v_mul_f32 v47, v47, v79
    v_mul_f32 v47, v47, v60
    v_cvt_pk_bf16_f32 v60, v44, v45
    v_cvt_pk_bf16_f32 v61, v46, v47
    buffer_store_dwordx2 v[60:61], v161, s[20:23], 0 offen offset:32
    v_accvgpr_read_b32 v44, a40
    v_accvgpr_read_b32 v45, a41
    v_accvgpr_read_b32 v46, a42
    v_accvgpr_read_b32 v47, a43
    v_fma_f32 v44, -v141, v116, v44
    v_mul_f32 v44, v145, v44
    v_fma_f32 v45, -v141, v117, v45
    v_mul_f32 v45, v145, v45
    v_fma_f32 v46, -v141, v118, v46
    v_mul_f32 v46, v145, v46
    v_fma_f32 v47, -v141, v119, v47
    v_mul_f32 v47, v145, v47
    v_accvgpr_read_b32 v76, a56
    v_accvgpr_read_b32 v77, a57
    v_accvgpr_read_b32 v78, a58
    v_accvgpr_read_b32 v79, a59
    v_fma_f32 v76, -v141, v132, v76
    v_mul_f32 v76, v145, v76
    v_fma_f32 v77, -v141, v133, v77
    v_mul_f32 v77, v145, v77
    v_fma_f32 v78, -v141, v134, v78
    v_mul_f32 v78, v145, v78
    v_fma_f32 v79, -v141, v135, v79
    v_mul_f32 v79, v145, v79
    v_mul_f32 v60, 0xbfb8aa3b, v44
    v_exp_f32 v60, v60
    s_nop 0
    v_add_f32 v60, 1.0, v60
    v_rcp_f32 v60, v60
    v_mul_f32 v44, v44, v76
    v_mul_f32 v44, v44, v60
    v_mul_f32 v60, 0xbfb8aa3b, v45
    v_exp_f32 v60, v60
    s_nop 0
    v_add_f32 v60, 1.0, v60
    v_rcp_f32 v60, v60
    v_mul_f32 v45, v45, v77
    v_mul_f32 v45, v45, v60
    v_mul_f32 v60, 0xbfb8aa3b, v46
    v_exp_f32 v60, v60
    s_nop 0
    v_add_f32 v60, 1.0, v60
    v_rcp_f32 v60, v60
    v_mul_f32 v46, v46, v78
    v_mul_f32 v46, v46, v60
    v_mul_f32 v60, 0xbfb8aa3b, v47
    v_exp_f32 v60, v60
    s_nop 0
    v_add_f32 v60, 1.0, v60
    v_rcp_f32 v60, v60
    v_mul_f32 v47, v47, v79
    v_mul_f32 v47, v47, v60
    v_cvt_pk_bf16_f32 v60, v44, v45
    v_cvt_pk_bf16_f32 v61, v46, v47
    buffer_store_dwordx2 v[60:61], v161, s[20:23], 0 offen offset:64
    v_accvgpr_read_b32 v44, a44
    v_accvgpr_read_b32 v45, a45
    v_accvgpr_read_b32 v46, a46
    v_accvgpr_read_b32 v47, a47
    v_fma_f32 v44, -v141, v120, v44
    v_mul_f32 v44, v145, v44
    v_fma_f32 v45, -v141, v121, v45
    v_mul_f32 v45, v145, v45
    v_fma_f32 v46, -v141, v122, v46
    v_mul_f32 v46, v145, v46
    v_fma_f32 v47, -v141, v123, v47
    v_mul_f32 v47, v145, v47
    v_accvgpr_read_b32 v76, a60
    v_accvgpr_read_b32 v77, a61
    v_accvgpr_read_b32 v78, a62
    v_accvgpr_read_b32 v79, a63
    v_fma_f32 v76, -v141, v136, v76
    v_mul_f32 v76, v145, v76
    v_fma_f32 v77, -v141, v137, v77
    v_mul_f32 v77, v145, v77
    v_fma_f32 v78, -v141, v138, v78
    v_mul_f32 v78, v145, v78
    v_fma_f32 v79, -v141, v139, v79
    v_mul_f32 v79, v145, v79
    v_mul_f32 v60, 0xbfb8aa3b, v44
    v_exp_f32 v60, v60
    s_nop 0
    v_add_f32 v60, 1.0, v60
    v_rcp_f32 v60, v60
    v_mul_f32 v44, v44, v76
    v_mul_f32 v44, v44, v60
    v_mul_f32 v60, 0xbfb8aa3b, v45
    v_exp_f32 v60, v60
    s_nop 0
    v_add_f32 v60, 1.0, v60
    v_rcp_f32 v60, v60
    v_mul_f32 v45, v45, v77
    v_mul_f32 v45, v45, v60
    v_mul_f32 v60, 0xbfb8aa3b, v46
    v_exp_f32 v60, v60
    s_nop 0
    v_add_f32 v60, 1.0, v60
    v_rcp_f32 v60, v60
    v_mul_f32 v46, v46, v78
    v_mul_f32 v46, v46, v60
    v_mul_f32 v60, 0xbfb8aa3b, v47
    v_exp_f32 v60, v60
    s_nop 0
    v_add_f32 v60, 1.0, v60
    v_rcp_f32 v60, v60
    v_mul_f32 v47, v47, v79
    v_mul_f32 v47, v47, v60
    v_cvt_pk_bf16_f32 v60, v44, v45
    v_cvt_pk_bf16_f32 v61, v46, v47
    buffer_store_dwordx2 v[60:61], v161, s[20:23], 0 offen offset:96
    v_accvgpr_read_b32 v44, a64
    v_accvgpr_read_b32 v45, a65
    v_accvgpr_read_b32 v46, a66
    v_accvgpr_read_b32 v47, a67
    v_fma_f32 v44, -v142, v108, v44
    v_mul_f32 v44, v146, v44
    v_fma_f32 v45, -v142, v109, v45
    v_mul_f32 v45, v146, v45
    v_fma_f32 v46, -v142, v110, v46
    v_mul_f32 v46, v146, v46
    v_fma_f32 v47, -v142, v111, v47
    v_mul_f32 v47, v146, v47
    v_accvgpr_read_b32 v76, a80
    v_accvgpr_read_b32 v77, a81
    v_accvgpr_read_b32 v78, a82
    v_accvgpr_read_b32 v79, a83
    v_fma_f32 v76, -v142, v124, v76
    v_mul_f32 v76, v146, v76
    v_fma_f32 v77, -v142, v125, v77
    v_mul_f32 v77, v146, v77
    v_fma_f32 v78, -v142, v126, v78
    v_mul_f32 v78, v146, v78
    v_fma_f32 v79, -v142, v127, v79
    v_mul_f32 v79, v146, v79
    v_mul_f32 v60, 0xbfb8aa3b, v44
    v_exp_f32 v60, v60
    s_nop 0
    v_add_f32 v60, 1.0, v60
    v_rcp_f32 v60, v60
    v_mul_f32 v44, v44, v76
    v_mul_f32 v44, v44, v60
    v_mul_f32 v60, 0xbfb8aa3b, v45
    v_exp_f32 v60, v60
    s_nop 0
    v_add_f32 v60, 1.0, v60
    v_rcp_f32 v60, v60
    v_mul_f32 v45, v45, v77
    v_mul_f32 v45, v45, v60
    v_mul_f32 v60, 0xbfb8aa3b, v46
    v_exp_f32 v60, v60
    s_nop 0
    v_add_f32 v60, 1.0, v60
    v_rcp_f32 v60, v60
    v_mul_f32 v46, v46, v78
    v_mul_f32 v46, v46, v60
    v_mul_f32 v60, 0xbfb8aa3b, v47
    v_exp_f32 v60, v60
    s_nop 0
    v_add_f32 v60, 1.0, v60
    v_rcp_f32 v60, v60
    v_mul_f32 v47, v47, v79
    v_mul_f32 v47, v47, v60
    v_cvt_pk_bf16_f32 v60, v44, v45
    v_cvt_pk_bf16_f32 v61, v46, v47
    buffer_store_dwordx2 v[60:61], v162, s[20:23], 0 offen offset:0
    v_accvgpr_read_b32 v44, a68
    v_accvgpr_read_b32 v45, a69
    v_accvgpr_read_b32 v46, a70
    v_accvgpr_read_b32 v47, a71
    v_fma_f32 v44, -v142, v112, v44
    v_mul_f32 v44, v146, v44
    v_fma_f32 v45, -v142, v113, v45
    v_mul_f32 v45, v146, v45
    v_fma_f32 v46, -v142, v114, v46
    v_mul_f32 v46, v146, v46
    v_fma_f32 v47, -v142, v115, v47
    v_mul_f32 v47, v146, v47
    v_accvgpr_read_b32 v76, a84
    v_accvgpr_read_b32 v77, a85
    v_accvgpr_read_b32 v78, a86
    v_accvgpr_read_b32 v79, a87
    v_fma_f32 v76, -v142, v128, v76
    v_mul_f32 v76, v146, v76
    v_fma_f32 v77, -v142, v129, v77
    v_mul_f32 v77, v146, v77
    v_fma_f32 v78, -v142, v130, v78
    v_mul_f32 v78, v146, v78
    v_fma_f32 v79, -v142, v131, v79
    v_mul_f32 v79, v146, v79
    v_mul_f32 v60, 0xbfb8aa3b, v44
    v_exp_f32 v60, v60
    s_nop 0
    v_add_f32 v60, 1.0, v60
    v_rcp_f32 v60, v60
    v_mul_f32 v44, v44, v76
    v_mul_f32 v44, v44, v60
    v_mul_f32 v60, 0xbfb8aa3b, v45
    v_exp_f32 v60, v60
    s_nop 0
    v_add_f32 v60, 1.0, v60
    v_rcp_f32 v60, v60
    v_mul_f32 v45, v45, v77
    v_mul_f32 v45, v45, v60
    v_mul_f32 v60, 0xbfb8aa3b, v46
    v_exp_f32 v60, v60
    s_nop 0
    v_add_f32 v60, 1.0, v60
    v_rcp_f32 v60, v60
    v_mul_f32 v46, v46, v78
    v_mul_f32 v46, v46, v60
    v_mul_f32 v60, 0xbfb8aa3b, v47
    v_exp_f32 v60, v60
    s_nop 0
    v_add_f32 v60, 1.0, v60
    v_rcp_f32 v60, v60
    v_mul_f32 v47, v47, v79
    v_mul_f32 v47, v47, v60
    v_cvt_pk_bf16_f32 v60, v44, v45
    v_cvt_pk_bf16_f32 v61, v46, v47
    buffer_store_dwordx2 v[60:61], v162, s[20:23], 0 offen offset:32
    v_accvgpr_read_b32 v44, a72
    v_accvgpr_read_b32 v45, a73
    v_accvgpr_read_b32 v46, a74
    v_accvgpr_read_b32 v47, a75
    v_fma_f32 v44, -v142, v116, v44
    v_mul_f32 v44, v146, v44
    v_fma_f32 v45, -v142, v117, v45
    v_mul_f32 v45, v146, v45
    v_fma_f32 v46, -v142, v118, v46
    v_mul_f32 v46, v146, v46
    v_fma_f32 v47, -v142, v119, v47
    v_mul_f32 v47, v146, v47
    v_accvgpr_read_b32 v76, a88
    v_accvgpr_read_b32 v77, a89
    v_accvgpr_read_b32 v78, a90
    v_accvgpr_read_b32 v79, a91
    v_fma_f32 v76, -v142, v132, v76
    v_mul_f32 v76, v146, v76
    v_fma_f32 v77, -v142, v133, v77
    v_mul_f32 v77, v146, v77
    v_fma_f32 v78, -v142, v134, v78
    v_mul_f32 v78, v146, v78
    v_fma_f32 v79, -v142, v135, v79
    v_mul_f32 v79, v146, v79
    v_mul_f32 v60, 0xbfb8aa3b, v44
    v_exp_f32 v60, v60
    s_nop 0
    v_add_f32 v60, 1.0, v60
    v_rcp_f32 v60, v60
    v_mul_f32 v44, v44, v76
    v_mul_f32 v44, v44, v60
    v_mul_f32 v60, 0xbfb8aa3b, v45
    v_exp_f32 v60, v60
    s_nop 0
    v_add_f32 v60, 1.0, v60
    v_rcp_f32 v60, v60
    v_mul_f32 v45, v45, v77
    v_mul_f32 v45, v45, v60
    v_mul_f32 v60, 0xbfb8aa3b, v46
    v_exp_f32 v60, v60
    s_nop 0
    v_add_f32 v60, 1.0, v60
    v_rcp_f32 v60, v60
    v_mul_f32 v46, v46, v78
    v_mul_f32 v46, v46, v60
    v_mul_f32 v60, 0xbfb8aa3b, v47
    v_exp_f32 v60, v60
    s_nop 0
    v_add_f32 v60, 1.0, v60
    v_rcp_f32 v60, v60
    v_mul_f32 v47, v47, v79
    v_mul_f32 v47, v47, v60
    v_cvt_pk_bf16_f32 v60, v44, v45
    v_cvt_pk_bf16_f32 v61, v46, v47
    buffer_store_dwordx2 v[60:61], v162, s[20:23], 0 offen offset:64
    v_accvgpr_read_b32 v44, a76
    v_accvgpr_read_b32 v45, a77
    v_accvgpr_read_b32 v46, a78
    v_accvgpr_read_b32 v47, a79
    v_fma_f32 v44, -v142, v120, v44
    v_mul_f32 v44, v146, v44
    v_fma_f32 v45, -v142, v121, v45
    v_mul_f32 v45, v146, v45
    v_fma_f32 v46, -v142, v122, v46
    v_mul_f32 v46, v146, v46
    v_fma_f32 v47, -v142, v123, v47
    v_mul_f32 v47, v146, v47
    v_accvgpr_read_b32 v76, a92
    v_accvgpr_read_b32 v77, a93
    v_accvgpr_read_b32 v78, a94
    v_accvgpr_read_b32 v79, a95
    v_fma_f32 v76, -v142, v136, v76
    v_mul_f32 v76, v146, v76
    v_fma_f32 v77, -v142, v137, v77
    v_mul_f32 v77, v146, v77
    v_fma_f32 v78, -v142, v138, v78
    v_mul_f32 v78, v146, v78
    v_fma_f32 v79, -v142, v139, v79
    v_mul_f32 v79, v146, v79
    v_mul_f32 v60, 0xbfb8aa3b, v44
    v_exp_f32 v60, v60
    s_nop 0
    v_add_f32 v60, 1.0, v60
    v_rcp_f32 v60, v60
    v_mul_f32 v44, v44, v76
    v_mul_f32 v44, v44, v60
    v_mul_f32 v60, 0xbfb8aa3b, v45
    v_exp_f32 v60, v60
    s_nop 0
    v_add_f32 v60, 1.0, v60
    v_rcp_f32 v60, v60
    v_mul_f32 v45, v45, v77
    v_mul_f32 v45, v45, v60
    v_mul_f32 v60, 0xbfb8aa3b, v46
    v_exp_f32 v60, v60
    s_nop 0
    v_add_f32 v60, 1.0, v60
    v_rcp_f32 v60, v60
    v_mul_f32 v46, v46, v78
    v_mul_f32 v46, v46, v60
    v_mul_f32 v60, 0xbfb8aa3b, v47
    v_exp_f32 v60, v60
    s_nop 0
    v_add_f32 v60, 1.0, v60
    v_rcp_f32 v60, v60
    v_mul_f32 v47, v47, v79
    v_mul_f32 v47, v47, v60
    v_cvt_pk_bf16_f32 v60, v44, v45
    v_cvt_pk_bf16_f32 v61, v46, v47
    buffer_store_dwordx2 v[60:61], v162, s[20:23], 0 offen offset:96
    v_accvgpr_read_b32 v44, a96
    v_accvgpr_read_b32 v45, a97
    v_accvgpr_read_b32 v46, a98
    v_accvgpr_read_b32 v47, a99
    v_fma_f32 v44, -v143, v108, v44
    v_mul_f32 v44, v147, v44
    v_fma_f32 v45, -v143, v109, v45
    v_mul_f32 v45, v147, v45
    v_fma_f32 v46, -v143, v110, v46
    v_mul_f32 v46, v147, v46
    v_fma_f32 v47, -v143, v111, v47
    v_mul_f32 v47, v147, v47
    v_accvgpr_read_b32 v76, a112
    v_accvgpr_read_b32 v77, a113
    v_accvgpr_read_b32 v78, a114
    v_accvgpr_read_b32 v79, a115
    v_fma_f32 v76, -v143, v124, v76
    v_mul_f32 v76, v147, v76
    v_fma_f32 v77, -v143, v125, v77
    v_mul_f32 v77, v147, v77
    v_fma_f32 v78, -v143, v126, v78
    v_mul_f32 v78, v147, v78
    v_fma_f32 v79, -v143, v127, v79
    v_mul_f32 v79, v147, v79
    v_mul_f32 v60, 0xbfb8aa3b, v44
    v_exp_f32 v60, v60
    s_nop 0
    v_add_f32 v60, 1.0, v60
    v_rcp_f32 v60, v60
    v_mul_f32 v44, v44, v76
    v_mul_f32 v44, v44, v60
    v_mul_f32 v60, 0xbfb8aa3b, v45
    v_exp_f32 v60, v60
    s_nop 0
    v_add_f32 v60, 1.0, v60
    v_rcp_f32 v60, v60
    v_mul_f32 v45, v45, v77
    v_mul_f32 v45, v45, v60
    v_mul_f32 v60, 0xbfb8aa3b, v46
    v_exp_f32 v60, v60
    s_nop 0
    v_add_f32 v60, 1.0, v60
    v_rcp_f32 v60, v60
    v_mul_f32 v46, v46, v78
    v_mul_f32 v46, v46, v60
    v_mul_f32 v60, 0xbfb8aa3b, v47
    v_exp_f32 v60, v60
    s_nop 0
    v_add_f32 v60, 1.0, v60
    v_rcp_f32 v60, v60
    v_mul_f32 v47, v47, v79
    v_mul_f32 v47, v47, v60
    v_cvt_pk_bf16_f32 v60, v44, v45
    v_cvt_pk_bf16_f32 v61, v46, v47
    buffer_store_dwordx2 v[60:61], v163, s[20:23], 0 offen offset:0
    v_accvgpr_read_b32 v44, a100
    v_accvgpr_read_b32 v45, a101
    v_accvgpr_read_b32 v46, a102
    v_accvgpr_read_b32 v47, a103
    v_fma_f32 v44, -v143, v112, v44
    v_mul_f32 v44, v147, v44
    v_fma_f32 v45, -v143, v113, v45
    v_mul_f32 v45, v147, v45
    v_fma_f32 v46, -v143, v114, v46
    v_mul_f32 v46, v147, v46
    v_fma_f32 v47, -v143, v115, v47
    v_mul_f32 v47, v147, v47
    v_accvgpr_read_b32 v76, a116
    v_accvgpr_read_b32 v77, a117
    v_accvgpr_read_b32 v78, a118
    v_accvgpr_read_b32 v79, a119
    v_fma_f32 v76, -v143, v128, v76
    v_mul_f32 v76, v147, v76
    v_fma_f32 v77, -v143, v129, v77
    v_mul_f32 v77, v147, v77
    v_fma_f32 v78, -v143, v130, v78
    v_mul_f32 v78, v147, v78
    v_fma_f32 v79, -v143, v131, v79
    v_mul_f32 v79, v147, v79
    v_mul_f32 v60, 0xbfb8aa3b, v44
    v_exp_f32 v60, v60
    s_nop 0
    v_add_f32 v60, 1.0, v60
    v_rcp_f32 v60, v60
    v_mul_f32 v44, v44, v76
    v_mul_f32 v44, v44, v60
    v_mul_f32 v60, 0xbfb8aa3b, v45
    v_exp_f32 v60, v60
    s_nop 0
    v_add_f32 v60, 1.0, v60
    v_rcp_f32 v60, v60
    v_mul_f32 v45, v45, v77
    v_mul_f32 v45, v45, v60
    v_mul_f32 v60, 0xbfb8aa3b, v46
    v_exp_f32 v60, v60
    s_nop 0
    v_add_f32 v60, 1.0, v60
    v_rcp_f32 v60, v60
    v_mul_f32 v46, v46, v78
    v_mul_f32 v46, v46, v60
    v_mul_f32 v60, 0xbfb8aa3b, v47
    v_exp_f32 v60, v60
    s_nop 0
    v_add_f32 v60, 1.0, v60
    v_rcp_f32 v60, v60
    v_mul_f32 v47, v47, v79
    v_mul_f32 v47, v47, v60
    v_cvt_pk_bf16_f32 v60, v44, v45
    v_cvt_pk_bf16_f32 v61, v46, v47
    buffer_store_dwordx2 v[60:61], v163, s[20:23], 0 offen offset:32
    v_accvgpr_read_b32 v44, a104
    v_accvgpr_read_b32 v45, a105
    v_accvgpr_read_b32 v46, a106
    v_accvgpr_read_b32 v47, a107
    v_fma_f32 v44, -v143, v116, v44
    v_mul_f32 v44, v147, v44
    v_fma_f32 v45, -v143, v117, v45
    v_mul_f32 v45, v147, v45
    v_fma_f32 v46, -v143, v118, v46
    v_mul_f32 v46, v147, v46
    v_fma_f32 v47, -v143, v119, v47
    v_mul_f32 v47, v147, v47
    v_accvgpr_read_b32 v76, a120
    v_accvgpr_read_b32 v77, a121
    v_accvgpr_read_b32 v78, a122
    v_accvgpr_read_b32 v79, a123
    v_fma_f32 v76, -v143, v132, v76
    v_mul_f32 v76, v147, v76
    v_fma_f32 v77, -v143, v133, v77
    v_mul_f32 v77, v147, v77
    v_fma_f32 v78, -v143, v134, v78
    v_mul_f32 v78, v147, v78
    v_fma_f32 v79, -v143, v135, v79
    v_mul_f32 v79, v147, v79
    v_mul_f32 v60, 0xbfb8aa3b, v44
    v_exp_f32 v60, v60
    s_nop 0
    v_add_f32 v60, 1.0, v60
    v_rcp_f32 v60, v60
    v_mul_f32 v44, v44, v76
    v_mul_f32 v44, v44, v60
    v_mul_f32 v60, 0xbfb8aa3b, v45
    v_exp_f32 v60, v60
    s_nop 0
    v_add_f32 v60, 1.0, v60
    v_rcp_f32 v60, v60
    v_mul_f32 v45, v45, v77
    v_mul_f32 v45, v45, v60
    v_mul_f32 v60, 0xbfb8aa3b, v46
    v_exp_f32 v60, v60
    s_nop 0
    v_add_f32 v60, 1.0, v60
    v_rcp_f32 v60, v60
    v_mul_f32 v46, v46, v78
    v_mul_f32 v46, v46, v60
    v_mul_f32 v60, 0xbfb8aa3b, v47
    v_exp_f32 v60, v60
    s_nop 0
    v_add_f32 v60, 1.0, v60
    v_rcp_f32 v60, v60
    v_mul_f32 v47, v47, v79
    v_mul_f32 v47, v47, v60
    v_cvt_pk_bf16_f32 v60, v44, v45
    v_cvt_pk_bf16_f32 v61, v46, v47
    buffer_store_dwordx2 v[60:61], v163, s[20:23], 0 offen offset:64
    v_accvgpr_read_b32 v44, a108
    v_accvgpr_read_b32 v45, a109
    v_accvgpr_read_b32 v46, a110
    v_accvgpr_read_b32 v47, a111
    v_fma_f32 v44, -v143, v120, v44
    v_mul_f32 v44, v147, v44
    v_fma_f32 v45, -v143, v121, v45
    v_mul_f32 v45, v147, v45
    v_fma_f32 v46, -v143, v122, v46
    v_mul_f32 v46, v147, v46
    v_fma_f32 v47, -v143, v123, v47
    v_mul_f32 v47, v147, v47
    v_accvgpr_read_b32 v76, a124
    v_accvgpr_read_b32 v77, a125
    v_accvgpr_read_b32 v78, a126
    v_accvgpr_read_b32 v79, a127
    v_fma_f32 v76, -v143, v136, v76
    v_mul_f32 v76, v147, v76
    v_fma_f32 v77, -v143, v137, v77
    v_mul_f32 v77, v147, v77
    v_fma_f32 v78, -v143, v138, v78
    v_mul_f32 v78, v147, v78
    v_fma_f32 v79, -v143, v139, v79
    v_mul_f32 v79, v147, v79
    v_mul_f32 v60, 0xbfb8aa3b, v44
    v_exp_f32 v60, v60
    s_nop 0
    v_add_f32 v60, 1.0, v60
    v_rcp_f32 v60, v60
    v_mul_f32 v44, v44, v76
    v_mul_f32 v44, v44, v60
    v_mul_f32 v60, 0xbfb8aa3b, v45
    v_exp_f32 v60, v60
    s_nop 0
    v_add_f32 v60, 1.0, v60
    v_rcp_f32 v60, v60
    v_mul_f32 v45, v45, v77
    v_mul_f32 v45, v45, v60
    v_mul_f32 v60, 0xbfb8aa3b, v46
    v_exp_f32 v60, v60
    s_nop 0
    v_add_f32 v60, 1.0, v60
    v_rcp_f32 v60, v60
    v_mul_f32 v46, v46, v78
    v_mul_f32 v46, v46, v60
    v_mul_f32 v60, 0xbfb8aa3b, v47
    v_exp_f32 v60, v60
    s_nop 0
    v_add_f32 v60, 1.0, v60
    v_rcp_f32 v60, v60
    v_mul_f32 v47, v47, v79
    v_mul_f32 v47, v47, v60
    v_cvt_pk_bf16_f32 v60, v44, v45
    v_cvt_pk_bf16_f32 v61, v46, v47
    buffer_store_dwordx2 v[60:61], v163, s[20:23], 0 offen offset:96
L_ffn1_kernel_end:
    s_endpgm
.globl ffn2_0_kernel
.p2align 8
.type ffn2_0_kernel,@function
ffn2_0_kernel:
    s_cmp_ge_u32 s2, 224
    s_cbranch_scc1 L_ffn2_0_kernel_end
    s_load_dwordx2 s[4:5], s[0:1], 72
    s_load_dwordx2 s[34:35], s[0:1], 48
    s_lshr_b32 s45, s2, 3
    s_mov_b32 s44, 0x24924925
    s_mul_hi_u32 s28, s45, s44
    s_mul_i32 s44, s28, 7
    s_sub_u32 s29, s45, s44
    s_and_b32 s44, s2, 7
    s_mul_i32 s44, s44, 4
    s_add_u32 s28, s28, s44
    s_mov_b32 s50, 0x3f803f80
    v_lshrrev_b32 v2, 6, v0
    s_nop 0
    v_readfirstlane_b32 s51, v2
    v_and_b32 v9, 63, v0
    s_and_b32 s44, s51, 1
    s_lshl_b32 s44, s44, 2
    v_lshrrev_b32 v2, 4, v9
    v_add_u32 v2, s44, v2
    v_and_b32 v2, 7, v2
    v_and_b32 v3, 7, v9
    v_xor_b32 v2, v2, v3
    v_lshrrev_b32 v3, 3, v9
    v_mul_u32_u24 v3, 3584, v3
    v_lshl_add_u32 v10, v2, 4, v3
    s_and_b32 s44, s51, 1
    s_lshl_b32 s44, s44, 1
    v_lshrrev_b32 v2, 3, v9
    v_bfe_u32 v3, v9, 4, 1
    v_or_b32 v3, s44, v3
    v_bfe_u32 v4, v9, 1, 2
    v_xor_b32 v3, v3, v4
    v_and_b32 v4, 1, v9
    v_lshl_add_u32 v3, v3, 1, v4
    v_mul_u32_u24 v2, 896, v2
    v_lshl_add_u32 v2, v3, 4, v2
    v_mov_b32 v11, v2
    s_waitcnt lgkmcnt(0)
    s_add_u32 s8, s4, 0xc00000
    s_addc_u32 s9, s5, 0
    s_mov_b32 s10, 0x700000
    s_mov_b32 s11, 0x00020000
    s_mov_b32 s12, s34
    s_mov_b32 s13, s35
    s_mov_b32 s14, 0x188000
    s_mov_b32 s15, 0x00020000
    s_mul_i32 s52, s28, 229376
    s_mul_i32 s44, s51, 28672
    s_add_u32 s52, s52, s44
    s_mul_i32 s53, s29, 128
    s_mul_i32 s44, s51, 7168
    s_add_u32 s53, s53, s44
    s_lshl_b32 s54, s51, 10
    s_add_u32 s55, s52, 0
    s_add_u32 m0, s54, 0
    s_nop 0
    buffer_load_dwordx4 v10, s[8:11], s55 offen lds
    s_add_u32 s55, s52, 114688
    s_add_u32 m0, s54, 4096
    s_nop 0
    buffer_load_dwordx4 v10, s[8:11], s55 offen lds
    s_add_u32 s55, s53, 0
    s_add_u32 m0, s54, 8192
    s_nop 0
    buffer_load_dwordx4 v11, s[12:15], s55 offen lds
    s_add_u32 s55, s53, 28672
    s_add_u32 m0, s54, 12288
    s_nop 0
    buffer_load_dwordx4 v11, s[12:15], s55 offen lds
    s_add_u32 s55, s52, 128
    s_add_u32 m0, s54, 16384
    s_nop 0
    buffer_load_dwordx4 v10, s[8:11], s55 offen lds
    s_add_u32 s55, s52, 114816
    s_add_u32 m0, s54, 20480
    s_nop 0
    buffer_load_dwordx4 v10, s[8:11], s55 offen lds
    s_add_u32 s55, s53, 57344
    s_add_u32 m0, s54, 24576
    s_nop 0
    buffer_load_dwordx4 v11, s[12:15], s55 offen lds
    s_add_u32 s55, s53, 86016
    s_add_u32 m0, s54, 28672
    s_nop 0
    buffer_load_dwordx4 v11, s[12:15], s55 offen lds
    s_add_u32 s55, s52, 256
    s_add_u32 m0, s54, 32768
    s_nop 0
    buffer_load_dwordx4 v10, s[8:11], s55 offen lds
    s_add_u32 s55, s52, 114944
    s_add_u32 m0, s54, 36864
    s_nop 0
    buffer_load_dwordx4 v10, s[8:11], s55 offen lds
    s_add_u32 s55, s53, 114688
    s_add_u32 m0, s54, 40960
    s_nop 0
    buffer_load_dwordx4 v11, s[12:15], s55 offen lds
    s_add_u32 s55, s53, 143360
    s_add_u32 m0, s54, 45056
    s_nop 0
    buffer_load_dwordx4 v11, s[12:15], s55 offen lds
    s_add_u32 s55, s52, 384
    s_add_u32 m0, s54, 49152
    s_nop 0
    buffer_load_dwordx4 v10, s[8:11], s55 offen lds
    s_add_u32 s55, s52, 115072
    s_add_u32 m0, s54, 53248
    s_nop 0
    buffer_load_dwordx4 v10, s[8:11], s55 offen lds
    s_add_u32 s55, s53, 172032
    s_add_u32 m0, s54, 57344
    s_nop 0
    buffer_load_dwordx4 v11, s[12:15], s55 offen lds
    s_add_u32 s55, s53, 200704
    s_add_u32 m0, s54, 61440
    s_nop 0
    buffer_load_dwordx4 v11, s[12:15], s55 offen lds
    s_add_u32 s55, s52, 512
    s_add_u32 m0, s54, 65536
    s_nop 0
    buffer_load_dwordx4 v10, s[8:11], s55 offen lds
    s_add_u32 s55, s52, 115200
    s_add_u32 m0, s54, 69632
    s_nop 0
    buffer_load_dwordx4 v10, s[8:11], s55 offen lds
    s_add_u32 s55, s53, 229376
    s_add_u32 m0, s54, 73728
    s_nop 0
    buffer_load_dwordx4 v11, s[12:15], s55 offen lds
    s_add_u32 s55, s53, 258048
    s_add_u32 m0, s54, 77824
    s_nop 0
    buffer_load_dwordx4 v11, s[12:15], s55 offen lds
    s_add_u32 s55, s52, 640
    s_add_u32 m0, s54, 81920
    s_nop 0
    buffer_load_dwordx4 v10, s[8:11], s55 offen lds
    s_add_u32 s55, s52, 115328
    s_add_u32 m0, s54, 86016
    s_nop 0
    buffer_load_dwordx4 v10, s[8:11], s55 offen lds
    s_add_u32 s55, s53, 286720
    s_add_u32 m0, s54, 90112
    s_nop 0
    buffer_load_dwordx4 v11, s[12:15], s55 offen lds
    s_add_u32 s55, s53, 315392
    s_add_u32 m0, s54, 94208
    s_nop 0
    buffer_load_dwordx4 v11, s[12:15], s55 offen lds
    s_add_u32 s55, s52, 768
    s_add_u32 m0, s54, 98304
    s_nop 0
    buffer_load_dwordx4 v10, s[8:11], s55 offen lds
    s_add_u32 s55, s52, 115456
    s_add_u32 m0, s54, 102400
    s_nop 0
    buffer_load_dwordx4 v10, s[8:11], s55 offen lds
    s_add_u32 s55, s53, 344064
    s_add_u32 m0, s54, 106496
    s_nop 0
    buffer_load_dwordx4 v11, s[12:15], s55 offen lds
    s_add_u32 s55, s53, 372736
    s_add_u32 m0, s54, 110592
    s_nop 0
    buffer_load_dwordx4 v11, s[12:15], s55 offen lds
    s_add_u32 s20, s4, 0x200000
    s_addc_u32 s21, s5, 0
    s_mov_b32 s22, 0x1c0000
    s_mov_b32 s23, 0x00020000
    s_mov_b32 s24, s4
    s_mov_b32 s25, s5
    s_mov_b32 s26, 0x1c0000
    s_mov_b32 s27, 0x00020000
    v_and_b32 v6, 15, v0
    v_bfe_u32 v7, v0, 4, 2
    s_lshr_b32 s44, s51, 1
    s_mul_i32 s44, s44, 32
    s_mul_i32 s45, s28, 64
    s_add_u32 s44, s44, s45
    v_add_u32 v84, s44, v6
    s_and_b32 s44, s51, 1
    s_mul_i32 s44, s44, 32
    s_mul_i32 s45, s29, 64
    s_add_u32 s44, s44, s45
    v_lshlrev_b32 v85, 2, v7
    v_add_u32 v85, s44, v85
    v_mul_u32_u24 v86, 896, v84
    v_lshl_add_u32 v86, v85, 1, v86
    v_add_u32 v87, 0, v86
    v_add_u32 v88, 14336, v86
    buffer_load_dwordx2 v[76:77], v87, s[24:27], 0 offen offset:0
    buffer_load_dwordx2 v[78:79], v87, s[24:27], 0 offen offset:32
    buffer_load_dwordx2 v[80:81], v88, s[24:27], 0 offen offset:0
    buffer_load_dwordx2 v[82:83], v88, s[24:27], 0 offen offset:32
    s_lshr_b32 s44, s51, 1
    s_mul_i32 s44, s44, 4096
    v_bfe_u32 v2, v6, 1, 3
    v_mul_u32_u24 v3, 128, v6
    v_add_u32 v3, s44, v3
    v_add_u32 v4, 0, v7
    v_xor_b32 v4, v4, v2
    v_lshl_add_u32 v4, v4, 4, v3
    v_add_u32 v12, 0, v4
    v_add_u32 v14, 16384, v4
    v_add_u32 v16, 32768, v4
    v_add_u32 v18, 49152, v4
    v_add_u32 v20, 65536, v4
    v_add_u32 v22, 81920, v4
    v_add_u32 v24, 98304, v4
    v_add_u32 v26, 114688, v4
    v_add_u32 v4, 4, v7
    v_xor_b32 v4, v4, v2
    v_lshl_add_u32 v4, v4, 4, v3
    v_add_u32 v13, 0, v4
    v_add_u32 v15, 16384, v4
    v_add_u32 v17, 32768, v4
    v_add_u32 v19, 49152, v4
    v_add_u32 v21, 65536, v4
    v_add_u32 v23, 81920, v4
    v_add_u32 v25, 98304, v4
    v_add_u32 v27, 114688, v4
    v_lshrrev_b32 v2, 2, v6
    v_lshl_add_u32 v3, v7, 3, v2
    v_mul_u32_u24 v3, 128, v3
    v_and_b32 v4, 3, v6
    v_lshl_add_u32 v3, v4, 3, v3
    v_bfe_u32 v2, v6, 3, 1
    v_and_b32 v4, 1, v7
    v_lshl_or_b32 v2, v4, 1, v2
    s_and_b32 s44, s51, 1
    s_mul_i32 s45, s44, 2
    s_add_u32 s45, s45, 0
    v_xor_b32 v4, s45, v2
    v_lshl_add_u32 v4, v4, 5, v3
    v_add_u32 v28, 8192, v4
    v_add_u32 v30, 24576, v4
    v_add_u32 v32, 40960, v4
    v_add_u32 v34, 57344, v4
    v_add_u32 v36, 73728, v4
    v_add_u32 v38, 90112, v4
    v_add_u32 v40, 106496, v4
    v_add_u32 v42, 122880, v4
    s_mul_i32 s45, s44, 2
    s_add_u32 s45, s45, 1
    v_xor_b32 v4, s45, v2
    v_lshl_add_u32 v4, v4, 5, v3
    v_add_u32 v29, 8192, v4
    v_add_u32 v31, 24576, v4
    v_add_u32 v33, 40960, v4
    v_add_u32 v35, 57344, v4
    v_add_u32 v37, 73728, v4
    v_add_u32 v39, 90112, v4
    v_add_u32 v41, 106496, v4
    v_add_u32 v43, 122880, v4
    s_waitcnt vmcnt(28)
    s_barrier
    s_add_u32 s55, s52, 896
    s_add_u32 m0, s54, 114688
    s_nop 0
    buffer_load_dwordx4 v10, s[8:11], s55 offen lds
    s_add_u32 s55, s52, 115584
    s_add_u32 m0, s54, 118784
    s_nop 0
    buffer_load_dwordx4 v10, s[8:11], s55 offen lds
    s_add_u32 s55, s53, 401408
    s_add_u32 m0, s54, 122880
    s_nop 0
    buffer_load_dwordx4 v11, s[12:15], s55 offen lds
    s_add_u32 s55, s53, 430080
    s_add_u32 m0, s54, 126976
    s_nop 0
    buffer_load_dwordx4 v11, s[12:15], s55 offen lds
    ds_read_b128 v[44:47], v12 offset:0
    ds_read_b128 v[48:51], v12 offset:2048
    ds_read_b64_tr_b16 v[60:61], v28 offset:0
    ds_read_b64_tr_b16 v[62:63], v28 offset:512
    ds_read_b64_tr_b16 v[64:65], v29 offset:0
    ds_read_b64_tr_b16 v[66:67], v29 offset:512
    ds_read_b128 v[52:55], v13 offset:0
    ds_read_b128 v[56:59], v13 offset:2048
    ds_read_b64_tr_b16 v[68:69], v28 offset:4096
    ds_read_b64_tr_b16 v[70:71], v28 offset:4608
    ds_read_b64_tr_b16 v[72:73], v29 offset:4096
    ds_read_b64_tr_b16 v[74:75], v29 offset:4608
    s_waitcnt lgkmcnt(6)
    v_mfma_f32_16x16x32_bf16 a[0:3], v[60:63], v[44:47], 0
    v_mfma_f32_16x16x32_bf16 a[4:7], v[64:67], v[44:47], 0
    v_mfma_f32_16x16x32_bf16 a[8:11], v[60:63], v[48:51], 0
    v_mfma_f32_16x16x32_bf16 a[12:15], v[64:67], v[48:51], 0
    s_waitcnt lgkmcnt(0)
    v_mfma_f32_16x16x32_bf16 a[0:3], v[68:71], v[52:55], a[0:3]
    v_mfma_f32_16x16x32_bf16 a[4:7], v[72:75], v[52:55], a[4:7]
    v_mfma_f32_16x16x32_bf16 a[8:11], v[68:71], v[56:59], a[8:11]
    v_mfma_f32_16x16x32_bf16 a[12:15], v[72:75], v[56:59], a[12:15]
    s_waitcnt vmcnt(28)
    s_barrier
    s_add_u32 s55, s52, 1024
    s_add_u32 m0, s54, 0
    s_nop 0
    buffer_load_dwordx4 v10, s[8:11], s55 offen lds
    s_add_u32 s55, s52, 115712
    s_add_u32 m0, s54, 4096
    s_nop 0
    buffer_load_dwordx4 v10, s[8:11], s55 offen lds
    s_add_u32 s55, s53, 458752
    s_add_u32 m0, s54, 8192
    s_nop 0
    buffer_load_dwordx4 v11, s[12:15], s55 offen lds
    s_add_u32 s55, s53, 487424
    s_add_u32 m0, s54, 12288
    s_nop 0
    buffer_load_dwordx4 v11, s[12:15], s55 offen lds
    ds_read_b128 v[44:47], v14 offset:0
    ds_read_b128 v[48:51], v14 offset:2048
    ds_read_b64_tr_b16 v[60:61], v30 offset:0
    ds_read_b64_tr_b16 v[62:63], v30 offset:512
    ds_read_b64_tr_b16 v[64:65], v31 offset:0
    ds_read_b64_tr_b16 v[66:67], v31 offset:512
    ds_read_b128 v[52:55], v15 offset:0
    ds_read_b128 v[56:59], v15 offset:2048
    ds_read_b64_tr_b16 v[68:69], v30 offset:4096
    ds_read_b64_tr_b16 v[70:71], v30 offset:4608
    ds_read_b64_tr_b16 v[72:73], v31 offset:4096
    ds_read_b64_tr_b16 v[74:75], v31 offset:4608
    s_waitcnt lgkmcnt(6)
    v_mfma_f32_16x16x32_bf16 a[0:3], v[60:63], v[44:47], a[0:3]
    v_mfma_f32_16x16x32_bf16 a[4:7], v[64:67], v[44:47], a[4:7]
    v_mfma_f32_16x16x32_bf16 a[8:11], v[60:63], v[48:51], a[8:11]
    v_mfma_f32_16x16x32_bf16 a[12:15], v[64:67], v[48:51], a[12:15]
    s_waitcnt lgkmcnt(0)
    v_mfma_f32_16x16x32_bf16 a[0:3], v[68:71], v[52:55], a[0:3]
    v_mfma_f32_16x16x32_bf16 a[4:7], v[72:75], v[52:55], a[4:7]
    v_mfma_f32_16x16x32_bf16 a[8:11], v[68:71], v[56:59], a[8:11]
    v_mfma_f32_16x16x32_bf16 a[12:15], v[72:75], v[56:59], a[12:15]
    s_waitcnt vmcnt(28)
    s_barrier
    s_add_u32 s55, s52, 1152
    s_add_u32 m0, s54, 16384
    s_nop 0
    buffer_load_dwordx4 v10, s[8:11], s55 offen lds
    s_add_u32 s55, s52, 115840
    s_add_u32 m0, s54, 20480
    s_nop 0
    buffer_load_dwordx4 v10, s[8:11], s55 offen lds
    s_add_u32 s55, s53, 516096
    s_add_u32 m0, s54, 24576
    s_nop 0
    buffer_load_dwordx4 v11, s[12:15], s55 offen lds
    s_add_u32 s55, s53, 544768
    s_add_u32 m0, s54, 28672
    s_nop 0
    buffer_load_dwordx4 v11, s[12:15], s55 offen lds
    ds_read_b128 v[44:47], v16 offset:0
    ds_read_b128 v[48:51], v16 offset:2048
    ds_read_b64_tr_b16 v[60:61], v32 offset:0
    ds_read_b64_tr_b16 v[62:63], v32 offset:512
    ds_read_b64_tr_b16 v[64:65], v33 offset:0
    ds_read_b64_tr_b16 v[66:67], v33 offset:512
    ds_read_b128 v[52:55], v17 offset:0
    ds_read_b128 v[56:59], v17 offset:2048
    ds_read_b64_tr_b16 v[68:69], v32 offset:4096
    ds_read_b64_tr_b16 v[70:71], v32 offset:4608
    ds_read_b64_tr_b16 v[72:73], v33 offset:4096
    ds_read_b64_tr_b16 v[74:75], v33 offset:4608
    s_waitcnt lgkmcnt(6)
    v_mfma_f32_16x16x32_bf16 a[0:3], v[60:63], v[44:47], a[0:3]
    v_mfma_f32_16x16x32_bf16 a[4:7], v[64:67], v[44:47], a[4:7]
    v_mfma_f32_16x16x32_bf16 a[8:11], v[60:63], v[48:51], a[8:11]
    v_mfma_f32_16x16x32_bf16 a[12:15], v[64:67], v[48:51], a[12:15]
    s_waitcnt lgkmcnt(0)
    v_mfma_f32_16x16x32_bf16 a[0:3], v[68:71], v[52:55], a[0:3]
    v_mfma_f32_16x16x32_bf16 a[4:7], v[72:75], v[52:55], a[4:7]
    v_mfma_f32_16x16x32_bf16 a[8:11], v[68:71], v[56:59], a[8:11]
    v_mfma_f32_16x16x32_bf16 a[12:15], v[72:75], v[56:59], a[12:15]
    s_waitcnt vmcnt(28)
    s_barrier
    s_add_u32 s55, s52, 1280
    s_add_u32 m0, s54, 32768
    s_nop 0
    buffer_load_dwordx4 v10, s[8:11], s55 offen lds
    s_add_u32 s55, s52, 115968
    s_add_u32 m0, s54, 36864
    s_nop 0
    buffer_load_dwordx4 v10, s[8:11], s55 offen lds
    s_add_u32 s55, s53, 573440
    s_add_u32 m0, s54, 40960
    s_nop 0
    buffer_load_dwordx4 v11, s[12:15], s55 offen lds
    s_add_u32 s55, s53, 602112
    s_add_u32 m0, s54, 45056
    s_nop 0
    buffer_load_dwordx4 v11, s[12:15], s55 offen lds
    ds_read_b128 v[44:47], v18 offset:0
    ds_read_b128 v[48:51], v18 offset:2048
    ds_read_b64_tr_b16 v[60:61], v34 offset:0
    ds_read_b64_tr_b16 v[62:63], v34 offset:512
    ds_read_b64_tr_b16 v[64:65], v35 offset:0
    ds_read_b64_tr_b16 v[66:67], v35 offset:512
    ds_read_b128 v[52:55], v19 offset:0
    ds_read_b128 v[56:59], v19 offset:2048
    ds_read_b64_tr_b16 v[68:69], v34 offset:4096
    ds_read_b64_tr_b16 v[70:71], v34 offset:4608
    ds_read_b64_tr_b16 v[72:73], v35 offset:4096
    ds_read_b64_tr_b16 v[74:75], v35 offset:4608
    s_waitcnt lgkmcnt(6)
    v_mfma_f32_16x16x32_bf16 a[0:3], v[60:63], v[44:47], a[0:3]
    v_mfma_f32_16x16x32_bf16 a[4:7], v[64:67], v[44:47], a[4:7]
    v_mfma_f32_16x16x32_bf16 a[8:11], v[60:63], v[48:51], a[8:11]
    v_mfma_f32_16x16x32_bf16 a[12:15], v[64:67], v[48:51], a[12:15]
    s_waitcnt lgkmcnt(0)
    v_mfma_f32_16x16x32_bf16 a[0:3], v[68:71], v[52:55], a[0:3]
    v_mfma_f32_16x16x32_bf16 a[4:7], v[72:75], v[52:55], a[4:7]
    v_mfma_f32_16x16x32_bf16 a[8:11], v[68:71], v[56:59], a[8:11]
    v_mfma_f32_16x16x32_bf16 a[12:15], v[72:75], v[56:59], a[12:15]
    s_waitcnt vmcnt(28)
    s_barrier
    s_add_u32 s55, s52, 1408
    s_add_u32 m0, s54, 49152
    s_nop 0
    buffer_load_dwordx4 v10, s[8:11], s55 offen lds
    s_add_u32 s55, s52, 116096
    s_add_u32 m0, s54, 53248
    s_nop 0
    buffer_load_dwordx4 v10, s[8:11], s55 offen lds
    s_add_u32 s55, s53, 630784
    s_add_u32 m0, s54, 57344
    s_nop 0
    buffer_load_dwordx4 v11, s[12:15], s55 offen lds
    s_add_u32 s55, s53, 659456
    s_add_u32 m0, s54, 61440
    s_nop 0
    buffer_load_dwordx4 v11, s[12:15], s55 offen lds
    ds_read_b128 v[44:47], v20 offset:0
    ds_read_b128 v[48:51], v20 offset:2048
    ds_read_b64_tr_b16 v[60:61], v36 offset:0
    ds_read_b64_tr_b16 v[62:63], v36 offset:512
    ds_read_b64_tr_b16 v[64:65], v37 offset:0
    ds_read_b64_tr_b16 v[66:67], v37 offset:512
    ds_read_b128 v[52:55], v21 offset:0
    ds_read_b128 v[56:59], v21 offset:2048
    ds_read_b64_tr_b16 v[68:69], v36 offset:4096
    ds_read_b64_tr_b16 v[70:71], v36 offset:4608
    ds_read_b64_tr_b16 v[72:73], v37 offset:4096
    ds_read_b64_tr_b16 v[74:75], v37 offset:4608
    s_waitcnt lgkmcnt(6)
    v_mfma_f32_16x16x32_bf16 a[0:3], v[60:63], v[44:47], a[0:3]
    v_mfma_f32_16x16x32_bf16 a[4:7], v[64:67], v[44:47], a[4:7]
    v_mfma_f32_16x16x32_bf16 a[8:11], v[60:63], v[48:51], a[8:11]
    v_mfma_f32_16x16x32_bf16 a[12:15], v[64:67], v[48:51], a[12:15]
    s_waitcnt lgkmcnt(0)
    v_mfma_f32_16x16x32_bf16 a[0:3], v[68:71], v[52:55], a[0:3]
    v_mfma_f32_16x16x32_bf16 a[4:7], v[72:75], v[52:55], a[4:7]
    v_mfma_f32_16x16x32_bf16 a[8:11], v[68:71], v[56:59], a[8:11]
    v_mfma_f32_16x16x32_bf16 a[12:15], v[72:75], v[56:59], a[12:15]
    s_waitcnt vmcnt(28)
    s_barrier
    s_add_u32 s55, s52, 1536
    s_add_u32 m0, s54, 65536
    s_nop 0
    buffer_load_dwordx4 v10, s[8:11], s55 offen lds
    s_add_u32 s55, s52, 116224
    s_add_u32 m0, s54, 69632
    s_nop 0
    buffer_load_dwordx4 v10, s[8:11], s55 offen lds
    s_add_u32 s55, s53, 688128
    s_add_u32 m0, s54, 73728
    s_nop 0
    buffer_load_dwordx4 v11, s[12:15], s55 offen lds
    s_add_u32 s55, s53, 716800
    s_add_u32 m0, s54, 77824
    s_nop 0
    buffer_load_dwordx4 v11, s[12:15], s55 offen lds
    ds_read_b128 v[44:47], v22 offset:0
    ds_read_b128 v[48:51], v22 offset:2048
    ds_read_b64_tr_b16 v[60:61], v38 offset:0
    ds_read_b64_tr_b16 v[62:63], v38 offset:512
    ds_read_b64_tr_b16 v[64:65], v39 offset:0
    ds_read_b64_tr_b16 v[66:67], v39 offset:512
    ds_read_b128 v[52:55], v23 offset:0
    ds_read_b128 v[56:59], v23 offset:2048
    ds_read_b64_tr_b16 v[68:69], v38 offset:4096
    ds_read_b64_tr_b16 v[70:71], v38 offset:4608
    ds_read_b64_tr_b16 v[72:73], v39 offset:4096
    ds_read_b64_tr_b16 v[74:75], v39 offset:4608
    s_waitcnt lgkmcnt(6)
    v_mfma_f32_16x16x32_bf16 a[0:3], v[60:63], v[44:47], a[0:3]
    v_mfma_f32_16x16x32_bf16 a[4:7], v[64:67], v[44:47], a[4:7]
    v_mfma_f32_16x16x32_bf16 a[8:11], v[60:63], v[48:51], a[8:11]
    v_mfma_f32_16x16x32_bf16 a[12:15], v[64:67], v[48:51], a[12:15]
    s_waitcnt lgkmcnt(0)
    v_mfma_f32_16x16x32_bf16 a[0:3], v[68:71], v[52:55], a[0:3]
    v_mfma_f32_16x16x32_bf16 a[4:7], v[72:75], v[52:55], a[4:7]
    v_mfma_f32_16x16x32_bf16 a[8:11], v[68:71], v[56:59], a[8:11]
    v_mfma_f32_16x16x32_bf16 a[12:15], v[72:75], v[56:59], a[12:15]
    s_waitcnt vmcnt(28)
    s_barrier
    s_add_u32 s55, s52, 1664
    s_add_u32 m0, s54, 81920
    s_nop 0
    buffer_load_dwordx4 v10, s[8:11], s55 offen lds
    s_add_u32 s55, s52, 116352
    s_add_u32 m0, s54, 86016
    s_nop 0
    buffer_load_dwordx4 v10, s[8:11], s55 offen lds
    s_add_u32 s55, s53, 745472
    s_add_u32 m0, s54, 90112
    s_nop 0
    buffer_load_dwordx4 v11, s[12:15], s55 offen lds
    s_add_u32 s55, s53, 774144
    s_add_u32 m0, s54, 94208
    s_nop 0
    buffer_load_dwordx4 v11, s[12:15], s55 offen lds
    ds_read_b128 v[44:47], v24 offset:0
    ds_read_b128 v[48:51], v24 offset:2048
    ds_read_b64_tr_b16 v[60:61], v40 offset:0
    ds_read_b64_tr_b16 v[62:63], v40 offset:512
    ds_read_b64_tr_b16 v[64:65], v41 offset:0
    ds_read_b64_tr_b16 v[66:67], v41 offset:512
    ds_read_b128 v[52:55], v25 offset:0
    ds_read_b128 v[56:59], v25 offset:2048
    ds_read_b64_tr_b16 v[68:69], v40 offset:4096
    ds_read_b64_tr_b16 v[70:71], v40 offset:4608
    ds_read_b64_tr_b16 v[72:73], v41 offset:4096
    ds_read_b64_tr_b16 v[74:75], v41 offset:4608
    s_waitcnt lgkmcnt(6)
    v_mfma_f32_16x16x32_bf16 a[0:3], v[60:63], v[44:47], a[0:3]
    v_mfma_f32_16x16x32_bf16 a[4:7], v[64:67], v[44:47], a[4:7]
    v_mfma_f32_16x16x32_bf16 a[8:11], v[60:63], v[48:51], a[8:11]
    v_mfma_f32_16x16x32_bf16 a[12:15], v[64:67], v[48:51], a[12:15]
    s_waitcnt lgkmcnt(0)
    v_mfma_f32_16x16x32_bf16 a[0:3], v[68:71], v[52:55], a[0:3]
    v_mfma_f32_16x16x32_bf16 a[4:7], v[72:75], v[52:55], a[4:7]
    v_mfma_f32_16x16x32_bf16 a[8:11], v[68:71], v[56:59], a[8:11]
    v_mfma_f32_16x16x32_bf16 a[12:15], v[72:75], v[56:59], a[12:15]
    s_waitcnt vmcnt(24)
    s_barrier
    s_add_u32 s55, s52, 1792
    s_add_u32 m0, s54, 98304
    s_nop 0
    buffer_load_dwordx4 v10, s[8:11], s55 offen lds
    s_add_u32 s55, s52, 116480
    s_add_u32 m0, s54, 102400
    s_nop 0
    buffer_load_dwordx4 v10, s[8:11], s55 offen lds
    s_add_u32 s55, s53, 802816
    s_add_u32 m0, s54, 106496
    s_nop 0
    buffer_load_dwordx4 v11, s[12:15], s55 offen lds
    s_add_u32 s55, s53, 831488
    s_add_u32 m0, s54, 110592
    s_nop 0
    buffer_load_dwordx4 v11, s[12:15], s55 offen lds
    ds_read_b128 v[44:47], v26 offset:0
    ds_read_b128 v[48:51], v26 offset:2048
    ds_read_b64_tr_b16 v[60:61], v42 offset:0
    ds_read_b64_tr_b16 v[62:63], v42 offset:512
    ds_read_b64_tr_b16 v[64:65], v43 offset:0
    ds_read_b64_tr_b16 v[66:67], v43 offset:512
    ds_read_b128 v[52:55], v27 offset:0
    ds_read_b128 v[56:59], v27 offset:2048
    ds_read_b64_tr_b16 v[68:69], v42 offset:4096
    ds_read_b64_tr_b16 v[70:71], v42 offset:4608
    ds_read_b64_tr_b16 v[72:73], v43 offset:4096
    ds_read_b64_tr_b16 v[74:75], v43 offset:4608
    s_waitcnt lgkmcnt(6)
    v_mfma_f32_16x16x32_bf16 a[0:3], v[60:63], v[44:47], a[0:3]
    v_mfma_f32_16x16x32_bf16 a[4:7], v[64:67], v[44:47], a[4:7]
    v_mfma_f32_16x16x32_bf16 a[8:11], v[60:63], v[48:51], a[8:11]
    v_mfma_f32_16x16x32_bf16 a[12:15], v[64:67], v[48:51], a[12:15]
    s_waitcnt lgkmcnt(0)
    v_mfma_f32_16x16x32_bf16 a[0:3], v[68:71], v[52:55], a[0:3]
    v_mfma_f32_16x16x32_bf16 a[4:7], v[72:75], v[52:55], a[4:7]
    v_mfma_f32_16x16x32_bf16 a[8:11], v[68:71], v[56:59], a[8:11]
    v_mfma_f32_16x16x32_bf16 a[12:15], v[72:75], v[56:59], a[12:15]
    s_waitcnt vmcnt(24)
    s_barrier
    s_add_u32 s55, s52, 1920
    s_add_u32 m0, s54, 114688
    s_nop 0
    buffer_load_dwordx4 v10, s[8:11], s55 offen lds
    s_add_u32 s55, s52, 116608
    s_add_u32 m0, s54, 118784
    s_nop 0
    buffer_load_dwordx4 v10, s[8:11], s55 offen lds
    s_add_u32 s55, s53, 860160
    s_add_u32 m0, s54, 122880
    s_nop 0
    buffer_load_dwordx4 v11, s[12:15], s55 offen lds
    s_add_u32 s55, s53, 888832
    s_add_u32 m0, s54, 126976
    s_nop 0
    buffer_load_dwordx4 v11, s[12:15], s55 offen lds
    ds_read_b128 v[44:47], v12 offset:0
    ds_read_b128 v[48:51], v12 offset:2048
    ds_read_b64_tr_b16 v[60:61], v28 offset:0
    ds_read_b64_tr_b16 v[62:63], v28 offset:512
    ds_read_b64_tr_b16 v[64:65], v29 offset:0
    ds_read_b64_tr_b16 v[66:67], v29 offset:512
    ds_read_b128 v[52:55], v13 offset:0
    ds_read_b128 v[56:59], v13 offset:2048
    ds_read_b64_tr_b16 v[68:69], v28 offset:4096
    ds_read_b64_tr_b16 v[70:71], v28 offset:4608
    ds_read_b64_tr_b16 v[72:73], v29 offset:4096
    ds_read_b64_tr_b16 v[74:75], v29 offset:4608
    s_waitcnt lgkmcnt(6)
    v_mfma_f32_16x16x32_bf16 a[0:3], v[60:63], v[44:47], a[0:3]
    v_mfma_f32_16x16x32_bf16 a[4:7], v[64:67], v[44:47], a[4:7]
    v_mfma_f32_16x16x32_bf16 a[8:11], v[60:63], v[48:51], a[8:11]
    v_mfma_f32_16x16x32_bf16 a[12:15], v[64:67], v[48:51], a[12:15]
    s_waitcnt lgkmcnt(0)
    v_mfma_f32_16x16x32_bf16 a[0:3], v[68:71], v[52:55], a[0:3]
    v_mfma_f32_16x16x32_bf16 a[4:7], v[72:75], v[52:55], a[4:7]
    v_mfma_f32_16x16x32_bf16 a[8:11], v[68:71], v[56:59], a[8:11]
    v_mfma_f32_16x16x32_bf16 a[12:15], v[72:75], v[56:59], a[12:15]
    s_waitcnt vmcnt(24)
    s_barrier
    s_add_u32 s55, s52, 2048
    s_add_u32 m0, s54, 0
    s_nop 0
    buffer_load_dwordx4 v10, s[8:11], s55 offen lds
    s_add_u32 s55, s52, 116736
    s_add_u32 m0, s54, 4096
    s_nop 0
    buffer_load_dwordx4 v10, s[8:11], s55 offen lds
    s_add_u32 s55, s53, 917504
    s_add_u32 m0, s54, 8192
    s_nop 0
    buffer_load_dwordx4 v11, s[12:15], s55 offen lds
    s_add_u32 s55, s53, 946176
    s_add_u32 m0, s54, 12288
    s_nop 0
    buffer_load_dwordx4 v11, s[12:15], s55 offen lds
    ds_read_b128 v[44:47], v14 offset:0
    ds_read_b128 v[48:51], v14 offset:2048
    ds_read_b64_tr_b16 v[60:61], v30 offset:0
    ds_read_b64_tr_b16 v[62:63], v30 offset:512
    ds_read_b64_tr_b16 v[64:65], v31 offset:0
    ds_read_b64_tr_b16 v[66:67], v31 offset:512
    ds_read_b128 v[52:55], v15 offset:0
    ds_read_b128 v[56:59], v15 offset:2048
    ds_read_b64_tr_b16 v[68:69], v30 offset:4096
    ds_read_b64_tr_b16 v[70:71], v30 offset:4608
    ds_read_b64_tr_b16 v[72:73], v31 offset:4096
    ds_read_b64_tr_b16 v[74:75], v31 offset:4608
    s_waitcnt lgkmcnt(6)
    v_mfma_f32_16x16x32_bf16 a[0:3], v[60:63], v[44:47], a[0:3]
    v_mfma_f32_16x16x32_bf16 a[4:7], v[64:67], v[44:47], a[4:7]
    v_mfma_f32_16x16x32_bf16 a[8:11], v[60:63], v[48:51], a[8:11]
    v_mfma_f32_16x16x32_bf16 a[12:15], v[64:67], v[48:51], a[12:15]
    s_waitcnt lgkmcnt(0)
    v_mfma_f32_16x16x32_bf16 a[0:3], v[68:71], v[52:55], a[0:3]
    v_mfma_f32_16x16x32_bf16 a[4:7], v[72:75], v[52:55], a[4:7]
    v_mfma_f32_16x16x32_bf16 a[8:11], v[68:71], v[56:59], a[8:11]
    v_mfma_f32_16x16x32_bf16 a[12:15], v[72:75], v[56:59], a[12:15]
    s_waitcnt vmcnt(24)
    s_barrier
    s_add_u32 s55, s52, 2176
    s_add_u32 m0, s54, 16384
    s_nop 0
    buffer_load_dwordx4 v10, s[8:11], s55 offen lds
    s_add_u32 s55, s52, 116864
    s_add_u32 m0, s54, 20480
    s_nop 0
    buffer_load_dwordx4 v10, s[8:11], s55 offen lds
    s_add_u32 s55, s53, 974848
    s_add_u32 m0, s54, 24576
    s_nop 0
    buffer_load_dwordx4 v11, s[12:15], s55 offen lds
    s_add_u32 s55, s53, 1003520
    s_add_u32 m0, s54, 28672
    s_nop 0
    buffer_load_dwordx4 v11, s[12:15], s55 offen lds
    ds_read_b128 v[44:47], v16 offset:0
    ds_read_b128 v[48:51], v16 offset:2048
    ds_read_b64_tr_b16 v[60:61], v32 offset:0
    ds_read_b64_tr_b16 v[62:63], v32 offset:512
    ds_read_b64_tr_b16 v[64:65], v33 offset:0
    ds_read_b64_tr_b16 v[66:67], v33 offset:512
    ds_read_b128 v[52:55], v17 offset:0
    ds_read_b128 v[56:59], v17 offset:2048
    ds_read_b64_tr_b16 v[68:69], v32 offset:4096
    ds_read_b64_tr_b16 v[70:71], v32 offset:4608
    ds_read_b64_tr_b16 v[72:73], v33 offset:4096
    ds_read_b64_tr_b16 v[74:75], v33 offset:4608
    s_waitcnt lgkmcnt(6)
    v_mfma_f32_16x16x32_bf16 a[0:3], v[60:63], v[44:47], a[0:3]
    v_mfma_f32_16x16x32_bf16 a[4:7], v[64:67], v[44:47], a[4:7]
    v_mfma_f32_16x16x32_bf16 a[8:11], v[60:63], v[48:51], a[8:11]
    v_mfma_f32_16x16x32_bf16 a[12:15], v[64:67], v[48:51], a[12:15]
    s_waitcnt lgkmcnt(0)
    v_mfma_f32_16x16x32_bf16 a[0:3], v[68:71], v[52:55], a[0:3]
    v_mfma_f32_16x16x32_bf16 a[4:7], v[72:75], v[52:55], a[4:7]
    v_mfma_f32_16x16x32_bf16 a[8:11], v[68:71], v[56:59], a[8:11]
    v_mfma_f32_16x16x32_bf16 a[12:15], v[72:75], v[56:59], a[12:15]
    s_waitcnt vmcnt(24)
    s_barrier
    s_add_u32 s55, s52, 2304
    s_add_u32 m0, s54, 32768
    s_nop 0
    buffer_load_dwordx4 v10, s[8:11], s55 offen lds
    s_add_u32 s55, s52, 116992
    s_add_u32 m0, s54, 36864
    s_nop 0
    buffer_load_dwordx4 v10, s[8:11], s55 offen lds
    s_add_u32 s55, s53, 1032192
    s_add_u32 m0, s54, 40960
    s_nop 0
    buffer_load_dwordx4 v11, s[12:15], s55 offen lds
    s_add_u32 s55, s53, 1060864
    s_add_u32 m0, s54, 45056
    s_nop 0
    buffer_load_dwordx4 v11, s[12:15], s55 offen lds
    ds_read_b128 v[44:47], v18 offset:0
    ds_read_b128 v[48:51], v18 offset:2048
    ds_read_b64_tr_b16 v[60:61], v34 offset:0
    ds_read_b64_tr_b16 v[62:63], v34 offset:512
    ds_read_b64_tr_b16 v[64:65], v35 offset:0
    ds_read_b64_tr_b16 v[66:67], v35 offset:512
    ds_read_b128 v[52:55], v19 offset:0
    ds_read_b128 v[56:59], v19 offset:2048
    ds_read_b64_tr_b16 v[68:69], v34 offset:4096
    ds_read_b64_tr_b16 v[70:71], v34 offset:4608
    ds_read_b64_tr_b16 v[72:73], v35 offset:4096
    ds_read_b64_tr_b16 v[74:75], v35 offset:4608
    s_waitcnt lgkmcnt(6)
    v_mfma_f32_16x16x32_bf16 a[0:3], v[60:63], v[44:47], a[0:3]
    v_mfma_f32_16x16x32_bf16 a[4:7], v[64:67], v[44:47], a[4:7]
    v_mfma_f32_16x16x32_bf16 a[8:11], v[60:63], v[48:51], a[8:11]
    v_mfma_f32_16x16x32_bf16 a[12:15], v[64:67], v[48:51], a[12:15]
    s_waitcnt lgkmcnt(0)
    v_mfma_f32_16x16x32_bf16 a[0:3], v[68:71], v[52:55], a[0:3]
    v_mfma_f32_16x16x32_bf16 a[4:7], v[72:75], v[52:55], a[4:7]
    v_mfma_f32_16x16x32_bf16 a[8:11], v[68:71], v[56:59], a[8:11]
    v_mfma_f32_16x16x32_bf16 a[12:15], v[72:75], v[56:59], a[12:15]
    s_waitcnt vmcnt(24)
    s_barrier
    s_add_u32 s55, s52, 2432
    s_add_u32 m0, s54, 49152
    s_nop 0
    buffer_load_dwordx4 v10, s[8:11], s55 offen lds
    s_add_u32 s55, s52, 117120
    s_add_u32 m0, s54, 53248
    s_nop 0
    buffer_load_dwordx4 v10, s[8:11], s55 offen lds
    s_add_u32 s55, s53, 1089536
    s_add_u32 m0, s54, 57344
    s_nop 0
    buffer_load_dwordx4 v11, s[12:15], s55 offen lds
    s_add_u32 s55, s53, 1118208
    s_add_u32 m0, s54, 61440
    s_nop 0
    buffer_load_dwordx4 v11, s[12:15], s55 offen lds
    ds_read_b128 v[44:47], v20 offset:0
    ds_read_b128 v[48:51], v20 offset:2048
    ds_read_b64_tr_b16 v[60:61], v36 offset:0
    ds_read_b64_tr_b16 v[62:63], v36 offset:512
    ds_read_b64_tr_b16 v[64:65], v37 offset:0
    ds_read_b64_tr_b16 v[66:67], v37 offset:512
    ds_read_b128 v[52:55], v21 offset:0
    ds_read_b128 v[56:59], v21 offset:2048
    ds_read_b64_tr_b16 v[68:69], v36 offset:4096
    ds_read_b64_tr_b16 v[70:71], v36 offset:4608
    ds_read_b64_tr_b16 v[72:73], v37 offset:4096
    ds_read_b64_tr_b16 v[74:75], v37 offset:4608
    s_waitcnt lgkmcnt(6)
    v_mfma_f32_16x16x32_bf16 a[0:3], v[60:63], v[44:47], a[0:3]
    v_mfma_f32_16x16x32_bf16 a[4:7], v[64:67], v[44:47], a[4:7]
    v_mfma_f32_16x16x32_bf16 a[8:11], v[60:63], v[48:51], a[8:11]
    v_mfma_f32_16x16x32_bf16 a[12:15], v[64:67], v[48:51], a[12:15]
    s_waitcnt lgkmcnt(0)
    v_mfma_f32_16x16x32_bf16 a[0:3], v[68:71], v[52:55], a[0:3]
    v_mfma_f32_16x16x32_bf16 a[4:7], v[72:75], v[52:55], a[4:7]
    v_mfma_f32_16x16x32_bf16 a[8:11], v[68:71], v[56:59], a[8:11]
    v_mfma_f32_16x16x32_bf16 a[12:15], v[72:75], v[56:59], a[12:15]
    s_waitcnt vmcnt(24)
    s_barrier
    s_add_u32 s55, s52, 2560
    s_add_u32 m0, s54, 65536
    s_nop 0
    buffer_load_dwordx4 v10, s[8:11], s55 offen lds
    s_add_u32 s55, s52, 117248
    s_add_u32 m0, s54, 69632
    s_nop 0
    buffer_load_dwordx4 v10, s[8:11], s55 offen lds
    s_add_u32 s55, s53, 1146880
    s_add_u32 m0, s54, 73728
    s_nop 0
    buffer_load_dwordx4 v11, s[12:15], s55 offen lds
    s_add_u32 s55, s53, 1175552
    s_add_u32 m0, s54, 77824
    s_nop 0
    buffer_load_dwordx4 v11, s[12:15], s55 offen lds
    ds_read_b128 v[44:47], v22 offset:0
    ds_read_b128 v[48:51], v22 offset:2048
    ds_read_b64_tr_b16 v[60:61], v38 offset:0
    ds_read_b64_tr_b16 v[62:63], v38 offset:512
    ds_read_b64_tr_b16 v[64:65], v39 offset:0
    ds_read_b64_tr_b16 v[66:67], v39 offset:512
    ds_read_b128 v[52:55], v23 offset:0
    ds_read_b128 v[56:59], v23 offset:2048
    ds_read_b64_tr_b16 v[68:69], v38 offset:4096
    ds_read_b64_tr_b16 v[70:71], v38 offset:4608
    ds_read_b64_tr_b16 v[72:73], v39 offset:4096
    ds_read_b64_tr_b16 v[74:75], v39 offset:4608
    s_waitcnt lgkmcnt(6)
    v_mfma_f32_16x16x32_bf16 a[0:3], v[60:63], v[44:47], a[0:3]
    v_mfma_f32_16x16x32_bf16 a[4:7], v[64:67], v[44:47], a[4:7]
    v_mfma_f32_16x16x32_bf16 a[8:11], v[60:63], v[48:51], a[8:11]
    v_mfma_f32_16x16x32_bf16 a[12:15], v[64:67], v[48:51], a[12:15]
    s_waitcnt lgkmcnt(0)
    v_mfma_f32_16x16x32_bf16 a[0:3], v[68:71], v[52:55], a[0:3]
    v_mfma_f32_16x16x32_bf16 a[4:7], v[72:75], v[52:55], a[4:7]
    v_mfma_f32_16x16x32_bf16 a[8:11], v[68:71], v[56:59], a[8:11]
    v_mfma_f32_16x16x32_bf16 a[12:15], v[72:75], v[56:59], a[12:15]
    s_waitcnt vmcnt(24)
    s_barrier
    s_add_u32 s55, s52, 2688
    s_add_u32 m0, s54, 81920
    s_nop 0
    buffer_load_dwordx4 v10, s[8:11], s55 offen lds
    s_add_u32 s55, s52, 117376
    s_add_u32 m0, s54, 86016
    s_nop 0
    buffer_load_dwordx4 v10, s[8:11], s55 offen lds
    s_add_u32 s55, s53, 1204224
    s_add_u32 m0, s54, 90112
    s_nop 0
    buffer_load_dwordx4 v11, s[12:15], s55 offen lds
    s_add_u32 s55, s53, 1232896
    s_add_u32 m0, s54, 94208
    s_nop 0
    buffer_load_dwordx4 v11, s[12:15], s55 offen lds
    ds_read_b128 v[44:47], v24 offset:0
    ds_read_b128 v[48:51], v24 offset:2048
    ds_read_b64_tr_b16 v[60:61], v40 offset:0
    ds_read_b64_tr_b16 v[62:63], v40 offset:512
    ds_read_b64_tr_b16 v[64:65], v41 offset:0
    ds_read_b64_tr_b16 v[66:67], v41 offset:512
    ds_read_b128 v[52:55], v25 offset:0
    ds_read_b128 v[56:59], v25 offset:2048
    ds_read_b64_tr_b16 v[68:69], v40 offset:4096
    ds_read_b64_tr_b16 v[70:71], v40 offset:4608
    ds_read_b64_tr_b16 v[72:73], v41 offset:4096
    ds_read_b64_tr_b16 v[74:75], v41 offset:4608
    s_waitcnt lgkmcnt(6)
    v_mfma_f32_16x16x32_bf16 a[0:3], v[60:63], v[44:47], a[0:3]
    v_mfma_f32_16x16x32_bf16 a[4:7], v[64:67], v[44:47], a[4:7]
    v_mfma_f32_16x16x32_bf16 a[8:11], v[60:63], v[48:51], a[8:11]
    v_mfma_f32_16x16x32_bf16 a[12:15], v[64:67], v[48:51], a[12:15]
    s_waitcnt lgkmcnt(0)
    v_mfma_f32_16x16x32_bf16 a[0:3], v[68:71], v[52:55], a[0:3]
    v_mfma_f32_16x16x32_bf16 a[4:7], v[72:75], v[52:55], a[4:7]
    v_mfma_f32_16x16x32_bf16 a[8:11], v[68:71], v[56:59], a[8:11]
    v_mfma_f32_16x16x32_bf16 a[12:15], v[72:75], v[56:59], a[12:15]
    s_waitcnt vmcnt(24)
    s_barrier
    s_add_u32 s55, s52, 2816
    s_add_u32 m0, s54, 98304
    s_nop 0
    buffer_load_dwordx4 v10, s[8:11], s55 offen lds
    s_add_u32 s55, s52, 117504
    s_add_u32 m0, s54, 102400
    s_nop 0
    buffer_load_dwordx4 v10, s[8:11], s55 offen lds
    s_add_u32 s55, s53, 1261568
    s_add_u32 m0, s54, 106496
    s_nop 0
    buffer_load_dwordx4 v11, s[12:15], s55 offen lds
    s_add_u32 s55, s53, 1290240
    s_add_u32 m0, s54, 110592
    s_nop 0
    buffer_load_dwordx4 v11, s[12:15], s55 offen lds
    ds_read_b128 v[44:47], v26 offset:0
    ds_read_b128 v[48:51], v26 offset:2048
    ds_read_b64_tr_b16 v[60:61], v42 offset:0
    ds_read_b64_tr_b16 v[62:63], v42 offset:512
    ds_read_b64_tr_b16 v[64:65], v43 offset:0
    ds_read_b64_tr_b16 v[66:67], v43 offset:512
    ds_read_b128 v[52:55], v27 offset:0
    ds_read_b128 v[56:59], v27 offset:2048
    ds_read_b64_tr_b16 v[68:69], v42 offset:4096
    ds_read_b64_tr_b16 v[70:71], v42 offset:4608
    ds_read_b64_tr_b16 v[72:73], v43 offset:4096
    ds_read_b64_tr_b16 v[74:75], v43 offset:4608
    s_waitcnt lgkmcnt(6)
    v_mfma_f32_16x16x32_bf16 a[0:3], v[60:63], v[44:47], a[0:3]
    v_mfma_f32_16x16x32_bf16 a[4:7], v[64:67], v[44:47], a[4:7]
    v_mfma_f32_16x16x32_bf16 a[8:11], v[60:63], v[48:51], a[8:11]
    v_mfma_f32_16x16x32_bf16 a[12:15], v[64:67], v[48:51], a[12:15]
    s_waitcnt lgkmcnt(0)
    v_mfma_f32_16x16x32_bf16 a[0:3], v[68:71], v[52:55], a[0:3]
    v_mfma_f32_16x16x32_bf16 a[4:7], v[72:75], v[52:55], a[4:7]
    v_mfma_f32_16x16x32_bf16 a[8:11], v[68:71], v[56:59], a[8:11]
    v_mfma_f32_16x16x32_bf16 a[12:15], v[72:75], v[56:59], a[12:15]
    s_waitcnt vmcnt(24)
    s_barrier
    s_add_u32 s55, s52, 2944
    s_add_u32 m0, s54, 114688
    s_nop 0
    buffer_load_dwordx4 v10, s[8:11], s55 offen lds
    s_add_u32 s55, s52, 117632
    s_add_u32 m0, s54, 118784
    s_nop 0
    buffer_load_dwordx4 v10, s[8:11], s55 offen lds
    s_add_u32 s55, s53, 1318912
    s_add_u32 m0, s54, 122880
    s_nop 0
    buffer_load_dwordx4 v11, s[12:15], s55 offen lds
    s_add_u32 s55, s53, 1347584
    s_add_u32 m0, s54, 126976
    s_nop 0
    buffer_load_dwordx4 v11, s[12:15], s55 offen lds
    ds_read_b128 v[44:47], v12 offset:0
    ds_read_b128 v[48:51], v12 offset:2048
    ds_read_b64_tr_b16 v[60:61], v28 offset:0
    ds_read_b64_tr_b16 v[62:63], v28 offset:512
    ds_read_b64_tr_b16 v[64:65], v29 offset:0
    ds_read_b64_tr_b16 v[66:67], v29 offset:512
    ds_read_b128 v[52:55], v13 offset:0
    ds_read_b128 v[56:59], v13 offset:2048
    ds_read_b64_tr_b16 v[68:69], v28 offset:4096
    ds_read_b64_tr_b16 v[70:71], v28 offset:4608
    ds_read_b64_tr_b16 v[72:73], v29 offset:4096
    ds_read_b64_tr_b16 v[74:75], v29 offset:4608
    s_waitcnt lgkmcnt(6)
    v_mfma_f32_16x16x32_bf16 a[0:3], v[60:63], v[44:47], a[0:3]
    v_mfma_f32_16x16x32_bf16 a[4:7], v[64:67], v[44:47], a[4:7]
    v_mfma_f32_16x16x32_bf16 a[8:11], v[60:63], v[48:51], a[8:11]
    v_mfma_f32_16x16x32_bf16 a[12:15], v[64:67], v[48:51], a[12:15]
    s_waitcnt lgkmcnt(0)
    v_mfma_f32_16x16x32_bf16 a[0:3], v[68:71], v[52:55], a[0:3]
    v_mfma_f32_16x16x32_bf16 a[4:7], v[72:75], v[52:55], a[4:7]
    v_mfma_f32_16x16x32_bf16 a[8:11], v[68:71], v[56:59], a[8:11]
    v_mfma_f32_16x16x32_bf16 a[12:15], v[72:75], v[56:59], a[12:15]
    s_waitcnt vmcnt(24)
    s_barrier
    s_add_u32 s55, s52, 3072
    s_add_u32 m0, s54, 0
    s_nop 0
    buffer_load_dwordx4 v10, s[8:11], s55 offen lds
    s_add_u32 s55, s52, 117760
    s_add_u32 m0, s54, 4096
    s_nop 0
    buffer_load_dwordx4 v10, s[8:11], s55 offen lds
    s_add_u32 s55, s53, 1376256
    s_add_u32 m0, s54, 8192
    s_nop 0
    buffer_load_dwordx4 v11, s[12:15], s55 offen lds
    s_add_u32 s55, s53, 1404928
    s_add_u32 m0, s54, 12288
    s_nop 0
    buffer_load_dwordx4 v11, s[12:15], s55 offen lds
    ds_read_b128 v[44:47], v14 offset:0
    ds_read_b128 v[48:51], v14 offset:2048
    ds_read_b64_tr_b16 v[60:61], v30 offset:0
    ds_read_b64_tr_b16 v[62:63], v30 offset:512
    ds_read_b64_tr_b16 v[64:65], v31 offset:0
    ds_read_b64_tr_b16 v[66:67], v31 offset:512
    ds_read_b128 v[52:55], v15 offset:0
    ds_read_b128 v[56:59], v15 offset:2048
    ds_read_b64_tr_b16 v[68:69], v30 offset:4096
    ds_read_b64_tr_b16 v[70:71], v30 offset:4608
    ds_read_b64_tr_b16 v[72:73], v31 offset:4096
    ds_read_b64_tr_b16 v[74:75], v31 offset:4608
    s_waitcnt lgkmcnt(6)
    v_mfma_f32_16x16x32_bf16 a[0:3], v[60:63], v[44:47], a[0:3]
    v_mfma_f32_16x16x32_bf16 a[4:7], v[64:67], v[44:47], a[4:7]
    v_mfma_f32_16x16x32_bf16 a[8:11], v[60:63], v[48:51], a[8:11]
    v_mfma_f32_16x16x32_bf16 a[12:15], v[64:67], v[48:51], a[12:15]
    s_waitcnt lgkmcnt(0)
    v_mfma_f32_16x16x32_bf16 a[0:3], v[68:71], v[52:55], a[0:3]
    v_mfma_f32_16x16x32_bf16 a[4:7], v[72:75], v[52:55], a[4:7]
    v_mfma_f32_16x16x32_bf16 a[8:11], v[68:71], v[56:59], a[8:11]
    v_mfma_f32_16x16x32_bf16 a[12:15], v[72:75], v[56:59], a[12:15]
    s_waitcnt vmcnt(24)
    s_barrier
    s_add_u32 s55, s52, 3200
    s_add_u32 m0, s54, 16384
    s_nop 0
    buffer_load_dwordx4 v10, s[8:11], s55 offen lds
    s_add_u32 s55, s52, 117888
    s_add_u32 m0, s54, 20480
    s_nop 0
    buffer_load_dwordx4 v10, s[8:11], s55 offen lds
    s_add_u32 s55, s53, 1433600
    s_add_u32 m0, s54, 24576
    s_nop 0
    buffer_load_dwordx4 v11, s[12:15], s55 offen lds
    s_add_u32 s55, s53, 1462272
    s_add_u32 m0, s54, 28672
    s_nop 0
    buffer_load_dwordx4 v11, s[12:15], s55 offen lds
    ds_read_b128 v[44:47], v16 offset:0
    ds_read_b128 v[48:51], v16 offset:2048
    ds_read_b64_tr_b16 v[60:61], v32 offset:0
    ds_read_b64_tr_b16 v[62:63], v32 offset:512
    ds_read_b64_tr_b16 v[64:65], v33 offset:0
    ds_read_b64_tr_b16 v[66:67], v33 offset:512
    ds_read_b128 v[52:55], v17 offset:0
    ds_read_b128 v[56:59], v17 offset:2048
    ds_read_b64_tr_b16 v[68:69], v32 offset:4096
    ds_read_b64_tr_b16 v[70:71], v32 offset:4608
    ds_read_b64_tr_b16 v[72:73], v33 offset:4096
    ds_read_b64_tr_b16 v[74:75], v33 offset:4608
    s_waitcnt lgkmcnt(6)
    v_mfma_f32_16x16x32_bf16 a[0:3], v[60:63], v[44:47], a[0:3]
    v_mfma_f32_16x16x32_bf16 a[4:7], v[64:67], v[44:47], a[4:7]
    v_mfma_f32_16x16x32_bf16 a[8:11], v[60:63], v[48:51], a[8:11]
    v_mfma_f32_16x16x32_bf16 a[12:15], v[64:67], v[48:51], a[12:15]
    s_waitcnt lgkmcnt(0)
    v_mfma_f32_16x16x32_bf16 a[0:3], v[68:71], v[52:55], a[0:3]
    v_mfma_f32_16x16x32_bf16 a[4:7], v[72:75], v[52:55], a[4:7]
    v_mfma_f32_16x16x32_bf16 a[8:11], v[68:71], v[56:59], a[8:11]
    v_mfma_f32_16x16x32_bf16 a[12:15], v[72:75], v[56:59], a[12:15]
    s_waitcnt vmcnt(24)
    s_barrier
    s_add_u32 s55, s52, 3328
    s_add_u32 m0, s54, 32768
    s_nop 0
    buffer_load_dwordx4 v10, s[8:11], s55 offen lds
    s_add_u32 s55, s52, 118016
    s_add_u32 m0, s54, 36864
    s_nop 0
    buffer_load_dwordx4 v10, s[8:11], s55 offen lds
    s_add_u32 s55, s53, 1490944
    s_add_u32 m0, s54, 40960
    s_nop 0
    buffer_load_dwordx4 v11, s[12:15], s55 offen lds
    s_add_u32 s55, s53, 1519616
    s_add_u32 m0, s54, 45056
    s_nop 0
    buffer_load_dwordx4 v11, s[12:15], s55 offen lds
    ds_read_b128 v[44:47], v18 offset:0
    ds_read_b128 v[48:51], v18 offset:2048
    ds_read_b64_tr_b16 v[60:61], v34 offset:0
    ds_read_b64_tr_b16 v[62:63], v34 offset:512
    ds_read_b64_tr_b16 v[64:65], v35 offset:0
    ds_read_b64_tr_b16 v[66:67], v35 offset:512
    ds_read_b128 v[52:55], v19 offset:0
    ds_read_b128 v[56:59], v19 offset:2048
    ds_read_b64_tr_b16 v[68:69], v34 offset:4096
    ds_read_b64_tr_b16 v[70:71], v34 offset:4608
    ds_read_b64_tr_b16 v[72:73], v35 offset:4096
    ds_read_b64_tr_b16 v[74:75], v35 offset:4608
    s_waitcnt lgkmcnt(6)
    v_mfma_f32_16x16x32_bf16 a[0:3], v[60:63], v[44:47], a[0:3]
    v_mfma_f32_16x16x32_bf16 a[4:7], v[64:67], v[44:47], a[4:7]
    v_mfma_f32_16x16x32_bf16 a[8:11], v[60:63], v[48:51], a[8:11]
    v_mfma_f32_16x16x32_bf16 a[12:15], v[64:67], v[48:51], a[12:15]
    s_waitcnt lgkmcnt(0)
    v_mfma_f32_16x16x32_bf16 a[0:3], v[68:71], v[52:55], a[0:3]
    v_mfma_f32_16x16x32_bf16 a[4:7], v[72:75], v[52:55], a[4:7]
    v_mfma_f32_16x16x32_bf16 a[8:11], v[68:71], v[56:59], a[8:11]
    v_mfma_f32_16x16x32_bf16 a[12:15], v[72:75], v[56:59], a[12:15]
    s_waitcnt vmcnt(24)
    s_barrier
    s_add_u32 s55, s52, 3456
    s_add_u32 m0, s54, 49152
    s_nop 0
    buffer_load_dwordx4 v10, s[8:11], s55 offen lds
    s_add_u32 s55, s52, 118144
    s_add_u32 m0, s54, 53248
    s_nop 0
    buffer_load_dwordx4 v10, s[8:11], s55 offen lds
    s_add_u32 s55, s53, 1548288
    s_add_u32 m0, s54, 57344
    s_nop 0
    buffer_load_dwordx4 v11, s[12:15], s55 offen lds
    s_add_u32 s55, s53, 1576960
    s_add_u32 m0, s54, 61440
    s_nop 0
    buffer_load_dwordx4 v11, s[12:15], s55 offen lds
    ds_read_b128 v[44:47], v20 offset:0
    ds_read_b128 v[48:51], v20 offset:2048
    ds_read_b64_tr_b16 v[60:61], v36 offset:0
    ds_read_b64_tr_b16 v[62:63], v36 offset:512
    ds_read_b64_tr_b16 v[64:65], v37 offset:0
    ds_read_b64_tr_b16 v[66:67], v37 offset:512
    ds_read_b128 v[52:55], v21 offset:0
    ds_read_b128 v[56:59], v21 offset:2048
    ds_read_b64_tr_b16 v[68:69], v36 offset:4096
    ds_read_b64_tr_b16 v[70:71], v36 offset:4608
    ds_read_b64_tr_b16 v[72:73], v37 offset:4096
    ds_read_b64_tr_b16 v[74:75], v37 offset:4608
    s_waitcnt lgkmcnt(6)
    v_mfma_f32_16x16x32_bf16 a[0:3], v[60:63], v[44:47], a[0:3]
    v_mfma_f32_16x16x32_bf16 a[4:7], v[64:67], v[44:47], a[4:7]
    v_mfma_f32_16x16x32_bf16 a[8:11], v[60:63], v[48:51], a[8:11]
    v_mfma_f32_16x16x32_bf16 a[12:15], v[64:67], v[48:51], a[12:15]
    s_waitcnt lgkmcnt(0)
    v_mfma_f32_16x16x32_bf16 a[0:3], v[68:71], v[52:55], a[0:3]
    v_mfma_f32_16x16x32_bf16 a[4:7], v[72:75], v[52:55], a[4:7]
    v_mfma_f32_16x16x32_bf16 a[8:11], v[68:71], v[56:59], a[8:11]
    v_mfma_f32_16x16x32_bf16 a[12:15], v[72:75], v[56:59], a[12:15]
    s_waitcnt vmcnt(24)
    s_barrier
    ds_read_b128 v[44:47], v22 offset:0
    ds_read_b128 v[48:51], v22 offset:2048
    ds_read_b64_tr_b16 v[60:61], v38 offset:0
    ds_read_b64_tr_b16 v[62:63], v38 offset:512
    ds_read_b64_tr_b16 v[64:65], v39 offset:0
    ds_read_b64_tr_b16 v[66:67], v39 offset:512
    ds_read_b128 v[52:55], v23 offset:0
    ds_read_b128 v[56:59], v23 offset:2048
    ds_read_b64_tr_b16 v[68:69], v38 offset:4096
    ds_read_b64_tr_b16 v[70:71], v38 offset:4608
    ds_read_b64_tr_b16 v[72:73], v39 offset:4096
    ds_read_b64_tr_b16 v[74:75], v39 offset:4608
    s_waitcnt lgkmcnt(6)
    v_mfma_f32_16x16x32_bf16 a[0:3], v[60:63], v[44:47], a[0:3]
    v_mfma_f32_16x16x32_bf16 a[4:7], v[64:67], v[44:47], a[4:7]
    v_mfma_f32_16x16x32_bf16 a[8:11], v[60:63], v[48:51], a[8:11]
    v_mfma_f32_16x16x32_bf16 a[12:15], v[64:67], v[48:51], a[12:15]
    s_waitcnt lgkmcnt(0)
    v_mfma_f32_16x16x32_bf16 a[0:3], v[68:71], v[52:55], a[0:3]
    v_mfma_f32_16x16x32_bf16 a[4:7], v[72:75], v[52:55], a[4:7]
    v_mfma_f32_16x16x32_bf16 a[8:11], v[68:71], v[56:59], a[8:11]
    v_mfma_f32_16x16x32_bf16 a[12:15], v[72:75], v[56:59], a[12:15]
    s_waitcnt vmcnt(20)
    s_barrier
    ds_read_b128 v[44:47], v24 offset:0
    ds_read_b128 v[48:51], v24 offset:2048
    ds_read_b64_tr_b16 v[60:61], v40 offset:0
    ds_read_b64_tr_b16 v[62:63], v40 offset:512
    ds_read_b64_tr_b16 v[64:65], v41 offset:0
    ds_read_b64_tr_b16 v[66:67], v41 offset:512
    ds_read_b128 v[52:55], v25 offset:0
    ds_read_b128 v[56:59], v25 offset:2048
    ds_read_b64_tr_b16 v[68:69], v40 offset:4096
    ds_read_b64_tr_b16 v[70:71], v40 offset:4608
    ds_read_b64_tr_b16 v[72:73], v41 offset:4096
    ds_read_b64_tr_b16 v[74:75], v41 offset:4608
    s_waitcnt lgkmcnt(6)
    v_mfma_f32_16x16x32_bf16 a[0:3], v[60:63], v[44:47], a[0:3]
    v_mfma_f32_16x16x32_bf16 a[4:7], v[64:67], v[44:47], a[4:7]
    v_mfma_f32_16x16x32_bf16 a[8:11], v[60:63], v[48:51], a[8:11]
    v_mfma_f32_16x16x32_bf16 a[12:15], v[64:67], v[48:51], a[12:15]
    s_waitcnt lgkmcnt(0)
    v_mfma_f32_16x16x32_bf16 a[0:3], v[68:71], v[52:55], a[0:3]
    v_mfma_f32_16x16x32_bf16 a[4:7], v[72:75], v[52:55], a[4:7]
    v_mfma_f32_16x16x32_bf16 a[8:11], v[68:71], v[56:59], a[8:11]
    v_mfma_f32_16x16x32_bf16 a[12:15], v[72:75], v[56:59], a[12:15]
    s_waitcnt vmcnt(16)
    s_barrier
    ds_read_b128 v[44:47], v26 offset:0
    ds_read_b128 v[48:51], v26 offset:2048
    ds_read_b64_tr_b16 v[60:61], v42 offset:0
    ds_read_b64_tr_b16 v[62:63], v42 offset:512
    ds_read_b64_tr_b16 v[64:65], v43 offset:0
    ds_read_b64_tr_b16 v[66:67], v43 offset:512
    ds_read_b128 v[52:55], v27 offset:0
    ds_read_b128 v[56:59], v27 offset:2048
    ds_read_b64_tr_b16 v[68:69], v42 offset:4096
    ds_read_b64_tr_b16 v[70:71], v42 offset:4608
    ds_read_b64_tr_b16 v[72:73], v43 offset:4096
    ds_read_b64_tr_b16 v[74:75], v43 offset:4608
    s_waitcnt lgkmcnt(6)
    v_mfma_f32_16x16x32_bf16 a[0:3], v[60:63], v[44:47], a[0:3]
    v_mfma_f32_16x16x32_bf16 a[4:7], v[64:67], v[44:47], a[4:7]
    v_mfma_f32_16x16x32_bf16 a[8:11], v[60:63], v[48:51], a[8:11]
    v_mfma_f32_16x16x32_bf16 a[12:15], v[64:67], v[48:51], a[12:15]
    s_waitcnt lgkmcnt(0)
    v_mfma_f32_16x16x32_bf16 a[0:3], v[68:71], v[52:55], a[0:3]
    v_mfma_f32_16x16x32_bf16 a[4:7], v[72:75], v[52:55], a[4:7]
    v_mfma_f32_16x16x32_bf16 a[8:11], v[68:71], v[56:59], a[8:11]
    v_mfma_f32_16x16x32_bf16 a[12:15], v[72:75], v[56:59], a[12:15]
    s_waitcnt vmcnt(12)
    s_barrier
    ds_read_b128 v[44:47], v12 offset:0
    ds_read_b128 v[48:51], v12 offset:2048
    ds_read_b64_tr_b16 v[60:61], v28 offset:0
    ds_read_b64_tr_b16 v[62:63], v28 offset:512
    ds_read_b64_tr_b16 v[64:65], v29 offset:0
    ds_read_b64_tr_b16 v[66:67], v29 offset:512
    ds_read_b128 v[52:55], v13 offset:0
    ds_read_b128 v[56:59], v13 offset:2048
    ds_read_b64_tr_b16 v[68:69], v28 offset:4096
    ds_read_b64_tr_b16 v[70:71], v28 offset:4608
    ds_read_b64_tr_b16 v[72:73], v29 offset:4096
    ds_read_b64_tr_b16 v[74:75], v29 offset:4608
    s_waitcnt lgkmcnt(6)
    v_mfma_f32_16x16x32_bf16 a[0:3], v[60:63], v[44:47], a[0:3]
    v_mfma_f32_16x16x32_bf16 a[4:7], v[64:67], v[44:47], a[4:7]
    v_mfma_f32_16x16x32_bf16 a[8:11], v[60:63], v[48:51], a[8:11]
    v_mfma_f32_16x16x32_bf16 a[12:15], v[64:67], v[48:51], a[12:15]
    s_waitcnt lgkmcnt(0)
    v_mfma_f32_16x16x32_bf16 a[0:3], v[68:71], v[52:55], a[0:3]
    v_mfma_f32_16x16x32_bf16 a[4:7], v[72:75], v[52:55], a[4:7]
    v_mfma_f32_16x16x32_bf16 a[8:11], v[68:71], v[56:59], a[8:11]
    v_mfma_f32_16x16x32_bf16 a[12:15], v[72:75], v[56:59], a[12:15]
    s_waitcnt vmcnt(8)
    s_barrier
    ds_read_b128 v[44:47], v14 offset:0
    ds_read_b128 v[48:51], v14 offset:2048
    ds_read_b64_tr_b16 v[60:61], v30 offset:0
    ds_read_b64_tr_b16 v[62:63], v30 offset:512
    ds_read_b64_tr_b16 v[64:65], v31 offset:0
    ds_read_b64_tr_b16 v[66:67], v31 offset:512
    ds_read_b128 v[52:55], v15 offset:0
    ds_read_b128 v[56:59], v15 offset:2048
    ds_read_b64_tr_b16 v[68:69], v30 offset:4096
    ds_read_b64_tr_b16 v[70:71], v30 offset:4608
    ds_read_b64_tr_b16 v[72:73], v31 offset:4096
    ds_read_b64_tr_b16 v[74:75], v31 offset:4608
    s_waitcnt lgkmcnt(6)
    v_mfma_f32_16x16x32_bf16 a[0:3], v[60:63], v[44:47], a[0:3]
    v_mfma_f32_16x16x32_bf16 a[4:7], v[64:67], v[44:47], a[4:7]
    v_mfma_f32_16x16x32_bf16 a[8:11], v[60:63], v[48:51], a[8:11]
    v_mfma_f32_16x16x32_bf16 a[12:15], v[64:67], v[48:51], a[12:15]
    s_waitcnt lgkmcnt(0)
    v_mfma_f32_16x16x32_bf16 a[0:3], v[68:71], v[52:55], a[0:3]
    v_mfma_f32_16x16x32_bf16 a[4:7], v[72:75], v[52:55], a[4:7]
    v_mfma_f32_16x16x32_bf16 a[8:11], v[68:71], v[56:59], a[8:11]
    v_mfma_f32_16x16x32_bf16 a[12:15], v[72:75], v[56:59], a[12:15]
    s_waitcnt vmcnt(4)
    s_barrier
    ds_read_b128 v[44:47], v16 offset:0
    ds_read_b128 v[48:51], v16 offset:2048
    ds_read_b64_tr_b16 v[60:61], v32 offset:0
    ds_read_b64_tr_b16 v[62:63], v32 offset:512
    ds_read_b64_tr_b16 v[64:65], v33 offset:0
    ds_read_b64_tr_b16 v[66:67], v33 offset:512
    ds_read_b128 v[52:55], v17 offset:0
    ds_read_b128 v[56:59], v17 offset:2048
    ds_read_b64_tr_b16 v[68:69], v32 offset:4096
    ds_read_b64_tr_b16 v[70:71], v32 offset:4608
    ds_read_b64_tr_b16 v[72:73], v33 offset:4096
    ds_read_b64_tr_b16 v[74:75], v33 offset:4608
    s_waitcnt lgkmcnt(6)
    v_mfma_f32_16x16x32_bf16 a[0:3], v[60:63], v[44:47], a[0:3]
    v_mfma_f32_16x16x32_bf16 a[4:7], v[64:67], v[44:47], a[4:7]
    v_mfma_f32_16x16x32_bf16 a[8:11], v[60:63], v[48:51], a[8:11]
    v_mfma_f32_16x16x32_bf16 a[12:15], v[64:67], v[48:51], a[12:15]
    s_waitcnt lgkmcnt(0)
    v_mfma_f32_16x16x32_bf16 a[0:3], v[68:71], v[52:55], a[0:3]
    v_mfma_f32_16x16x32_bf16 a[4:7], v[72:75], v[52:55], a[4:7]
    v_mfma_f32_16x16x32_bf16 a[8:11], v[68:71], v[56:59], a[8:11]
    v_mfma_f32_16x16x32_bf16 a[12:15], v[72:75], v[56:59], a[12:15]
    s_waitcnt vmcnt(0)
    s_barrier
    ds_read_b128 v[44:47], v18 offset:0
    ds_read_b128 v[48:51], v18 offset:2048
    ds_read_b64_tr_b16 v[60:61], v34 offset:0
    ds_read_b64_tr_b16 v[62:63], v34 offset:512
    ds_read_b64_tr_b16 v[64:65], v35 offset:0
    ds_read_b64_tr_b16 v[66:67], v35 offset:512
    ds_read_b128 v[52:55], v19 offset:0
    ds_read_b128 v[56:59], v19 offset:2048
    ds_read_b64_tr_b16 v[68:69], v34 offset:4096
    ds_read_b64_tr_b16 v[70:71], v34 offset:4608
    ds_read_b64_tr_b16 v[72:73], v35 offset:4096
    ds_read_b64_tr_b16 v[74:75], v35 offset:4608
    s_waitcnt lgkmcnt(6)
    v_mfma_f32_16x16x32_bf16 a[0:3], v[60:63], v[44:47], a[0:3]
    v_mfma_f32_16x16x32_bf16 a[4:7], v[64:67], v[44:47], a[4:7]
    v_mfma_f32_16x16x32_bf16 a[8:11], v[60:63], v[48:51], a[8:11]
    v_mfma_f32_16x16x32_bf16 a[12:15], v[64:67], v[48:51], a[12:15]
    s_waitcnt lgkmcnt(0)
    v_mfma_f32_16x16x32_bf16 a[0:3], v[68:71], v[52:55], a[0:3]
    v_mfma_f32_16x16x32_bf16 a[4:7], v[72:75], v[52:55], a[4:7]
    v_mfma_f32_16x16x32_bf16 a[8:11], v[68:71], v[56:59], a[8:11]
    v_mfma_f32_16x16x32_bf16 a[12:15], v[72:75], v[56:59], a[12:15]
    s_waitcnt vmcnt(0)
    s_nop 3
    v_accvgpr_read_b32 v44, a0
    v_accvgpr_read_b32 v45, a1
    v_accvgpr_read_b32 v46, a2
    v_accvgpr_read_b32 v47, a3
    v_lshlrev_b32 v52, 16, v76
    v_and_b32 v53, 0xffff0000, v76
    v_lshlrev_b32 v54, 16, v77
    v_and_b32 v55, 0xffff0000, v77
    v_add_f32 v44, v44, v52
    v_add_f32 v45, v45, v53
    v_add_f32 v46, v46, v54
    v_add_f32 v47, v47, v55
    v_cvt_pk_bf16_f32 v52, v44, v45
    v_cvt_pk_bf16_f32 v53, v46, v47
    buffer_store_dwordx2 v[52:53], v87, s[20:23], 0 offen offset:0
    v_accvgpr_read_b32 v44, a4
    v_accvgpr_read_b32 v45, a5
    v_accvgpr_read_b32 v46, a6
    v_accvgpr_read_b32 v47, a7
    v_lshlrev_b32 v52, 16, v78
    v_and_b32 v53, 0xffff0000, v78
    v_lshlrev_b32 v54, 16, v79
    v_and_b32 v55, 0xffff0000, v79
    v_add_f32 v44, v44, v52
    v_add_f32 v45, v45, v53
    v_add_f32 v46, v46, v54
    v_add_f32 v47, v47, v55
    v_cvt_pk_bf16_f32 v52, v44, v45
    v_cvt_pk_bf16_f32 v53, v46, v47
    buffer_store_dwordx2 v[52:53], v87, s[20:23], 0 offen offset:32
    v_accvgpr_read_b32 v44, a8
    v_accvgpr_read_b32 v45, a9
    v_accvgpr_read_b32 v46, a10
    v_accvgpr_read_b32 v47, a11
    v_lshlrev_b32 v52, 16, v80
    v_and_b32 v53, 0xffff0000, v80
    v_lshlrev_b32 v54, 16, v81
    v_and_b32 v55, 0xffff0000, v81
    v_add_f32 v44, v44, v52
    v_add_f32 v45, v45, v53
    v_add_f32 v46, v46, v54
    v_add_f32 v47, v47, v55
    v_cvt_pk_bf16_f32 v52, v44, v45
    v_cvt_pk_bf16_f32 v53, v46, v47
    buffer_store_dwordx2 v[52:53], v88, s[20:23], 0 offen offset:0
    v_accvgpr_read_b32 v44, a12
    v_accvgpr_read_b32 v45, a13
    v_accvgpr_read_b32 v46, a14
    v_accvgpr_read_b32 v47, a15
    v_lshlrev_b32 v52, 16, v82
    v_and_b32 v53, 0xffff0000, v82
    v_lshlrev_b32 v54, 16, v83
    v_and_b32 v55, 0xffff0000, v83
    v_add_f32 v44, v44, v52
    v_add_f32 v45, v45, v53
    v_add_f32 v46, v46, v54
    v_add_f32 v47, v47, v55
    v_cvt_pk_bf16_f32 v52, v44, v45
    v_cvt_pk_bf16_f32 v53, v46, v47
    buffer_store_dwordx2 v[52:53], v88, s[20:23], 0 offen offset:32
L_ffn2_0_kernel_end:
    s_endpgm
.globl qkv1_kernel
.p2align 8
.type qkv1_kernel,@function
qkv1_kernel:
    s_cmp_ge_u32 s2, 224
    s_cbranch_scc1 L_qkv1_kernel_end
    s_load_dwordx2 s[4:5], s[0:1], 72
    s_load_dwordx2 s[34:35], s[0:1], 8
    s_lshr_b32 s45, s2, 3
    s_mov_b32 s44, 0x12492493
    s_mul_hi_u32 s28, s45, s44
    s_mul_i32 s44, s28, 14
    s_sub_u32 s29, s45, s44
    s_and_b32 s44, s2, 7
    s_mul_i32 s44, s44, 2
    s_add_u32 s28, s28, s44
    s_mov_b32 s50, 0x3f803f80
    v_lshrrev_b32 v2, 6, v0
    s_nop 0
    v_readfirstlane_b32 s51, v2
    v_and_b32 v9, 63, v0
    s_and_b32 s44, s51, 1
    s_lshl_b32 s44, s44, 2
    v_lshrrev_b32 v2, 4, v9
    v_add_u32 v2, s44, v2
    v_and_b32 v2, 7, v2
    v_and_b32 v3, 7, v9
    v_xor_b32 v2, v2, v3
    v_lshrrev_b32 v3, 3, v9
    v_mul_u32_u24 v3, 896, v3
    v_lshl_add_u32 v10, v2, 4, v3
    s_lshr_b32 s44, s51, 1
    s_lshl_b32 s44, s44, 2
    v_lshrrev_b32 v2, 4, v9
    v_or_b32 v3, s44, v2
    v_bfe_u32 v4, v9, 1, 3
    v_xor_b32 v3, v3, v4
    v_cmp_gt_u32 vcc, 6, v3
    s_nop 1
    v_cndmask_b32 v3, 0, v3, vcc
    v_and_b32 v4, 1, v9
    v_lshl_add_u32 v3, v3, 1, v4
    v_mul_u32_u24 v2, 2688, v2
    v_lshl_add_u32 v2, v3, 4, v2
    v_mov_b32 v11, v2
    s_waitcnt lgkmcnt(0)
    s_add_u32 s8, s4, 0x200000
    s_addc_u32 s9, s5, 0
    s_mov_b32 s10, 0x1c0000
    s_mov_b32 s11, 0x00020000
    s_mov_b32 s12, s34
    s_mov_b32 s13, s35
    s_mov_b32 s14, 0x126000
    s_mov_b32 s15, 0x00020000
    s_mul_i32 s52, s28, 114688
    s_mul_i32 s44, s51, 7168
    s_add_u32 s52, s52, s44
    s_mul_i32 s53, s29, 192
    s_mul_i32 s44, s51, 10752
    s_add_u32 s53, s53, s44
    s_lshl_b32 s54, s51, 10
    s_add_u32 s55, s52, 0
    s_add_u32 m0, s54, 0
    s_nop 0
    buffer_load_dwordx4 v10, s[8:11], s55 offen lds
    s_add_u32 s55, s52, 28672
    s_add_u32 m0, s54, 4096
    s_nop 0
    buffer_load_dwordx4 v10, s[8:11], s55 offen lds
    s_add_u32 s55, s52, 57344
    s_add_u32 m0, s54, 8192
    s_nop 0
    buffer_load_dwordx4 v10, s[8:11], s55 offen lds
    s_add_u32 s55, s52, 86016
    s_add_u32 m0, s54, 12288
    s_nop 0
    buffer_load_dwordx4 v10, s[8:11], s55 offen lds
    s_add_u32 s55, s53, 0
    s_add_u32 m0, s54, 16384
    s_nop 0
    buffer_load_dwordx4 v11, s[12:15], s55 offen lds
    s_add_u32 s55, s53, 43008
    s_add_u32 m0, s54, 20480
    s_nop 0
    buffer_load_dwordx4 v11, s[12:15], s55 offen lds
    s_add_u32 s55, s53, 86016
    s_add_u32 m0, s54, 24576
    s_nop 0
    buffer_load_dwordx4 v11, s[12:15], s55 offen lds
    s_add_u32 s55, s53, 129024
    s_add_u32 m0, s54, 28672
    s_nop 0
    buffer_load_dwordx4 v11, s[12:15], s55 offen lds
    s_add_u32 s55, s52, 128
    s_add_u32 m0, s54, 32768
    s_nop 0
    buffer_load_dwordx4 v10, s[8:11], s55 offen lds
    s_add_u32 s55, s52, 28800
    s_add_u32 m0, s54, 36864
    s_nop 0
    buffer_load_dwordx4 v10, s[8:11], s55 offen lds
    s_add_u32 s55, s52, 57472
    s_add_u32 m0, s54, 40960
    s_nop 0
    buffer_load_dwordx4 v10, s[8:11], s55 offen lds
    s_add_u32 s55, s52, 86144
    s_add_u32 m0, s54, 45056
    s_nop 0
    buffer_load_dwordx4 v10, s[8:11], s55 offen lds
    s_add_u32 s55, s53, 172032
    s_add_u32 m0, s54, 49152
    s_nop 0
    buffer_load_dwordx4 v11, s[12:15], s55 offen lds
    s_add_u32 s55, s53, 215040
    s_add_u32 m0, s54, 53248
    s_nop 0
    buffer_load_dwordx4 v11, s[12:15], s55 offen lds
    s_add_u32 s55, s53, 258048
    s_add_u32 m0, s54, 57344
    s_nop 0
    buffer_load_dwordx4 v11, s[12:15], s55 offen lds
    s_add_u32 s55, s53, 301056
    s_add_u32 m0, s54, 61440
    s_nop 0
    buffer_load_dwordx4 v11, s[12:15], s55 offen lds
    s_add_u32 s55, s52, 256
    s_add_u32 m0, s54, 65536
    s_nop 0
    buffer_load_dwordx4 v10, s[8:11], s55 offen lds
    s_add_u32 s55, s52, 28928
    s_add_u32 m0, s54, 69632
    s_nop 0
    buffer_load_dwordx4 v10, s[8:11], s55 offen lds
    s_add_u32 s55, s52, 57600
    s_add_u32 m0, s54, 73728
    s_nop 0
    buffer_load_dwordx4 v10, s[8:11], s55 offen lds
    s_add_u32 s55, s52, 86272
    s_add_u32 m0, s54, 77824
    s_nop 0
    buffer_load_dwordx4 v10, s[8:11], s55 offen lds
    s_add_u32 s55, s53, 344064
    s_add_u32 m0, s54, 81920
    s_nop 0
    buffer_load_dwordx4 v11, s[12:15], s55 offen lds
    s_add_u32 s55, s53, 387072
    s_add_u32 m0, s54, 86016
    s_nop 0
    buffer_load_dwordx4 v11, s[12:15], s55 offen lds
    s_add_u32 s55, s53, 430080
    s_add_u32 m0, s54, 90112
    s_nop 0
    buffer_load_dwordx4 v11, s[12:15], s55 offen lds
    s_add_u32 s55, s53, 473088
    s_add_u32 m0, s54, 94208
    s_nop 0
    buffer_load_dwordx4 v11, s[12:15], s55 offen lds
    s_add_u32 s20, s4, 0x400000
    s_addc_u32 s21, s5, 0
    s_mov_b32 s22, 0x600000
    s_mov_b32 s23, 0x00020000
    v_and_b32 v6, 15, v0
    v_bfe_u32 v7, v0, 4, 2
    s_lshr_b32 s44, s51, 1
    s_mul_i32 s44, s44, 64
    s_mul_i32 s45, s28, 128
    s_add_u32 s44, s44, s45
    v_add_u32 v100, s44, v6
    s_and_b32 s44, s51, 1
    s_mul_i32 s44, s44, 48
    s_mul_i32 s45, s29, 96
    s_add_u32 s44, s44, s45
    v_lshlrev_b32 v101, 2, v7
    v_add_u32 v101, s44, v101
    s_lshr_b32 s44, s51, 1
    s_mul_i32 s44, s44, 8192
    v_bfe_u32 v2, v6, 1, 3
    v_mul_u32_u24 v3, 128, v6
    v_add_u32 v3, s44, v3
    v_add_u32 v4, 0, v7
    v_xor_b32 v4, v4, v2
    v_lshl_add_u32 v4, v4, 4, v3
    v_add_u32 v12, 0, v4
    v_add_u32 v14, 32768, v4
    v_add_u32 v16, 65536, v4
    v_add_u32 v18, 98304, v4
    v_add_u32 v4, 4, v7
    v_xor_b32 v4, v4, v2
    v_lshl_add_u32 v4, v4, 4, v3
    v_add_u32 v13, 0, v4
    v_add_u32 v15, 32768, v4
    v_add_u32 v17, 65536, v4
    v_add_u32 v19, 98304, v4
    v_lshrrev_b32 v2, 2, v6
    v_lshl_add_u32 v3, v7, 3, v2
    v_mul_u32_u24 v3, 256, v3
    v_and_b32 v4, 3, v6
    v_lshl_add_u32 v3, v4, 3, v3
    v_and_b32 v4, 1, v7
    v_lshl_or_b32 v2, v4, 2, v2
    s_and_b32 s44, s51, 1
    s_mul_i32 s45, s44, 3
    s_add_u32 s45, s45, 0
    v_xor_b32 v4, s45, v2
    v_lshl_add_u32 v4, v4, 5, v3
    v_add_u32 v20, 16384, v4
    v_add_u32 v23, 49152, v4
    v_add_u32 v26, 81920, v4
    v_add_u32 v29, 114688, v4
    s_mul_i32 s45, s44, 3
    s_add_u32 s45, s45, 1
    v_xor_b32 v4, s45, v2
    v_lshl_add_u32 v4, v4, 5, v3
    v_add_u32 v21, 16384, v4
    v_add_u32 v24, 49152, v4
    v_add_u32 v27, 81920, v4
    v_add_u32 v30, 114688, v4
    s_mul_i32 s45, s44, 3
    s_add_u32 s45, s45, 2
    v_xor_b32 v4, s45, v2
    v_lshl_add_u32 v4, v4, 5, v3
    v_add_u32 v22, 16384, v4
    v_add_u32 v25, 49152, v4
    v_add_u32 v28, 81920, v4
    v_add_u32 v31, 114688, v4
    v_mov_b32 v99, s50
    v_mov_b32 v88, 0
    v_mov_b32 v92, 0
    v_mov_b32 v89, 0
    v_mov_b32 v93, 0
    v_mov_b32 v90, 0
    v_mov_b32 v94, 0
    v_mov_b32 v91, 0
    v_mov_b32 v95, 0
    v_mov_b32 v96, 0
    v_mov_b32 v97, 0
    v_mov_b32 v98, 0
    s_waitcnt vmcnt(16)
    s_barrier
    s_add_u32 s55, s52, 384
    s_add_u32 m0, s54, 98304
    s_nop 0
    buffer_load_dwordx4 v10, s[8:11], s55 offen lds
    s_add_u32 s55, s52, 29056
    s_add_u32 m0, s54, 102400
    s_nop 0
    buffer_load_dwordx4 v10, s[8:11], s55 offen lds
    s_add_u32 s55, s52, 57728
    s_add_u32 m0, s54, 106496
    s_nop 0
    buffer_load_dwordx4 v10, s[8:11], s55 offen lds
    s_add_u32 s55, s52, 86400
    s_add_u32 m0, s54, 110592
    s_nop 0
    buffer_load_dwordx4 v10, s[8:11], s55 offen lds
    s_add_u32 s55, s53, 516096
    s_add_u32 m0, s54, 114688
    s_nop 0
    buffer_load_dwordx4 v11, s[12:15], s55 offen lds
    s_add_u32 s55, s53, 559104
    s_add_u32 m0, s54, 118784
    s_nop 0
    buffer_load_dwordx4 v11, s[12:15], s55 offen lds
    s_add_u32 s55, s53, 602112
    s_add_u32 m0, s54, 122880
    s_nop 0
    buffer_load_dwordx4 v11, s[12:15], s55 offen lds
    s_add_u32 s55, s53, 645120
    s_add_u32 m0, s54, 126976
    s_nop 0
    buffer_load_dwordx4 v11, s[12:15], s55 offen lds
    ds_read_b128 v[32:35], v12 offset:0
    ds_read_b128 v[36:39], v12 offset:2048
    ds_read_b128 v[40:43], v12 offset:4096
    ds_read_b128 v[44:47], v12 offset:6144
    ds_read_b64_tr_b16 v[64:65], v20 offset:0
    ds_read_b64_tr_b16 v[66:67], v20 offset:1024
    ds_read_b64_tr_b16 v[68:69], v21 offset:0
    ds_read_b64_tr_b16 v[70:71], v21 offset:1024
    ds_read_b64_tr_b16 v[72:73], v22 offset:0
    ds_read_b64_tr_b16 v[74:75], v22 offset:1024
    ds_read_b128 v[48:51], v13 offset:0
    ds_read_b128 v[52:55], v13 offset:2048
    ds_read_b128 v[56:59], v13 offset:4096
    ds_read_b128 v[60:63], v13 offset:6144
    ds_read_b64_tr_b16 v[76:77], v20 offset:8192
    ds_read_b64_tr_b16 v[78:79], v20 offset:9216
    ds_read_b64_tr_b16 v[80:81], v21 offset:8192
    ds_read_b64_tr_b16 v[82:83], v21 offset:9216
    ds_read_b64_tr_b16 v[84:85], v22 offset:8192
    ds_read_b64_tr_b16 v[86:87], v22 offset:9216
    s_waitcnt lgkmcnt(10)
    v_mfma_f32_16x16x32_bf16 a[0:3], v[64:67], v[32:35], 0
    v_mfma_f32_16x16x32_bf16 a[4:7], v[68:71], v[32:35], 0
    v_mfma_f32_16x16x32_bf16 a[8:11], v[72:75], v[32:35], 0
    v_mfma_f32_16x16x32_bf16 a[12:15], v[64:67], v[36:39], 0
    v_mfma_f32_16x16x32_bf16 a[16:19], v[68:71], v[36:39], 0
    v_mfma_f32_16x16x32_bf16 a[20:23], v[72:75], v[36:39], 0
    v_mfma_f32_16x16x32_bf16 a[24:27], v[64:67], v[40:43], 0
    v_mfma_f32_16x16x32_bf16 a[28:31], v[68:71], v[40:43], 0
    v_mfma_f32_16x16x32_bf16 a[32:35], v[72:75], v[40:43], 0
    v_mfma_f32_16x16x32_bf16 a[36:39], v[64:67], v[44:47], 0
    v_mfma_f32_16x16x32_bf16 a[40:43], v[68:71], v[44:47], 0
    v_mfma_f32_16x16x32_bf16 a[44:47], v[72:75], v[44:47], 0
    v_dot2_f32_bf16 v88, v32, v99, v88
    v_dot2_f32_bf16 v92, v32, v32, v92
    v_dot2_f32_bf16 v89, v36, v99, v89
    v_dot2_f32_bf16 v93, v36, v36, v93
    v_dot2_f32_bf16 v90, v40, v99, v90
    v_dot2_f32_bf16 v94, v40, v40, v94
    v_dot2_f32_bf16 v91, v44, v99, v91
    v_dot2_f32_bf16 v95, v44, v44, v95
    v_dot2_f32_bf16 v96, v64, v99, v96
    v_dot2_f32_bf16 v97, v68, v99, v97
    v_dot2_f32_bf16 v98, v72, v99, v98
    v_dot2_f32_bf16 v88, v33, v99, v88
    v_dot2_f32_bf16 v92, v33, v33, v92
    v_dot2_f32_bf16 v89, v37, v99, v89
    v_dot2_f32_bf16 v93, v37, v37, v93
    v_dot2_f32_bf16 v90, v41, v99, v90
    v_dot2_f32_bf16 v94, v41, v41, v94
    v_dot2_f32_bf16 v91, v45, v99, v91
    v_dot2_f32_bf16 v95, v45, v45, v95
    v_dot2_f32_bf16 v96, v65, v99, v96
    v_dot2_f32_bf16 v97, v69, v99, v97
    v_dot2_f32_bf16 v98, v73, v99, v98
    v_dot2_f32_bf16 v88, v34, v99, v88
    v_dot2_f32_bf16 v92, v34, v34, v92
    v_dot2_f32_bf16 v89, v38, v99, v89
    v_dot2_f32_bf16 v93, v38, v38, v93
    v_dot2_f32_bf16 v90, v42, v99, v90
    v_dot2_f32_bf16 v94, v42, v42, v94
    v_dot2_f32_bf16 v91, v46, v99, v91
    v_dot2_f32_bf16 v95, v46, v46, v95
    v_dot2_f32_bf16 v96, v66, v99, v96
    v_dot2_f32_bf16 v97, v70, v99, v97
    v_dot2_f32_bf16 v98, v74, v99, v98
    v_dot2_f32_bf16 v88, v35, v99, v88
    v_dot2_f32_bf16 v92, v35, v35, v92
    v_dot2_f32_bf16 v89, v39, v99, v89
    v_dot2_f32_bf16 v93, v39, v39, v93
    v_dot2_f32_bf16 v90, v43, v99, v90
    v_dot2_f32_bf16 v94, v43, v43, v94
    v_dot2_f32_bf16 v91, v47, v99, v91
    v_dot2_f32_bf16 v95, v47, v47, v95
    v_dot2_f32_bf16 v96, v67, v99, v96
    v_dot2_f32_bf16 v97, v71, v99, v97
    v_dot2_f32_bf16 v98, v75, v99, v98
    s_waitcnt lgkmcnt(0)
    v_mfma_f32_16x16x32_bf16 a[0:3], v[76:79], v[48:51], a[0:3]
    v_mfma_f32_16x16x32_bf16 a[4:7], v[80:83], v[48:51], a[4:7]
    v_mfma_f32_16x16x32_bf16 a[8:11], v[84:87], v[48:51], a[8:11]
    v_mfma_f32_16x16x32_bf16 a[12:15], v[76:79], v[52:55], a[12:15]
    v_mfma_f32_16x16x32_bf16 a[16:19], v[80:83], v[52:55], a[16:19]
    v_mfma_f32_16x16x32_bf16 a[20:23], v[84:87], v[52:55], a[20:23]
    v_mfma_f32_16x16x32_bf16 a[24:27], v[76:79], v[56:59], a[24:27]
    v_mfma_f32_16x16x32_bf16 a[28:31], v[80:83], v[56:59], a[28:31]
    v_mfma_f32_16x16x32_bf16 a[32:35], v[84:87], v[56:59], a[32:35]
    v_mfma_f32_16x16x32_bf16 a[36:39], v[76:79], v[60:63], a[36:39]
    v_mfma_f32_16x16x32_bf16 a[40:43], v[80:83], v[60:63], a[40:43]
    v_mfma_f32_16x16x32_bf16 a[44:47], v[84:87], v[60:63], a[44:47]
    v_dot2_f32_bf16 v88, v48, v99, v88
    v_dot2_f32_bf16 v92, v48, v48, v92
    v_dot2_f32_bf16 v89, v52, v99, v89
    v_dot2_f32_bf16 v93, v52, v52, v93
    v_dot2_f32_bf16 v90, v56, v99, v90
    v_dot2_f32_bf16 v94, v56, v56, v94
    v_dot2_f32_bf16 v91, v60, v99, v91
    v_dot2_f32_bf16 v95, v60, v60, v95
    v_dot2_f32_bf16 v96, v76, v99, v96
    v_dot2_f32_bf16 v97, v80, v99, v97
    v_dot2_f32_bf16 v98, v84, v99, v98
    v_dot2_f32_bf16 v88, v49, v99, v88
    v_dot2_f32_bf16 v92, v49, v49, v92
    v_dot2_f32_bf16 v89, v53, v99, v89
    v_dot2_f32_bf16 v93, v53, v53, v93
    v_dot2_f32_bf16 v90, v57, v99, v90
    v_dot2_f32_bf16 v94, v57, v57, v94
    v_dot2_f32_bf16 v91, v61, v99, v91
    v_dot2_f32_bf16 v95, v61, v61, v95
    v_dot2_f32_bf16 v96, v77, v99, v96
    v_dot2_f32_bf16 v97, v81, v99, v97
    v_dot2_f32_bf16 v98, v85, v99, v98
    v_dot2_f32_bf16 v88, v50, v99, v88
    v_dot2_f32_bf16 v92, v50, v50, v92
    v_dot2_f32_bf16 v89, v54, v99, v89
    v_dot2_f32_bf16 v93, v54, v54, v93
    v_dot2_f32_bf16 v90, v58, v99, v90
    v_dot2_f32_bf16 v94, v58, v58, v94
    v_dot2_f32_bf16 v91, v62, v99, v91
    v_dot2_f32_bf16 v95, v62, v62, v95
    v_dot2_f32_bf16 v96, v78, v99, v96
    v_dot2_f32_bf16 v97, v82, v99, v97
    v_dot2_f32_bf16 v98, v86, v99, v98
    v_dot2_f32_bf16 v88, v51, v99, v88
    v_dot2_f32_bf16 v92, v51, v51, v92
    v_dot2_f32_bf16 v89, v55, v99, v89
    v_dot2_f32_bf16 v93, v55, v55, v93
    v_dot2_f32_bf16 v90, v59, v99, v90
    v_dot2_f32_bf16 v94, v59, v59, v94
    v_dot2_f32_bf16 v91, v63, v99, v91
    v_dot2_f32_bf16 v95, v63, v63, v95
    v_dot2_f32_bf16 v96, v79, v99, v96
    v_dot2_f32_bf16 v97, v83, v99, v97
    v_dot2_f32_bf16 v98, v87, v99, v98
    s_waitcnt vmcnt(16)
    s_barrier
    s_add_u32 s55, s52, 512
    s_add_u32 m0, s54, 0
    s_nop 0
    buffer_load_dwordx4 v10, s[8:11], s55 offen lds
    s_add_u32 s55, s52, 29184
    s_add_u32 m0, s54, 4096
    s_nop 0
    buffer_load_dwordx4 v10, s[8:11], s55 offen lds
    s_add_u32 s55, s52, 57856
    s_add_u32 m0, s54, 8192
    s_nop 0
    buffer_load_dwordx4 v10, s[8:11], s55 offen lds
    s_add_u32 s55, s52, 86528
    s_add_u32 m0, s54, 12288
    s_nop 0
    buffer_load_dwordx4 v10, s[8:11], s55 offen lds
    s_add_u32 s55, s53, 688128
    s_add_u32 m0, s54, 16384
    s_nop 0
    buffer_load_dwordx4 v11, s[12:15], s55 offen lds
    s_add_u32 s55, s53, 731136
    s_add_u32 m0, s54, 20480
    s_nop 0
    buffer_load_dwordx4 v11, s[12:15], s55 offen lds
    s_add_u32 s55, s53, 774144
    s_add_u32 m0, s54, 24576
    s_nop 0
    buffer_load_dwordx4 v11, s[12:15], s55 offen lds
    s_add_u32 s55, s53, 817152
    s_add_u32 m0, s54, 28672
    s_nop 0
    buffer_load_dwordx4 v11, s[12:15], s55 offen lds
    ds_read_b128 v[32:35], v14 offset:0
    ds_read_b128 v[36:39], v14 offset:2048
    ds_read_b128 v[40:43], v14 offset:4096
    ds_read_b128 v[44:47], v14 offset:6144
    ds_read_b64_tr_b16 v[64:65], v23 offset:0
    ds_read_b64_tr_b16 v[66:67], v23 offset:1024
    ds_read_b64_tr_b16 v[68:69], v24 offset:0
    ds_read_b64_tr_b16 v[70:71], v24 offset:1024
    ds_read_b64_tr_b16 v[72:73], v25 offset:0
    ds_read_b64_tr_b16 v[74:75], v25 offset:1024
    ds_read_b128 v[48:51], v15 offset:0
    ds_read_b128 v[52:55], v15 offset:2048
    ds_read_b128 v[56:59], v15 offset:4096
    ds_read_b128 v[60:63], v15 offset:6144
    ds_read_b64_tr_b16 v[76:77], v23 offset:8192
    ds_read_b64_tr_b16 v[78:79], v23 offset:9216
    ds_read_b64_tr_b16 v[80:81], v24 offset:8192
    ds_read_b64_tr_b16 v[82:83], v24 offset:9216
    ds_read_b64_tr_b16 v[84:85], v25 offset:8192
    ds_read_b64_tr_b16 v[86:87], v25 offset:9216
    s_waitcnt lgkmcnt(10)
    v_mfma_f32_16x16x32_bf16 a[0:3], v[64:67], v[32:35], a[0:3]
    v_mfma_f32_16x16x32_bf16 a[4:7], v[68:71], v[32:35], a[4:7]
    v_mfma_f32_16x16x32_bf16 a[8:11], v[72:75], v[32:35], a[8:11]
    v_mfma_f32_16x16x32_bf16 a[12:15], v[64:67], v[36:39], a[12:15]
    v_mfma_f32_16x16x32_bf16 a[16:19], v[68:71], v[36:39], a[16:19]
    v_mfma_f32_16x16x32_bf16 a[20:23], v[72:75], v[36:39], a[20:23]
    v_mfma_f32_16x16x32_bf16 a[24:27], v[64:67], v[40:43], a[24:27]
    v_mfma_f32_16x16x32_bf16 a[28:31], v[68:71], v[40:43], a[28:31]
    v_mfma_f32_16x16x32_bf16 a[32:35], v[72:75], v[40:43], a[32:35]
    v_mfma_f32_16x16x32_bf16 a[36:39], v[64:67], v[44:47], a[36:39]
    v_mfma_f32_16x16x32_bf16 a[40:43], v[68:71], v[44:47], a[40:43]
    v_mfma_f32_16x16x32_bf16 a[44:47], v[72:75], v[44:47], a[44:47]
    v_dot2_f32_bf16 v88, v32, v99, v88
    v_dot2_f32_bf16 v92, v32, v32, v92
    v_dot2_f32_bf16 v89, v36, v99, v89
    v_dot2_f32_bf16 v93, v36, v36, v93
    v_dot2_f32_bf16 v90, v40, v99, v90
    v_dot2_f32_bf16 v94, v40, v40, v94
    v_dot2_f32_bf16 v91, v44, v99, v91
    v_dot2_f32_bf16 v95, v44, v44, v95
    v_dot2_f32_bf16 v96, v64, v99, v96
    v_dot2_f32_bf16 v97, v68, v99, v97
    v_dot2_f32_bf16 v98, v72, v99, v98
    v_dot2_f32_bf16 v88, v33, v99, v88
    v_dot2_f32_bf16 v92, v33, v33, v92
    v_dot2_f32_bf16 v89, v37, v99, v89
    v_dot2_f32_bf16 v93, v37, v37, v93
    v_dot2_f32_bf16 v90, v41, v99, v90
    v_dot2_f32_bf16 v94, v41, v41, v94
    v_dot2_f32_bf16 v91, v45, v99, v91
    v_dot2_f32_bf16 v95, v45, v45, v95
    v_dot2_f32_bf16 v96, v65, v99, v96
    v_dot2_f32_bf16 v97, v69, v99, v97
    v_dot2_f32_bf16 v98, v73, v99, v98
    v_dot2_f32_bf16 v88, v34, v99, v88
    v_dot2_f32_bf16 v92, v34, v34, v92
    v_dot2_f32_bf16 v89, v38, v99, v89
    v_dot2_f32_bf16 v93, v38, v38, v93
    v_dot2_f32_bf16 v90, v42, v99, v90
    v_dot2_f32_bf16 v94, v42, v42, v94
    v_dot2_f32_bf16 v91, v46, v99, v91
    v_dot2_f32_bf16 v95, v46, v46, v95
    v_dot2_f32_bf16 v96, v66, v99, v96
    v_dot2_f32_bf16 v97, v70, v99, v97
    v_dot2_f32_bf16 v98, v74, v99, v98
    v_dot2_f32_bf16 v88, v35, v99, v88
    v_dot2_f32_bf16 v92, v35, v35, v92
    v_dot2_f32_bf16 v89, v39, v99, v89
    v_dot2_f32_bf16 v93, v39, v39, v93
    v_dot2_f32_bf16 v90, v43, v99, v90
    v_dot2_f32_bf16 v94, v43, v43, v94
    v_dot2_f32_bf16 v91, v47, v99, v91
    v_dot2_f32_bf16 v95, v47, v47, v95
    v_dot2_f32_bf16 v96, v67, v99, v96
    v_dot2_f32_bf16 v97, v71, v99, v97
    v_dot2_f32_bf16 v98, v75, v99, v98
    s_waitcnt lgkmcnt(0)
    v_mfma_f32_16x16x32_bf16 a[0:3], v[76:79], v[48:51], a[0:3]
    v_mfma_f32_16x16x32_bf16 a[4:7], v[80:83], v[48:51], a[4:7]
    v_mfma_f32_16x16x32_bf16 a[8:11], v[84:87], v[48:51], a[8:11]
    v_mfma_f32_16x16x32_bf16 a[12:15], v[76:79], v[52:55], a[12:15]
    v_mfma_f32_16x16x32_bf16 a[16:19], v[80:83], v[52:55], a[16:19]
    v_mfma_f32_16x16x32_bf16 a[20:23], v[84:87], v[52:55], a[20:23]
    v_mfma_f32_16x16x32_bf16 a[24:27], v[76:79], v[56:59], a[24:27]
    v_mfma_f32_16x16x32_bf16 a[28:31], v[80:83], v[56:59], a[28:31]
    v_mfma_f32_16x16x32_bf16 a[32:35], v[84:87], v[56:59], a[32:35]
    v_mfma_f32_16x16x32_bf16 a[36:39], v[76:79], v[60:63], a[36:39]
    v_mfma_f32_16x16x32_bf16 a[40:43], v[80:83], v[60:63], a[40:43]
    v_mfma_f32_16x16x32_bf16 a[44:47], v[84:87], v[60:63], a[44:47]
    v_dot2_f32_bf16 v88, v48, v99, v88
    v_dot2_f32_bf16 v92, v48, v48, v92
    v_dot2_f32_bf16 v89, v52, v99, v89
    v_dot2_f32_bf16 v93, v52, v52, v93
    v_dot2_f32_bf16 v90, v56, v99, v90
    v_dot2_f32_bf16 v94, v56, v56, v94
    v_dot2_f32_bf16 v91, v60, v99, v91
    v_dot2_f32_bf16 v95, v60, v60, v95
    v_dot2_f32_bf16 v96, v76, v99, v96
    v_dot2_f32_bf16 v97, v80, v99, v97
    v_dot2_f32_bf16 v98, v84, v99, v98
    v_dot2_f32_bf16 v88, v49, v99, v88
    v_dot2_f32_bf16 v92, v49, v49, v92
    v_dot2_f32_bf16 v89, v53, v99, v89
    v_dot2_f32_bf16 v93, v53, v53, v93
    v_dot2_f32_bf16 v90, v57, v99, v90
    v_dot2_f32_bf16 v94, v57, v57, v94
    v_dot2_f32_bf16 v91, v61, v99, v91
    v_dot2_f32_bf16 v95, v61, v61, v95
    v_dot2_f32_bf16 v96, v77, v99, v96
    v_dot2_f32_bf16 v97, v81, v99, v97
    v_dot2_f32_bf16 v98, v85, v99, v98
    v_dot2_f32_bf16 v88, v50, v99, v88
    v_dot2_f32_bf16 v92, v50, v50, v92
    v_dot2_f32_bf16 v89, v54, v99, v89
    v_dot2_f32_bf16 v93, v54, v54, v93
    v_dot2_f32_bf16 v90, v58, v99, v90
    v_dot2_f32_bf16 v94, v58, v58, v94
    v_dot2_f32_bf16 v91, v62, v99, v91
    v_dot2_f32_bf16 v95, v62, v62, v95
    v_dot2_f32_bf16 v96, v78, v99, v96
    v_dot2_f32_bf16 v97, v82, v99, v97
    v_dot2_f32_bf16 v98, v86, v99, v98
    v_dot2_f32_bf16 v88, v51, v99, v88
    v_dot2_f32_bf16 v92, v51, v51, v92
    v_dot2_f32_bf16 v89, v55, v99, v89
    v_dot2_f32_bf16 v93, v55, v55, v93
    v_dot2_f32_bf16 v90, v59, v99, v90
    v_dot2_f32_bf16 v94, v59, v59, v94
    v_dot2_f32_bf16 v91, v63, v99, v91
    v_dot2_f32_bf16 v95, v63, v63, v95
    v_dot2_f32_bf16 v96, v79, v99, v96
    v_dot2_f32_bf16 v97, v83, v99, v97
    v_dot2_f32_bf16 v98, v87, v99, v98
    s_waitcnt vmcnt(16)
    s_barrier
    s_add_u32 s55, s52, 640
    s_add_u32 m0, s54, 32768
    s_nop 0
    buffer_load_dwordx4 v10, s[8:11], s55 offen lds
    s_add_u32 s55, s52, 29312
    s_add_u32 m0, s54, 36864
    s_nop 0
    buffer_load_dwordx4 v10, s[8:11], s55 offen lds
    s_add_u32 s55, s52, 57984
    s_add_u32 m0, s54, 40960
    s_nop 0
    buffer_load_dwordx4 v10, s[8:11], s55 offen lds
    s_add_u32 s55, s52, 86656
    s_add_u32 m0, s54, 45056
    s_nop 0
    buffer_load_dwordx4 v10, s[8:11], s55 offen lds
    s_add_u32 s55, s53, 860160
    s_add_u32 m0, s54, 49152
    s_nop 0
    buffer_load_dwordx4 v11, s[12:15], s55 offen lds
    s_add_u32 s55, s53, 903168
    s_add_u32 m0, s54, 53248
    s_nop 0
    buffer_load_dwordx4 v11, s[12:15], s55 offen lds
    s_add_u32 s55, s53, 946176
    s_add_u32 m0, s54, 57344
    s_nop 0
    buffer_load_dwordx4 v11, s[12:15], s55 offen lds
    s_add_u32 s55, s53, 989184
    s_add_u32 m0, s54, 61440
    s_nop 0
    buffer_load_dwordx4 v11, s[12:15], s55 offen lds
    ds_read_b128 v[32:35], v16 offset:0
    ds_read_b128 v[36:39], v16 offset:2048
    ds_read_b128 v[40:43], v16 offset:4096
    ds_read_b128 v[44:47], v16 offset:6144
    ds_read_b64_tr_b16 v[64:65], v26 offset:0
    ds_read_b64_tr_b16 v[66:67], v26 offset:1024
    ds_read_b64_tr_b16 v[68:69], v27 offset:0
    ds_read_b64_tr_b16 v[70:71], v27 offset:1024
    ds_read_b64_tr_b16 v[72:73], v28 offset:0
    ds_read_b64_tr_b16 v[74:75], v28 offset:1024
    ds_read_b128 v[48:51], v17 offset:0
    ds_read_b128 v[52:55], v17 offset:2048
    ds_read_b128 v[56:59], v17 offset:4096
    ds_read_b128 v[60:63], v17 offset:6144
    ds_read_b64_tr_b16 v[76:77], v26 offset:8192
    ds_read_b64_tr_b16 v[78:79], v26 offset:9216
    ds_read_b64_tr_b16 v[80:81], v27 offset:8192
    ds_read_b64_tr_b16 v[82:83], v27 offset:9216
    ds_read_b64_tr_b16 v[84:85], v28 offset:8192
    ds_read_b64_tr_b16 v[86:87], v28 offset:9216
    s_waitcnt lgkmcnt(10)
    v_mfma_f32_16x16x32_bf16 a[0:3], v[64:67], v[32:35], a[0:3]
    v_mfma_f32_16x16x32_bf16 a[4:7], v[68:71], v[32:35], a[4:7]
    v_mfma_f32_16x16x32_bf16 a[8:11], v[72:75], v[32:35], a[8:11]
    v_mfma_f32_16x16x32_bf16 a[12:15], v[64:67], v[36:39], a[12:15]
    v_mfma_f32_16x16x32_bf16 a[16:19], v[68:71], v[36:39], a[16:19]
    v_mfma_f32_16x16x32_bf16 a[20:23], v[72:75], v[36:39], a[20:23]
    v_mfma_f32_16x16x32_bf16 a[24:27], v[64:67], v[40:43], a[24:27]
    v_mfma_f32_16x16x32_bf16 a[28:31], v[68:71], v[40:43], a[28:31]
    v_mfma_f32_16x16x32_bf16 a[32:35], v[72:75], v[40:43], a[32:35]
    v_mfma_f32_16x16x32_bf16 a[36:39], v[64:67], v[44:47], a[36:39]
    v_mfma_f32_16x16x32_bf16 a[40:43], v[68:71], v[44:47], a[40:43]
    v_mfma_f32_16x16x32_bf16 a[44:47], v[72:75], v[44:47], a[44:47]
    v_dot2_f32_bf16 v88, v32, v99, v88
    v_dot2_f32_bf16 v92, v32, v32, v92
    v_dot2_f32_bf16 v89, v36, v99, v89
    v_dot2_f32_bf16 v93, v36, v36, v93
    v_dot2_f32_bf16 v90, v40, v99, v90
    v_dot2_f32_bf16 v94, v40, v40, v94
    v_dot2_f32_bf16 v91, v44, v99, v91
    v_dot2_f32_bf16 v95, v44, v44, v95
    v_dot2_f32_bf16 v96, v64, v99, v96
    v_dot2_f32_bf16 v97, v68, v99, v97
    v_dot2_f32_bf16 v98, v72, v99, v98
    v_dot2_f32_bf16 v88, v33, v99, v88
    v_dot2_f32_bf16 v92, v33, v33, v92
    v_dot2_f32_bf16 v89, v37, v99, v89
    v_dot2_f32_bf16 v93, v37, v37, v93
    v_dot2_f32_bf16 v90, v41, v99, v90
    v_dot2_f32_bf16 v94, v41, v41, v94
    v_dot2_f32_bf16 v91, v45, v99, v91
    v_dot2_f32_bf16 v95, v45, v45, v95
    v_dot2_f32_bf16 v96, v65, v99, v96
    v_dot2_f32_bf16 v97, v69, v99, v97
    v_dot2_f32_bf16 v98, v73, v99, v98
    v_dot2_f32_bf16 v88, v34, v99, v88
    v_dot2_f32_bf16 v92, v34, v34, v92
    v_dot2_f32_bf16 v89, v38, v99, v89
    v_dot2_f32_bf16 v93, v38, v38, v93
    v_dot2_f32_bf16 v90, v42, v99, v90
    v_dot2_f32_bf16 v94, v42, v42, v94
    v_dot2_f32_bf16 v91, v46, v99, v91
    v_dot2_f32_bf16 v95, v46, v46, v95
    v_dot2_f32_bf16 v96, v66, v99, v96
    v_dot2_f32_bf16 v97, v70, v99, v97
    v_dot2_f32_bf16 v98, v74, v99, v98
    v_dot2_f32_bf16 v88, v35, v99, v88
    v_dot2_f32_bf16 v92, v35, v35, v92
    v_dot2_f32_bf16 v89, v39, v99, v89
    v_dot2_f32_bf16 v93, v39, v39, v93
    v_dot2_f32_bf16 v90, v43, v99, v90
    v_dot2_f32_bf16 v94, v43, v43, v94
    v_dot2_f32_bf16 v91, v47, v99, v91
    v_dot2_f32_bf16 v95, v47, v47, v95
    v_dot2_f32_bf16 v96, v67, v99, v96
    v_dot2_f32_bf16 v97, v71, v99, v97
    v_dot2_f32_bf16 v98, v75, v99, v98
    s_waitcnt lgkmcnt(0)
    v_mfma_f32_16x16x32_bf16 a[0:3], v[76:79], v[48:51], a[0:3]
    v_mfma_f32_16x16x32_bf16 a[4:7], v[80:83], v[48:51], a[4:7]
    v_mfma_f32_16x16x32_bf16 a[8:11], v[84:87], v[48:51], a[8:11]
    v_mfma_f32_16x16x32_bf16 a[12:15], v[76:79], v[52:55], a[12:15]
    v_mfma_f32_16x16x32_bf16 a[16:19], v[80:83], v[52:55], a[16:19]
    v_mfma_f32_16x16x32_bf16 a[20:23], v[84:87], v[52:55], a[20:23]
    v_mfma_f32_16x16x32_bf16 a[24:27], v[76:79], v[56:59], a[24:27]
    v_mfma_f32_16x16x32_bf16 a[28:31], v[80:83], v[56:59], a[28:31]
    v_mfma_f32_16x16x32_bf16 a[32:35], v[84:87], v[56:59], a[32:35]
    v_mfma_f32_16x16x32_bf16 a[36:39], v[76:79], v[60:63], a[36:39]
    v_mfma_f32_16x16x32_bf16 a[40:43], v[80:83], v[60:63], a[40:43]
    v_mfma_f32_16x16x32_bf16 a[44:47], v[84:87], v[60:63], a[44:47]
    v_dot2_f32_bf16 v88, v48, v99, v88
    v_dot2_f32_bf16 v92, v48, v48, v92
    v_dot2_f32_bf16 v89, v52, v99, v89
    v_dot2_f32_bf16 v93, v52, v52, v93
    v_dot2_f32_bf16 v90, v56, v99, v90
    v_dot2_f32_bf16 v94, v56, v56, v94
    v_dot2_f32_bf16 v91, v60, v99, v91
    v_dot2_f32_bf16 v95, v60, v60, v95
    v_dot2_f32_bf16 v96, v76, v99, v96
    v_dot2_f32_bf16 v97, v80, v99, v97
    v_dot2_f32_bf16 v98, v84, v99, v98
    v_dot2_f32_bf16 v88, v49, v99, v88
    v_dot2_f32_bf16 v92, v49, v49, v92
    v_dot2_f32_bf16 v89, v53, v99, v89
    v_dot2_f32_bf16 v93, v53, v53, v93
    v_dot2_f32_bf16 v90, v57, v99, v90
    v_dot2_f32_bf16 v94, v57, v57, v94
    v_dot2_f32_bf16 v91, v61, v99, v91
    v_dot2_f32_bf16 v95, v61, v61, v95
    v_dot2_f32_bf16 v96, v77, v99, v96
    v_dot2_f32_bf16 v97, v81, v99, v97
    v_dot2_f32_bf16 v98, v85, v99, v98
    v_dot2_f32_bf16 v88, v50, v99, v88
    v_dot2_f32_bf16 v92, v50, v50, v92
    v_dot2_f32_bf16 v89, v54, v99, v89
    v_dot2_f32_bf16 v93, v54, v54, v93
    v_dot2_f32_bf16 v90, v58, v99, v90
    v_dot2_f32_bf16 v94, v58, v58, v94
    v_dot2_f32_bf16 v91, v62, v99, v91
    v_dot2_f32_bf16 v95, v62, v62, v95
    v_dot2_f32_bf16 v96, v78, v99, v96
    v_dot2_f32_bf16 v97, v82, v99, v97
    v_dot2_f32_bf16 v98, v86, v99, v98
    v_dot2_f32_bf16 v88, v51, v99, v88
    v_dot2_f32_bf16 v92, v51, v51, v92
    v_dot2_f32_bf16 v89, v55, v99, v89
    v_dot2_f32_bf16 v93, v55, v55, v93
    v_dot2_f32_bf16 v90, v59, v99, v90
    v_dot2_f32_bf16 v94, v59, v59, v94
    v_dot2_f32_bf16 v91, v63, v99, v91
    v_dot2_f32_bf16 v95, v63, v63, v95
    v_dot2_f32_bf16 v96, v79, v99, v96
    v_dot2_f32_bf16 v97, v83, v99, v97
    v_dot2_f32_bf16 v98, v87, v99, v98
    s_waitcnt vmcnt(16)
    s_barrier
    s_add_u32 s55, s52, 768
    s_add_u32 m0, s54, 65536
    s_nop 0
    buffer_load_dwordx4 v10, s[8:11], s55 offen lds
    s_add_u32 s55, s52, 29440
    s_add_u32 m0, s54, 69632
    s_nop 0
    buffer_load_dwordx4 v10, s[8:11], s55 offen lds
    s_add_u32 s55, s52, 58112
    s_add_u32 m0, s54, 73728
    s_nop 0
    buffer_load_dwordx4 v10, s[8:11], s55 offen lds
    s_add_u32 s55, s52, 86784
    s_add_u32 m0, s54, 77824
    s_nop 0
    buffer_load_dwordx4 v10, s[8:11], s55 offen lds
    s_add_u32 s55, s53, 1032192
    s_add_u32 m0, s54, 81920
    s_nop 0
    buffer_load_dwordx4 v11, s[12:15], s55 offen lds
    s_add_u32 s55, s53, 1075200
    s_add_u32 m0, s54, 86016
    s_nop 0
    buffer_load_dwordx4 v11, s[12:15], s55 offen lds
    s_add_u32 s55, s53, 1118208
    s_add_u32 m0, s54, 90112
    s_nop 0
    buffer_load_dwordx4 v11, s[12:15], s55 offen lds
    s_add_u32 s55, s53, 1161216
    s_add_u32 m0, s54, 94208
    s_nop 0
    buffer_load_dwordx4 v11, s[12:15], s55 offen lds
    ds_read_b128 v[32:35], v18 offset:0
    ds_read_b128 v[36:39], v18 offset:2048
    ds_read_b128 v[40:43], v18 offset:4096
    ds_read_b128 v[44:47], v18 offset:6144
    ds_read_b64_tr_b16 v[64:65], v29 offset:0
    ds_read_b64_tr_b16 v[66:67], v29 offset:1024
    ds_read_b64_tr_b16 v[68:69], v30 offset:0
    ds_read_b64_tr_b16 v[70:71], v30 offset:1024
    ds_read_b64_tr_b16 v[72:73], v31 offset:0
    ds_read_b64_tr_b16 v[74:75], v31 offset:1024
    ds_read_b128 v[48:51], v19 offset:0
    ds_read_b128 v[52:55], v19 offset:2048
    ds_read_b128 v[56:59], v19 offset:4096
    ds_read_b128 v[60:63], v19 offset:6144
    ds_read_b64_tr_b16 v[76:77], v29 offset:8192
    ds_read_b64_tr_b16 v[78:79], v29 offset:9216
    ds_read_b64_tr_b16 v[80:81], v30 offset:8192
    ds_read_b64_tr_b16 v[82:83], v30 offset:9216
    ds_read_b64_tr_b16 v[84:85], v31 offset:8192
    ds_read_b64_tr_b16 v[86:87], v31 offset:9216
    s_waitcnt lgkmcnt(10)
    v_mfma_f32_16x16x32_bf16 a[0:3], v[64:67], v[32:35], a[0:3]
    v_mfma_f32_16x16x32_bf16 a[4:7], v[68:71], v[32:35], a[4:7]
    v_mfma_f32_16x16x32_bf16 a[8:11], v[72:75], v[32:35], a[8:11]
    v_mfma_f32_16x16x32_bf16 a[12:15], v[64:67], v[36:39], a[12:15]
    v_mfma_f32_16x16x32_bf16 a[16:19], v[68:71], v[36:39], a[16:19]
    v_mfma_f32_16x16x32_bf16 a[20:23], v[72:75], v[36:39], a[20:23]
    v_mfma_f32_16x16x32_bf16 a[24:27], v[64:67], v[40:43], a[24:27]
    v_mfma_f32_16x16x32_bf16 a[28:31], v[68:71], v[40:43], a[28:31]
    v_mfma_f32_16x16x32_bf16 a[32:35], v[72:75], v[40:43], a[32:35]
    v_mfma_f32_16x16x32_bf16 a[36:39], v[64:67], v[44:47], a[36:39]
    v_mfma_f32_16x16x32_bf16 a[40:43], v[68:71], v[44:47], a[40:43]
    v_mfma_f32_16x16x32_bf16 a[44:47], v[72:75], v[44:47], a[44:47]
    v_dot2_f32_bf16 v88, v32, v99, v88
    v_dot2_f32_bf16 v92, v32, v32, v92
    v_dot2_f32_bf16 v89, v36, v99, v89
    v_dot2_f32_bf16 v93, v36, v36, v93
    v_dot2_f32_bf16 v90, v40, v99, v90
    v_dot2_f32_bf16 v94, v40, v40, v94
    v_dot2_f32_bf16 v91, v44, v99, v91
    v_dot2_f32_bf16 v95, v44, v44, v95
    v_dot2_f32_bf16 v96, v64, v99, v96
    v_dot2_f32_bf16 v97, v68, v99, v97
    v_dot2_f32_bf16 v98, v72, v99, v98
    v_dot2_f32_bf16 v88, v33, v99, v88
    v_dot2_f32_bf16 v92, v33, v33, v92
    v_dot2_f32_bf16 v89, v37, v99, v89
    v_dot2_f32_bf16 v93, v37, v37, v93
    v_dot2_f32_bf16 v90, v41, v99, v90
    v_dot2_f32_bf16 v94, v41, v41, v94
    v_dot2_f32_bf16 v91, v45, v99, v91
    v_dot2_f32_bf16 v95, v45, v45, v95
    v_dot2_f32_bf16 v96, v65, v99, v96
    v_dot2_f32_bf16 v97, v69, v99, v97
    v_dot2_f32_bf16 v98, v73, v99, v98
    v_dot2_f32_bf16 v88, v34, v99, v88
    v_dot2_f32_bf16 v92, v34, v34, v92
    v_dot2_f32_bf16 v89, v38, v99, v89
    v_dot2_f32_bf16 v93, v38, v38, v93
    v_dot2_f32_bf16 v90, v42, v99, v90
    v_dot2_f32_bf16 v94, v42, v42, v94
    v_dot2_f32_bf16 v91, v46, v99, v91
    v_dot2_f32_bf16 v95, v46, v46, v95
    v_dot2_f32_bf16 v96, v66, v99, v96
    v_dot2_f32_bf16 v97, v70, v99, v97
    v_dot2_f32_bf16 v98, v74, v99, v98
    v_dot2_f32_bf16 v88, v35, v99, v88
    v_dot2_f32_bf16 v92, v35, v35, v92
    v_dot2_f32_bf16 v89, v39, v99, v89
    v_dot2_f32_bf16 v93, v39, v39, v93
    v_dot2_f32_bf16 v90, v43, v99, v90
    v_dot2_f32_bf16 v94, v43, v43, v94
    v_dot2_f32_bf16 v91, v47, v99, v91
    v_dot2_f32_bf16 v95, v47, v47, v95
    v_dot2_f32_bf16 v96, v67, v99, v96
    v_dot2_f32_bf16 v97, v71, v99, v97
    v_dot2_f32_bf16 v98, v75, v99, v98
    s_waitcnt lgkmcnt(0)
    v_mfma_f32_16x16x32_bf16 a[0:3], v[76:79], v[48:51], a[0:3]
    v_mfma_f32_16x16x32_bf16 a[4:7], v[80:83], v[48:51], a[4:7]
    v_mfma_f32_16x16x32_bf16 a[8:11], v[84:87], v[48:51], a[8:11]
    v_mfma_f32_16x16x32_bf16 a[12:15], v[76:79], v[52:55], a[12:15]
    v_mfma_f32_16x16x32_bf16 a[16:19], v[80:83], v[52:55], a[16:19]
    v_mfma_f32_16x16x32_bf16 a[20:23], v[84:87], v[52:55], a[20:23]
    v_mfma_f32_16x16x32_bf16 a[24:27], v[76:79], v[56:59], a[24:27]
    v_mfma_f32_16x16x32_bf16 a[28:31], v[80:83], v[56:59], a[28:31]
    v_mfma_f32_16x16x32_bf16 a[32:35], v[84:87], v[56:59], a[32:35]
    v_mfma_f32_16x16x32_bf16 a[36:39], v[76:79], v[60:63], a[36:39]
    v_mfma_f32_16x16x32_bf16 a[40:43], v[80:83], v[60:63], a[40:43]
    v_mfma_f32_16x16x32_bf16 a[44:47], v[84:87], v[60:63], a[44:47]
    v_dot2_f32_bf16 v88, v48, v99, v88
    v_dot2_f32_bf16 v92, v48, v48, v92
    v_dot2_f32_bf16 v89, v52, v99, v89
    v_dot2_f32_bf16 v93, v52, v52, v93
    v_dot2_f32_bf16 v90, v56, v99, v90
    v_dot2_f32_bf16 v94, v56, v56, v94
    v_dot2_f32_bf16 v91, v60, v99, v91
    v_dot2_f32_bf16 v95, v60, v60, v95
    v_dot2_f32_bf16 v96, v76, v99, v96
    v_dot2_f32_bf16 v97, v80, v99, v97
    v_dot2_f32_bf16 v98, v84, v99, v98
    v_dot2_f32_bf16 v88, v49, v99, v88
    v_dot2_f32_bf16 v92, v49, v49, v92
    v_dot2_f32_bf16 v89, v53, v99, v89
    v_dot2_f32_bf16 v93, v53, v53, v93
    v_dot2_f32_bf16 v90, v57, v99, v90
    v_dot2_f32_bf16 v94, v57, v57, v94
    v_dot2_f32_bf16 v91, v61, v99, v91
    v_dot2_f32_bf16 v95, v61, v61, v95
    v_dot2_f32_bf16 v96, v77, v99, v96
    v_dot2_f32_bf16 v97, v81, v99, v97
    v_dot2_f32_bf16 v98, v85, v99, v98
    v_dot2_f32_bf16 v88, v50, v99, v88
    v_dot2_f32_bf16 v92, v50, v50, v92
    v_dot2_f32_bf16 v89, v54, v99, v89
    v_dot2_f32_bf16 v93, v54, v54, v93
    v_dot2_f32_bf16 v90, v58, v99, v90
    v_dot2_f32_bf16 v94, v58, v58, v94
    v_dot2_f32_bf16 v91, v62, v99, v91
    v_dot2_f32_bf16 v95, v62, v62, v95
    v_dot2_f32_bf16 v96, v78, v99, v96
    v_dot2_f32_bf16 v97, v82, v99, v97
    v_dot2_f32_bf16 v98, v86, v99, v98
    v_dot2_f32_bf16 v88, v51, v99, v88
    v_dot2_f32_bf16 v92, v51, v51, v92
    v_dot2_f32_bf16 v89, v55, v99, v89
    v_dot2_f32_bf16 v93, v55, v55, v93
    v_dot2_f32_bf16 v90, v59, v99, v90
    v_dot2_f32_bf16 v94, v59, v59, v94
    v_dot2_f32_bf16 v91, v63, v99, v91
    v_dot2_f32_bf16 v95, v63, v63, v95
    v_dot2_f32_bf16 v96, v79, v99, v96
    v_dot2_f32_bf16 v97, v83, v99, v97
    v_dot2_f32_bf16 v98, v87, v99, v98
    s_waitcnt vmcnt(16)
    s_barrier
    ds_read_b128 v[32:35], v12 offset:0
    ds_read_b128 v[36:39], v12 offset:2048
    ds_read_b128 v[40:43], v12 offset:4096
    ds_read_b128 v[44:47], v12 offset:6144
    ds_read_b64_tr_b16 v[64:65], v20 offset:0
    ds_read_b64_tr_b16 v[66:67], v20 offset:1024
    ds_read_b64_tr_b16 v[68:69], v21 offset:0
    ds_read_b64_tr_b16 v[70:71], v21 offset:1024
    ds_read_b64_tr_b16 v[72:73], v22 offset:0
    ds_read_b64_tr_b16 v[74:75], v22 offset:1024
    ds_read_b128 v[48:51], v13 offset:0
    ds_read_b128 v[52:55], v13 offset:2048
    ds_read_b128 v[56:59], v13 offset:4096
    ds_read_b128 v[60:63], v13 offset:6144
    ds_read_b64_tr_b16 v[76:77], v20 offset:8192
    ds_read_b64_tr_b16 v[78:79], v20 offset:9216
    ds_read_b64_tr_b16 v[80:81], v21 offset:8192
    ds_read_b64_tr_b16 v[82:83], v21 offset:9216
    ds_read_b64_tr_b16 v[84:85], v22 offset:8192
    ds_read_b64_tr_b16 v[86:87], v22 offset:9216
    s_waitcnt lgkmcnt(10)
    v_mfma_f32_16x16x32_bf16 a[0:3], v[64:67], v[32:35], a[0:3]
    v_mfma_f32_16x16x32_bf16 a[4:7], v[68:71], v[32:35], a[4:7]
    v_mfma_f32_16x16x32_bf16 a[8:11], v[72:75], v[32:35], a[8:11]
    v_mfma_f32_16x16x32_bf16 a[12:15], v[64:67], v[36:39], a[12:15]
    v_mfma_f32_16x16x32_bf16 a[16:19], v[68:71], v[36:39], a[16:19]
    v_mfma_f32_16x16x32_bf16 a[20:23], v[72:75], v[36:39], a[20:23]
    v_mfma_f32_16x16x32_bf16 a[24:27], v[64:67], v[40:43], a[24:27]
    v_mfma_f32_16x16x32_bf16 a[28:31], v[68:71], v[40:43], a[28:31]
    v_mfma_f32_16x16x32_bf16 a[32:35], v[72:75], v[40:43], a[32:35]
    v_mfma_f32_16x16x32_bf16 a[36:39], v[64:67], v[44:47], a[36:39]
    v_mfma_f32_16x16x32_bf16 a[40:43], v[68:71], v[44:47], a[40:43]
    v_mfma_f32_16x16x32_bf16 a[44:47], v[72:75], v[44:47], a[44:47]
    v_dot2_f32_bf16 v88, v32, v99, v88
    v_dot2_f32_bf16 v92, v32, v32, v92
    v_dot2_f32_bf16 v89, v36, v99, v89
    v_dot2_f32_bf16 v93, v36, v36, v93
    v_dot2_f32_bf16 v90, v40, v99, v90
    v_dot2_f32_bf16 v94, v40, v40, v94
    v_dot2_f32_bf16 v91, v44, v99, v91
    v_dot2_f32_bf16 v95, v44, v44, v95
    v_dot2_f32_bf16 v96, v64, v99, v96
    v_dot2_f32_bf16 v97, v68, v99, v97
    v_dot2_f32_bf16 v98, v72, v99, v98
    v_dot2_f32_bf16 v88, v33, v99, v88
    v_dot2_f32_bf16 v92, v33, v33, v92
    v_dot2_f32_bf16 v89, v37, v99, v89
    v_dot2_f32_bf16 v93, v37, v37, v93
    v_dot2_f32_bf16 v90, v41, v99, v90
    v_dot2_f32_bf16 v94, v41, v41, v94
    v_dot2_f32_bf16 v91, v45, v99, v91
    v_dot2_f32_bf16 v95, v45, v45, v95
    v_dot2_f32_bf16 v96, v65, v99, v96
    v_dot2_f32_bf16 v97, v69, v99, v97
    v_dot2_f32_bf16 v98, v73, v99, v98
    v_dot2_f32_bf16 v88, v34, v99, v88
    v_dot2_f32_bf16 v92, v34, v34, v92
    v_dot2_f32_bf16 v89, v38, v99, v89
    v_dot2_f32_bf16 v93, v38, v38, v93
    v_dot2_f32_bf16 v90, v42, v99, v90
    v_dot2_f32_bf16 v94, v42, v42, v94
    v_dot2_f32_bf16 v91, v46, v99, v91
    v_dot2_f32_bf16 v95, v46, v46, v95
    v_dot2_f32_bf16 v96, v66, v99, v96
    v_dot2_f32_bf16 v97, v70, v99, v97
    v_dot2_f32_bf16 v98, v74, v99, v98
    v_dot2_f32_bf16 v88, v35, v99, v88
    v_dot2_f32_bf16 v92, v35, v35, v92
    v_dot2_f32_bf16 v89, v39, v99, v89
    v_dot2_f32_bf16 v93, v39, v39, v93
    v_dot2_f32_bf16 v90, v43, v99, v90
    v_dot2_f32_bf16 v94, v43, v43, v94
    v_dot2_f32_bf16 v91, v47, v99, v91
    v_dot2_f32_bf16 v95, v47, v47, v95
    v_dot2_f32_bf16 v96, v67, v99, v96
    v_dot2_f32_bf16 v97, v71, v99, v97
    v_dot2_f32_bf16 v98, v75, v99, v98
    s_waitcnt lgkmcnt(0)
    v_mfma_f32_16x16x32_bf16 a[0:3], v[76:79], v[48:51], a[0:3]
    v_mfma_f32_16x16x32_bf16 a[4:7], v[80:83], v[48:51], a[4:7]
    v_mfma_f32_16x16x32_bf16 a[8:11], v[84:87], v[48:51], a[8:11]
    v_mfma_f32_16x16x32_bf16 a[12:15], v[76:79], v[52:55], a[12:15]
    v_mfma_f32_16x16x32_bf16 a[16:19], v[80:83], v[52:55], a[16:19]
    v_mfma_f32_16x16x32_bf16 a[20:23], v[84:87], v[52:55], a[20:23]
    v_mfma_f32_16x16x32_bf16 a[24:27], v[76:79], v[56:59], a[24:27]
    v_mfma_f32_16x16x32_bf16 a[28:31], v[80:83], v[56:59], a[28:31]
    v_mfma_f32_16x16x32_bf16 a[32:35], v[84:87], v[56:59], a[32:35]
    v_mfma_f32_16x16x32_bf16 a[36:39], v[76:79], v[60:63], a[36:39]
    v_mfma_f32_16x16x32_bf16 a[40:43], v[80:83], v[60:63], a[40:43]
    v_mfma_f32_16x16x32_bf16 a[44:47], v[84:87], v[60:63], a[44:47]
    v_dot2_f32_bf16 v88, v48, v99, v88
    v_dot2_f32_bf16 v92, v48, v48, v92
    v_dot2_f32_bf16 v89, v52, v99, v89
    v_dot2_f32_bf16 v93, v52, v52, v93
    v_dot2_f32_bf16 v90, v56, v99, v90
    v_dot2_f32_bf16 v94, v56, v56, v94
    v_dot2_f32_bf16 v91, v60, v99, v91
    v_dot2_f32_bf16 v95, v60, v60, v95
    v_dot2_f32_bf16 v96, v76, v99, v96
    v_dot2_f32_bf16 v97, v80, v99, v97
    v_dot2_f32_bf16 v98, v84, v99, v98
    v_dot2_f32_bf16 v88, v49, v99, v88
    v_dot2_f32_bf16 v92, v49, v49, v92
    v_dot2_f32_bf16 v89, v53, v99, v89
    v_dot2_f32_bf16 v93, v53, v53, v93
    v_dot2_f32_bf16 v90, v57, v99, v90
    v_dot2_f32_bf16 v94, v57, v57, v94
    v_dot2_f32_bf16 v91, v61, v99, v91
    v_dot2_f32_bf16 v95, v61, v61, v95
    v_dot2_f32_bf16 v96, v77, v99, v96
    v_dot2_f32_bf16 v97, v81, v99, v97
    v_dot2_f32_bf16 v98, v85, v99, v98
    v_dot2_f32_bf16 v88, v50, v99, v88
    v_dot2_f32_bf16 v92, v50, v50, v92
    v_dot2_f32_bf16 v89, v54, v99, v89
    v_dot2_f32_bf16 v93, v54, v54, v93
    v_dot2_f32_bf16 v90, v58, v99, v90
    v_dot2_f32_bf16 v94, v58, v58, v94
    v_dot2_f32_bf16 v91, v62, v99, v91
    v_dot2_f32_bf16 v95, v62, v62, v95
    v_dot2_f32_bf16 v96, v78, v99, v96
    v_dot2_f32_bf16 v97, v82, v99, v97
    v_dot2_f32_bf16 v98, v86, v99, v98
    v_dot2_f32_bf16 v88, v51, v99, v88
    v_dot2_f32_bf16 v92, v51, v51, v92
    v_dot2_f32_bf16 v89, v55, v99, v89
    v_dot2_f32_bf16 v93, v55, v55, v93
    v_dot2_f32_bf16 v90, v59, v99, v90
    v_dot2_f32_bf16 v94, v59, v59, v94
    v_dot2_f32_bf16 v91, v63, v99, v91
    v_dot2_f32_bf16 v95, v63, v63, v95
    v_dot2_f32_bf16 v96, v79, v99, v96
    v_dot2_f32_bf16 v97, v83, v99, v97
    v_dot2_f32_bf16 v98, v87, v99, v98
    s_waitcnt vmcnt(8)
    s_barrier
    ds_read_b128 v[32:35], v14 offset:0
    ds_read_b128 v[36:39], v14 offset:2048
    ds_read_b128 v[40:43], v14 offset:4096
    ds_read_b128 v[44:47], v14 offset:6144
    ds_read_b64_tr_b16 v[64:65], v23 offset:0
    ds_read_b64_tr_b16 v[66:67], v23 offset:1024
    ds_read_b64_tr_b16 v[68:69], v24 offset:0
    ds_read_b64_tr_b16 v[70:71], v24 offset:1024
    ds_read_b64_tr_b16 v[72:73], v25 offset:0
    ds_read_b64_tr_b16 v[74:75], v25 offset:1024
    ds_read_b128 v[48:51], v15 offset:0
    ds_read_b128 v[52:55], v15 offset:2048
    ds_read_b128 v[56:59], v15 offset:4096
    ds_read_b128 v[60:63], v15 offset:6144
    ds_read_b64_tr_b16 v[76:77], v23 offset:8192
    ds_read_b64_tr_b16 v[78:79], v23 offset:9216
    ds_read_b64_tr_b16 v[80:81], v24 offset:8192
    ds_read_b64_tr_b16 v[82:83], v24 offset:9216
    ds_read_b64_tr_b16 v[84:85], v25 offset:8192
    ds_read_b64_tr_b16 v[86:87], v25 offset:9216
    s_waitcnt lgkmcnt(10)
    v_mfma_f32_16x16x32_bf16 a[0:3], v[64:67], v[32:35], a[0:3]
    v_mfma_f32_16x16x32_bf16 a[4:7], v[68:71], v[32:35], a[4:7]
    v_mfma_f32_16x16x32_bf16 a[8:11], v[72:75], v[32:35], a[8:11]
    v_mfma_f32_16x16x32_bf16 a[12:15], v[64:67], v[36:39], a[12:15]
    v_mfma_f32_16x16x32_bf16 a[16:19], v[68:71], v[36:39], a[16:19]
    v_mfma_f32_16x16x32_bf16 a[20:23], v[72:75], v[36:39], a[20:23]
    v_mfma_f32_16x16x32_bf16 a[24:27], v[64:67], v[40:43], a[24:27]
    v_mfma_f32_16x16x32_bf16 a[28:31], v[68:71], v[40:43], a[28:31]
    v_mfma_f32_16x16x32_bf16 a[32:35], v[72:75], v[40:43], a[32:35]
    v_mfma_f32_16x16x32_bf16 a[36:39], v[64:67], v[44:47], a[36:39]
    v_mfma_f32_16x16x32_bf16 a[40:43], v[68:71], v[44:47], a[40:43]
    v_mfma_f32_16x16x32_bf16 a[44:47], v[72:75], v[44:47], a[44:47]
    v_dot2_f32_bf16 v88, v32, v99, v88
    v_dot2_f32_bf16 v92, v32, v32, v92
    v_dot2_f32_bf16 v89, v36, v99, v89
    v_dot2_f32_bf16 v93, v36, v36, v93
    v_dot2_f32_bf16 v90, v40, v99, v90
    v_dot2_f32_bf16 v94, v40, v40, v94
    v_dot2_f32_bf16 v91, v44, v99, v91
    v_dot2_f32_bf16 v95, v44, v44, v95
    v_dot2_f32_bf16 v96, v64, v99, v96
    v_dot2_f32_bf16 v97, v68, v99, v97
    v_dot2_f32_bf16 v98, v72, v99, v98
    v_dot2_f32_bf16 v88, v33, v99, v88
    v_dot2_f32_bf16 v92, v33, v33, v92
    v_dot2_f32_bf16 v89, v37, v99, v89
    v_dot2_f32_bf16 v93, v37, v37, v93
    v_dot2_f32_bf16 v90, v41, v99, v90
    v_dot2_f32_bf16 v94, v41, v41, v94
    v_dot2_f32_bf16 v91, v45, v99, v91
    v_dot2_f32_bf16 v95, v45, v45, v95
    v_dot2_f32_bf16 v96, v65, v99, v96
    v_dot2_f32_bf16 v97, v69, v99, v97
    v_dot2_f32_bf16 v98, v73, v99, v98
    v_dot2_f32_bf16 v88, v34, v99, v88
    v_dot2_f32_bf16 v92, v34, v34, v92
    v_dot2_f32_bf16 v89, v38, v99, v89
    v_dot2_f32_bf16 v93, v38, v38, v93
    v_dot2_f32_bf16 v90, v42, v99, v90
    v_dot2_f32_bf16 v94, v42, v42, v94
    v_dot2_f32_bf16 v91, v46, v99, v91
    v_dot2_f32_bf16 v95, v46, v46, v95
    v_dot2_f32_bf16 v96, v66, v99, v96
    v_dot2_f32_bf16 v97, v70, v99, v97
    v_dot2_f32_bf16 v98, v74, v99, v98
    v_dot2_f32_bf16 v88, v35, v99, v88
    v_dot2_f32_bf16 v92, v35, v35, v92
    v_dot2_f32_bf16 v89, v39, v99, v89
    v_dot2_f32_bf16 v93, v39, v39, v93
    v_dot2_f32_bf16 v90, v43, v99, v90
    v_dot2_f32_bf16 v94, v43, v43, v94
    v_dot2_f32_bf16 v91, v47, v99, v91
    v_dot2_f32_bf16 v95, v47, v47, v95
    v_dot2_f32_bf16 v96, v67, v99, v96
    v_dot2_f32_bf16 v97, v71, v99, v97
    v_dot2_f32_bf16 v98, v75, v99, v98
    s_waitcnt lgkmcnt(0)
    v_mfma_f32_16x16x32_bf16 a[0:3], v[76:79], v[48:51], a[0:3]
    v_mfma_f32_16x16x32_bf16 a[4:7], v[80:83], v[48:51], a[4:7]
    v_mfma_f32_16x16x32_bf16 a[8:11], v[84:87], v[48:51], a[8:11]
    v_mfma_f32_16x16x32_bf16 a[12:15], v[76:79], v[52:55], a[12:15]
    v_mfma_f32_16x16x32_bf16 a[16:19], v[80:83], v[52:55], a[16:19]
    v_mfma_f32_16x16x32_bf16 a[20:23], v[84:87], v[52:55], a[20:23]
    v_mfma_f32_16x16x32_bf16 a[24:27], v[76:79], v[56:59], a[24:27]
    v_mfma_f32_16x16x32_bf16 a[28:31], v[80:83], v[56:59], a[28:31]
    v_mfma_f32_16x16x32_bf16 a[32:35], v[84:87], v[56:59], a[32:35]
    v_mfma_f32_16x16x32_bf16 a[36:39], v[76:79], v[60:63], a[36:39]
    v_mfma_f32_16x16x32_bf16 a[40:43], v[80:83], v[60:63], a[40:43]
    v_mfma_f32_16x16x32_bf16 a[44:47], v[84:87], v[60:63], a[44:47]
    v_dot2_f32_bf16 v88, v48, v99, v88
    v_dot2_f32_bf16 v92, v48, v48, v92
    v_dot2_f32_bf16 v89, v52, v99, v89
    v_dot2_f32_bf16 v93, v52, v52, v93
    v_dot2_f32_bf16 v90, v56, v99, v90
    v_dot2_f32_bf16 v94, v56, v56, v94
    v_dot2_f32_bf16 v91, v60, v99, v91
    v_dot2_f32_bf16 v95, v60, v60, v95
    v_dot2_f32_bf16 v96, v76, v99, v96
    v_dot2_f32_bf16 v97, v80, v99, v97
    v_dot2_f32_bf16 v98, v84, v99, v98
    v_dot2_f32_bf16 v88, v49, v99, v88
    v_dot2_f32_bf16 v92, v49, v49, v92
    v_dot2_f32_bf16 v89, v53, v99, v89
    v_dot2_f32_bf16 v93, v53, v53, v93
    v_dot2_f32_bf16 v90, v57, v99, v90
    v_dot2_f32_bf16 v94, v57, v57, v94
    v_dot2_f32_bf16 v91, v61, v99, v91
    v_dot2_f32_bf16 v95, v61, v61, v95
    v_dot2_f32_bf16 v96, v77, v99, v96
    v_dot2_f32_bf16 v97, v81, v99, v97
    v_dot2_f32_bf16 v98, v85, v99, v98
    v_dot2_f32_bf16 v88, v50, v99, v88
    v_dot2_f32_bf16 v92, v50, v50, v92
    v_dot2_f32_bf16 v89, v54, v99, v89
    v_dot2_f32_bf16 v93, v54, v54, v93
    v_dot2_f32_bf16 v90, v58, v99, v90
    v_dot2_f32_bf16 v94, v58, v58, v94
    v_dot2_f32_bf16 v91, v62, v99, v91
    v_dot2_f32_bf16 v95, v62, v62, v95
    v_dot2_f32_bf16 v96, v78, v99, v96
    v_dot2_f32_bf16 v97, v82, v99, v97
    v_dot2_f32_bf16 v98, v86, v99, v98
    v_dot2_f32_bf16 v88, v51, v99, v88
    v_dot2_f32_bf16 v92, v51, v51, v92
    v_dot2_f32_bf16 v89, v55, v99, v89
    v_dot2_f32_bf16 v93, v55, v55, v93
    v_dot2_f32_bf16 v90, v59, v99, v90
    v_dot2_f32_bf16 v94, v59, v59, v94
    v_dot2_f32_bf16 v91, v63, v99, v91
    v_dot2_f32_bf16 v95, v63, v63, v95
    v_dot2_f32_bf16 v96, v79, v99, v96
    v_dot2_f32_bf16 v97, v83, v99, v97
    v_dot2_f32_bf16 v98, v87, v99, v98
    s_waitcnt vmcnt(0)
    s_barrier
    ds_read_b128 v[32:35], v16 offset:0
    ds_read_b128 v[36:39], v16 offset:2048
    ds_read_b128 v[40:43], v16 offset:4096
    ds_read_b128 v[44:47], v16 offset:6144
    ds_read_b64_tr_b16 v[64:65], v26 offset:0
    ds_read_b64_tr_b16 v[66:67], v26 offset:1024
    ds_read_b64_tr_b16 v[68:69], v27 offset:0
    ds_read_b64_tr_b16 v[70:71], v27 offset:1024
    ds_read_b64_tr_b16 v[72:73], v28 offset:0
    ds_read_b64_tr_b16 v[74:75], v28 offset:1024
    ds_read_b128 v[48:51], v17 offset:0
    ds_read_b128 v[52:55], v17 offset:2048
    ds_read_b128 v[56:59], v17 offset:4096
    ds_read_b128 v[60:63], v17 offset:6144
    ds_read_b64_tr_b16 v[76:77], v26 offset:8192
    ds_read_b64_tr_b16 v[78:79], v26 offset:9216
    ds_read_b64_tr_b16 v[80:81], v27 offset:8192
    ds_read_b64_tr_b16 v[82:83], v27 offset:9216
    ds_read_b64_tr_b16 v[84:85], v28 offset:8192
    ds_read_b64_tr_b16 v[86:87], v28 offset:9216
    s_waitcnt lgkmcnt(10)
    v_mfma_f32_16x16x32_bf16 a[0:3], v[64:67], v[32:35], a[0:3]
    v_mfma_f32_16x16x32_bf16 a[4:7], v[68:71], v[32:35], a[4:7]
    v_mfma_f32_16x16x32_bf16 a[8:11], v[72:75], v[32:35], a[8:11]
    v_mfma_f32_16x16x32_bf16 a[12:15], v[64:67], v[36:39], a[12:15]
    v_mfma_f32_16x16x32_bf16 a[16:19], v[68:71], v[36:39], a[16:19]
    v_mfma_f32_16x16x32_bf16 a[20:23], v[72:75], v[36:39], a[20:23]
    v_mfma_f32_16x16x32_bf16 a[24:27], v[64:67], v[40:43], a[24:27]
    v_mfma_f32_16x16x32_bf16 a[28:31], v[68:71], v[40:43], a[28:31]
    v_mfma_f32_16x16x32_bf16 a[32:35], v[72:75], v[40:43], a[32:35]
    v_mfma_f32_16x16x32_bf16 a[36:39], v[64:67], v[44:47], a[36:39]
    v_mfma_f32_16x16x32_bf16 a[40:43], v[68:71], v[44:47], a[40:43]
    v_mfma_f32_16x16x32_bf16 a[44:47], v[72:75], v[44:47], a[44:47]
    v_dot2_f32_bf16 v88, v32, v99, v88
    v_dot2_f32_bf16 v92, v32, v32, v92
    v_dot2_f32_bf16 v89, v36, v99, v89
    v_dot2_f32_bf16 v93, v36, v36, v93
    v_dot2_f32_bf16 v90, v40, v99, v90
    v_dot2_f32_bf16 v94, v40, v40, v94
    v_dot2_f32_bf16 v91, v44, v99, v91
    v_dot2_f32_bf16 v95, v44, v44, v95
    v_dot2_f32_bf16 v96, v64, v99, v96
    v_dot2_f32_bf16 v97, v68, v99, v97
    v_dot2_f32_bf16 v98, v72, v99, v98
    v_dot2_f32_bf16 v88, v33, v99, v88
    v_dot2_f32_bf16 v92, v33, v33, v92
    v_dot2_f32_bf16 v89, v37, v99, v89
    v_dot2_f32_bf16 v93, v37, v37, v93
    v_dot2_f32_bf16 v90, v41, v99, v90
    v_dot2_f32_bf16 v94, v41, v41, v94
    v_dot2_f32_bf16 v91, v45, v99, v91
    v_dot2_f32_bf16 v95, v45, v45, v95
    v_dot2_f32_bf16 v96, v65, v99, v96
    v_dot2_f32_bf16 v97, v69, v99, v97
    v_dot2_f32_bf16 v98, v73, v99, v98
    v_dot2_f32_bf16 v88, v34, v99, v88
    v_dot2_f32_bf16 v92, v34, v34, v92
    v_dot2_f32_bf16 v89, v38, v99, v89
    v_dot2_f32_bf16 v93, v38, v38, v93
    v_dot2_f32_bf16 v90, v42, v99, v90
    v_dot2_f32_bf16 v94, v42, v42, v94
    v_dot2_f32_bf16 v91, v46, v99, v91
    v_dot2_f32_bf16 v95, v46, v46, v95
    v_dot2_f32_bf16 v96, v66, v99, v96
    v_dot2_f32_bf16 v97, v70, v99, v97
    v_dot2_f32_bf16 v98, v74, v99, v98
    v_dot2_f32_bf16 v88, v35, v99, v88
    v_dot2_f32_bf16 v92, v35, v35, v92
    v_dot2_f32_bf16 v89, v39, v99, v89
    v_dot2_f32_bf16 v93, v39, v39, v93
    v_dot2_f32_bf16 v90, v43, v99, v90
    v_dot2_f32_bf16 v94, v43, v43, v94
    v_dot2_f32_bf16 v91, v47, v99, v91
    v_dot2_f32_bf16 v95, v47, v47, v95
    v_dot2_f32_bf16 v96, v67, v99, v96
    v_dot2_f32_bf16 v97, v71, v99, v97
    v_dot2_f32_bf16 v98, v75, v99, v98
    s_waitcnt lgkmcnt(0)
    v_mfma_f32_16x16x32_bf16 a[0:3], v[76:79], v[48:51], a[0:3]
    v_mfma_f32_16x16x32_bf16 a[4:7], v[80:83], v[48:51], a[4:7]
    v_mfma_f32_16x16x32_bf16 a[8:11], v[84:87], v[48:51], a[8:11]
    v_mfma_f32_16x16x32_bf16 a[12:15], v[76:79], v[52:55], a[12:15]
    v_mfma_f32_16x16x32_bf16 a[16:19], v[80:83], v[52:55], a[16:19]
    v_mfma_f32_16x16x32_bf16 a[20:23], v[84:87], v[52:55], a[20:23]
    v_mfma_f32_16x16x32_bf16 a[24:27], v[76:79], v[56:59], a[24:27]
    v_mfma_f32_16x16x32_bf16 a[28:31], v[80:83], v[56:59], a[28:31]
    v_mfma_f32_16x16x32_bf16 a[32:35], v[84:87], v[56:59], a[32:35]
    v_mfma_f32_16x16x32_bf16 a[36:39], v[76:79], v[60:63], a[36:39]
    v_mfma_f32_16x16x32_bf16 a[40:43], v[80:83], v[60:63], a[40:43]
    v_mfma_f32_16x16x32_bf16 a[44:47], v[84:87], v[60:63], a[44:47]
    v_dot2_f32_bf16 v88, v48, v99, v88
    v_dot2_f32_bf16 v92, v48, v48, v92
    v_dot2_f32_bf16 v89, v52, v99, v89
    v_dot2_f32_bf16 v93, v52, v52, v93
    v_dot2_f32_bf16 v90, v56, v99, v90
    v_dot2_f32_bf16 v94, v56, v56, v94
    v_dot2_f32_bf16 v91, v60, v99, v91
    v_dot2_f32_bf16 v95, v60, v60, v95
    v_dot2_f32_bf16 v96, v76, v99, v96
    v_dot2_f32_bf16 v97, v80, v99, v97
    v_dot2_f32_bf16 v98, v84, v99, v98
    v_dot2_f32_bf16 v88, v49, v99, v88
    v_dot2_f32_bf16 v92, v49, v49, v92
    v_dot2_f32_bf16 v89, v53, v99, v89
    v_dot2_f32_bf16 v93, v53, v53, v93
    v_dot2_f32_bf16 v90, v57, v99, v90
    v_dot2_f32_bf16 v94, v57, v57, v94
    v_dot2_f32_bf16 v91, v61, v99, v91
    v_dot2_f32_bf16 v95, v61, v61, v95
    v_dot2_f32_bf16 v96, v77, v99, v96
    v_dot2_f32_bf16 v97, v81, v99, v97
    v_dot2_f32_bf16 v98, v85, v99, v98
    v_dot2_f32_bf16 v88, v50, v99, v88
    v_dot2_f32_bf16 v92, v50, v50, v92
    v_dot2_f32_bf16 v89, v54, v99, v89
    v_dot2_f32_bf16 v93, v54, v54, v93
    v_dot2_f32_bf16 v90, v58, v99, v90
    v_dot2_f32_bf16 v94, v58, v58, v94
    v_dot2_f32_bf16 v91, v62, v99, v91
    v_dot2_f32_bf16 v95, v62, v62, v95
    v_dot2_f32_bf16 v96, v78, v99, v96
    v_dot2_f32_bf16 v97, v82, v99, v97
    v_dot2_f32_bf16 v98, v86, v99, v98
    v_dot2_f32_bf16 v88, v51, v99, v88
    v_dot2_f32_bf16 v92, v51, v51, v92
    v_dot2_f32_bf16 v89, v55, v99, v89
    v_dot2_f32_bf16 v93, v55, v55, v93
    v_dot2_f32_bf16 v90, v59, v99, v90
    v_dot2_f32_bf16 v94, v59, v59, v94
    v_dot2_f32_bf16 v91, v63, v99, v91
    v_dot2_f32_bf16 v95, v63, v63, v95
    v_dot2_f32_bf16 v96, v79, v99, v96
    v_dot2_f32_bf16 v97, v83, v99, v97
    v_dot2_f32_bf16 v98, v87, v99, v98
    v_mov_b32 v2, v88
    s_nop 1
    v_permlane32_swap_b32 v88, v2
    v_add_f32 v88, v88, v2
    v_mov_b32 v2, v88
    s_nop 1
    v_permlane16_swap_b32 v88, v2
    v_add_f32 v88, v88, v2
    v_mov_b32 v2, v89
    s_nop 1
    v_permlane32_swap_b32 v89, v2
    v_add_f32 v89, v89, v2
    v_mov_b32 v2, v89
    s_nop 1
    v_permlane16_swap_b32 v89, v2
    v_add_f32 v89, v89, v2
    v_mov_b32 v2, v90
    s_nop 1
    v_permlane32_swap_b32 v90, v2
    v_add_f32 v90, v90, v2
    v_mov_b32 v2, v90
    s_nop 1
    v_permlane16_swap_b32 v90, v2
    v_add_f32 v90, v90, v2
    v_mov_b32 v2, v91
    s_nop 1
    v_permlane32_swap_b32 v91, v2
    v_add_f32 v91, v91, v2
    v_mov_b32 v2, v91
    s_nop 1
    v_permlane16_swap_b32 v91, v2
    v_add_f32 v91, v91, v2
    v_mov_b32 v2, v92
    s_nop 1
    v_permlane32_swap_b32 v92, v2
    v_add_f32 v92, v92, v2
    v_mov_b32 v2, v92
    s_nop 1
    v_permlane16_swap_b32 v92, v2
    v_add_f32 v92, v92, v2
    v_mov_b32 v2, v93
    s_nop 1
    v_permlane32_swap_b32 v93, v2
    v_add_f32 v93, v93, v2
    v_mov_b32 v2, v93
    s_nop 1
    v_permlane16_swap_b32 v93, v2
    v_add_f32 v93, v93, v2
    v_mov_b32 v2, v94
    s_nop 1
    v_permlane32_swap_b32 v94, v2
    v_add_f32 v94, v94, v2
    v_mov_b32 v2, v94
    s_nop 1
    v_permlane16_swap_b32 v94, v2
    v_add_f32 v94, v94, v2
    v_mov_b32 v2, v95
    s_nop 1
    v_permlane32_swap_b32 v95, v2
    v_add_f32 v95, v95, v2
    v_mov_b32 v2, v95
    s_nop 1
    v_permlane16_swap_b32 v95, v2
    v_add_f32 v95, v95, v2
    v_mov_b32 v2, v96
    s_nop 1
    v_permlane32_swap_b32 v96, v2
    v_add_f32 v96, v96, v2
    v_mov_b32 v2, v96
    s_nop 1
    v_permlane16_swap_b32 v96, v2
    v_add_f32 v96, v96, v2
    v_mov_b32 v2, v97
    s_nop 1
    v_permlane32_swap_b32 v97, v2
    v_add_f32 v97, v97, v2
    v_mov_b32 v2, v97
    s_nop 1
    v_permlane16_swap_b32 v97, v2
    v_add_f32 v97, v97, v2
    v_mov_b32 v2, v98
    s_nop 1
    v_permlane32_swap_b32 v98, v2
    v_add_f32 v98, v98, v2
    v_mov_b32 v2, v98
    s_nop 1
    v_permlane16_swap_b32 v98, v2
    v_add_f32 v98, v98, v2
    s_mov_b32 s44, 0x3b124925
    v_mul_f32 v88, s44, v88
    v_mul_f32 v92, s44, v92
    v_fma_f32 v92, -v88, v88, v92
    v_max_f32 v92, 0, v92
    v_add_f32 v92, 0x3727c5ac, v92
    v_rsq_f32 v92, v92
    v_mul_f32 v89, s44, v89
    v_mul_f32 v93, s44, v93
    v_fma_f32 v93, -v89, v89, v93
    v_max_f32 v93, 0, v93
    v_add_f32 v93, 0x3727c5ac, v93
    v_rsq_f32 v93, v93
    v_mul_f32 v90, s44, v90
    v_mul_f32 v94, s44, v94
    v_fma_f32 v94, -v90, v90, v94
    v_max_f32 v94, 0, v94
    v_add_f32 v94, 0x3727c5ac, v94
    v_rsq_f32 v94, v94
    v_mul_f32 v91, s44, v91
    v_mul_f32 v95, s44, v95
    v_fma_f32 v95, -v91, v91, v95
    v_max_f32 v95, 0, v95
    v_add_f32 v95, 0x3727c5ac, v95
    v_rsq_f32 v95, v95
    s_lshl_b32 s44, s51, 9
    v_lshlrev_b32 v2, 2, v6
    v_add_u32 v2, s44, v2
    v_add_u32 v2, 131072, v2
    v_lshlrev_b32 v3, 4, v7
    v_add_u32 v3, s44, v3
    v_add_u32 v3, 131072, v3
    ds_write_b32 v2, v96 offset:0
    ds_write_b32 v2, v97 offset:64
    ds_write_b32 v2, v98 offset:128
    s_waitcnt lgkmcnt(0)
    ds_read_b128 v[76:79], v3 offset:0
    ds_read_b128 v[80:83], v3 offset:64
    ds_read_b128 v[84:87], v3 offset:128
    s_waitcnt lgkmcnt(0)
    v_mov_b32 v102, 0x3f80
    v_add_u32 v2, 0, v101
    v_mul_u32_u24 v3, 2341, v2
    v_lshrrev_b32 v3, 16, v3
    v_mul_u32_u24 v4, 28, v3
    v_sub_u32 v4, v2, v4
    v_mov_b32 v109, v4
    v_lshlrev_b32 v103, 17, v3
    v_lshrrev_b32 v5, 3, v4
    v_lshlrev_b32 v5, 9, v5
    v_and_b32 v2, 7, v4
    v_lshl_add_u32 v5, v2, 1, v5
    v_lshlrev_b32 v2, 1, v4
    v_cmp_lt_u32 vcc, 31, v3
    s_nop 1
    v_cndmask_b32 v5, v5, v2, vcc
    v_add_u32 v103, v103, v5
    v_cndmask_b32 v106, 0, 1, vcc
    v_add_u32 v2, 16, v101
    v_mul_u32_u24 v3, 2341, v2
    v_lshrrev_b32 v3, 16, v3
    v_mul_u32_u24 v4, 28, v3
    v_sub_u32 v4, v2, v4
    v_mov_b32 v110, v4
    v_lshlrev_b32 v104, 17, v3
    v_lshrrev_b32 v5, 3, v4
    v_lshlrev_b32 v5, 9, v5
    v_and_b32 v2, 7, v4
    v_lshl_add_u32 v5, v2, 1, v5
    v_lshlrev_b32 v2, 1, v4
    v_cmp_lt_u32 vcc, 31, v3
    s_nop 1
    v_cndmask_b32 v5, v5, v2, vcc
    v_add_u32 v104, v104, v5
    v_cndmask_b32 v107, 0, 1, vcc
    v_add_u32 v2, 32, v101
    v_mul_u32_u24 v3, 2341, v2
    v_lshrrev_b32 v3, 16, v3
    v_mul_u32_u24 v4, 28, v3
    v_sub_u32 v4, v2, v4
    v_mov_b32 v111, v4
    v_lshlrev_b32 v105, 17, v3
    v_lshrrev_b32 v5, 3, v4
    v_lshlrev_b32 v5, 9, v5
    v_and_b32 v2, 7, v4
    v_lshl_add_u32 v5, v2, 1, v5
    v_lshlrev_b32 v2, 1, v4
    v_cmp_lt_u32 vcc, 31, v3
    s_nop 1
    v_cndmask_b32 v5, v5, v2, vcc
    v_add_u32 v105, v105, v5
    v_cndmask_b32 v108, 0, 1, vcc
    v_add_u32 v2, 0, v100
    v_lshrrev_b32 v5, 5, v2
    v_lshlrev_b32 v112, 11, v5
    v_and_b32 v5, 31, v2
    v_lshl_add_u32 v112, v5, 4, v112
    v_lshlrev_b32 v113, 6, v2
    v_accvgpr_read_b32 v32, a0
    v_accvgpr_read_b32 v33, a1
    v_accvgpr_read_b32 v34, a2
    v_accvgpr_read_b32 v35, a3
    v_fma_f32 v32, -v88, v76, v32
    v_mul_f32 v32, v92, v32
    v_fma_f32 v33, -v88, v77, v33
    v_mul_f32 v33, v92, v33
    v_fma_f32 v34, -v88, v78, v34
    v_mul_f32 v34, v92, v34
    v_fma_f32 v35, -v88, v79, v35
    v_mul_f32 v35, v92, v35
    v_cvt_pk_bf16_f32 v48, v32, v33
    v_cvt_pk_bf16_f32 v49, v34, v35
    v_cmp_eq_u32 vcc, 1, v106
    s_nop 1
    v_cndmask_b32 v3, v112, v113, vcc
    v_add_u32 v3, v3, v103
    buffer_store_dwordx2 v[48:49], v3, s[20:23], 0 offen
    v_cndmask_b32 v64, 0, v102, vcc
    v_mov_b32 v65, 0
    v_cmp_eq_u32 vcc, 24, v109
    s_and_saveexec_b64 s[42:43], vcc
    buffer_store_dwordx2 v[64:65], v3, s[20:23], 0 offen offset:8
    s_mov_b64 exec, s[42:43]
    v_accvgpr_read_b32 v32, a4
    v_accvgpr_read_b32 v33, a5
    v_accvgpr_read_b32 v34, a6
    v_accvgpr_read_b32 v35, a7
    v_fma_f32 v32, -v88, v80, v32
    v_mul_f32 v32, v92, v32
    v_fma_f32 v33, -v88, v81, v33
    v_mul_f32 v33, v92, v33
    v_fma_f32 v34, -v88, v82, v34
    v_mul_f32 v34, v92, v34
    v_fma_f32 v35, -v88, v83, v35
    v_mul_f32 v35, v92, v35
    v_cvt_pk_bf16_f32 v48, v32, v33
    v_cvt_pk_bf16_f32 v49, v34, v35
    v_cmp_eq_u32 vcc, 1, v107
    s_nop 1
    v_cndmask_b32 v3, v112, v113, vcc
    v_add_u32 v3, v3, v104
    buffer_store_dwordx2 v[48:49], v3, s[20:23], 0 offen
    v_cndmask_b32 v64, 0, v102, vcc
    v_mov_b32 v65, 0
    v_cmp_eq_u32 vcc, 24, v110
    s_and_saveexec_b64 s[42:43], vcc
    buffer_store_dwordx2 v[64:65], v3, s[20:23], 0 offen offset:8
    s_mov_b64 exec, s[42:43]
    v_accvgpr_read_b32 v32, a8
    v_accvgpr_read_b32 v33, a9
    v_accvgpr_read_b32 v34, a10
    v_accvgpr_read_b32 v35, a11
    v_fma_f32 v32, -v88, v84, v32
    v_mul_f32 v32, v92, v32
    v_fma_f32 v33, -v88, v85, v33
    v_mul_f32 v33, v92, v33
    v_fma_f32 v34, -v88, v86, v34
    v_mul_f32 v34, v92, v34
    v_fma_f32 v35, -v88, v87, v35
    v_mul_f32 v35, v92, v35
    v_cvt_pk_bf16_f32 v48, v32, v33
    v_cvt_pk_bf16_f32 v49, v34, v35
    v_cmp_eq_u32 vcc, 1, v108
    s_nop 1
    v_cndmask_b32 v3, v112, v113, vcc
    v_add_u32 v3, v3, v105
    buffer_store_dwordx2 v[48:49], v3, s[20:23], 0 offen
    v_cndmask_b32 v64, 0, v102, vcc
    v_mov_b32 v65, 0
    v_cmp_eq_u32 vcc, 24, v111
    s_and_saveexec_b64 s[42:43], vcc
    buffer_store_dwordx2 v[64:65], v3, s[20:23], 0 offen offset:8
    s_mov_b64 exec, s[42:43]
    v_add_u32 v2, 16, v100
    v_lshrrev_b32 v5, 5, v2
    v_lshlrev_b32 v112, 11, v5
    v_and_b32 v5, 31, v2
    v_lshl_add_u32 v112, v5, 4, v112
    v_lshlrev_b32 v113, 6, v2
    v_accvgpr_read_b32 v32, a12
    v_accvgpr_read_b32 v33, a13
    v_accvgpr_read_b32 v34, a14
    v_accvgpr_read_b32 v35, a15
    v_fma_f32 v32, -v89, v76, v32
    v_mul_f32 v32, v93, v32
    v_fma_f32 v33, -v89, v77, v33
    v_mul_f32 v33, v93, v33
    v_fma_f32 v34, -v89, v78, v34
    v_mul_f32 v34, v93, v34
    v_fma_f32 v35, -v89, v79, v35
    v_mul_f32 v35, v93, v35
    v_cvt_pk_bf16_f32 v48, v32, v33
    v_cvt_pk_bf16_f32 v49, v34, v35
    v_cmp_eq_u32 vcc, 1, v106
    s_nop 1
    v_cndmask_b32 v3, v112, v113, vcc
    v_add_u32 v3, v3, v103
    buffer_store_dwordx2 v[48:49], v3, s[20:23], 0 offen
    v_cndmask_b32 v64, 0, v102, vcc
    v_mov_b32 v65, 0
    v_cmp_eq_u32 vcc, 24, v109
    s_and_saveexec_b64 s[42:43], vcc
    buffer_store_dwordx2 v[64:65], v3, s[20:23], 0 offen offset:8
    s_mov_b64 exec, s[42:43]
    v_accvgpr_read_b32 v32, a16
    v_accvgpr_read_b32 v33, a17
    v_accvgpr_read_b32 v34, a18
    v_accvgpr_read_b32 v35, a19
    v_fma_f32 v32, -v89, v80, v32
    v_mul_f32 v32, v93, v32
    v_fma_f32 v33, -v89, v81, v33
    v_mul_f32 v33, v93, v33
    v_fma_f32 v34, -v89, v82, v34
    v_mul_f32 v34, v93, v34
    v_fma_f32 v35, -v89, v83, v35
    v_mul_f32 v35, v93, v35
    v_cvt_pk_bf16_f32 v48, v32, v33
    v_cvt_pk_bf16_f32 v49, v34, v35
    v_cmp_eq_u32 vcc, 1, v107
    s_nop 1
    v_cndmask_b32 v3, v112, v113, vcc
    v_add_u32 v3, v3, v104
    buffer_store_dwordx2 v[48:49], v3, s[20:23], 0 offen
    v_cndmask_b32 v64, 0, v102, vcc
    v_mov_b32 v65, 0
    v_cmp_eq_u32 vcc, 24, v110
    s_and_saveexec_b64 s[42:43], vcc
    buffer_store_dwordx2 v[64:65], v3, s[20:23], 0 offen offset:8
    s_mov_b64 exec, s[42:43]
    v_accvgpr_read_b32 v32, a20
    v_accvgpr_read_b32 v33, a21
    v_accvgpr_read_b32 v34, a22
    v_accvgpr_read_b32 v35, a23
    v_fma_f32 v32, -v89, v84, v32
    v_mul_f32 v32, v93, v32
    v_fma_f32 v33, -v89, v85, v33
    v_mul_f32 v33, v93, v33
    v_fma_f32 v34, -v89, v86, v34
    v_mul_f32 v34, v93, v34
    v_fma_f32 v35, -v89, v87, v35
    v_mul_f32 v35, v93, v35
    v_cvt_pk_bf16_f32 v48, v32, v33
    v_cvt_pk_bf16_f32 v49, v34, v35
    v_cmp_eq_u32 vcc, 1, v108
    s_nop 1
    v_cndmask_b32 v3, v112, v113, vcc
    v_add_u32 v3, v3, v105
    buffer_store_dwordx2 v[48:49], v3, s[20:23], 0 offen
    v_cndmask_b32 v64, 0, v102, vcc
    v_mov_b32 v65, 0
    v_cmp_eq_u32 vcc, 24, v111
    s_and_saveexec_b64 s[42:43], vcc
    buffer_store_dwordx2 v[64:65], v3, s[20:23], 0 offen offset:8
    s_mov_b64 exec, s[42:43]
    v_add_u32 v2, 32, v100
    v_lshrrev_b32 v5, 5, v2
    v_lshlrev_b32 v112, 11, v5
    v_and_b32 v5, 31, v2
    v_lshl_add_u32 v112, v5, 4, v112
    v_lshlrev_b32 v113, 6, v2
    v_accvgpr_read_b32 v32, a24
    v_accvgpr_read_b32 v33, a25
    v_accvgpr_read_b32 v34, a26
    v_accvgpr_read_b32 v35, a27
    v_fma_f32 v32, -v90, v76, v32
    v_mul_f32 v32, v94, v32
    v_fma_f32 v33, -v90, v77, v33
    v_mul_f32 v33, v94, v33
    v_fma_f32 v34, -v90, v78, v34
    v_mul_f32 v34, v94, v34
    v_fma_f32 v35, -v90, v79, v35
    v_mul_f32 v35, v94, v35
    v_cvt_pk_bf16_f32 v48, v32, v33
    v_cvt_pk_bf16_f32 v49, v34, v35
    v_cmp_eq_u32 vcc, 1, v106
    s_nop 1
    v_cndmask_b32 v3, v112, v113, vcc
    v_add_u32 v3, v3, v103
    buffer_store_dwordx2 v[48:49], v3, s[20:23], 0 offen
    v_cndmask_b32 v64, 0, v102, vcc
    v_mov_b32 v65, 0
    v_cmp_eq_u32 vcc, 24, v109
    s_and_saveexec_b64 s[42:43], vcc
    buffer_store_dwordx2 v[64:65], v3, s[20:23], 0 offen offset:8
    s_mov_b64 exec, s[42:43]
    v_accvgpr_read_b32 v32, a28
    v_accvgpr_read_b32 v33, a29
    v_accvgpr_read_b32 v34, a30
    v_accvgpr_read_b32 v35, a31
    v_fma_f32 v32, -v90, v80, v32
    v_mul_f32 v32, v94, v32
    v_fma_f32 v33, -v90, v81, v33
    v_mul_f32 v33, v94, v33
    v_fma_f32 v34, -v90, v82, v34
    v_mul_f32 v34, v94, v34
    v_fma_f32 v35, -v90, v83, v35
    v_mul_f32 v35, v94, v35
    v_cvt_pk_bf16_f32 v48, v32, v33
    v_cvt_pk_bf16_f32 v49, v34, v35
    v_cmp_eq_u32 vcc, 1, v107
    s_nop 1
    v_cndmask_b32 v3, v112, v113, vcc
    v_add_u32 v3, v3, v104
    buffer_store_dwordx2 v[48:49], v3, s[20:23], 0 offen
    v_cndmask_b32 v64, 0, v102, vcc
    v_mov_b32 v65, 0
    v_cmp_eq_u32 vcc, 24, v110
    s_and_saveexec_b64 s[42:43], vcc
    buffer_store_dwordx2 v[64:65], v3, s[20:23], 0 offen offset:8
    s_mov_b64 exec, s[42:43]
    v_accvgpr_read_b32 v32, a32
    v_accvgpr_read_b32 v33, a33
    v_accvgpr_read_b32 v34, a34
    v_accvgpr_read_b32 v35, a35
    v_fma_f32 v32, -v90, v84, v32
    v_mul_f32 v32, v94, v32
    v_fma_f32 v33, -v90, v85, v33
    v_mul_f32 v33, v94, v33
    v_fma_f32 v34, -v90, v86, v34
    v_mul_f32 v34, v94, v34
    v_fma_f32 v35, -v90, v87, v35
    v_mul_f32 v35, v94, v35
    v_cvt_pk_bf16_f32 v48, v32, v33
    v_cvt_pk_bf16_f32 v49, v34, v35
    v_cmp_eq_u32 vcc, 1, v108
    s_nop 1
    v_cndmask_b32 v3, v112, v113, vcc
    v_add_u32 v3, v3, v105
    buffer_store_dwordx2 v[48:49], v3, s[20:23], 0 offen
    v_cndmask_b32 v64, 0, v102, vcc
    v_mov_b32 v65, 0
    v_cmp_eq_u32 vcc, 24, v111
    s_and_saveexec_b64 s[42:43], vcc
    buffer_store_dwordx2 v[64:65], v3, s[20:23], 0 offen offset:8
    s_mov_b64 exec, s[42:43]
    v_add_u32 v2, 48, v100
    v_lshrrev_b32 v5, 5, v2
    v_lshlrev_b32 v112, 11, v5
    v_and_b32 v5, 31, v2
    v_lshl_add_u32 v112, v5, 4, v112
    v_lshlrev_b32 v113, 6, v2
    v_accvgpr_read_b32 v32, a36
    v_accvgpr_read_b32 v33, a37
    v_accvgpr_read_b32 v34, a38
    v_accvgpr_read_b32 v35, a39
    v_fma_f32 v32, -v91, v76, v32
    v_mul_f32 v32, v95, v32
    v_fma_f32 v33, -v91, v77, v33
    v_mul_f32 v33, v95, v33
    v_fma_f32 v34, -v91, v78, v34
    v_mul_f32 v34, v95, v34
    v_fma_f32 v35, -v91, v79, v35
    v_mul_f32 v35, v95, v35
    v_cvt_pk_bf16_f32 v48, v32, v33
    v_cvt_pk_bf16_f32 v49, v34, v35
    v_cmp_eq_u32 vcc, 1, v106
    s_nop 1
    v_cndmask_b32 v3, v112, v113, vcc
    v_add_u32 v3, v3, v103
    buffer_store_dwordx2 v[48:49], v3, s[20:23], 0 offen
    v_cndmask_b32 v64, 0, v102, vcc
    v_mov_b32 v65, 0
    v_cmp_eq_u32 vcc, 24, v109
    s_and_saveexec_b64 s[42:43], vcc
    buffer_store_dwordx2 v[64:65], v3, s[20:23], 0 offen offset:8
    s_mov_b64 exec, s[42:43]
    v_accvgpr_read_b32 v32, a40
    v_accvgpr_read_b32 v33, a41
    v_accvgpr_read_b32 v34, a42
    v_accvgpr_read_b32 v35, a43
    v_fma_f32 v32, -v91, v80, v32
    v_mul_f32 v32, v95, v32
    v_fma_f32 v33, -v91, v81, v33
    v_mul_f32 v33, v95, v33
    v_fma_f32 v34, -v91, v82, v34
    v_mul_f32 v34, v95, v34
    v_fma_f32 v35, -v91, v83, v35
    v_mul_f32 v35, v95, v35
    v_cvt_pk_bf16_f32 v48, v32, v33
    v_cvt_pk_bf16_f32 v49, v34, v35
    v_cmp_eq_u32 vcc, 1, v107
    s_nop 1
    v_cndmask_b32 v3, v112, v113, vcc
    v_add_u32 v3, v3, v104
    buffer_store_dwordx2 v[48:49], v3, s[20:23], 0 offen
    v_cndmask_b32 v64, 0, v102, vcc
    v_mov_b32 v65, 0
    v_cmp_eq_u32 vcc, 24, v110
    s_and_saveexec_b64 s[42:43], vcc
    buffer_store_dwordx2 v[64:65], v3, s[20:23], 0 offen offset:8
    s_mov_b64 exec, s[42:43]
    v_accvgpr_read_b32 v32, a44
    v_accvgpr_read_b32 v33, a45
    v_accvgpr_read_b32 v34, a46
    v_accvgpr_read_b32 v35, a47
    v_fma_f32 v32, -v91, v84, v32
    v_mul_f32 v32, v95, v32
    v_fma_f32 v33, -v91, v85, v33
    v_mul_f32 v33, v95, v33
    v_fma_f32 v34, -v91, v86, v34
    v_mul_f32 v34, v95, v34
    v_fma_f32 v35, -v91, v87, v35
    v_mul_f32 v35, v95, v35
    v_cvt_pk_bf16_f32 v48, v32, v33
    v_cvt_pk_bf16_f32 v49, v34, v35
    v_cmp_eq_u32 vcc, 1, v108
    s_nop 1
    v_cndmask_b32 v3, v112, v113, vcc
    v_add_u32 v3, v3, v105
    buffer_store_dwordx2 v[48:49], v3, s[20:23], 0 offen
    v_cndmask_b32 v64, 0, v102, vcc
    v_mov_b32 v65, 0
    v_cmp_eq_u32 vcc, 24, v111
    s_and_saveexec_b64 s[42:43], vcc
    buffer_store_dwordx2 v[64:65], v3, s[20:23], 0 offen offset:8
    s_mov_b64 exec, s[42:43]
L_qkv1_kernel_end:
    s_endpgm
.globl wo1_kernel
.p2align 8
.type wo1_kernel,@function
wo1_kernel:
    s_cmp_ge_u32 s2, 224
    s_cbranch_scc1 L_wo1_kernel_end
    s_load_dwordx2 s[4:5], s[0:1], 72
    s_load_dwordx2 s[34:35], s[0:1], 16
    s_lshr_b32 s45, s2, 3
    s_mov_b32 s44, 0x24924925
    s_mul_hi_u32 s28, s45, s44
    s_mul_i32 s44, s28, 7
    s_sub_u32 s29, s45, s44
    s_and_b32 s44, s2, 7
    s_mul_i32 s44, s44, 4
    s_add_u32 s28, s28, s44
    s_mov_b32 s50, 0x3f803f80
    v_lshrrev_b32 v2, 6, v0
    s_nop 0
    v_readfirstlane_b32 s51, v2
    v_and_b32 v9, 63, v0
    s_and_b32 s44, s51, 1
    s_lshl_b32 s44, s44, 2
    v_lshrrev_b32 v2, 4, v9
    v_add_u32 v2, s44, v2
    v_and_b32 v2, 7, v2
    v_and_b32 v3, 7, v9
    v_xor_b32 v2, v2, v3
    v_lshrrev_b32 v3, 3, v9
    v_mul_u32_u24 v3, 896, v3
    v_lshl_add_u32 v10, v2, 4, v3
    s_and_b32 s44, s51, 1
    s_lshl_b32 s44, s44, 1
    v_lshrrev_b32 v2, 3, v9
    v_bfe_u32 v3, v9, 4, 1
    v_or_b32 v3, s44, v3
    v_bfe_u32 v4, v9, 1, 2
    v_xor_b32 v3, v3, v4
    v_and_b32 v4, 1, v9
    v_lshl_add_u32 v3, v3, 1, v4
    v_mul_u32_u24 v2, 896, v2
    v_lshl_add_u32 v2, v3, 4, v2
    v_mov_b32 v11, v2
    s_waitcnt lgkmcnt(0)
    s_add_u32 s8, s4, 0xa00000
    s_addc_u32 s9, s5, 0
    s_mov_b32 s10, 0x1c0000
    s_mov_b32 s11, 0x00020000
    s_mov_b32 s12, s34
    s_mov_b32 s13, s35
    s_mov_b32 s14, 0x62000
    s_mov_b32 s15, 0x00020000
    s_mul_i32 s52, s28, 57344
    s_mul_i32 s44, s51, 7168
    s_add_u32 s52, s52, s44
    s_mul_i32 s53, s29, 128
    s_mul_i32 s44, s51, 7168
    s_add_u32 s53, s53, s44
    s_lshl_b32 s54, s51, 10
    s_add_u32 s55, s52, 0
    s_add_u32 m0, s54, 0
    s_nop 0
    buffer_load_dwordx4 v10, s[8:11], s55 offen lds
    s_add_u32 s55, s52, 28672
    s_add_u32 m0, s54, 4096
    s_nop 0
    buffer_load_dwordx4 v10, s[8:11], s55 offen lds
    s_add_u32 s55, s53, 0
    s_add_u32 m0, s54, 8192
    s_nop 0
    buffer_load_dwordx4 v11, s[12:15], s55 offen lds
    s_add_u32 s55, s53, 28672
    s_add_u32 m0, s54, 12288
    s_nop 0
    buffer_load_dwordx4 v11, s[12:15], s55 offen lds
    s_add_u32 s55, s52, 128
    s_add_u32 m0, s54, 16384
    s_nop 0
    buffer_load_dwordx4 v10, s[8:11], s55 offen lds
    s_add_u32 s55, s52, 28800
    s_add_u32 m0, s54, 20480
    s_nop 0
    buffer_load_dwordx4 v10, s[8:11], s55 offen lds
    s_add_u32 s55, s53, 57344
    s_add_u32 m0, s54, 24576
    s_nop 0
    buffer_load_dwordx4 v11, s[12:15], s55 offen lds
    s_add_u32 s55, s53, 86016
    s_add_u32 m0, s54, 28672
    s_nop 0
    buffer_load_dwordx4 v11, s[12:15], s55 offen lds
    s_add_u32 s55, s52, 256
    s_add_u32 m0, s54, 32768
    s_nop 0
    buffer_load_dwordx4 v10, s[8:11], s55 offen lds
    s_add_u32 s55, s52, 28928
    s_add_u32 m0, s54, 36864
    s_nop 0
    buffer_load_dwordx4 v10, s[8:11], s55 offen lds
    s_add_u32 s55, s53, 114688
    s_add_u32 m0, s54, 40960
    s_nop 0
    buffer_load_dwordx4 v11, s[12:15], s55 offen lds
    s_add_u32 s55, s53, 143360
    s_add_u32 m0, s54, 45056
    s_nop 0
    buffer_load_dwordx4 v11, s[12:15], s55 offen lds
    s_add_u32 s55, s52, 384
    s_add_u32 m0, s54, 49152
    s_nop 0
    buffer_load_dwordx4 v10, s[8:11], s55 offen lds
    s_add_u32 s55, s52, 29056
    s_add_u32 m0, s54, 53248
    s_nop 0
    buffer_load_dwordx4 v10, s[8:11], s55 offen lds
    s_add_u32 s55, s53, 172032
    s_add_u32 m0, s54, 57344
    s_nop 0
    buffer_load_dwordx4 v11, s[12:15], s55 offen lds
    s_add_u32 s55, s53, 200704
    s_add_u32 m0, s54, 61440
    s_nop 0
    buffer_load_dwordx4 v11, s[12:15], s55 offen lds
    s_add_u32 s55, s52, 512
    s_add_u32 m0, s54, 65536
    s_nop 0
    buffer_load_dwordx4 v10, s[8:11], s55 offen lds
    s_add_u32 s55, s52, 29184
    s_add_u32 m0, s54, 69632
    s_nop 0
    buffer_load_dwordx4 v10, s[8:11], s55 offen lds
    s_add_u32 s55, s53, 229376
    s_add_u32 m0, s54, 73728
    s_nop 0
    buffer_load_dwordx4 v11, s[12:15], s55 offen lds
    s_add_u32 s55, s53, 258048
    s_add_u32 m0, s54, 77824
    s_nop 0
    buffer_load_dwordx4 v11, s[12:15], s55 offen lds
    s_add_u32 s55, s52, 640
    s_add_u32 m0, s54, 81920
    s_nop 0
    buffer_load_dwordx4 v10, s[8:11], s55 offen lds
    s_add_u32 s55, s52, 29312
    s_add_u32 m0, s54, 86016
    s_nop 0
    buffer_load_dwordx4 v10, s[8:11], s55 offen lds
    s_add_u32 s55, s53, 286720
    s_add_u32 m0, s54, 90112
    s_nop 0
    buffer_load_dwordx4 v11, s[12:15], s55 offen lds
    s_add_u32 s55, s53, 315392
    s_add_u32 m0, s54, 94208
    s_nop 0
    buffer_load_dwordx4 v11, s[12:15], s55 offen lds
    s_mov_b32 s20, s4
    s_mov_b32 s21, s5
    s_mov_b32 s22, 0x1c0000
    s_mov_b32 s23, 0x00020000
    s_add_u32 s24, s4, 0x200000
    s_addc_u32 s25, s5, 0
    s_mov_b32 s26, 0x1c0000
    s_mov_b32 s27, 0x00020000
    v_and_b32 v6, 15, v0
    v_bfe_u32 v7, v0, 4, 2
    s_lshr_b32 s44, s51, 1
    s_mul_i32 s44, s44, 32
    s_mul_i32 s45, s28, 64
    s_add_u32 s44, s44, s45
    v_add_u32 v80, s44, v6
    s_and_b32 s44, s51, 1
    s_mul_i32 s44, s44, 32
    s_mul_i32 s45, s29, 64
    s_add_u32 s44, s44, s45
    v_lshlrev_b32 v81, 2, v7
    v_add_u32 v81, s44, v81
    v_mul_u32_u24 v82, 896, v80
    v_lshl_add_u32 v82, v81, 1, v82
    v_add_u32 v83, 0, v82
    v_add_u32 v84, 14336, v82
    buffer_load_dwordx2 v[72:73], v83, s[24:27], 0 offen offset:0
    buffer_load_dwordx2 v[74:75], v83, s[24:27], 0 offen offset:32
    buffer_load_dwordx2 v[76:77], v84, s[24:27], 0 offen offset:0
    buffer_load_dwordx2 v[78:79], v84, s[24:27], 0 offen offset:32
    s_lshr_b32 s44, s51, 1
    s_mul_i32 s44, s44, 4096
    v_bfe_u32 v2, v6, 1, 3
    v_mul_u32_u24 v3, 128, v6
    v_add_u32 v3, s44, v3
    v_add_u32 v4, 0, v7
    v_xor_b32 v4, v4, v2
    v_lshl_add_u32 v4, v4, 4, v3
    v_add_u32 v12, 0, v4
    v_add_u32 v14, 16384, v4
    v_add_u32 v16, 32768, v4
    v_add_u32 v18, 49152, v4
    v_add_u32 v20, 65536, v4
    v_add_u32 v22, 81920, v4
    v_add_u32 v24, 98304, v4
    v_add_u32 v4, 4, v7
    v_xor_b32 v4, v4, v2
    v_lshl_add_u32 v4, v4, 4, v3
    v_add_u32 v13, 0, v4
    v_add_u32 v15, 16384, v4
    v_add_u32 v17, 32768, v4
    v_add_u32 v19, 49152, v4
    v_add_u32 v21, 65536, v4
    v_add_u32 v23, 81920, v4
    v_add_u32 v25, 98304, v4
    v_lshrrev_b32 v2, 2, v6
    v_lshl_add_u32 v3, v7, 3, v2
    v_mul_u32_u24 v3, 128, v3
    v_and_b32 v4, 3, v6
    v_lshl_add_u32 v3, v4, 3, v3
    v_bfe_u32 v2, v6, 3, 1
    v_and_b32 v4, 1, v7
    v_lshl_or_b32 v2, v4, 1, v2
    s_and_b32 s44, s51, 1
    s_mul_i32 s45, s44, 2
    s_add_u32 s45, s45, 0
    v_xor_b32 v4, s45, v2
    v_lshl_add_u32 v4, v4, 5, v3
    v_add_u32 v26, 8192, v4
    v_add_u32 v28, 24576, v4
    v_add_u32 v30, 40960, v4
    v_add_u32 v32, 57344, v4
    v_add_u32 v34, 73728, v4
    v_add_u32 v36, 90112, v4
    v_add_u32 v38, 106496, v4
    s_mul_i32 s45, s44, 2
    s_add_u32 s45, s45, 1
    v_xor_b32 v4, s45, v2
    v_lshl_add_u32 v4, v4, 5, v3
    v_add_u32 v27, 8192, v4
    v_add_u32 v29, 24576, v4
    v_add_u32 v31, 40960, v4
    v_add_u32 v33, 57344, v4
    v_add_u32 v35, 73728, v4
    v_add_u32 v37, 90112, v4
    v_add_u32 v39, 106496, v4
    s_waitcnt vmcnt(24)
    s_barrier
    s_add_u32 s55, s52, 768
    s_add_u32 m0, s54, 98304
    s_nop 0
    buffer_load_dwordx4 v10, s[8:11], s55 offen lds
    s_add_u32 s55, s52, 29440
    s_add_u32 m0, s54, 102400
    s_nop 0
    buffer_load_dwordx4 v10, s[8:11], s55 offen lds
    s_add_u32 s55, s53, 344064
    s_add_u32 m0, s54, 106496
    s_nop 0
    buffer_load_dwordx4 v11, s[12:15], s55 offen lds
    s_add_u32 s55, s53, 372736
    s_add_u32 m0, s54, 110592
    s_nop 0
    buffer_load_dwordx4 v11, s[12:15], s55 offen lds
    ds_read_b128 v[40:43], v12 offset:0
    ds_read_b128 v[44:47], v12 offset:2048
    ds_read_b64_tr_b16 v[56:57], v26 offset:0
    ds_read_b64_tr_b16 v[58:59], v26 offset:512
    ds_read_b64_tr_b16 v[60:61], v27 offset:0
    ds_read_b64_tr_b16 v[62:63], v27 offset:512
    ds_read_b128 v[48:51], v13 offset:0
    ds_read_b128 v[52:55], v13 offset:2048
    ds_read_b64_tr_b16 v[64:65], v26 offset:4096
    ds_read_b64_tr_b16 v[66:67], v26 offset:4608
    ds_read_b64_tr_b16 v[68:69], v27 offset:4096
    ds_read_b64_tr_b16 v[70:71], v27 offset:4608
    s_waitcnt lgkmcnt(6)
    v_mfma_f32_16x16x32_bf16 a[0:3], v[56:59], v[40:43], 0
    v_mfma_f32_16x16x32_bf16 a[4:7], v[60:63], v[40:43], 0
    v_mfma_f32_16x16x32_bf16 a[8:11], v[56:59], v[44:47], 0
    v_mfma_f32_16x16x32_bf16 a[12:15], v[60:63], v[44:47], 0
    s_waitcnt lgkmcnt(0)
    v_mfma_f32_16x16x32_bf16 a[0:3], v[64:67], v[48:51], a[0:3]
    v_mfma_f32_16x16x32_bf16 a[4:7], v[68:71], v[48:51], a[4:7]
    v_mfma_f32_16x16x32_bf16 a[8:11], v[64:67], v[52:55], a[8:11]
    v_mfma_f32_16x16x32_bf16 a[12:15], v[68:71], v[52:55], a[12:15]
    s_waitcnt vmcnt(24)
    s_barrier
    ds_read_b128 v[40:43], v14 offset:0
    ds_read_b128 v[44:47], v14 offset:2048
    ds_read_b64_tr_b16 v[56:57], v28 offset:0
    ds_read_b64_tr_b16 v[58:59], v28 offset:512
    ds_read_b64_tr_b16 v[60:61], v29 offset:0
    ds_read_b64_tr_b16 v[62:63], v29 offset:512
    ds_read_b128 v[48:51], v15 offset:0
    ds_read_b128 v[52:55], v15 offset:2048
    ds_read_b64_tr_b16 v[64:65], v28 offset:4096
    ds_read_b64_tr_b16 v[66:67], v28 offset:4608
    ds_read_b64_tr_b16 v[68:69], v29 offset:4096
    ds_read_b64_tr_b16 v[70:71], v29 offset:4608
    s_waitcnt lgkmcnt(6)
    v_mfma_f32_16x16x32_bf16 a[0:3], v[56:59], v[40:43], a[0:3]
    v_mfma_f32_16x16x32_bf16 a[4:7], v[60:63], v[40:43], a[4:7]
    v_mfma_f32_16x16x32_bf16 a[8:11], v[56:59], v[44:47], a[8:11]
    v_mfma_f32_16x16x32_bf16 a[12:15], v[60:63], v[44:47], a[12:15]
    s_waitcnt lgkmcnt(0)
    v_mfma_f32_16x16x32_bf16 a[0:3], v[64:67], v[48:51], a[0:3]
    v_mfma_f32_16x16x32_bf16 a[4:7], v[68:71], v[48:51], a[4:7]
    v_mfma_f32_16x16x32_bf16 a[8:11], v[64:67], v[52:55], a[8:11]
    v_mfma_f32_16x16x32_bf16 a[12:15], v[68:71], v[52:55], a[12:15]
    s_waitcnt vmcnt(20)
    s_barrier
    ds_read_b128 v[40:43], v16 offset:0
    ds_read_b128 v[44:47], v16 offset:2048
    ds_read_b64_tr_b16 v[56:57], v30 offset:0
    ds_read_b64_tr_b16 v[58:59], v30 offset:512
    ds_read_b64_tr_b16 v[60:61], v31 offset:0
    ds_read_b64_tr_b16 v[62:63], v31 offset:512
    ds_read_b128 v[48:51], v17 offset:0
    ds_read_b128 v[52:55], v17 offset:2048
    ds_read_b64_tr_b16 v[64:65], v30 offset:4096
    ds_read_b64_tr_b16 v[66:67], v30 offset:4608
    ds_read_b64_tr_b16 v[68:69], v31 offset:4096
    ds_read_b64_tr_b16 v[70:71], v31 offset:4608
    s_waitcnt lgkmcnt(6)
    v_mfma_f32_16x16x32_bf16 a[0:3], v[56:59], v[40:43], a[0:3]
    v_mfma_f32_16x16x32_bf16 a[4:7], v[60:63], v[40:43], a[4:7]
    v_mfma_f32_16x16x32_bf16 a[8:11], v[56:59], v[44:47], a[8:11]
    v_mfma_f32_16x16x32_bf16 a[12:15], v[60:63], v[44:47], a[12:15]
    s_waitcnt lgkmcnt(0)
    v_mfma_f32_16x16x32_bf16 a[0:3], v[64:67], v[48:51], a[0:3]
    v_mfma_f32_16x16x32_bf16 a[4:7], v[68:71], v[48:51], a[4:7]
    v_mfma_f32_16x16x32_bf16 a[8:11], v[64:67], v[52:55], a[8:11]
    v_mfma_f32_16x16x32_bf16 a[12:15], v[68:71], v[52:55], a[12:15]
    s_waitcnt vmcnt(16)
    s_barrier
    ds_read_b128 v[40:43], v18 offset:0
    ds_read_b128 v[44:47], v18 offset:2048
    ds_read_b64_tr_b16 v[56:57], v32 offset:0
    ds_read_b64_tr_b16 v[58:59], v32 offset:512
    ds_read_b64_tr_b16 v[60:61], v33 offset:0
    ds_read_b64_tr_b16 v[62:63], v33 offset:512
    ds_read_b128 v[48:51], v19 offset:0
    ds_read_b128 v[52:55], v19 offset:2048
    ds_read_b64_tr_b16 v[64:65], v32 offset:4096
    ds_read_b64_tr_b16 v[66:67], v32 offset:4608
    ds_read_b64_tr_b16 v[68:69], v33 offset:4096
    ds_read_b64_tr_b16 v[70:71], v33 offset:4608
    s_waitcnt lgkmcnt(6)
    v_mfma_f32_16x16x32_bf16 a[0:3], v[56:59], v[40:43], a[0:3]
    v_mfma_f32_16x16x32_bf16 a[4:7], v[60:63], v[40:43], a[4:7]
    v_mfma_f32_16x16x32_bf16 a[8:11], v[56:59], v[44:47], a[8:11]
    v_mfma_f32_16x16x32_bf16 a[12:15], v[60:63], v[44:47], a[12:15]
    s_waitcnt lgkmcnt(0)
    v_mfma_f32_16x16x32_bf16 a[0:3], v[64:67], v[48:51], a[0:3]
    v_mfma_f32_16x16x32_bf16 a[4:7], v[68:71], v[48:51], a[4:7]
    v_mfma_f32_16x16x32_bf16 a[8:11], v[64:67], v[52:55], a[8:11]
    v_mfma_f32_16x16x32_bf16 a[12:15], v[68:71], v[52:55], a[12:15]
    s_waitcnt vmcnt(12)
    s_barrier
    ds_read_b128 v[40:43], v20 offset:0
    ds_read_b128 v[44:47], v20 offset:2048
    ds_read_b64_tr_b16 v[56:57], v34 offset:0
    ds_read_b64_tr_b16 v[58:59], v34 offset:512
    ds_read_b64_tr_b16 v[60:61], v35 offset:0
    ds_read_b64_tr_b16 v[62:63], v35 offset:512
    ds_read_b128 v[48:51], v21 offset:0
    ds_read_b128 v[52:55], v21 offset:2048
    ds_read_b64_tr_b16 v[64:65], v34 offset:4096
    ds_read_b64_tr_b16 v[66:67], v34 offset:4608
    ds_read_b64_tr_b16 v[68:69], v35 offset:4096
    ds_read_b64_tr_b16 v[70:71], v35 offset:4608
    s_waitcnt lgkmcnt(6)
    v_mfma_f32_16x16x32_bf16 a[0:3], v[56:59], v[40:43], a[0:3]
    v_mfma_f32_16x16x32_bf16 a[4:7], v[60:63], v[40:43], a[4:7]
    v_mfma_f32_16x16x32_bf16 a[8:11], v[56:59], v[44:47], a[8:11]
    v_mfma_f32_16x16x32_bf16 a[12:15], v[60:63], v[44:47], a[12:15]
    s_waitcnt lgkmcnt(0)
    v_mfma_f32_16x16x32_bf16 a[0:3], v[64:67], v[48:51], a[0:3]
    v_mfma_f32_16x16x32_bf16 a[4:7], v[68:71], v[48:51], a[4:7]
    v_mfma_f32_16x16x32_bf16 a[8:11], v[64:67], v[52:55], a[8:11]
    v_mfma_f32_16x16x32_bf16 a[12:15], v[68:71], v[52:55], a[12:15]
    s_waitcnt vmcnt(8)
    s_barrier
    ds_read_b128 v[40:43], v22 offset:0
    ds_read_b128 v[44:47], v22 offset:2048
    ds_read_b64_tr_b16 v[56:57], v36 offset:0
    ds_read_b64_tr_b16 v[58:59], v36 offset:512
    ds_read_b64_tr_b16 v[60:61], v37 offset:0
    ds_read_b64_tr_b16 v[62:63], v37 offset:512
    ds_read_b128 v[48:51], v23 offset:0
    ds_read_b128 v[52:55], v23 offset:2048
    ds_read_b64_tr_b16 v[64:65], v36 offset:4096
    ds_read_b64_tr_b16 v[66:67], v36 offset:4608
    ds_read_b64_tr_b16 v[68:69], v37 offset:4096
    ds_read_b64_tr_b16 v[70:71], v37 offset:4608
    s_waitcnt lgkmcnt(6)
    v_mfma_f32_16x16x32_bf16 a[0:3], v[56:59], v[40:43], a[0:3]
    v_mfma_f32_16x16x32_bf16 a[4:7], v[60:63], v[40:43], a[4:7]
    v_mfma_f32_16x16x32_bf16 a[8:11], v[56:59], v[44:47], a[8:11]
    v_mfma_f32_16x16x32_bf16 a[12:15], v[60:63], v[44:47], a[12:15]
    s_waitcnt lgkmcnt(0)
    v_mfma_f32_16x16x32_bf16 a[0:3], v[64:67], v[48:51], a[0:3]
    v_mfma_f32_16x16x32_bf16 a[4:7], v[68:71], v[48:51], a[4:7]
    v_mfma_f32_16x16x32_bf16 a[8:11], v[64:67], v[52:55], a[8:11]
    v_mfma_f32_16x16x32_bf16 a[12:15], v[68:71], v[52:55], a[12:15]
    s_waitcnt vmcnt(0)
    s_barrier
    ds_read_b128 v[40:43], v24 offset:0
    ds_read_b128 v[44:47], v24 offset:2048
    ds_read_b64_tr_b16 v[56:57], v38 offset:0
    ds_read_b64_tr_b16 v[58:59], v38 offset:512
    ds_read_b64_tr_b16 v[60:61], v39 offset:0
    ds_read_b64_tr_b16 v[62:63], v39 offset:512
    ds_read_b128 v[48:51], v25 offset:0
    ds_read_b128 v[52:55], v25 offset:2048
    ds_read_b64_tr_b16 v[64:65], v38 offset:4096
    ds_read_b64_tr_b16 v[66:67], v38 offset:4608
    ds_read_b64_tr_b16 v[68:69], v39 offset:4096
    ds_read_b64_tr_b16 v[70:71], v39 offset:4608
    s_waitcnt lgkmcnt(6)
    v_mfma_f32_16x16x32_bf16 a[0:3], v[56:59], v[40:43], a[0:3]
    v_mfma_f32_16x16x32_bf16 a[4:7], v[60:63], v[40:43], a[4:7]
    v_mfma_f32_16x16x32_bf16 a[8:11], v[56:59], v[44:47], a[8:11]
    v_mfma_f32_16x16x32_bf16 a[12:15], v[60:63], v[44:47], a[12:15]
    s_waitcnt lgkmcnt(0)
    v_mfma_f32_16x16x32_bf16 a[0:3], v[64:67], v[48:51], a[0:3]
    v_mfma_f32_16x16x32_bf16 a[4:7], v[68:71], v[48:51], a[4:7]
    v_mfma_f32_16x16x32_bf16 a[8:11], v[64:67], v[52:55], a[8:11]
    v_mfma_f32_16x16x32_bf16 a[12:15], v[68:71], v[52:55], a[12:15]
    s_waitcnt vmcnt(0)
    s_nop 3
    v_accvgpr_read_b32 v40, a0
    v_accvgpr_read_b32 v41, a1
    v_accvgpr_read_b32 v42, a2
    v_accvgpr_read_b32 v43, a3
    v_lshlrev_b32 v48, 16, v72
    v_and_b32 v49, 0xffff0000, v72
    v_lshlrev_b32 v50, 16, v73
    v_and_b32 v51, 0xffff0000, v73
    v_add_f32 v40, v40, v48
    v_add_f32 v41, v41, v49
    v_add_f32 v42, v42, v50
    v_add_f32 v43, v43, v51
    v_cvt_pk_bf16_f32 v48, v40, v41
    v_cvt_pk_bf16_f32 v49, v42, v43
    buffer_store_dwordx2 v[48:49], v83, s[20:23], 0 offen offset:0
    v_accvgpr_read_b32 v40, a4
    v_accvgpr_read_b32 v41, a5
    v_accvgpr_read_b32 v42, a6
    v_accvgpr_read_b32 v43, a7
    v_lshlrev_b32 v48, 16, v74
    v_and_b32 v49, 0xffff0000, v74
    v_lshlrev_b32 v50, 16, v75
    v_and_b32 v51, 0xffff0000, v75
    v_add_f32 v40, v40, v48
    v_add_f32 v41, v41, v49
    v_add_f32 v42, v42, v50
    v_add_f32 v43, v43, v51
    v_cvt_pk_bf16_f32 v48, v40, v41
    v_cvt_pk_bf16_f32 v49, v42, v43
    buffer_store_dwordx2 v[48:49], v83, s[20:23], 0 offen offset:32
    v_accvgpr_read_b32 v40, a8
    v_accvgpr_read_b32 v41, a9
    v_accvgpr_read_b32 v42, a10
    v_accvgpr_read_b32 v43, a11
    v_lshlrev_b32 v48, 16, v76
    v_and_b32 v49, 0xffff0000, v76
    v_lshlrev_b32 v50, 16, v77
    v_and_b32 v51, 0xffff0000, v77
    v_add_f32 v40, v40, v48
    v_add_f32 v41, v41, v49
    v_add_f32 v42, v42, v50
    v_add_f32 v43, v43, v51
    v_cvt_pk_bf16_f32 v48, v40, v41
    v_cvt_pk_bf16_f32 v49, v42, v43
    buffer_store_dwordx2 v[48:49], v84, s[20:23], 0 offen offset:0
    v_accvgpr_read_b32 v40, a12
    v_accvgpr_read_b32 v41, a13
    v_accvgpr_read_b32 v42, a14
    v_accvgpr_read_b32 v43, a15
    v_lshlrev_b32 v48, 16, v78
    v_and_b32 v49, 0xffff0000, v78
    v_lshlrev_b32 v50, 16, v79
    v_and_b32 v51, 0xffff0000, v79
    v_add_f32 v40, v40, v48
    v_add_f32 v41, v41, v49
    v_add_f32 v42, v42, v50
    v_add_f32 v43, v43, v51
    v_cvt_pk_bf16_f32 v48, v40, v41
    v_cvt_pk_bf16_f32 v49, v42, v43
    buffer_store_dwordx2 v[48:49], v84, s[20:23], 0 offen offset:32
L_wo1_kernel_end:
    s_endpgm
.globl ffn2_1_kernel
.p2align 8
.type ffn2_1_kernel,@function
ffn2_1_kernel:
    s_cmp_ge_u32 s2, 224
    s_cbranch_scc1 L_ffn2_1_kernel_end
    s_load_dwordx2 s[4:5], s[0:1], 72
    s_load_dwordx2 s[34:35], s[0:1], 48
    s_load_dwordx2 s[38:39], s[0:1], 56
    s_lshr_b32 s45, s2, 3
    s_mov_b32 s44, 0x24924925
    s_mul_hi_u32 s28, s45, s44
    s_mul_i32 s44, s28, 7
    s_sub_u32 s29, s45, s44
    s_and_b32 s44, s2, 7
    s_mul_i32 s44, s44, 4
    s_add_u32 s28, s28, s44
    s_mov_b32 s50, 0x3f803f80
    v_lshrrev_b32 v2, 6, v0
    s_nop 0
    v_readfirstlane_b32 s51, v2
    v_and_b32 v9, 63, v0
    s_and_b32 s44, s51, 1
    s_lshl_b32 s44, s44, 2
    v_lshrrev_b32 v2, 4, v9
    v_add_u32 v2, s44, v2
    v_and_b32 v2, 7, v2
    v_and_b32 v3, 7, v9
    v_xor_b32 v2, v2, v3
    v_lshrrev_b32 v3, 3, v9
    v_mul_u32_u24 v3, 3584, v3
    v_lshl_add_u32 v10, v2, 4, v3
    s_and_b32 s44, s51, 1
    s_lshl_b32 s44, s44, 1
    v_lshrrev_b32 v2, 3, v9
    v_bfe_u32 v3, v9, 4, 1
    v_or_b32 v3, s44, v3
    v_bfe_u32 v4, v9, 1, 2
    v_xor_b32 v3, v3, v4
    v_and_b32 v4, 1, v9
    v_lshl_add_u32 v3, v3, 1, v4
    v_mul_u32_u24 v2, 896, v2
    v_lshl_add_u32 v2, v3, 4, v2
    v_mov_b32 v11, v2
    s_waitcnt lgkmcnt(0)
    s_add_u32 s8, s4, 0xc00000
    s_addc_u32 s9, s5, 0
    s_mov_b32 s10, 0x700000
    s_mov_b32 s11, 0x00020000
    s_mov_b32 s12, s34
    s_mov_b32 s13, s35
    s_mov_b32 s14, 0x188000
    s_mov_b32 s15, 0x00020000
    s_mul_i32 s52, s28, 229376
    s_mul_i32 s44, s51, 28672
    s_add_u32 s52, s52, s44
    s_mul_i32 s53, s29, 128
    s_mul_i32 s44, s51, 7168
    s_add_u32 s53, s53, s44
    s_lshl_b32 s54, s51, 10
    s_add_u32 s55, s52, 0
    s_add_u32 m0, s54, 0
    s_nop 0
    buffer_load_dwordx4 v10, s[8:11], s55 offen lds
    s_add_u32 s55, s52, 114688
    s_add_u32 m0, s54, 4096
    s_nop 0
    buffer_load_dwordx4 v10, s[8:11], s55 offen lds
    s_add_u32 s55, s53, 0
    s_add_u32 m0, s54, 8192
    s_nop 0
    buffer_load_dwordx4 v11, s[12:15], s55 offen lds
    s_add_u32 s55, s53, 28672
    s_add_u32 m0, s54, 12288
    s_nop 0
    buffer_load_dwordx4 v11, s[12:15], s55 offen lds
    s_add_u32 s55, s52, 128
    s_add_u32 m0, s54, 16384
    s_nop 0
    buffer_load_dwordx4 v10, s[8:11], s55 offen lds
    s_add_u32 s55, s52, 114816
    s_add_u32 m0, s54, 20480
    s_nop 0
    buffer_load_dwordx4 v10, s[8:11], s55 offen lds
    s_add_u32 s55, s53, 57344
    s_add_u32 m0, s54, 24576
    s_nop 0
    buffer_load_dwordx4 v11, s[12:15], s55 offen lds
    s_add_u32 s55, s53, 86016
    s_add_u32 m0, s54, 28672
    s_nop 0
    buffer_load_dwordx4 v11, s[12:15], s55 offen lds
    s_add_u32 s55, s52, 256
    s_add_u32 m0, s54, 32768
    s_nop 0
    buffer_load_dwordx4 v10, s[8:11], s55 offen lds
    s_add_u32 s55, s52, 114944
    s_add_u32 m0, s54, 36864
    s_nop 0
    buffer_load_dwordx4 v10, s[8:11], s55 offen lds
    s_add_u32 s55, s53, 114688
    s_add_u32 m0, s54, 40960
    s_nop 0
    buffer_load_dwordx4 v11, s[12:15], s55 offen lds
    s_add_u32 s55, s53, 143360
    s_add_u32 m0, s54, 45056
    s_nop 0
    buffer_load_dwordx4 v11, s[12:15], s55 offen lds
    s_add_u32 s55, s52, 384
    s_add_u32 m0, s54, 49152
    s_nop 0
    buffer_load_dwordx4 v10, s[8:11], s55 offen lds
    s_add_u32 s55, s52, 115072
    s_add_u32 m0, s54, 53248
    s_nop 0
    buffer_load_dwordx4 v10, s[8:11], s55 offen lds
    s_add_u32 s55, s53, 172032
    s_add_u32 m0, s54, 57344
    s_nop 0
    buffer_load_dwordx4 v11, s[12:15], s55 offen lds
    s_add_u32 s55, s53, 200704
    s_add_u32 m0, s54, 61440
    s_nop 0
    buffer_load_dwordx4 v11, s[12:15], s55 offen lds
    s_add_u32 s55, s52, 512
    s_add_u32 m0, s54, 65536
    s_nop 0
    buffer_load_dwordx4 v10, s[8:11], s55 offen lds
    s_add_u32 s55, s52, 115200
    s_add_u32 m0, s54, 69632
    s_nop 0
    buffer_load_dwordx4 v10, s[8:11], s55 offen lds
    s_add_u32 s55, s53, 229376
    s_add_u32 m0, s54, 73728
    s_nop 0
    buffer_load_dwordx4 v11, s[12:15], s55 offen lds
    s_add_u32 s55, s53, 258048
    s_add_u32 m0, s54, 77824
    s_nop 0
    buffer_load_dwordx4 v11, s[12:15], s55 offen lds
    s_add_u32 s55, s52, 640
    s_add_u32 m0, s54, 81920
    s_nop 0
    buffer_load_dwordx4 v10, s[8:11], s55 offen lds
    s_add_u32 s55, s52, 115328
    s_add_u32 m0, s54, 86016
    s_nop 0
    buffer_load_dwordx4 v10, s[8:11], s55 offen lds
    s_add_u32 s55, s53, 286720
    s_add_u32 m0, s54, 90112
    s_nop 0
    buffer_load_dwordx4 v11, s[12:15], s55 offen lds
    s_add_u32 s55, s53, 315392
    s_add_u32 m0, s54, 94208
    s_nop 0
    buffer_load_dwordx4 v11, s[12:15], s55 offen lds
    s_add_u32 s55, s52, 768
    s_add_u32 m0, s54, 98304
    s_nop 0
    buffer_load_dwordx4 v10, s[8:11], s55 offen lds
    s_add_u32 s55, s52, 115456
    s_add_u32 m0, s54, 102400
    s_nop 0
    buffer_load_dwordx4 v10, s[8:11], s55 offen lds
    s_add_u32 s55, s53, 344064
    s_add_u32 m0, s54, 106496
    s_nop 0
    buffer_load_dwordx4 v11, s[12:15], s55 offen lds
    s_add_u32 s55, s53, 372736
    s_add_u32 m0, s54, 110592
    s_nop 0
    buffer_load_dwordx4 v11, s[12:15], s55 offen lds
    s_mov_b32 s20, s38
    s_mov_b32 s21, s39
    s_mov_b32 s22, 0x1c0000
    s_mov_b32 s23, 0x00020000
    s_mov_b32 s24, s4
    s_mov_b32 s25, s5
    s_mov_b32 s26, 0x1c0000
    s_mov_b32 s27, 0x00020000
    v_and_b32 v6, 15, v0
    v_bfe_u32 v7, v0, 4, 2
    s_lshr_b32 s44, s51, 1
    s_mul_i32 s44, s44, 32
    s_mul_i32 s45, s28, 64
    s_add_u32 s44, s44, s45
    v_add_u32 v84, s44, v6
    s_and_b32 s44, s51, 1
    s_mul_i32 s44, s44, 32
    s_mul_i32 s45, s29, 64
    s_add_u32 s44, s44, s45
    v_lshlrev_b32 v85, 2, v7
    v_add_u32 v85, s44, v85
    v_mul_u32_u24 v86, 896, v84
    v_lshl_add_u32 v86, v85, 1, v86
    v_add_u32 v87, 0, v86
    v_add_u32 v88, 14336, v86
    buffer_load_dwordx2 v[76:77], v87, s[24:27], 0 offen offset:0
    buffer_load_dwordx2 v[78:79], v87, s[24:27], 0 offen offset:32
    buffer_load_dwordx2 v[80:81], v88, s[24:27], 0 offen offset:0
    buffer_load_dwordx2 v[82:83], v88, s[24:27], 0 offen offset:32
    s_lshr_b32 s44, s51, 1
    s_mul_i32 s44, s44, 4096
    v_bfe_u32 v2, v6, 1, 3
    v_mul_u32_u24 v3, 128, v6
    v_add_u32 v3, s44, v3
    v_add_u32 v4, 0, v7
    v_xor_b32 v4, v4, v2
    v_lshl_add_u32 v4, v4, 4, v3
    v_add_u32 v12, 0, v4
    v_add_u32 v14, 16384, v4
    v_add_u32 v16, 32768, v4
    v_add_u32 v18, 49152, v4
    v_add_u32 v20, 65536, v4
    v_add_u32 v22, 81920, v4
    v_add_u32 v24, 98304, v4
    v_add_u32 v26, 114688, v4
    v_add_u32 v4, 4, v7
    v_xor_b32 v4, v4, v2
    v_lshl_add_u32 v4, v4, 4, v3
    v_add_u32 v13, 0, v4
    v_add_u32 v15, 16384, v4
    v_add_u32 v17, 32768, v4
    v_add_u32 v19, 49152, v4
    v_add_u32 v21, 65536, v4
    v_add_u32 v23, 81920, v4
    v_add_u32 v25, 98304, v4
    v_add_u32 v27, 114688, v4
    v_lshrrev_b32 v2, 2, v6
    v_lshl_add_u32 v3, v7, 3, v2
    v_mul_u32_u24 v3, 128, v3
    v_and_b32 v4, 3, v6
    v_lshl_add_u32 v3, v4, 3, v3
    v_bfe_u32 v2, v6, 3, 1
    v_and_b32 v4, 1, v7
    v_lshl_or_b32 v2, v4, 1, v2
    s_and_b32 s44, s51, 1
    s_mul_i32 s45, s44, 2
    s_add_u32 s45, s45, 0
    v_xor_b32 v4, s45, v2
    v_lshl_add_u32 v4, v4, 5, v3
    v_add_u32 v28, 8192, v4
    v_add_u32 v30, 24576, v4
    v_add_u32 v32, 40960, v4
    v_add_u32 v34, 57344, v4
    v_add_u32 v36, 73728, v4
    v_add_u32 v38, 90112, v4
    v_add_u32 v40, 106496, v4
    v_add_u32 v42, 122880, v4
    s_mul_i32 s45, s44, 2
    s_add_u32 s45, s45, 1
    v_xor_b32 v4, s45, v2
    v_lshl_add_u32 v4, v4, 5, v3
    v_add_u32 v29, 8192, v4
    v_add_u32 v31, 24576, v4
    v_add_u32 v33, 40960, v4
    v_add_u32 v35, 57344, v4
    v_add_u32 v37, 73728, v4
    v_add_u32 v39, 90112, v4
    v_add_u32 v41, 106496, v4
    v_add_u32 v43, 122880, v4
    s_waitcnt vmcnt(28)
    s_barrier
    s_add_u32 s55, s52, 896
    s_add_u32 m0, s54, 114688
    s_nop 0
    buffer_load_dwordx4 v10, s[8:11], s55 offen lds
    s_add_u32 s55, s52, 115584
    s_add_u32 m0, s54, 118784
    s_nop 0
    buffer_load_dwordx4 v10, s[8:11], s55 offen lds
    s_add_u32 s55, s53, 401408
    s_add_u32 m0, s54, 122880
    s_nop 0
    buffer_load_dwordx4 v11, s[12:15], s55 offen lds
    s_add_u32 s55, s53, 430080
    s_add_u32 m0, s54, 126976
    s_nop 0
    buffer_load_dwordx4 v11, s[12:15], s55 offen lds
    ds_read_b128 v[44:47], v12 offset:0
    ds_read_b128 v[48:51], v12 offset:2048
    ds_read_b64_tr_b16 v[60:61], v28 offset:0
    ds_read_b64_tr_b16 v[62:63], v28 offset:512
    ds_read_b64_tr_b16 v[64:65], v29 offset:0
    ds_read_b64_tr_b16 v[66:67], v29 offset:512
    ds_read_b128 v[52:55], v13 offset:0
    ds_read_b128 v[56:59], v13 offset:2048
    ds_read_b64_tr_b16 v[68:69], v28 offset:4096
    ds_read_b64_tr_b16 v[70:71], v28 offset:4608
    ds_read_b64_tr_b16 v[72:73], v29 offset:4096
    ds_read_b64_tr_b16 v[74:75], v29 offset:4608
    s_waitcnt lgkmcnt(6)
    v_mfma_f32_16x16x32_bf16 a[0:3], v[60:63], v[44:47], 0
    v_mfma_f32_16x16x32_bf16 a[4:7], v[64:67], v[44:47], 0
    v_mfma_f32_16x16x32_bf16 a[8:11], v[60:63], v[48:51], 0
    v_mfma_f32_16x16x32_bf16 a[12:15], v[64:67], v[48:51], 0
    s_waitcnt lgkmcnt(0)
    v_mfma_f32_16x16x32_bf16 a[0:3], v[68:71], v[52:55], a[0:3]
    v_mfma_f32_16x16x32_bf16 a[4:7], v[72:75], v[52:55], a[4:7]
    v_mfma_f32_16x16x32_bf16 a[8:11], v[68:71], v[56:59], a[8:11]
    v_mfma_f32_16x16x32_bf16 a[12:15], v[72:75], v[56:59], a[12:15]
    s_waitcnt vmcnt(28)
    s_barrier
    s_add_u32 s55, s52, 1024
    s_add_u32 m0, s54, 0
    s_nop 0
    buffer_load_dwordx4 v10, s[8:11], s55 offen lds
    s_add_u32 s55, s52, 115712
    s_add_u32 m0, s54, 4096
    s_nop 0
    buffer_load_dwordx4 v10, s[8:11], s55 offen lds
    s_add_u32 s55, s53, 458752
    s_add_u32 m0, s54, 8192
    s_nop 0
    buffer_load_dwordx4 v11, s[12:15], s55 offen lds
    s_add_u32 s55, s53, 487424
    s_add_u32 m0, s54, 12288
    s_nop 0
    buffer_load_dwordx4 v11, s[12:15], s55 offen lds
    ds_read_b128 v[44:47], v14 offset:0
    ds_read_b128 v[48:51], v14 offset:2048
    ds_read_b64_tr_b16 v[60:61], v30 offset:0
    ds_read_b64_tr_b16 v[62:63], v30 offset:512
    ds_read_b64_tr_b16 v[64:65], v31 offset:0
    ds_read_b64_tr_b16 v[66:67], v31 offset:512
    ds_read_b128 v[52:55], v15 offset:0
    ds_read_b128 v[56:59], v15 offset:2048
    ds_read_b64_tr_b16 v[68:69], v30 offset:4096
    ds_read_b64_tr_b16 v[70:71], v30 offset:4608
    ds_read_b64_tr_b16 v[72:73], v31 offset:4096
    ds_read_b64_tr_b16 v[74:75], v31 offset:4608
    s_waitcnt lgkmcnt(6)
    v_mfma_f32_16x16x32_bf16 a[0:3], v[60:63], v[44:47], a[0:3]
    v_mfma_f32_16x16x32_bf16 a[4:7], v[64:67], v[44:47], a[4:7]
    v_mfma_f32_16x16x32_bf16 a[8:11], v[60:63], v[48:51], a[8:11]
    v_mfma_f32_16x16x32_bf16 a[12:15], v[64:67], v[48:51], a[12:15]
    s_waitcnt lgkmcnt(0)
    v_mfma_f32_16x16x32_bf16 a[0:3], v[68:71], v[52:55], a[0:3]
    v_mfma_f32_16x16x32_bf16 a[4:7], v[72:75], v[52:55], a[4:7]
    v_mfma_f32_16x16x32_bf16 a[8:11], v[68:71], v[56:59], a[8:11]
    v_mfma_f32_16x16x32_bf16 a[12:15], v[72:75], v[56:59], a[12:15]
    s_waitcnt vmcnt(28)
    s_barrier
    s_add_u32 s55, s52, 1152
    s_add_u32 m0, s54, 16384
    s_nop 0
    buffer_load_dwordx4 v10, s[8:11], s55 offen lds
    s_add_u32 s55, s52, 115840
    s_add_u32 m0, s54, 20480
    s_nop 0
    buffer_load_dwordx4 v10, s[8:11], s55 offen lds
    s_add_u32 s55, s53, 516096
    s_add_u32 m0, s54, 24576
    s_nop 0
    buffer_load_dwordx4 v11, s[12:15], s55 offen lds
    s_add_u32 s55, s53, 544768
    s_add_u32 m0, s54, 28672
    s_nop 0
    buffer_load_dwordx4 v11, s[12:15], s55 offen lds
    ds_read_b128 v[44:47], v16 offset:0
    ds_read_b128 v[48:51], v16 offset:2048
    ds_read_b64_tr_b16 v[60:61], v32 offset:0
    ds_read_b64_tr_b16 v[62:63], v32 offset:512
    ds_read_b64_tr_b16 v[64:65], v33 offset:0
    ds_read_b64_tr_b16 v[66:67], v33 offset:512
    ds_read_b128 v[52:55], v17 offset:0
    ds_read_b128 v[56:59], v17 offset:2048
    ds_read_b64_tr_b16 v[68:69], v32 offset:4096
    ds_read_b64_tr_b16 v[70:71], v32 offset:4608
    ds_read_b64_tr_b16 v[72:73], v33 offset:4096
    ds_read_b64_tr_b16 v[74:75], v33 offset:4608
    s_waitcnt lgkmcnt(6)
    v_mfma_f32_16x16x32_bf16 a[0:3], v[60:63], v[44:47], a[0:3]
    v_mfma_f32_16x16x32_bf16 a[4:7], v[64:67], v[44:47], a[4:7]
    v_mfma_f32_16x16x32_bf16 a[8:11], v[60:63], v[48:51], a[8:11]
    v_mfma_f32_16x16x32_bf16 a[12:15], v[64:67], v[48:51], a[12:15]
    s_waitcnt lgkmcnt(0)
    v_mfma_f32_16x16x32_bf16 a[0:3], v[68:71], v[52:55], a[0:3]
    v_mfma_f32_16x16x32_bf16 a[4:7], v[72:75], v[52:55], a[4:7]
    v_mfma_f32_16x16x32_bf16 a[8:11], v[68:71], v[56:59], a[8:11]
    v_mfma_f32_16x16x32_bf16 a[12:15], v[72:75], v[56:59], a[12:15]
    s_waitcnt vmcnt(28)
    s_barrier
    s_add_u32 s55, s52, 1280
    s_add_u32 m0, s54, 32768
    s_nop 0
    buffer_load_dwordx4 v10, s[8:11], s55 offen lds
    s_add_u32 s55, s52, 115968
    s_add_u32 m0, s54, 36864
    s_nop 0
    buffer_load_dwordx4 v10, s[8:11], s55 offen lds
    s_add_u32 s55, s53, 573440
    s_add_u32 m0, s54, 40960
    s_nop 0
    buffer_load_dwordx4 v11, s[12:15], s55 offen lds
    s_add_u32 s55, s53, 602112
    s_add_u32 m0, s54, 45056
    s_nop 0
    buffer_load_dwordx4 v11, s[12:15], s55 offen lds
    ds_read_b128 v[44:47], v18 offset:0
    ds_read_b128 v[48:51], v18 offset:2048
    ds_read_b64_tr_b16 v[60:61], v34 offset:0
    ds_read_b64_tr_b16 v[62:63], v34 offset:512
    ds_read_b64_tr_b16 v[64:65], v35 offset:0
    ds_read_b64_tr_b16 v[66:67], v35 offset:512
    ds_read_b128 v[52:55], v19 offset:0
    ds_read_b128 v[56:59], v19 offset:2048
    ds_read_b64_tr_b16 v[68:69], v34 offset:4096
    ds_read_b64_tr_b16 v[70:71], v34 offset:4608
    ds_read_b64_tr_b16 v[72:73], v35 offset:4096
    ds_read_b64_tr_b16 v[74:75], v35 offset:4608
    s_waitcnt lgkmcnt(6)
    v_mfma_f32_16x16x32_bf16 a[0:3], v[60:63], v[44:47], a[0:3]
    v_mfma_f32_16x16x32_bf16 a[4:7], v[64:67], v[44:47], a[4:7]
    v_mfma_f32_16x16x32_bf16 a[8:11], v[60:63], v[48:51], a[8:11]
    v_mfma_f32_16x16x32_bf16 a[12:15], v[64:67], v[48:51], a[12:15]
    s_waitcnt lgkmcnt(0)
    v_mfma_f32_16x16x32_bf16 a[0:3], v[68:71], v[52:55], a[0:3]
    v_mfma_f32_16x16x32_bf16 a[4:7], v[72:75], v[52:55], a[4:7]
    v_mfma_f32_16x16x32_bf16 a[8:11], v[68:71], v[56:59], a[8:11]
    v_mfma_f32_16x16x32_bf16 a[12:15], v[72:75], v[56:59], a[12:15]
    s_waitcnt vmcnt(28)
    s_barrier
    s_add_u32 s55, s52, 1408
    s_add_u32 m0, s54, 49152
    s_nop 0
    buffer_load_dwordx4 v10, s[8:11], s55 offen lds
    s_add_u32 s55, s52, 116096
    s_add_u32 m0, s54, 53248
    s_nop 0
    buffer_load_dwordx4 v10, s[8:11], s55 offen lds
    s_add_u32 s55, s53, 630784
    s_add_u32 m0, s54, 57344
    s_nop 0
    buffer_load_dwordx4 v11, s[12:15], s55 offen lds
    s_add_u32 s55, s53, 659456
    s_add_u32 m0, s54, 61440
    s_nop 0
    buffer_load_dwordx4 v11, s[12:15], s55 offen lds
    ds_read_b128 v[44:47], v20 offset:0
    ds_read_b128 v[48:51], v20 offset:2048
    ds_read_b64_tr_b16 v[60:61], v36 offset:0
    ds_read_b64_tr_b16 v[62:63], v36 offset:512
    ds_read_b64_tr_b16 v[64:65], v37 offset:0
    ds_read_b64_tr_b16 v[66:67], v37 offset:512
    ds_read_b128 v[52:55], v21 offset:0
    ds_read_b128 v[56:59], v21 offset:2048
    ds_read_b64_tr_b16 v[68:69], v36 offset:4096
    ds_read_b64_tr_b16 v[70:71], v36 offset:4608
    ds_read_b64_tr_b16 v[72:73], v37 offset:4096
    ds_read_b64_tr_b16 v[74:75], v37 offset:4608
    s_waitcnt lgkmcnt(6)
    v_mfma_f32_16x16x32_bf16 a[0:3], v[60:63], v[44:47], a[0:3]
    v_mfma_f32_16x16x32_bf16 a[4:7], v[64:67], v[44:47], a[4:7]
    v_mfma_f32_16x16x32_bf16 a[8:11], v[60:63], v[48:51], a[8:11]
    v_mfma_f32_16x16x32_bf16 a[12:15], v[64:67], v[48:51], a[12:15]
    s_waitcnt lgkmcnt(0)
    v_mfma_f32_16x16x32_bf16 a[0:3], v[68:71], v[52:55], a[0:3]
    v_mfma_f32_16x16x32_bf16 a[4:7], v[72:75], v[52:55], a[4:7]
    v_mfma_f32_16x16x32_bf16 a[8:11], v[68:71], v[56:59], a[8:11]
    v_mfma_f32_16x16x32_bf16 a[12:15], v[72:75], v[56:59], a[12:15]
    s_waitcnt vmcnt(28)
    s_barrier
    s_add_u32 s55, s52, 1536
    s_add_u32 m0, s54, 65536
    s_nop 0
    buffer_load_dwordx4 v10, s[8:11], s55 offen lds
    s_add_u32 s55, s52, 116224
    s_add_u32 m0, s54, 69632
    s_nop 0
    buffer_load_dwordx4 v10, s[8:11], s55 offen lds
    s_add_u32 s55, s53, 688128
    s_add_u32 m0, s54, 73728
    s_nop 0
    buffer_load_dwordx4 v11, s[12:15], s55 offen lds
    s_add_u32 s55, s53, 716800
    s_add_u32 m0, s54, 77824
    s_nop 0
    buffer_load_dwordx4 v11, s[12:15], s55 offen lds
    ds_read_b128 v[44:47], v22 offset:0
    ds_read_b128 v[48:51], v22 offset:2048
    ds_read_b64_tr_b16 v[60:61], v38 offset:0
    ds_read_b64_tr_b16 v[62:63], v38 offset:512
    ds_read_b64_tr_b16 v[64:65], v39 offset:0
    ds_read_b64_tr_b16 v[66:67], v39 offset:512
    ds_read_b128 v[52:55], v23 offset:0
    ds_read_b128 v[56:59], v23 offset:2048
    ds_read_b64_tr_b16 v[68:69], v38 offset:4096
    ds_read_b64_tr_b16 v[70:71], v38 offset:4608
    ds_read_b64_tr_b16 v[72:73], v39 offset:4096
    ds_read_b64_tr_b16 v[74:75], v39 offset:4608
    s_waitcnt lgkmcnt(6)
    v_mfma_f32_16x16x32_bf16 a[0:3], v[60:63], v[44:47], a[0:3]
    v_mfma_f32_16x16x32_bf16 a[4:7], v[64:67], v[44:47], a[4:7]
    v_mfma_f32_16x16x32_bf16 a[8:11], v[60:63], v[48:51], a[8:11]
    v_mfma_f32_16x16x32_bf16 a[12:15], v[64:67], v[48:51], a[12:15]
    s_waitcnt lgkmcnt(0)
    v_mfma_f32_16x16x32_bf16 a[0:3], v[68:71], v[52:55], a[0:3]
    v_mfma_f32_16x16x32_bf16 a[4:7], v[72:75], v[52:55], a[4:7]
    v_mfma_f32_16x16x32_bf16 a[8:11], v[68:71], v[56:59], a[8:11]
    v_mfma_f32_16x16x32_bf16 a[12:15], v[72:75], v[56:59], a[12:15]
    s_waitcnt vmcnt(28)
    s_barrier
    s_add_u32 s55, s52, 1664
    s_add_u32 m0, s54, 81920
    s_nop 0
    buffer_load_dwordx4 v10, s[8:11], s55 offen lds
    s_add_u32 s55, s52, 116352
    s_add_u32 m0, s54, 86016
    s_nop 0
    buffer_load_dwordx4 v10, s[8:11], s55 offen lds
    s_add_u32 s55, s53, 745472
    s_add_u32 m0, s54, 90112
    s_nop 0
    buffer_load_dwordx4 v11, s[12:15], s55 offen lds
    s_add_u32 s55, s53, 774144
    s_add_u32 m0, s54, 94208
    s_nop 0
    buffer_load_dwordx4 v11, s[12:15], s55 offen lds
    ds_read_b128 v[44:47], v24 offset:0
    ds_read_b128 v[48:51], v24 offset:2048
    ds_read_b64_tr_b16 v[60:61], v40 offset:0
    ds_read_b64_tr_b16 v[62:63], v40 offset:512
    ds_read_b64_tr_b16 v[64:65], v41 offset:0
    ds_read_b64_tr_b16 v[66:67], v41 offset:512
    ds_read_b128 v[52:55], v25 offset:0
    ds_read_b128 v[56:59], v25 offset:2048
    ds_read_b64_tr_b16 v[68:69], v40 offset:4096
    ds_read_b64_tr_b16 v[70:71], v40 offset:4608
    ds_read_b64_tr_b16 v[72:73], v41 offset:4096
    ds_read_b64_tr_b16 v[74:75], v41 offset:4608
    s_waitcnt lgkmcnt(6)
    v_mfma_f32_16x16x32_bf16 a[0:3], v[60:63], v[44:47], a[0:3]
    v_mfma_f32_16x16x32_bf16 a[4:7], v[64:67], v[44:47], a[4:7]
    v_mfma_f32_16x16x32_bf16 a[8:11], v[60:63], v[48:51], a[8:11]
    v_mfma_f32_16x16x32_bf16 a[12:15], v[64:67], v[48:51], a[12:15]
    s_waitcnt lgkmcnt(0)
    v_mfma_f32_16x16x32_bf16 a[0:3], v[68:71], v[52:55], a[0:3]
    v_mfma_f32_16x16x32_bf16 a[4:7], v[72:75], v[52:55], a[4:7]
    v_mfma_f32_16x16x32_bf16 a[8:11], v[68:71], v[56:59], a[8:11]
    v_mfma_f32_16x16x32_bf16 a[12:15], v[72:75], v[56:59], a[12:15]
    s_waitcnt vmcnt(24)
    s_barrier
    s_add_u32 s55, s52, 1792
    s_add_u32 m0, s54, 98304
    s_nop 0
    buffer_load_dwordx4 v10, s[8:11], s55 offen lds
    s_add_u32 s55, s52, 116480
    s_add_u32 m0, s54, 102400
    s_nop 0
    buffer_load_dwordx4 v10, s[8:11], s55 offen lds
    s_add_u32 s55, s53, 802816
    s_add_u32 m0, s54, 106496
    s_nop 0
    buffer_load_dwordx4 v11, s[12:15], s55 offen lds
    s_add_u32 s55, s53, 831488
    s_add_u32 m0, s54, 110592
    s_nop 0
    buffer_load_dwordx4 v11, s[12:15], s55 offen lds
    ds_read_b128 v[44:47], v26 offset:0
    ds_read_b128 v[48:51], v26 offset:2048
    ds_read_b64_tr_b16 v[60:61], v42 offset:0
    ds_read_b64_tr_b16 v[62:63], v42 offset:512
    ds_read_b64_tr_b16 v[64:65], v43 offset:0
    ds_read_b64_tr_b16 v[66:67], v43 offset:512
    ds_read_b128 v[52:55], v27 offset:0
    ds_read_b128 v[56:59], v27 offset:2048
    ds_read_b64_tr_b16 v[68:69], v42 offset:4096
    ds_read_b64_tr_b16 v[70:71], v42 offset:4608
    ds_read_b64_tr_b16 v[72:73], v43 offset:4096
    ds_read_b64_tr_b16 v[74:75], v43 offset:4608
    s_waitcnt lgkmcnt(6)
    v_mfma_f32_16x16x32_bf16 a[0:3], v[60:63], v[44:47], a[0:3]
    v_mfma_f32_16x16x32_bf16 a[4:7], v[64:67], v[44:47], a[4:7]
    v_mfma_f32_16x16x32_bf16 a[8:11], v[60:63], v[48:51], a[8:11]
    v_mfma_f32_16x16x32_bf16 a[12:15], v[64:67], v[48:51], a[12:15]
    s_waitcnt lgkmcnt(0)
    v_mfma_f32_16x16x32_bf16 a[0:3], v[68:71], v[52:55], a[0:3]
    v_mfma_f32_16x16x32_bf16 a[4:7], v[72:75], v[52:55], a[4:7]
    v_mfma_f32_16x16x32_bf16 a[8:11], v[68:71], v[56:59], a[8:11]
    v_mfma_f32_16x16x32_bf16 a[12:15], v[72:75], v[56:59], a[12:15]
    s_waitcnt vmcnt(24)
    s_barrier
    s_add_u32 s55, s52, 1920
    s_add_u32 m0, s54, 114688
    s_nop 0
    buffer_load_dwordx4 v10, s[8:11], s55 offen lds
    s_add_u32 s55, s52, 116608
    s_add_u32 m0, s54, 118784
    s_nop 0
    buffer_load_dwordx4 v10, s[8:11], s55 offen lds
    s_add_u32 s55, s53, 860160
    s_add_u32 m0, s54, 122880
    s_nop 0
    buffer_load_dwordx4 v11, s[12:15], s55 offen lds
    s_add_u32 s55, s53, 888832
    s_add_u32 m0, s54, 126976
    s_nop 0
    buffer_load_dwordx4 v11, s[12:15], s55 offen lds
    ds_read_b128 v[44:47], v12 offset:0
    ds_read_b128 v[48:51], v12 offset:2048
    ds_read_b64_tr_b16 v[60:61], v28 offset:0
    ds_read_b64_tr_b16 v[62:63], v28 offset:512
    ds_read_b64_tr_b16 v[64:65], v29 offset:0
    ds_read_b64_tr_b16 v[66:67], v29 offset:512
    ds_read_b128 v[52:55], v13 offset:0
    ds_read_b128 v[56:59], v13 offset:2048
    ds_read_b64_tr_b16 v[68:69], v28 offset:4096
    ds_read_b64_tr_b16 v[70:71], v28 offset:4608
    ds_read_b64_tr_b16 v[72:73], v29 offset:4096
    ds_read_b64_tr_b16 v[74:75], v29 offset:4608
    s_waitcnt lgkmcnt(6)
    v_mfma_f32_16x16x32_bf16 a[0:3], v[60:63], v[44:47], a[0:3]
    v_mfma_f32_16x16x32_bf16 a[4:7], v[64:67], v[44:47], a[4:7]
    v_mfma_f32_16x16x32_bf16 a[8:11], v[60:63], v[48:51], a[8:11]
    v_mfma_f32_16x16x32_bf16 a[12:15], v[64:67], v[48:51], a[12:15]
    s_waitcnt lgkmcnt(0)
    v_mfma_f32_16x16x32_bf16 a[0:3], v[68:71], v[52:55], a[0:3]
    v_mfma_f32_16x16x32_bf16 a[4:7], v[72:75], v[52:55], a[4:7]
    v_mfma_f32_16x16x32_bf16 a[8:11], v[68:71], v[56:59], a[8:11]
    v_mfma_f32_16x16x32_bf16 a[12:15], v[72:75], v[56:59], a[12:15]
    s_waitcnt vmcnt(24)
    s_barrier
    s_add_u32 s55, s52, 2048
    s_add_u32 m0, s54, 0
    s_nop 0
    buffer_load_dwordx4 v10, s[8:11], s55 offen lds
    s_add_u32 s55, s52, 116736
    s_add_u32 m0, s54, 4096
    s_nop 0
    buffer_load_dwordx4 v10, s[8:11], s55 offen lds
    s_add_u32 s55, s53, 917504
    s_add_u32 m0, s54, 8192
    s_nop 0
    buffer_load_dwordx4 v11, s[12:15], s55 offen lds
    s_add_u32 s55, s53, 946176
    s_add_u32 m0, s54, 12288
    s_nop 0
    buffer_load_dwordx4 v11, s[12:15], s55 offen lds
    ds_read_b128 v[44:47], v14 offset:0
    ds_read_b128 v[48:51], v14 offset:2048
    ds_read_b64_tr_b16 v[60:61], v30 offset:0
    ds_read_b64_tr_b16 v[62:63], v30 offset:512
    ds_read_b64_tr_b16 v[64:65], v31 offset:0
    ds_read_b64_tr_b16 v[66:67], v31 offset:512
    ds_read_b128 v[52:55], v15 offset:0
    ds_read_b128 v[56:59], v15 offset:2048
    ds_read_b64_tr_b16 v[68:69], v30 offset:4096
    ds_read_b64_tr_b16 v[70:71], v30 offset:4608
    ds_read_b64_tr_b16 v[72:73], v31 offset:4096
    ds_read_b64_tr_b16 v[74:75], v31 offset:4608
    s_waitcnt lgkmcnt(6)
    v_mfma_f32_16x16x32_bf16 a[0:3], v[60:63], v[44:47], a[0:3]
    v_mfma_f32_16x16x32_bf16 a[4:7], v[64:67], v[44:47], a[4:7]
    v_mfma_f32_16x16x32_bf16 a[8:11], v[60:63], v[48:51], a[8:11]
    v_mfma_f32_16x16x32_bf16 a[12:15], v[64:67], v[48:51], a[12:15]
    s_waitcnt lgkmcnt(0)
    v_mfma_f32_16x16x32_bf16 a[0:3], v[68:71], v[52:55], a[0:3]
    v_mfma_f32_16x16x32_bf16 a[4:7], v[72:75], v[52:55], a[4:7]
    v_mfma_f32_16x16x32_bf16 a[8:11], v[68:71], v[56:59], a[8:11]
    v_mfma_f32_16x16x32_bf16 a[12:15], v[72:75], v[56:59], a[12:15]
    s_waitcnt vmcnt(24)
    s_barrier
    s_add_u32 s55, s52, 2176
    s_add_u32 m0, s54, 16384
    s_nop 0
    buffer_load_dwordx4 v10, s[8:11], s55 offen lds
    s_add_u32 s55, s52, 116864
    s_add_u32 m0, s54, 20480
    s_nop 0
    buffer_load_dwordx4 v10, s[8:11], s55 offen lds
    s_add_u32 s55, s53, 974848
    s_add_u32 m0, s54, 24576
    s_nop 0
    buffer_load_dwordx4 v11, s[12:15], s55 offen lds
    s_add_u32 s55, s53, 1003520
    s_add_u32 m0, s54, 28672
    s_nop 0
    buffer_load_dwordx4 v11, s[12:15], s55 offen lds
    ds_read_b128 v[44:47], v16 offset:0
    ds_read_b128 v[48:51], v16 offset:2048
    ds_read_b64_tr_b16 v[60:61], v32 offset:0
    ds_read_b64_tr_b16 v[62:63], v32 offset:512
    ds_read_b64_tr_b16 v[64:65], v33 offset:0
    ds_read_b64_tr_b16 v[66:67], v33 offset:512
    ds_read_b128 v[52:55], v17 offset:0
    ds_read_b128 v[56:59], v17 offset:2048
    ds_read_b64_tr_b16 v[68:69], v32 offset:4096
    ds_read_b64_tr_b16 v[70:71], v32 offset:4608
    ds_read_b64_tr_b16 v[72:73], v33 offset:4096
    ds_read_b64_tr_b16 v[74:75], v33 offset:4608
    s_waitcnt lgkmcnt(6)
    v_mfma_f32_16x16x32_bf16 a[0:3], v[60:63], v[44:47], a[0:3]
    v_mfma_f32_16x16x32_bf16 a[4:7], v[64:67], v[44:47], a[4:7]
    v_mfma_f32_16x16x32_bf16 a[8:11], v[60:63], v[48:51], a[8:11]
    v_mfma_f32_16x16x32_bf16 a[12:15], v[64:67], v[48:51], a[12:15]
    s_waitcnt lgkmcnt(0)
    v_mfma_f32_16x16x32_bf16 a[0:3], v[68:71], v[52:55], a[0:3]
    v_mfma_f32_16x16x32_bf16 a[4:7], v[72:75], v[52:55], a[4:7]
    v_mfma_f32_16x16x32_bf16 a[8:11], v[68:71], v[56:59], a[8:11]
    v_mfma_f32_16x16x32_bf16 a[12:15], v[72:75], v[56:59], a[12:15]
    s_waitcnt vmcnt(24)
    s_barrier
    s_add_u32 s55, s52, 2304
    s_add_u32 m0, s54, 32768
    s_nop 0
    buffer_load_dwordx4 v10, s[8:11], s55 offen lds
    s_add_u32 s55, s52, 116992
    s_add_u32 m0, s54, 36864
    s_nop 0
    buffer_load_dwordx4 v10, s[8:11], s55 offen lds
    s_add_u32 s55, s53, 1032192
    s_add_u32 m0, s54, 40960
    s_nop 0
    buffer_load_dwordx4 v11, s[12:15], s55 offen lds
    s_add_u32 s55, s53, 1060864
    s_add_u32 m0, s54, 45056
    s_nop 0
    buffer_load_dwordx4 v11, s[12:15], s55 offen lds
    ds_read_b128 v[44:47], v18 offset:0
    ds_read_b128 v[48:51], v18 offset:2048
    ds_read_b64_tr_b16 v[60:61], v34 offset:0
    ds_read_b64_tr_b16 v[62:63], v34 offset:512
    ds_read_b64_tr_b16 v[64:65], v35 offset:0
    ds_read_b64_tr_b16 v[66:67], v35 offset:512
    ds_read_b128 v[52:55], v19 offset:0
    ds_read_b128 v[56:59], v19 offset:2048
    ds_read_b64_tr_b16 v[68:69], v34 offset:4096
    ds_read_b64_tr_b16 v[70:71], v34 offset:4608
    ds_read_b64_tr_b16 v[72:73], v35 offset:4096
    ds_read_b64_tr_b16 v[74:75], v35 offset:4608
    s_waitcnt lgkmcnt(6)
    v_mfma_f32_16x16x32_bf16 a[0:3], v[60:63], v[44:47], a[0:3]
    v_mfma_f32_16x16x32_bf16 a[4:7], v[64:67], v[44:47], a[4:7]
    v_mfma_f32_16x16x32_bf16 a[8:11], v[60:63], v[48:51], a[8:11]
    v_mfma_f32_16x16x32_bf16 a[12:15], v[64:67], v[48:51], a[12:15]
    s_waitcnt lgkmcnt(0)
    v_mfma_f32_16x16x32_bf16 a[0:3], v[68:71], v[52:55], a[0:3]
    v_mfma_f32_16x16x32_bf16 a[4:7], v[72:75], v[52:55], a[4:7]
    v_mfma_f32_16x16x32_bf16 a[8:11], v[68:71], v[56:59], a[8:11]
    v_mfma_f32_16x16x32_bf16 a[12:15], v[72:75], v[56:59], a[12:15]
    s_waitcnt vmcnt(24)
    s_barrier
    s_add_u32 s55, s52, 2432
    s_add_u32 m0, s54, 49152
    s_nop 0
    buffer_load_dwordx4 v10, s[8:11], s55 offen lds
    s_add_u32 s55, s52, 117120
    s_add_u32 m0, s54, 53248
    s_nop 0
    buffer_load_dwordx4 v10, s[8:11], s55 offen lds
    s_add_u32 s55, s53, 1089536
    s_add_u32 m0, s54, 57344
    s_nop 0
    buffer_load_dwordx4 v11, s[12:15], s55 offen lds
    s_add_u32 s55, s53, 1118208
    s_add_u32 m0, s54, 61440
    s_nop 0
    buffer_load_dwordx4 v11, s[12:15], s55 offen lds
    ds_read_b128 v[44:47], v20 offset:0
    ds_read_b128 v[48:51], v20 offset:2048
    ds_read_b64_tr_b16 v[60:61], v36 offset:0
    ds_read_b64_tr_b16 v[62:63], v36 offset:512
    ds_read_b64_tr_b16 v[64:65], v37 offset:0
    ds_read_b64_tr_b16 v[66:67], v37 offset:512
    ds_read_b128 v[52:55], v21 offset:0
    ds_read_b128 v[56:59], v21 offset:2048
    ds_read_b64_tr_b16 v[68:69], v36 offset:4096
    ds_read_b64_tr_b16 v[70:71], v36 offset:4608
    ds_read_b64_tr_b16 v[72:73], v37 offset:4096
    ds_read_b64_tr_b16 v[74:75], v37 offset:4608
    s_waitcnt lgkmcnt(6)
    v_mfma_f32_16x16x32_bf16 a[0:3], v[60:63], v[44:47], a[0:3]
    v_mfma_f32_16x16x32_bf16 a[4:7], v[64:67], v[44:47], a[4:7]
    v_mfma_f32_16x16x32_bf16 a[8:11], v[60:63], v[48:51], a[8:11]
    v_mfma_f32_16x16x32_bf16 a[12:15], v[64:67], v[48:51], a[12:15]
    s_waitcnt lgkmcnt(0)
    v_mfma_f32_16x16x32_bf16 a[0:3], v[68:71], v[52:55], a[0:3]
    v_mfma_f32_16x16x32_bf16 a[4:7], v[72:75], v[52:55], a[4:7]
    v_mfma_f32_16x16x32_bf16 a[8:11], v[68:71], v[56:59], a[8:11]
    v_mfma_f32_16x16x32_bf16 a[12:15], v[72:75], v[56:59], a[12:15]
    s_waitcnt vmcnt(24)
    s_barrier
    s_add_u32 s55, s52, 2560
    s_add_u32 m0, s54, 65536
    s_nop 0
    buffer_load_dwordx4 v10, s[8:11], s55 offen lds
    s_add_u32 s55, s52, 117248
    s_add_u32 m0, s54, 69632
    s_nop 0
    buffer_load_dwordx4 v10, s[8:11], s55 offen lds
    s_add_u32 s55, s53, 1146880
    s_add_u32 m0, s54, 73728
    s_nop 0
    buffer_load_dwordx4 v11, s[12:15], s55 offen lds
    s_add_u32 s55, s53, 1175552
    s_add_u32 m0, s54, 77824
    s_nop 0
    buffer_load_dwordx4 v11, s[12:15], s55 offen lds
    ds_read_b128 v[44:47], v22 offset:0
    ds_read_b128 v[48:51], v22 offset:2048
    ds_read_b64_tr_b16 v[60:61], v38 offset:0
    ds_read_b64_tr_b16 v[62:63], v38 offset:512
    ds_read_b64_tr_b16 v[64:65], v39 offset:0
    ds_read_b64_tr_b16 v[66:67], v39 offset:512
    ds_read_b128 v[52:55], v23 offset:0
    ds_read_b128 v[56:59], v23 offset:2048
    ds_read_b64_tr_b16 v[68:69], v38 offset:4096
    ds_read_b64_tr_b16 v[70:71], v38 offset:4608
    ds_read_b64_tr_b16 v[72:73], v39 offset:4096
    ds_read_b64_tr_b16 v[74:75], v39 offset:4608
    s_waitcnt lgkmcnt(6)
    v_mfma_f32_16x16x32_bf16 a[0:3], v[60:63], v[44:47], a[0:3]
    v_mfma_f32_16x16x32_bf16 a[4:7], v[64:67], v[44:47], a[4:7]
    v_mfma_f32_16x16x32_bf16 a[8:11], v[60:63], v[48:51], a[8:11]
    v_mfma_f32_16x16x32_bf16 a[12:15], v[64:67], v[48:51], a[12:15]
    s_waitcnt lgkmcnt(0)
    v_mfma_f32_16x16x32_bf16 a[0:3], v[68:71], v[52:55], a[0:3]
    v_mfma_f32_16x16x32_bf16 a[4:7], v[72:75], v[52:55], a[4:7]
    v_mfma_f32_16x16x32_bf16 a[8:11], v[68:71], v[56:59], a[8:11]
    v_mfma_f32_16x16x32_bf16 a[12:15], v[72:75], v[56:59], a[12:15]
    s_waitcnt vmcnt(24)
    s_barrier
    s_add_u32 s55, s52, 2688
    s_add_u32 m0, s54, 81920
    s_nop 0
    buffer_load_dwordx4 v10, s[8:11], s55 offen lds
    s_add_u32 s55, s52, 117376
    s_add_u32 m0, s54, 86016
    s_nop 0
    buffer_load_dwordx4 v10, s[8:11], s55 offen lds
    s_add_u32 s55, s53, 1204224
    s_add_u32 m0, s54, 90112
    s_nop 0
    buffer_load_dwordx4 v11, s[12:15], s55 offen lds
    s_add_u32 s55, s53, 1232896
    s_add_u32 m0, s54, 94208
    s_nop 0
    buffer_load_dwordx4 v11, s[12:15], s55 offen lds
    ds_read_b128 v[44:47], v24 offset:0
    ds_read_b128 v[48:51], v24 offset:2048
    ds_read_b64_tr_b16 v[60:61], v40 offset:0
    ds_read_b64_tr_b16 v[62:63], v40 offset:512
    ds_read_b64_tr_b16 v[64:65], v41 offset:0
    ds_read_b64_tr_b16 v[66:67], v41 offset:512
    ds_read_b128 v[52:55], v25 offset:0
    ds_read_b128 v[56:59], v25 offset:2048
    ds_read_b64_tr_b16 v[68:69], v40 offset:4096
    ds_read_b64_tr_b16 v[70:71], v40 offset:4608
    ds_read_b64_tr_b16 v[72:73], v41 offset:4096
    ds_read_b64_tr_b16 v[74:75], v41 offset:4608
    s_waitcnt lgkmcnt(6)
    v_mfma_f32_16x16x32_bf16 a[0:3], v[60:63], v[44:47], a[0:3]
    v_mfma_f32_16x16x32_bf16 a[4:7], v[64:67], v[44:47], a[4:7]
    v_mfma_f32_16x16x32_bf16 a[8:11], v[60:63], v[48:51], a[8:11]
    v_mfma_f32_16x16x32_bf16 a[12:15], v[64:67], v[48:51], a[12:15]
    s_waitcnt lgkmcnt(0)
    v_mfma_f32_16x16x32_bf16 a[0:3], v[68:71], v[52:55], a[0:3]
    v_mfma_f32_16x16x32_bf16 a[4:7], v[72:75], v[52:55], a[4:7]
    v_mfma_f32_16x16x32_bf16 a[8:11], v[68:71], v[56:59], a[8:11]
    v_mfma_f32_16x16x32_bf16 a[12:15], v[72:75], v[56:59], a[12:15]
    s_waitcnt vmcnt(24)
    s_barrier
    s_add_u32 s55, s52, 2816
    s_add_u32 m0, s54, 98304
    s_nop 0
    buffer_load_dwordx4 v10, s[8:11], s55 offen lds
    s_add_u32 s55, s52, 117504
    s_add_u32 m0, s54, 102400
    s_nop 0
    buffer_load_dwordx4 v10, s[8:11], s55 offen lds
    s_add_u32 s55, s53, 1261568
    s_add_u32 m0, s54, 106496
    s_nop 0
    buffer_load_dwordx4 v11, s[12:15], s55 offen lds
    s_add_u32 s55, s53, 1290240
    s_add_u32 m0, s54, 110592
    s_nop 0
    buffer_load_dwordx4 v11, s[12:15], s55 offen lds
    ds_read_b128 v[44:47], v26 offset:0
    ds_read_b128 v[48:51], v26 offset:2048
    ds_read_b64_tr_b16 v[60:61], v42 offset:0
    ds_read_b64_tr_b16 v[62:63], v42 offset:512
    ds_read_b64_tr_b16 v[64:65], v43 offset:0
    ds_read_b64_tr_b16 v[66:67], v43 offset:512
    ds_read_b128 v[52:55], v27 offset:0
    ds_read_b128 v[56:59], v27 offset:2048
    ds_read_b64_tr_b16 v[68:69], v42 offset:4096
    ds_read_b64_tr_b16 v[70:71], v42 offset:4608
    ds_read_b64_tr_b16 v[72:73], v43 offset:4096
    ds_read_b64_tr_b16 v[74:75], v43 offset:4608
    s_waitcnt lgkmcnt(6)
    v_mfma_f32_16x16x32_bf16 a[0:3], v[60:63], v[44:47], a[0:3]
    v_mfma_f32_16x16x32_bf16 a[4:7], v[64:67], v[44:47], a[4:7]
    v_mfma_f32_16x16x32_bf16 a[8:11], v[60:63], v[48:51], a[8:11]
    v_mfma_f32_16x16x32_bf16 a[12:15], v[64:67], v[48:51], a[12:15]
    s_waitcnt lgkmcnt(0)
    v_mfma_f32_16x16x32_bf16 a[0:3], v[68:71], v[52:55], a[0:3]
    v_mfma_f32_16x16x32_bf16 a[4:7], v[72:75], v[52:55], a[4:7]
    v_mfma_f32_16x16x32_bf16 a[8:11], v[68:71], v[56:59], a[8:11]
    v_mfma_f32_16x16x32_bf16 a[12:15], v[72:75], v[56:59], a[12:15]
    s_waitcnt vmcnt(24)
    s_barrier
    s_add_u32 s55, s52, 2944
    s_add_u32 m0, s54, 114688
    s_nop 0
    buffer_load_dwordx4 v10, s[8:11], s55 offen lds
    s_add_u32 s55, s52, 117632
    s_add_u32 m0, s54, 118784
    s_nop 0
    buffer_load_dwordx4 v10, s[8:11], s55 offen lds
    s_add_u32 s55, s53, 1318912
    s_add_u32 m0, s54, 122880
    s_nop 0
    buffer_load_dwordx4 v11, s[12:15], s55 offen lds
    s_add_u32 s55, s53, 1347584
    s_add_u32 m0, s54, 126976
    s_nop 0
    buffer_load_dwordx4 v11, s[12:15], s55 offen lds
    ds_read_b128 v[44:47], v12 offset:0
    ds_read_b128 v[48:51], v12 offset:2048
    ds_read_b64_tr_b16 v[60:61], v28 offset:0
    ds_read_b64_tr_b16 v[62:63], v28 offset:512
    ds_read_b64_tr_b16 v[64:65], v29 offset:0
    ds_read_b64_tr_b16 v[66:67], v29 offset:512
    ds_read_b128 v[52:55], v13 offset:0
    ds_read_b128 v[56:59], v13 offset:2048
    ds_read_b64_tr_b16 v[68:69], v28 offset:4096
    ds_read_b64_tr_b16 v[70:71], v28 offset:4608
    ds_read_b64_tr_b16 v[72:73], v29 offset:4096
    ds_read_b64_tr_b16 v[74:75], v29 offset:4608
    s_waitcnt lgkmcnt(6)
    v_mfma_f32_16x16x32_bf16 a[0:3], v[60:63], v[44:47], a[0:3]
    v_mfma_f32_16x16x32_bf16 a[4:7], v[64:67], v[44:47], a[4:7]
    v_mfma_f32_16x16x32_bf16 a[8:11], v[60:63], v[48:51], a[8:11]
    v_mfma_f32_16x16x32_bf16 a[12:15], v[64:67], v[48:51], a[12:15]
    s_waitcnt lgkmcnt(0)
    v_mfma_f32_16x16x32_bf16 a[0:3], v[68:71], v[52:55], a[0:3]
    v_mfma_f32_16x16x32_bf16 a[4:7], v[72:75], v[52:55], a[4:7]
    v_mfma_f32_16x16x32_bf16 a[8:11], v[68:71], v[56:59], a[8:11]
    v_mfma_f32_16x16x32_bf16 a[12:15], v[72:75], v[56:59], a[12:15]
    s_waitcnt vmcnt(24)
    s_barrier
    s_add_u32 s55, s52, 3072
    s_add_u32 m0, s54, 0
    s_nop 0
    buffer_load_dwordx4 v10, s[8:11], s55 offen lds
    s_add_u32 s55, s52, 117760
    s_add_u32 m0, s54, 4096
    s_nop 0
    buffer_load_dwordx4 v10, s[8:11], s55 offen lds
    s_add_u32 s55, s53, 1376256
    s_add_u32 m0, s54, 8192
    s_nop 0
    buffer_load_dwordx4 v11, s[12:15], s55 offen lds
    s_add_u32 s55, s53, 1404928
    s_add_u32 m0, s54, 12288
    s_nop 0
    buffer_load_dwordx4 v11, s[12:15], s55 offen lds
    ds_read_b128 v[44:47], v14 offset:0
    ds_read_b128 v[48:51], v14 offset:2048
    ds_read_b64_tr_b16 v[60:61], v30 offset:0
    ds_read_b64_tr_b16 v[62:63], v30 offset:512
    ds_read_b64_tr_b16 v[64:65], v31 offset:0
    ds_read_b64_tr_b16 v[66:67], v31 offset:512
    ds_read_b128 v[52:55], v15 offset:0
    ds_read_b128 v[56:59], v15 offset:2048
    ds_read_b64_tr_b16 v[68:69], v30 offset:4096
    ds_read_b64_tr_b16 v[70:71], v30 offset:4608
    ds_read_b64_tr_b16 v[72:73], v31 offset:4096
    ds_read_b64_tr_b16 v[74:75], v31 offset:4608
    s_waitcnt lgkmcnt(6)
    v_mfma_f32_16x16x32_bf16 a[0:3], v[60:63], v[44:47], a[0:3]
    v_mfma_f32_16x16x32_bf16 a[4:7], v[64:67], v[44:47], a[4:7]
    v_mfma_f32_16x16x32_bf16 a[8:11], v[60:63], v[48:51], a[8:11]
    v_mfma_f32_16x16x32_bf16 a[12:15], v[64:67], v[48:51], a[12:15]
    s_waitcnt lgkmcnt(0)
    v_mfma_f32_16x16x32_bf16 a[0:3], v[68:71], v[52:55], a[0:3]
    v_mfma_f32_16x16x32_bf16 a[4:7], v[72:75], v[52:55], a[4:7]
    v_mfma_f32_16x16x32_bf16 a[8:11], v[68:71], v[56:59], a[8:11]
    v_mfma_f32_16x16x32_bf16 a[12:15], v[72:75], v[56:59], a[12:15]
    s_waitcnt vmcnt(24)
    s_barrier
    s_add_u32 s55, s52, 3200
    s_add_u32 m0, s54, 16384
    s_nop 0
    buffer_load_dwordx4 v10, s[8:11], s55 offen lds
    s_add_u32 s55, s52, 117888
    s_add_u32 m0, s54, 20480
    s_nop 0
    buffer_load_dwordx4 v10, s[8:11], s55 offen lds
    s_add_u32 s55, s53, 1433600
    s_add_u32 m0, s54, 24576
    s_nop 0
    buffer_load_dwordx4 v11, s[12:15], s55 offen lds
    s_add_u32 s55, s53, 1462272
    s_add_u32 m0, s54, 28672
    s_nop 0
    buffer_load_dwordx4 v11, s[12:15], s55 offen lds
    ds_read_b128 v[44:47], v16 offset:0
    ds_read_b128 v[48:51], v16 offset:2048
    ds_read_b64_tr_b16 v[60:61], v32 offset:0
    ds_read_b64_tr_b16 v[62:63], v32 offset:512
    ds_read_b64_tr_b16 v[64:65], v33 offset:0
    ds_read_b64_tr_b16 v[66:67], v33 offset:512
    ds_read_b128 v[52:55], v17 offset:0
    ds_read_b128 v[56:59], v17 offset:2048
    ds_read_b64_tr_b16 v[68:69], v32 offset:4096
    ds_read_b64_tr_b16 v[70:71], v32 offset:4608
    ds_read_b64_tr_b16 v[72:73], v33 offset:4096
    ds_read_b64_tr_b16 v[74:75], v33 offset:4608
    s_waitcnt lgkmcnt(6)
    v_mfma_f32_16x16x32_bf16 a[0:3], v[60:63], v[44:47], a[0:3]
    v_mfma_f32_16x16x32_bf16 a[4:7], v[64:67], v[44:47], a[4:7]
    v_mfma_f32_16x16x32_bf16 a[8:11], v[60:63], v[48:51], a[8:11]
    v_mfma_f32_16x16x32_bf16 a[12:15], v[64:67], v[48:51], a[12:15]
    s_waitcnt lgkmcnt(0)
    v_mfma_f32_16x16x32_bf16 a[0:3], v[68:71], v[52:55], a[0:3]
    v_mfma_f32_16x16x32_bf16 a[4:7], v[72:75], v[52:55], a[4:7]
    v_mfma_f32_16x16x32_bf16 a[8:11], v[68:71], v[56:59], a[8:11]
    v_mfma_f32_16x16x32_bf16 a[12:15], v[72:75], v[56:59], a[12:15]
    s_waitcnt vmcnt(24)
    s_barrier
    s_add_u32 s55, s52, 3328
    s_add_u32 m0, s54, 32768
    s_nop 0
    buffer_load_dwordx4 v10, s[8:11], s55 offen lds
    s_add_u32 s55, s52, 118016
    s_add_u32 m0, s54, 36864
    s_nop 0
    buffer_load_dwordx4 v10, s[8:11], s55 offen lds
    s_add_u32 s55, s53, 1490944
    s_add_u32 m0, s54, 40960
    s_nop 0
    buffer_load_dwordx4 v11, s[12:15], s55 offen lds
    s_add_u32 s55, s53, 1519616
    s_add_u32 m0, s54, 45056
    s_nop 0
    buffer_load_dwordx4 v11, s[12:15], s55 offen lds
    ds_read_b128 v[44:47], v18 offset:0
    ds_read_b128 v[48:51], v18 offset:2048
    ds_read_b64_tr_b16 v[60:61], v34 offset:0
    ds_read_b64_tr_b16 v[62:63], v34 offset:512
    ds_read_b64_tr_b16 v[64:65], v35 offset:0
    ds_read_b64_tr_b16 v[66:67], v35 offset:512
    ds_read_b128 v[52:55], v19 offset:0
    ds_read_b128 v[56:59], v19 offset:2048
    ds_read_b64_tr_b16 v[68:69], v34 offset:4096
    ds_read_b64_tr_b16 v[70:71], v34 offset:4608
    ds_read_b64_tr_b16 v[72:73], v35 offset:4096
    ds_read_b64_tr_b16 v[74:75], v35 offset:4608
    s_waitcnt lgkmcnt(6)
    v_mfma_f32_16x16x32_bf16 a[0:3], v[60:63], v[44:47], a[0:3]
    v_mfma_f32_16x16x32_bf16 a[4:7], v[64:67], v[44:47], a[4:7]
    v_mfma_f32_16x16x32_bf16 a[8:11], v[60:63], v[48:51], a[8:11]
    v_mfma_f32_16x16x32_bf16 a[12:15], v[64:67], v[48:51], a[12:15]
    s_waitcnt lgkmcnt(0)
    v_mfma_f32_16x16x32_bf16 a[0:3], v[68:71], v[52:55], a[0:3]
    v_mfma_f32_16x16x32_bf16 a[4:7], v[72:75], v[52:55], a[4:7]
    v_mfma_f32_16x16x32_bf16 a[8:11], v[68:71], v[56:59], a[8:11]
    v_mfma_f32_16x16x32_bf16 a[12:15], v[72:75], v[56:59], a[12:15]
    s_waitcnt vmcnt(24)
    s_barrier
    s_add_u32 s55, s52, 3456
    s_add_u32 m0, s54, 49152
    s_nop 0
    buffer_load_dwordx4 v10, s[8:11], s55 offen lds
    s_add_u32 s55, s52, 118144
    s_add_u32 m0, s54, 53248
    s_nop 0
    buffer_load_dwordx4 v10, s[8:11], s55 offen lds
    s_add_u32 s55, s53, 1548288
    s_add_u32 m0, s54, 57344
    s_nop 0
    buffer_load_dwordx4 v11, s[12:15], s55 offen lds
    s_add_u32 s55, s53, 1576960
    s_add_u32 m0, s54, 61440
    s_nop 0
    buffer_load_dwordx4 v11, s[12:15], s55 offen lds
    ds_read_b128 v[44:47], v20 offset:0
    ds_read_b128 v[48:51], v20 offset:2048
    ds_read_b64_tr_b16 v[60:61], v36 offset:0
    ds_read_b64_tr_b16 v[62:63], v36 offset:512
    ds_read_b64_tr_b16 v[64:65], v37 offset:0
    ds_read_b64_tr_b16 v[66:67], v37 offset:512
    ds_read_b128 v[52:55], v21 offset:0
    ds_read_b128 v[56:59], v21 offset:2048
    ds_read_b64_tr_b16 v[68:69], v36 offset:4096
    ds_read_b64_tr_b16 v[70:71], v36 offset:4608
    ds_read_b64_tr_b16 v[72:73], v37 offset:4096
    ds_read_b64_tr_b16 v[74:75], v37 offset:4608
    s_waitcnt lgkmcnt(6)
    v_mfma_f32_16x16x32_bf16 a[0:3], v[60:63], v[44:47], a[0:3]
    v_mfma_f32_16x16x32_bf16 a[4:7], v[64:67], v[44:47], a[4:7]
    v_mfma_f32_16x16x32_bf16 a[8:11], v[60:63], v[48:51], a[8:11]
    v_mfma_f32_16x16x32_bf16 a[12:15], v[64:67], v[48:51], a[12:15]
    s_waitcnt lgkmcnt(0)
    v_mfma_f32_16x16x32_bf16 a[0:3], v[68:71], v[52:55], a[0:3]
    v_mfma_f32_16x16x32_bf16 a[4:7], v[72:75], v[52:55], a[4:7]
    v_mfma_f32_16x16x32_bf16 a[8:11], v[68:71], v[56:59], a[8:11]
    v_mfma_f32_16x16x32_bf16 a[12:15], v[72:75], v[56:59], a[12:15]
    s_waitcnt vmcnt(24)
    s_barrier
    ds_read_b128 v[44:47], v22 offset:0
    ds_read_b128 v[48:51], v22 offset:2048
    ds_read_b64_tr_b16 v[60:61], v38 offset:0
    ds_read_b64_tr_b16 v[62:63], v38 offset:512
    ds_read_b64_tr_b16 v[64:65], v39 offset:0
    ds_read_b64_tr_b16 v[66:67], v39 offset:512
    ds_read_b128 v[52:55], v23 offset:0
    ds_read_b128 v[56:59], v23 offset:2048
    ds_read_b64_tr_b16 v[68:69], v38 offset:4096
    ds_read_b64_tr_b16 v[70:71], v38 offset:4608
    ds_read_b64_tr_b16 v[72:73], v39 offset:4096
    ds_read_b64_tr_b16 v[74:75], v39 offset:4608
    s_waitcnt lgkmcnt(6)
    v_mfma_f32_16x16x32_bf16 a[0:3], v[60:63], v[44:47], a[0:3]
    v_mfma_f32_16x16x32_bf16 a[4:7], v[64:67], v[44:47], a[4:7]
    v_mfma_f32_16x16x32_bf16 a[8:11], v[60:63], v[48:51], a[8:11]
    v_mfma_f32_16x16x32_bf16 a[12:15], v[64:67], v[48:51], a[12:15]
    s_waitcnt lgkmcnt(0)
    v_mfma_f32_16x16x32_bf16 a[0:3], v[68:71], v[52:55], a[0:3]
    v_mfma_f32_16x16x32_bf16 a[4:7], v[72:75], v[52:55], a[4:7]
    v_mfma_f32_16x16x32_bf16 a[8:11], v[68:71], v[56:59], a[8:11]
    v_mfma_f32_16x16x32_bf16 a[12:15], v[72:75], v[56:59], a[12:15]
    s_waitcnt vmcnt(20)
    s_barrier
    ds_read_b128 v[44:47], v24 offset:0
    ds_read_b128 v[48:51], v24 offset:2048
    ds_read_b64_tr_b16 v[60:61], v40 offset:0
    ds_read_b64_tr_b16 v[62:63], v40 offset:512
    ds_read_b64_tr_b16 v[64:65], v41 offset:0
    ds_read_b64_tr_b16 v[66:67], v41 offset:512
    ds_read_b128 v[52:55], v25 offset:0
    ds_read_b128 v[56:59], v25 offset:2048
    ds_read_b64_tr_b16 v[68:69], v40 offset:4096
    ds_read_b64_tr_b16 v[70:71], v40 offset:4608
    ds_read_b64_tr_b16 v[72:73], v41 offset:4096
    ds_read_b64_tr_b16 v[74:75], v41 offset:4608
    s_waitcnt lgkmcnt(6)
    v_mfma_f32_16x16x32_bf16 a[0:3], v[60:63], v[44:47], a[0:3]
    v_mfma_f32_16x16x32_bf16 a[4:7], v[64:67], v[44:47], a[4:7]
    v_mfma_f32_16x16x32_bf16 a[8:11], v[60:63], v[48:51], a[8:11]
    v_mfma_f32_16x16x32_bf16 a[12:15], v[64:67], v[48:51], a[12:15]
    s_waitcnt lgkmcnt(0)
    v_mfma_f32_16x16x32_bf16 a[0:3], v[68:71], v[52:55], a[0:3]
    v_mfma_f32_16x16x32_bf16 a[4:7], v[72:75], v[52:55], a[4:7]
    v_mfma_f32_16x16x32_bf16 a[8:11], v[68:71], v[56:59], a[8:11]
    v_mfma_f32_16x16x32_bf16 a[12:15], v[72:75], v[56:59], a[12:15]
    s_waitcnt vmcnt(16)
    s_barrier
    ds_read_b128 v[44:47], v26 offset:0
    ds_read_b128 v[48:51], v26 offset:2048
    ds_read_b64_tr_b16 v[60:61], v42 offset:0
    ds_read_b64_tr_b16 v[62:63], v42 offset:512
    ds_read_b64_tr_b16 v[64:65], v43 offset:0
    ds_read_b64_tr_b16 v[66:67], v43 offset:512
    ds_read_b128 v[52:55], v27 offset:0
    ds_read_b128 v[56:59], v27 offset:2048
    ds_read_b64_tr_b16 v[68:69], v42 offset:4096
    ds_read_b64_tr_b16 v[70:71], v42 offset:4608
    ds_read_b64_tr_b16 v[72:73], v43 offset:4096
    ds_read_b64_tr_b16 v[74:75], v43 offset:4608
    s_waitcnt lgkmcnt(6)
    v_mfma_f32_16x16x32_bf16 a[0:3], v[60:63], v[44:47], a[0:3]
    v_mfma_f32_16x16x32_bf16 a[4:7], v[64:67], v[44:47], a[4:7]
    v_mfma_f32_16x16x32_bf16 a[8:11], v[60:63], v[48:51], a[8:11]
    v_mfma_f32_16x16x32_bf16 a[12:15], v[64:67], v[48:51], a[12:15]
    s_waitcnt lgkmcnt(0)
    v_mfma_f32_16x16x32_bf16 a[0:3], v[68:71], v[52:55], a[0:3]
    v_mfma_f32_16x16x32_bf16 a[4:7], v[72:75], v[52:55], a[4:7]
    v_mfma_f32_16x16x32_bf16 a[8:11], v[68:71], v[56:59], a[8:11]
    v_mfma_f32_16x16x32_bf16 a[12:15], v[72:75], v[56:59], a[12:15]
    s_waitcnt vmcnt(12)
    s_barrier
    ds_read_b128 v[44:47], v12 offset:0
    ds_read_b128 v[48:51], v12 offset:2048
    ds_read_b64_tr_b16 v[60:61], v28 offset:0
    ds_read_b64_tr_b16 v[62:63], v28 offset:512
    ds_read_b64_tr_b16 v[64:65], v29 offset:0
    ds_read_b64_tr_b16 v[66:67], v29 offset:512
    ds_read_b128 v[52:55], v13 offset:0
    ds_read_b128 v[56:59], v13 offset:2048
    ds_read_b64_tr_b16 v[68:69], v28 offset:4096
    ds_read_b64_tr_b16 v[70:71], v28 offset:4608
    ds_read_b64_tr_b16 v[72:73], v29 offset:4096
    ds_read_b64_tr_b16 v[74:75], v29 offset:4608
    s_waitcnt lgkmcnt(6)
    v_mfma_f32_16x16x32_bf16 a[0:3], v[60:63], v[44:47], a[0:3]
    v_mfma_f32_16x16x32_bf16 a[4:7], v[64:67], v[44:47], a[4:7]
    v_mfma_f32_16x16x32_bf16 a[8:11], v[60:63], v[48:51], a[8:11]
    v_mfma_f32_16x16x32_bf16 a[12:15], v[64:67], v[48:51], a[12:15]
    s_waitcnt lgkmcnt(0)
    v_mfma_f32_16x16x32_bf16 a[0:3], v[68:71], v[52:55], a[0:3]
    v_mfma_f32_16x16x32_bf16 a[4:7], v[72:75], v[52:55], a[4:7]
    v_mfma_f32_16x16x32_bf16 a[8:11], v[68:71], v[56:59], a[8:11]
    v_mfma_f32_16x16x32_bf16 a[12:15], v[72:75], v[56:59], a[12:15]
    s_waitcnt vmcnt(8)
    s_barrier
    ds_read_b128 v[44:47], v14 offset:0
    ds_read_b128 v[48:51], v14 offset:2048
    ds_read_b64_tr_b16 v[60:61], v30 offset:0
    ds_read_b64_tr_b16 v[62:63], v30 offset:512
    ds_read_b64_tr_b16 v[64:65], v31 offset:0
    ds_read_b64_tr_b16 v[66:67], v31 offset:512
    ds_read_b128 v[52:55], v15 offset:0
    ds_read_b128 v[56:59], v15 offset:2048
    ds_read_b64_tr_b16 v[68:69], v30 offset:4096
    ds_read_b64_tr_b16 v[70:71], v30 offset:4608
    ds_read_b64_tr_b16 v[72:73], v31 offset:4096
    ds_read_b64_tr_b16 v[74:75], v31 offset:4608
    s_waitcnt lgkmcnt(6)
    v_mfma_f32_16x16x32_bf16 a[0:3], v[60:63], v[44:47], a[0:3]
    v_mfma_f32_16x16x32_bf16 a[4:7], v[64:67], v[44:47], a[4:7]
    v_mfma_f32_16x16x32_bf16 a[8:11], v[60:63], v[48:51], a[8:11]
    v_mfma_f32_16x16x32_bf16 a[12:15], v[64:67], v[48:51], a[12:15]
    s_waitcnt lgkmcnt(0)
    v_mfma_f32_16x16x32_bf16 a[0:3], v[68:71], v[52:55], a[0:3]
    v_mfma_f32_16x16x32_bf16 a[4:7], v[72:75], v[52:55], a[4:7]
    v_mfma_f32_16x16x32_bf16 a[8:11], v[68:71], v[56:59], a[8:11]
    v_mfma_f32_16x16x32_bf16 a[12:15], v[72:75], v[56:59], a[12:15]
    s_waitcnt vmcnt(4)
    s_barrier
    ds_read_b128 v[44:47], v16 offset:0
    ds_read_b128 v[48:51], v16 offset:2048
    ds_read_b64_tr_b16 v[60:61], v32 offset:0
    ds_read_b64_tr_b16 v[62:63], v32 offset:512
    ds_read_b64_tr_b16 v[64:65], v33 offset:0
    ds_read_b64_tr_b16 v[66:67], v33 offset:512
    ds_read_b128 v[52:55], v17 offset:0
    ds_read_b128 v[56:59], v17 offset:2048
    ds_read_b64_tr_b16 v[68:69], v32 offset:4096
    ds_read_b64_tr_b16 v[70:71], v32 offset:4608
    ds_read_b64_tr_b16 v[72:73], v33 offset:4096
    ds_read_b64_tr_b16 v[74:75], v33 offset:4608
    s_waitcnt lgkmcnt(6)
    v_mfma_f32_16x16x32_bf16 a[0:3], v[60:63], v[44:47], a[0:3]
    v_mfma_f32_16x16x32_bf16 a[4:7], v[64:67], v[44:47], a[4:7]
    v_mfma_f32_16x16x32_bf16 a[8:11], v[60:63], v[48:51], a[8:11]
    v_mfma_f32_16x16x32_bf16 a[12:15], v[64:67], v[48:51], a[12:15]
    s_waitcnt lgkmcnt(0)
    v_mfma_f32_16x16x32_bf16 a[0:3], v[68:71], v[52:55], a[0:3]
    v_mfma_f32_16x16x32_bf16 a[4:7], v[72:75], v[52:55], a[4:7]
    v_mfma_f32_16x16x32_bf16 a[8:11], v[68:71], v[56:59], a[8:11]
    v_mfma_f32_16x16x32_bf16 a[12:15], v[72:75], v[56:59], a[12:15]
    s_waitcnt vmcnt(0)
    s_barrier
    ds_read_b128 v[44:47], v18 offset:0
    ds_read_b128 v[48:51], v18 offset:2048
    ds_read_b64_tr_b16 v[60:61], v34 offset:0
    ds_read_b64_tr_b16 v[62:63], v34 offset:512
    ds_read_b64_tr_b16 v[64:65], v35 offset:0
    ds_read_b64_tr_b16 v[66:67], v35 offset:512
    ds_read_b128 v[52:55], v19 offset:0
    ds_read_b128 v[56:59], v19 offset:2048
    ds_read_b64_tr_b16 v[68:69], v34 offset:4096
    ds_read_b64_tr_b16 v[70:71], v34 offset:4608
    ds_read_b64_tr_b16 v[72:73], v35 offset:4096
    ds_read_b64_tr_b16 v[74:75], v35 offset:4608
    s_waitcnt lgkmcnt(6)
    v_mfma_f32_16x16x32_bf16 a[0:3], v[60:63], v[44:47], a[0:3]
    v_mfma_f32_16x16x32_bf16 a[4:7], v[64:67], v[44:47], a[4:7]
    v_mfma_f32_16x16x32_bf16 a[8:11], v[60:63], v[48:51], a[8:11]
    v_mfma_f32_16x16x32_bf16 a[12:15], v[64:67], v[48:51], a[12:15]
    s_waitcnt lgkmcnt(0)
    v_mfma_f32_16x16x32_bf16 a[0:3], v[68:71], v[52:55], a[0:3]
    v_mfma_f32_16x16x32_bf16 a[4:7], v[72:75], v[52:55], a[4:7]
    v_mfma_f32_16x16x32_bf16 a[8:11], v[68:71], v[56:59], a[8:11]
    v_mfma_f32_16x16x32_bf16 a[12:15], v[72:75], v[56:59], a[12:15]
    s_waitcnt vmcnt(0)
    s_nop 3
    v_accvgpr_read_b32 v44, a0
    v_accvgpr_read_b32 v45, a1
    v_accvgpr_read_b32 v46, a2
    v_accvgpr_read_b32 v47, a3
    v_lshlrev_b32 v52, 16, v76
    v_and_b32 v53, 0xffff0000, v76
    v_lshlrev_b32 v54, 16, v77
    v_and_b32 v55, 0xffff0000, v77
    v_add_f32 v44, v44, v52
    v_add_f32 v45, v45, v53
    v_add_f32 v46, v46, v54
    v_add_f32 v47, v47, v55
    v_cvt_pk_bf16_f32 v52, v44, v45
    v_cvt_pk_bf16_f32 v53, v46, v47
    buffer_store_dwordx2 v[52:53], v87, s[20:23], 0 offen offset:0
    v_accvgpr_read_b32 v44, a4
    v_accvgpr_read_b32 v45, a5
    v_accvgpr_read_b32 v46, a6
    v_accvgpr_read_b32 v47, a7
    v_lshlrev_b32 v52, 16, v78
    v_and_b32 v53, 0xffff0000, v78
    v_lshlrev_b32 v54, 16, v79
    v_and_b32 v55, 0xffff0000, v79
    v_add_f32 v44, v44, v52
    v_add_f32 v45, v45, v53
    v_add_f32 v46, v46, v54
    v_add_f32 v47, v47, v55
    v_cvt_pk_bf16_f32 v52, v44, v45
    v_cvt_pk_bf16_f32 v53, v46, v47
    buffer_store_dwordx2 v[52:53], v87, s[20:23], 0 offen offset:32
    v_accvgpr_read_b32 v44, a8
    v_accvgpr_read_b32 v45, a9
    v_accvgpr_read_b32 v46, a10
    v_accvgpr_read_b32 v47, a11
    v_lshlrev_b32 v52, 16, v80
    v_and_b32 v53, 0xffff0000, v80
    v_lshlrev_b32 v54, 16, v81
    v_and_b32 v55, 0xffff0000, v81
    v_add_f32 v44, v44, v52
    v_add_f32 v45, v45, v53
    v_add_f32 v46, v46, v54
    v_add_f32 v47, v47, v55
    v_cvt_pk_bf16_f32 v52, v44, v45
    v_cvt_pk_bf16_f32 v53, v46, v47
    buffer_store_dwordx2 v[52:53], v88, s[20:23], 0 offen offset:0
    v_accvgpr_read_b32 v44, a12
    v_accvgpr_read_b32 v45, a13
    v_accvgpr_read_b32 v46, a14
    v_accvgpr_read_b32 v47, a15
    v_lshlrev_b32 v52, 16, v82
    v_and_b32 v53, 0xffff0000, v82
    v_lshlrev_b32 v54, 16, v83
    v_and_b32 v55, 0xffff0000, v83
    v_add_f32 v44, v44, v52
    v_add_f32 v45, v45, v53
    v_add_f32 v46, v46, v54
    v_add_f32 v47, v47, v55
    v_cvt_pk_bf16_f32 v52, v44, v45
    v_cvt_pk_bf16_f32 v53, v46, v47
    buffer_store_dwordx2 v[52:53], v88, s[20:23], 0 offen offset:32
L_ffn2_1_kernel_end:
    s_endpgm
.section .rodata,"a"
.p2align 6
.amdhsa_kernel qkv0_kernel
  .amdhsa_next_free_vgpr 164
  .amdhsa_next_free_sgpr 92
  .amdhsa_accum_offset 116
  .amdhsa_group_segment_fixed_size 0
  .amdhsa_kernarg_size 80
  .amdhsa_user_sgpr_count 2
  .amdhsa_user_sgpr_kernarg_segment_ptr 1
  .amdhsa_system_sgpr_workgroup_id_x 1
.end_amdhsa_kernel
.p2align 6
.amdhsa_kernel attn_kernel
  .amdhsa_next_free_vgpr 130
  .amdhsa_next_free_sgpr 40
  .amdhsa_accum_offset 132
  .amdhsa_group_segment_fixed_size 0
  .amdhsa_kernarg_size 80
  .amdhsa_user_sgpr_count 2
  .amdhsa_user_sgpr_kernarg_segment_ptr 1
  .amdhsa_system_sgpr_workgroup_id_x 1
.end_amdhsa_kernel
.p2align 6
.amdhsa_kernel wo0_kernel
  .amdhsa_next_free_vgpr 104
  .amdhsa_next_free_sgpr 92
  .amdhsa_accum_offset 88
  .amdhsa_group_segment_fixed_size 0
  .amdhsa_kernarg_size 80
  .amdhsa_user_sgpr_count 2
  .amdhsa_user_sgpr_kernarg_segment_ptr 1
  .amdhsa_system_sgpr_workgroup_id_x 1
.end_amdhsa_kernel
.p2align 6
.amdhsa_kernel ffn1_kernel
  .amdhsa_next_free_vgpr 292
  .amdhsa_next_free_sgpr 92
  .amdhsa_accum_offset 164
  .amdhsa_group_segment_fixed_size 0
  .amdhsa_kernarg_size 80
  .amdhsa_user_sgpr_count 2
  .amdhsa_user_sgpr_kernarg_segment_ptr 1
  .amdhsa_system_sgpr_workgroup_id_x 1
.end_amdhsa_kernel
.p2align 6
.amdhsa_kernel ffn2_0_kernel
  .amdhsa_next_free_vgpr 108
  .amdhsa_next_free_sgpr 92
  .amdhsa_accum_offset 92
  .amdhsa_group_segment_fixed_size 0
  .amdhsa_kernarg_size 80
  .amdhsa_user_sgpr_count 2
  .amdhsa_user_sgpr_kernarg_segment_ptr 1
  .amdhsa_system_sgpr_workgroup_id_x 1
.end_amdhsa_kernel
.p2align 6
.amdhsa_kernel qkv1_kernel
  .amdhsa_next_free_vgpr 164
  .amdhsa_next_free_sgpr 92
  .amdhsa_accum_offset 116
  .amdhsa_group_segment_fixed_size 0
  .amdhsa_kernarg_size 80
  .amdhsa_user_sgpr_count 2
  .amdhsa_user_sgpr_kernarg_segment_ptr 1
  .amdhsa_system_sgpr_workgroup_id_x 1
.end_amdhsa_kernel
.p2align 6
.amdhsa_kernel wo1_kernel
  .amdhsa_next_free_vgpr 104
  .amdhsa_next_free_sgpr 92
  .amdhsa_accum_offset 88
  .amdhsa_group_segment_fixed_size 0
  .amdhsa_kernarg_size 80
  .amdhsa_user_sgpr_count 2
  .amdhsa_user_sgpr_kernarg_segment_ptr 1
  .amdhsa_system_sgpr_workgroup_id_x 1
.end_amdhsa_kernel
.p2align 6
.amdhsa_kernel ffn2_1_kernel
  .amdhsa_next_free_vgpr 108
  .amdhsa_next_free_sgpr 92
  .amdhsa_accum_offset 92
  .amdhsa_group_segment_fixed_size 0
  .amdhsa_kernarg_size 80
  .amdhsa_user_sgpr_count 2
  .amdhsa_user_sgpr_kernarg_segment_ptr 1
  .amdhsa_system_sgpr_workgroup_id_x 1
.end_amdhsa_kernel
```
